```python
import torch

def _softmax(x, axis=-1):
    return torch.softmax(x, dim=axis)

def _gelu(x):
    return torch.nn.functional.gelu(x, approximate='tanh')

def _silu(x):
    return torch.nn.functional.silu(x)

def _sigmoid(x):
    return torch.sigmoid(x)

def _layernorm(x, axis=-1, eps=1e-05):
    m = x.mean(dim=axis, keepdim=True)
    v = x.var(dim=axis, keepdim=True, unbiased=False)
    return (x - m) / torch.sqrt(v + eps)

def _scatter_add(tgt, idx, src, axis=0):
    return tgt.clone().index_add_(axis, idx, src)

def _segment_sum(src, seg, n):
    out = torch.zeros((n,) + src.shape[1:], dtype=src.dtype)
    return out.index_add_(0, seg, src)

def _pad(x, pw):
    flat = tuple((v for pair in reversed(pw) for v in pair))
    return torch.nn.functional.pad(x, flat)
kernel_name = 'parallel_sum__memory_aug_recurrent_mem_tr__dense_activation_gelu__prompt'

def setup_inputs():

    _w = lambda a: (lambda t: t.to(torch.bfloat16) if t.is_floating_point() else t)(torch.as_tensor(a))

    def _A_setup():
        B, S, Dm = (1, 2048, 576)
        H, Dh = (32, 128)
        M, seg = (8, 32)
        seg = min(seg, S)
        S = S // seg * seg
        return {'x': _w((lambda *s: torch.randn(*s, dtype=torch.bfloat16) * 0.05)(B, S, Dm)), 'mem0': _w((lambda *s: torch.randn(*s, dtype=torch.bfloat16) * 0.2)(B, M, Dm)), 'Wq': _w((lambda *s: torch.randn(*s, dtype=torch.bfloat16) * 1.6)(Dm, H, Dh) * Dm ** (-0.5)), 'Wk': _w((lambda *s: torch.randn(*s, dtype=torch.bfloat16) * 1.6)(Dm, H, Dh) * Dm ** (-0.5)), 'Wv': _w((lambda *s: torch.randn(*s, dtype=torch.bfloat16) * 0.2)(Dm, H, Dh) * Dm ** (-0.5)), 'Wo': _w((lambda *s: torch.randn(*s, dtype=torch.bfloat16) * 0.2)(H, Dh, Dm) * (H * Dh) ** (-0.5)), 'seg_len': seg}
    _A_in = _A_setup()

    def _B_setup():
        B, S, D, F = (1, 2048, 576, 4608)
        return {'x': _w((lambda *s: torch.randn(*s, dtype=torch.bfloat16) * 0.05)(B, S, D)), 'w1': _w((lambda *s: torch.randn(*s, dtype=torch.bfloat16) * 0.8)(D, F) * D ** (-0.5)), 'b1': _w((lambda *s: torch.randn(*s, dtype=torch.bfloat16) * 12.8)(F) * 0.01), 'w2': _w((lambda *s: torch.randn(*s, dtype=torch.bfloat16) * 0.2)(F, D) * F ** (-0.5)), 'b2': _w((lambda *s: torch.randn(*s, dtype=torch.bfloat16) * 3.2)(D) * 0.01)}
    _B_in = _B_setup()
    return {'A_x': _A_in['x'], 'A_mem0': _A_in['mem0'], 'A_Wq': _A_in['Wq'], 'A_Wk': _A_in['Wk'], 'A_Wv': _A_in['Wv'], 'A_Wo': _A_in['Wo'], 'A_seg_len': _A_in['seg_len'], 'B_x': _B_in['x'], 'B_w1': _B_in['w1'], 'B_b1': _B_in['b1'], 'B_w2': _B_in['w2'], 'B_b2': _B_in['b2']}

def reference(A_x, A_mem0, A_Wq, A_Wk, A_Wv, A_Wo, A_seg_len, B_x, B_w1, B_b1, B_w2, B_b2):

    def _A_ref(x, mem0, Wq, Wk, Wv, Wo, seg_len):
        B, S, Dm = x.shape
        H, Dh = (Wq.shape[1], Wq.shape[2])
        M = mem0.shape[1]
        scale = Dh ** (-0.5)
        n_seg = S // seg_len
        L = M + seg_len
        idx = torch.arange(L)
        mask = (idx[:, None] < M) | (idx[:, None] >= idx[None, :])
        mem = mem0
        outs = []
        for s in range(n_seg):
            xs = x[:, s * seg_len:(s + 1) * seg_len, :].clone()
            h = torch.concatenate([mem, xs], axis=1)
            q = torch.einsum('btd,dhe->bhte', h, Wq)
            k = torch.einsum('btd,dhe->bhte', h, Wk)
            v = torch.einsum('btd,dhe->bhte', h, Wv)
            scores = torch.einsum('bhqe,bhke->bhqk', q, k) * scale
            scores = torch.where(mask[None, None], scores, -1000000000.0)
            p = _softmax(scores, axis=-1)
            o = torch.einsum('bhqk,bhke->bhqe', p, v)
            o = torch.einsum('bhte,hed->btd', o, Wo)
            mem = o[:, :M, :].clone()
            outs.append(o[:, M:, :])
        return torch.concatenate(outs, axis=1)

    def _B_ref(x, w1, b1, w2, b2):
        h = torch.einsum('bsd,df->bsf', x, w1) + b1
        h = _gelu(h)
        return torch.einsum('bsf,fd->bsd', h, w2) + b2
    x = A_x
    xn = _layernorm(x, axis=-1)
    return x + _A_ref(xn, A_mem0, A_Wq, A_Wk, A_Wv, A_Wo, A_seg_len) + _B_ref(xn, B_w1, B_b1, B_w2, B_b2)
```

```asm
; @launch kernel=main_kernel grid=(256,1,1) block=(256,1,1) lds=163840
.amdgcn_target "amdgcn-amd-amdhsa--gfx950"
.text
.globl main_kernel
.p2align 8
.type main_kernel,@function
main_kernel:
	s_and_b32 s7, s2, 7
	s_cmp_lg_u32 s7, 0
	s_cbranch_scc1 main_kernel_worker
	s_lshr_b32 s3, s2, 3
	s_cmp_ge_u32 s3, 32
	s_cbranch_scc1 main_kernel_exit
	s_load_dwordx2 s[8:9], s[0:1], 112
	s_load_dwordx2 s[44:45], s[0:1], 104
	v_lshrrev_b32 v1, 6, v0
	s_nop 0
	v_readfirstlane_b32 s4, v1
	v_and_b32 v0, 63, v0
	s_mov_b32 s10, 268435456
	s_mov_b32 s11, 0x20000
	s_mov_b32 s46, 256
	s_mov_b32 s47, 0x20000
	s_mov_b32 s15, 0x20000
	s_mov_b32 s6, 400000
	s_mov_b32 s32, 0x00ff00ff
	s_mov_b32 s33, 0x00ff00ff
	s_mov_b32 s34, 0xff00ff00
	s_mov_b32 s35, 0xff00ff00
	s_mov_b32 s36, 0
	s_mov_b32 s37, 0x00ff00ff
	s_mov_b32 s38, 0x3e0293ee
	s_getreg_b32 s7, hwreg(HW_REG_XCC_ID, 0, 4)
	s_lshl_b32 s7, 1, s7
	s_waitcnt lgkmcnt(0)
	s_cmp_lg_u32 s4, 0
	s_cbranch_scc1 main_kernel_noatom
	s_mov_b64 exec, 1
	v_mov_b32 v2, s7
	v_mov_b32 v3, 0
	buffer_atomic_or v2, v3, s[44:47], 0 offen sc1
	s_mov_b64 exec, -1
main_kernel_noatom:
	s_mul_i32 s28, s4, 2304
	v_lshlrev_b32 v1, 4, v0
	v_add_u32 v1, s28, v1
	v_lshlrev_b32 v2, 2, v0
	v_add_u32 v2, s28, v2
	v_mov_b32 v4, -1
	v_mov_b32 v5, -1
	v_mov_b32 v6, -1
	v_mov_b32 v7, -1
	s_mul_i32 s28, s3, 9216
	s_add_u32 s28, s28, 102760448
	s_add_u32 s29, s28, 294912
	buffer_store_dwordx4 v[4:7], v1, s[8:11], s28 offen sc1
	buffer_store_dwordx4 v[4:7], v1, s[8:11], s28 offen offset:1024 sc1
	buffer_store_dword v4, v2, s[8:11], s28 offen offset:2048 sc1
	buffer_store_dwordx4 v[4:7], v1, s[8:11], s29 offen sc1
	buffer_store_dwordx4 v[4:7], v1, s[8:11], s29 offen offset:1024 sc1
	buffer_store_dword v4, v2, s[8:11], s29 offen offset:2048 sc1
	v_lshlrev_b32 v8, 3, v0
	s_lshl_b32 s28, s4, 9
	v_add_u32 v8, s28, v8
	v_lshlrev_b32 v9, 1, v8
	s_lshl_b32 s28, s3, 11
	s_add_u32 s29, s28, 94240768
	s_lshl_b32 s28, s28, 1
	s_add_u32 s28, s28, 102498304
	buffer_store_dwordx2 v[4:5], v8, s[8:11], s29 offen sc1
	buffer_store_dwordx4 v[4:7], v9, s[8:11], s28 offen sc1
	s_lshl_b32 s28, s3, 11
	s_add_u32 s29, s28, 94306304
	s_lshl_b32 s28, s28, 1
	s_add_u32 s28, s28, 102629376
	buffer_store_dwordx2 v[4:5], v8, s[8:11], s29 offen sc1
	buffer_store_dwordx4 v[4:7], v9, s[8:11], s28 offen sc1
	s_cmp_ge_u32 s3, 3
	s_cbranch_scc1 main_kernel_noarm
	s_lshl_b32 s28, s3, 14
	s_add_u32 s28, s28, 103809024
	buffer_store_dwordx4 v[4:7], v1, s[8:11], s28 offen sc1
	buffer_store_dwordx4 v[4:7], v1, s[8:11], s28 offen offset:1024 sc1
	buffer_store_dword v4, v2, s[8:11], s28 offen offset:2048 sc1
main_kernel_noarm:
	s_cmp_lg_u32 s4, 0
	s_cbranch_scc1 main_kernel_noarm2
	s_lshl_b32 s28, s3, 7
	s_add_u32 s29, s28, 111149056
	s_lshl_b32 s28, s28, 1
	s_add_u32 s28, s28, 111153152
	v_mov_b32 v4, 0
	v_mov_b32 v1, 0
	s_mov_b64 exec, 1
	buffer_store_dword v4, v1, s[8:11], s29 offen sc1
	buffer_store_dword v4, v1, s[8:11], s28 offen sc1
	buffer_store_dword v4, v1, s[8:11], s28 offen offset:128 sc1
	s_mov_b64 exec, -1
main_kernel_noarm2:
	v_lshrrev_b32 v40, 4, v0
	v_and_b32 v41, 15, v0
	s_load_dwordx2 s[12:13], s[0:1], 16
	s_mov_b32 s14, 4718592
	v_lshrrev_b32 v1, 4, v0
	v_lshlrev_b32 v1, 13, v1
	v_and_b32 v2, 15, v0
	s_lshl_b32 s28, s3, 8
	s_waitcnt lgkmcnt(0)
	v_xor_b32 v3, 0, v2
	v_lshlrev_b32 v3, 4, v3
	v_add_u32 v3, v3, v1
	v_xor_b32 v4, 8, v2
	v_lshlrev_b32 v4, 4, v4
	v_add_u32 v4, v4, v1
	s_add_u32 s29, s4, 0
	s_lshl_b32 s30, s29, 17
	s_add_u32 s30, s30, s28
	s_add_u32 s30, s30, 0
	s_lshl_b32 s31, s29, 12
	s_add_u32 s31, s31, 16384
	s_mov_b32 m0, s31
	s_nop 0
	buffer_load_dwordx4 v3, s[12:15], s30 offen lds
	s_add_u32 s30, s30, 32768
	s_add_u32 s31, s31, 1024
	s_mov_b32 m0, s31
	s_nop 0
	buffer_load_dwordx4 v4, s[12:15], s30 offen lds
	s_add_u32 s30, s30, 32768
	s_add_u32 s31, s31, 1024
	s_mov_b32 m0, s31
	s_nop 0
	buffer_load_dwordx4 v3, s[12:15], s30 offen lds
	s_add_u32 s30, s30, 32768
	s_add_u32 s31, s31, 1024
	s_mov_b32 m0, s31
	s_nop 0
	buffer_load_dwordx4 v4, s[12:15], s30 offen lds
	s_add_u32 s29, s4, 4
	s_lshl_b32 s30, s29, 17
	s_add_u32 s30, s30, s28
	s_add_u32 s30, s30, 0
	s_lshl_b32 s31, s29, 12
	s_add_u32 s31, s31, 16384
	s_mov_b32 m0, s31
	s_nop 0
	buffer_load_dwordx4 v3, s[12:15], s30 offen lds
	s_add_u32 s30, s30, 32768
	s_add_u32 s31, s31, 1024
	s_mov_b32 m0, s31
	s_nop 0
	buffer_load_dwordx4 v4, s[12:15], s30 offen lds
	s_add_u32 s30, s30, 32768
	s_add_u32 s31, s31, 1024
	s_mov_b32 m0, s31
	s_nop 0
	buffer_load_dwordx4 v3, s[12:15], s30 offen lds
	s_add_u32 s30, s30, 32768
	s_add_u32 s31, s31, 1024
	s_mov_b32 m0, s31
	s_nop 0
	buffer_load_dwordx4 v4, s[12:15], s30 offen lds
	s_add_u32 s29, s4, 8
	s_lshl_b32 s30, s29, 17
	s_add_u32 s30, s30, s28
	s_add_u32 s30, s30, 0
	s_lshl_b32 s31, s29, 12
	s_add_u32 s31, s31, 16384
	s_mov_b32 m0, s31
	s_nop 0
	buffer_load_dwordx4 v3, s[12:15], s30 offen lds
	s_add_u32 s30, s30, 32768
	s_add_u32 s31, s31, 1024
	s_mov_b32 m0, s31
	s_nop 0
	buffer_load_dwordx4 v4, s[12:15], s30 offen lds
	s_add_u32 s30, s30, 32768
	s_add_u32 s31, s31, 1024
	s_mov_b32 m0, s31
	s_nop 0
	buffer_load_dwordx4 v3, s[12:15], s30 offen lds
	s_add_u32 s30, s30, 32768
	s_add_u32 s31, s31, 1024
	s_mov_b32 m0, s31
	s_nop 0
	buffer_load_dwordx4 v4, s[12:15], s30 offen lds
	s_add_u32 s29, s4, 12
	s_lshl_b32 s30, s29, 17
	s_add_u32 s30, s30, s28
	s_add_u32 s30, s30, 0
	s_lshl_b32 s31, s29, 12
	s_add_u32 s31, s31, 16384
	s_mov_b32 m0, s31
	s_nop 0
	buffer_load_dwordx4 v3, s[12:15], s30 offen lds
	s_add_u32 s30, s30, 32768
	s_add_u32 s31, s31, 1024
	s_mov_b32 m0, s31
	s_nop 0
	buffer_load_dwordx4 v4, s[12:15], s30 offen lds
	s_add_u32 s30, s30, 32768
	s_add_u32 s31, s31, 1024
	s_mov_b32 m0, s31
	s_nop 0
	buffer_load_dwordx4 v3, s[12:15], s30 offen lds
	s_add_u32 s30, s30, 32768
	s_add_u32 s31, s31, 1024
	s_mov_b32 m0, s31
	s_nop 0
	buffer_load_dwordx4 v4, s[12:15], s30 offen lds
	s_add_u32 s29, s4, 16
	s_cmp_ge_u32 s29, 18
	s_cbranch_scc1 main_kernel_stg_1
	s_add_u32 s29, s4, 16
	s_lshl_b32 s30, s29, 17
	s_add_u32 s30, s30, s28
	s_add_u32 s30, s30, 0
	s_lshl_b32 s31, s29, 12
	s_add_u32 s31, s31, 16384
	s_mov_b32 m0, s31
	s_nop 0
	buffer_load_dwordx4 v3, s[12:15], s30 offen lds
	s_add_u32 s30, s30, 32768
	s_add_u32 s31, s31, 1024
	s_mov_b32 m0, s31
	s_nop 0
	buffer_load_dwordx4 v4, s[12:15], s30 offen lds
	s_add_u32 s30, s30, 32768
	s_add_u32 s31, s31, 1024
	s_mov_b32 m0, s31
	s_nop 0
	buffer_load_dwordx4 v3, s[12:15], s30 offen lds
	s_add_u32 s30, s30, 32768
	s_add_u32 s31, s31, 1024
	s_mov_b32 m0, s31
	s_nop 0
	buffer_load_dwordx4 v4, s[12:15], s30 offen lds
main_kernel_stg_1:
	s_load_dwordx2 s[12:13], s[0:1], 24
	s_mov_b32 s14, 4718592
	v_lshrrev_b32 v1, 4, v0
	v_lshlrev_b32 v1, 13, v1
	v_and_b32 v2, 15, v0
	s_lshl_b32 s28, s3, 8
	s_waitcnt lgkmcnt(0)
	v_xor_b32 v3, 4, v2
	v_lshlrev_b32 v3, 4, v3
	v_add_u32 v3, v3, v1
	v_xor_b32 v4, 12, v2
	v_lshlrev_b32 v4, 4, v4
	v_add_u32 v4, v4, v1
	s_add_u32 s29, s4, 0
	s_lshl_b32 s30, s29, 17
	s_add_u32 s30, s30, s28
	s_add_u32 s30, s30, 0
	s_lshl_b32 s31, s29, 12
	s_add_u32 s31, s31, 90112
	s_mov_b32 m0, s31
	s_nop 0
	buffer_load_dwordx4 v3, s[12:15], s30 offen lds
	s_add_u32 s30, s30, 32768
	s_add_u32 s31, s31, 1024
	s_mov_b32 m0, s31
	s_nop 0
	buffer_load_dwordx4 v4, s[12:15], s30 offen lds
	s_add_u32 s30, s30, 32768
	s_add_u32 s31, s31, 1024
	s_mov_b32 m0, s31
	s_nop 0
	buffer_load_dwordx4 v3, s[12:15], s30 offen lds
	s_add_u32 s30, s30, 32768
	s_add_u32 s31, s31, 1024
	s_mov_b32 m0, s31
	s_nop 0
	buffer_load_dwordx4 v4, s[12:15], s30 offen lds
	s_add_u32 s29, s4, 4
	s_lshl_b32 s30, s29, 17
	s_add_u32 s30, s30, s28
	s_add_u32 s30, s30, 0
	s_lshl_b32 s31, s29, 12
	s_add_u32 s31, s31, 90112
	s_mov_b32 m0, s31
	s_nop 0
	buffer_load_dwordx4 v3, s[12:15], s30 offen lds
	s_add_u32 s30, s30, 32768
	s_add_u32 s31, s31, 1024
	s_mov_b32 m0, s31
	s_nop 0
	buffer_load_dwordx4 v4, s[12:15], s30 offen lds
	s_add_u32 s30, s30, 32768
	s_add_u32 s31, s31, 1024
	s_mov_b32 m0, s31
	s_nop 0
	buffer_load_dwordx4 v3, s[12:15], s30 offen lds
	s_add_u32 s30, s30, 32768
	s_add_u32 s31, s31, 1024
	s_mov_b32 m0, s31
	s_nop 0
	buffer_load_dwordx4 v4, s[12:15], s30 offen lds
	s_add_u32 s29, s4, 8
	s_lshl_b32 s30, s29, 17
	s_add_u32 s30, s30, s28
	s_add_u32 s30, s30, 0
	s_lshl_b32 s31, s29, 12
	s_add_u32 s31, s31, 90112
	s_mov_b32 m0, s31
	s_nop 0
	buffer_load_dwordx4 v3, s[12:15], s30 offen lds
	s_add_u32 s30, s30, 32768
	s_add_u32 s31, s31, 1024
	s_mov_b32 m0, s31
	s_nop 0
	buffer_load_dwordx4 v4, s[12:15], s30 offen lds
	s_add_u32 s30, s30, 32768
	s_add_u32 s31, s31, 1024
	s_mov_b32 m0, s31
	s_nop 0
	buffer_load_dwordx4 v3, s[12:15], s30 offen lds
	s_add_u32 s30, s30, 32768
	s_add_u32 s31, s31, 1024
	s_mov_b32 m0, s31
	s_nop 0
	buffer_load_dwordx4 v4, s[12:15], s30 offen lds
	s_add_u32 s29, s4, 12
	s_lshl_b32 s30, s29, 17
	s_add_u32 s30, s30, s28
	s_add_u32 s30, s30, 0
	s_lshl_b32 s31, s29, 12
	s_add_u32 s31, s31, 90112
	s_mov_b32 m0, s31
	s_nop 0
	buffer_load_dwordx4 v3, s[12:15], s30 offen lds
	s_add_u32 s30, s30, 32768
	s_add_u32 s31, s31, 1024
	s_mov_b32 m0, s31
	s_nop 0
	buffer_load_dwordx4 v4, s[12:15], s30 offen lds
	s_add_u32 s30, s30, 32768
	s_add_u32 s31, s31, 1024
	s_mov_b32 m0, s31
	s_nop 0
	buffer_load_dwordx4 v3, s[12:15], s30 offen lds
	s_add_u32 s30, s30, 32768
	s_add_u32 s31, s31, 1024
	s_mov_b32 m0, s31
	s_nop 0
	buffer_load_dwordx4 v4, s[12:15], s30 offen lds
	s_add_u32 s29, s4, 16
	s_cmp_ge_u32 s29, 18
	s_cbranch_scc1 main_kernel_stg_2
	s_add_u32 s29, s4, 16
	s_lshl_b32 s30, s29, 17
	s_add_u32 s30, s30, s28
	s_add_u32 s30, s30, 0
	s_lshl_b32 s31, s29, 12
	s_add_u32 s31, s31, 90112
	s_mov_b32 m0, s31
	s_nop 0
	buffer_load_dwordx4 v3, s[12:15], s30 offen lds
	s_add_u32 s30, s30, 32768
	s_add_u32 s31, s31, 1024
	s_mov_b32 m0, s31
	s_nop 0
	buffer_load_dwordx4 v4, s[12:15], s30 offen lds
	s_add_u32 s30, s30, 32768
	s_add_u32 s31, s31, 1024
	s_mov_b32 m0, s31
	s_nop 0
	buffer_load_dwordx4 v3, s[12:15], s30 offen lds
	s_add_u32 s30, s30, 32768
	s_add_u32 s31, s31, 1024
	s_mov_b32 m0, s31
	s_nop 0
	buffer_load_dwordx4 v4, s[12:15], s30 offen lds
main_kernel_stg_2:
	s_waitcnt vmcnt(0)
	s_barrier
	s_cmp_lg_u32 s4, 0
	s_cbranch_scc1 main_kernel_nocnt
	s_mov_b64 exec, 1
	v_mov_b32 v2, 1
	v_mov_b32 v3, 0
	buffer_atomic_add v2, v3, s[44:47], 0 offen offset:4 sc1
	s_mov_b64 exec, -1
main_kernel_nocnt:
	v_lshrrev_b32 v1, 4, v0
	v_and_b32 v2, 1, v1
	v_lshrrev_b32 v1, 1, v1
	v_lshlrev_b32 v1, 3, v1
	v_lshl_add_u32 v1, v2, 2, v1
	v_lshrrev_b32 v3, 2, v0
	v_and_b32 v4, 1, v3
	v_add_u32 v1, v1, v4
	v_lshlrev_b32 v1, 8, v1
	v_bfe_u32 v3, v0, 3, 1
	v_mul_u32_u24 v4, 73728, v3
	v_add_u32 v1, v1, v4
	v_lshlrev_b32 v2, 3, v2
	v_lshl_add_u32 v2, v3, 2, v2
	v_and_b32 v3, 3, v0
	s_lshl_b32 s28, s4, 2
	v_add_u32 v3, s28, v3
	v_xor_b32 v3, v3, v2
	v_lshl_add_u32 v1, v3, 4, v1
	v_add_u32 v1, 16384, v1
	ds_read_b64_tr_b16 v[80:81], v1 offset:0
	ds_read_b64_tr_b16 v[82:83], v1 offset:512
	ds_read_b64_tr_b16 v[84:85], v1 offset:4096
	ds_read_b64_tr_b16 v[86:87], v1 offset:4608
	ds_read_b64_tr_b16 v[8:9], v1 offset:8
	ds_read_b64_tr_b16 v[10:11], v1 offset:520
	ds_read_b64_tr_b16 v[12:13], v1 offset:4104
	ds_read_b64_tr_b16 v[14:15], v1 offset:4616
	ds_read_b64_tr_b16 v[88:89], v1 offset:8192
	ds_read_b64_tr_b16 v[90:91], v1 offset:8704
	ds_read_b64_tr_b16 v[92:93], v1 offset:12288
	ds_read_b64_tr_b16 v[94:95], v1 offset:12800
	ds_read_b64_tr_b16 v[16:17], v1 offset:8200
	ds_read_b64_tr_b16 v[18:19], v1 offset:8712
	ds_read_b64_tr_b16 v[20:21], v1 offset:12296
	ds_read_b64_tr_b16 v[22:23], v1 offset:12808
	ds_read_b64_tr_b16 v[96:97], v1 offset:16384
	ds_read_b64_tr_b16 v[98:99], v1 offset:16896
	ds_read_b64_tr_b16 v[100:101], v1 offset:20480
	ds_read_b64_tr_b16 v[102:103], v1 offset:20992
	ds_read_b64_tr_b16 v[24:25], v1 offset:16392
	ds_read_b64_tr_b16 v[26:27], v1 offset:16904
	ds_read_b64_tr_b16 v[28:29], v1 offset:20488
	ds_read_b64_tr_b16 v[30:31], v1 offset:21000
	ds_read_b64_tr_b16 v[104:105], v1 offset:24576
	ds_read_b64_tr_b16 v[106:107], v1 offset:25088
	ds_read_b64_tr_b16 v[108:109], v1 offset:28672
	ds_read_b64_tr_b16 v[110:111], v1 offset:29184
	ds_read_b64_tr_b16 v[112:113], v1 offset:24584
	ds_read_b64_tr_b16 v[114:115], v1 offset:25096
	ds_read_b64_tr_b16 v[116:117], v1 offset:28680
	ds_read_b64_tr_b16 v[118:119], v1 offset:29192
	ds_read_b64_tr_b16 v[120:121], v1 offset:32768
	ds_read_b64_tr_b16 v[122:123], v1 offset:33280
	ds_read_b64_tr_b16 v[124:125], v1 offset:36864
	ds_read_b64_tr_b16 v[126:127], v1 offset:37376
	ds_read_b64_tr_b16 v[128:129], v1 offset:32776
	ds_read_b64_tr_b16 v[130:131], v1 offset:33288
	ds_read_b64_tr_b16 v[132:133], v1 offset:36872
	ds_read_b64_tr_b16 v[134:135], v1 offset:37384
	v_add_u32 v1, 40960, v1
	ds_read_b64_tr_b16 v[136:137], v1 offset:0
	ds_read_b64_tr_b16 v[138:139], v1 offset:512
	ds_read_b64_tr_b16 v[140:141], v1 offset:4096
	ds_read_b64_tr_b16 v[142:143], v1 offset:4608
	ds_read_b64_tr_b16 v[32:33], v1 offset:8
	ds_read_b64_tr_b16 v[34:35], v1 offset:520
	ds_read_b64_tr_b16 v[36:37], v1 offset:4104
	ds_read_b64_tr_b16 v[38:39], v1 offset:4616
	ds_read_b64_tr_b16 v[144:145], v1 offset:8192
	ds_read_b64_tr_b16 v[146:147], v1 offset:8704
	ds_read_b64_tr_b16 v[148:149], v1 offset:12288
	ds_read_b64_tr_b16 v[150:151], v1 offset:12800
	ds_read_b64_tr_b16 v[152:153], v1 offset:8200
	ds_read_b64_tr_b16 v[154:155], v1 offset:8712
	ds_read_b64_tr_b16 v[156:157], v1 offset:12296
	ds_read_b64_tr_b16 v[158:159], v1 offset:12808
	ds_read_b64_tr_b16 v[160:161], v1 offset:16384
	ds_read_b64_tr_b16 v[162:163], v1 offset:16896
	ds_read_b64_tr_b16 v[164:165], v1 offset:20480
	ds_read_b64_tr_b16 v[166:167], v1 offset:20992
	ds_read_b64_tr_b16 v[40:41], v1 offset:16392
	ds_read_b64_tr_b16 v[42:43], v1 offset:16904
	ds_read_b64_tr_b16 v[44:45], v1 offset:20488
	ds_read_b64_tr_b16 v[46:47], v1 offset:21000
	ds_read_b64_tr_b16 v[168:169], v1 offset:24576
	ds_read_b64_tr_b16 v[170:171], v1 offset:25088
	ds_read_b64_tr_b16 v[172:173], v1 offset:28672
	ds_read_b64_tr_b16 v[174:175], v1 offset:29184
	ds_read_b64_tr_b16 v[176:177], v1 offset:24584
	ds_read_b64_tr_b16 v[178:179], v1 offset:25096
	ds_read_b64_tr_b16 v[180:181], v1 offset:28680
	ds_read_b64_tr_b16 v[182:183], v1 offset:29192
	s_waitcnt lgkmcnt(0)
	s_barrier
	s_load_dwordx2 s[12:13], s[0:1], 16
	s_mov_b32 s14, 4718592
	v_lshrrev_b32 v1, 4, v0
	v_lshlrev_b32 v1, 13, v1
	v_and_b32 v2, 15, v0
	s_lshl_b32 s28, s3, 8
	s_waitcnt lgkmcnt(0)
	v_xor_b32 v3, 0, v2
	v_lshlrev_b32 v3, 4, v3
	v_add_u32 v3, v3, v1
	v_xor_b32 v4, 8, v2
	v_lshlrev_b32 v4, 4, v4
	v_add_u32 v4, v4, v1
	s_add_u32 s29, s4, 0
	s_lshl_b32 s30, s29, 17
	s_add_u32 s30, s30, s28
	s_add_u32 s30, s30, 2359296
	s_lshl_b32 s31, s29, 12
	s_add_u32 s31, s31, 16384
	s_mov_b32 m0, s31
	s_nop 0
	buffer_load_dwordx4 v3, s[12:15], s30 offen lds
	s_add_u32 s30, s30, 32768
	s_add_u32 s31, s31, 1024
	s_mov_b32 m0, s31
	s_nop 0
	buffer_load_dwordx4 v4, s[12:15], s30 offen lds
	s_add_u32 s30, s30, 32768
	s_add_u32 s31, s31, 1024
	s_mov_b32 m0, s31
	s_nop 0
	buffer_load_dwordx4 v3, s[12:15], s30 offen lds
	s_add_u32 s30, s30, 32768
	s_add_u32 s31, s31, 1024
	s_mov_b32 m0, s31
	s_nop 0
	buffer_load_dwordx4 v4, s[12:15], s30 offen lds
	s_add_u32 s29, s4, 4
	s_lshl_b32 s30, s29, 17
	s_add_u32 s30, s30, s28
	s_add_u32 s30, s30, 2359296
	s_lshl_b32 s31, s29, 12
	s_add_u32 s31, s31, 16384
	s_mov_b32 m0, s31
	s_nop 0
	buffer_load_dwordx4 v3, s[12:15], s30 offen lds
	s_add_u32 s30, s30, 32768
	s_add_u32 s31, s31, 1024
	s_mov_b32 m0, s31
	s_nop 0
	buffer_load_dwordx4 v4, s[12:15], s30 offen lds
	s_add_u32 s30, s30, 32768
	s_add_u32 s31, s31, 1024
	s_mov_b32 m0, s31
	s_nop 0
	buffer_load_dwordx4 v3, s[12:15], s30 offen lds
	s_add_u32 s30, s30, 32768
	s_add_u32 s31, s31, 1024
	s_mov_b32 m0, s31
	s_nop 0
	buffer_load_dwordx4 v4, s[12:15], s30 offen lds
	s_add_u32 s29, s4, 8
	s_lshl_b32 s30, s29, 17
	s_add_u32 s30, s30, s28
	s_add_u32 s30, s30, 2359296
	s_lshl_b32 s31, s29, 12
	s_add_u32 s31, s31, 16384
	s_mov_b32 m0, s31
	s_nop 0
	buffer_load_dwordx4 v3, s[12:15], s30 offen lds
	s_add_u32 s30, s30, 32768
	s_add_u32 s31, s31, 1024
	s_mov_b32 m0, s31
	s_nop 0
	buffer_load_dwordx4 v4, s[12:15], s30 offen lds
	s_add_u32 s30, s30, 32768
	s_add_u32 s31, s31, 1024
	s_mov_b32 m0, s31
	s_nop 0
	buffer_load_dwordx4 v3, s[12:15], s30 offen lds
	s_add_u32 s30, s30, 32768
	s_add_u32 s31, s31, 1024
	s_mov_b32 m0, s31
	s_nop 0
	buffer_load_dwordx4 v4, s[12:15], s30 offen lds
	s_add_u32 s29, s4, 12
	s_lshl_b32 s30, s29, 17
	s_add_u32 s30, s30, s28
	s_add_u32 s30, s30, 2359296
	s_lshl_b32 s31, s29, 12
	s_add_u32 s31, s31, 16384
	s_mov_b32 m0, s31
	s_nop 0
	buffer_load_dwordx4 v3, s[12:15], s30 offen lds
	s_add_u32 s30, s30, 32768
	s_add_u32 s31, s31, 1024
	s_mov_b32 m0, s31
	s_nop 0
	buffer_load_dwordx4 v4, s[12:15], s30 offen lds
	s_add_u32 s30, s30, 32768
	s_add_u32 s31, s31, 1024
	s_mov_b32 m0, s31
	s_nop 0
	buffer_load_dwordx4 v3, s[12:15], s30 offen lds
	s_add_u32 s30, s30, 32768
	s_add_u32 s31, s31, 1024
	s_mov_b32 m0, s31
	s_nop 0
	buffer_load_dwordx4 v4, s[12:15], s30 offen lds
	s_add_u32 s29, s4, 16
	s_cmp_ge_u32 s29, 18
	s_cbranch_scc1 main_kernel_stg_3
	s_add_u32 s29, s4, 16
	s_lshl_b32 s30, s29, 17
	s_add_u32 s30, s30, s28
	s_add_u32 s30, s30, 2359296
	s_lshl_b32 s31, s29, 12
	s_add_u32 s31, s31, 16384
	s_mov_b32 m0, s31
	s_nop 0
	buffer_load_dwordx4 v3, s[12:15], s30 offen lds
	s_add_u32 s30, s30, 32768
	s_add_u32 s31, s31, 1024
	s_mov_b32 m0, s31
	s_nop 0
	buffer_load_dwordx4 v4, s[12:15], s30 offen lds
	s_add_u32 s30, s30, 32768
	s_add_u32 s31, s31, 1024
	s_mov_b32 m0, s31
	s_nop 0
	buffer_load_dwordx4 v3, s[12:15], s30 offen lds
	s_add_u32 s30, s30, 32768
	s_add_u32 s31, s31, 1024
	s_mov_b32 m0, s31
	s_nop 0
	buffer_load_dwordx4 v4, s[12:15], s30 offen lds
main_kernel_stg_3:
	s_load_dwordx2 s[12:13], s[0:1], 24
	s_mov_b32 s14, 4718592
	v_lshrrev_b32 v1, 4, v0
	v_lshlrev_b32 v1, 13, v1
	v_and_b32 v2, 15, v0
	s_lshl_b32 s28, s3, 8
	s_waitcnt lgkmcnt(0)
	v_xor_b32 v3, 4, v2
	v_lshlrev_b32 v3, 4, v3
	v_add_u32 v3, v3, v1
	v_xor_b32 v4, 12, v2
	v_lshlrev_b32 v4, 4, v4
	v_add_u32 v4, v4, v1
	s_add_u32 s29, s4, 0
	s_lshl_b32 s30, s29, 17
	s_add_u32 s30, s30, s28
	s_add_u32 s30, s30, 2359296
	s_lshl_b32 s31, s29, 12
	s_add_u32 s31, s31, 90112
	s_mov_b32 m0, s31
	s_nop 0
	buffer_load_dwordx4 v3, s[12:15], s30 offen lds
	s_add_u32 s30, s30, 32768
	s_add_u32 s31, s31, 1024
	s_mov_b32 m0, s31
	s_nop 0
	buffer_load_dwordx4 v4, s[12:15], s30 offen lds
	s_add_u32 s30, s30, 32768
	s_add_u32 s31, s31, 1024
	s_mov_b32 m0, s31
	s_nop 0
	buffer_load_dwordx4 v3, s[12:15], s30 offen lds
	s_add_u32 s30, s30, 32768
	s_add_u32 s31, s31, 1024
	s_mov_b32 m0, s31
	s_nop 0
	buffer_load_dwordx4 v4, s[12:15], s30 offen lds
	s_add_u32 s29, s4, 4
	s_lshl_b32 s30, s29, 17
	s_add_u32 s30, s30, s28
	s_add_u32 s30, s30, 2359296
	s_lshl_b32 s31, s29, 12
	s_add_u32 s31, s31, 90112
	s_mov_b32 m0, s31
	s_nop 0
	buffer_load_dwordx4 v3, s[12:15], s30 offen lds
	s_add_u32 s30, s30, 32768
	s_add_u32 s31, s31, 1024
	s_mov_b32 m0, s31
	s_nop 0
	buffer_load_dwordx4 v4, s[12:15], s30 offen lds
	s_add_u32 s30, s30, 32768
	s_add_u32 s31, s31, 1024
	s_mov_b32 m0, s31
	s_nop 0
	buffer_load_dwordx4 v3, s[12:15], s30 offen lds
	s_add_u32 s30, s30, 32768
	s_add_u32 s31, s31, 1024
	s_mov_b32 m0, s31
	s_nop 0
	buffer_load_dwordx4 v4, s[12:15], s30 offen lds
	s_add_u32 s29, s4, 8
	s_lshl_b32 s30, s29, 17
	s_add_u32 s30, s30, s28
	s_add_u32 s30, s30, 2359296
	s_lshl_b32 s31, s29, 12
	s_add_u32 s31, s31, 90112
	s_mov_b32 m0, s31
	s_nop 0
	buffer_load_dwordx4 v3, s[12:15], s30 offen lds
	s_add_u32 s30, s30, 32768
	s_add_u32 s31, s31, 1024
	s_mov_b32 m0, s31
	s_nop 0
	buffer_load_dwordx4 v4, s[12:15], s30 offen lds
	s_add_u32 s30, s30, 32768
	s_add_u32 s31, s31, 1024
	s_mov_b32 m0, s31
	s_nop 0
	buffer_load_dwordx4 v3, s[12:15], s30 offen lds
	s_add_u32 s30, s30, 32768
	s_add_u32 s31, s31, 1024
	s_mov_b32 m0, s31
	s_nop 0
	buffer_load_dwordx4 v4, s[12:15], s30 offen lds
	s_add_u32 s29, s4, 12
	s_lshl_b32 s30, s29, 17
	s_add_u32 s30, s30, s28
	s_add_u32 s30, s30, 2359296
	s_lshl_b32 s31, s29, 12
	s_add_u32 s31, s31, 90112
	s_mov_b32 m0, s31
	s_nop 0
	buffer_load_dwordx4 v3, s[12:15], s30 offen lds
	s_add_u32 s30, s30, 32768
	s_add_u32 s31, s31, 1024
	s_mov_b32 m0, s31
	s_nop 0
	buffer_load_dwordx4 v4, s[12:15], s30 offen lds
	s_add_u32 s30, s30, 32768
	s_add_u32 s31, s31, 1024
	s_mov_b32 m0, s31
	s_nop 0
	buffer_load_dwordx4 v3, s[12:15], s30 offen lds
	s_add_u32 s30, s30, 32768
	s_add_u32 s31, s31, 1024
	s_mov_b32 m0, s31
	s_nop 0
	buffer_load_dwordx4 v4, s[12:15], s30 offen lds
	s_add_u32 s29, s4, 16
	s_cmp_ge_u32 s29, 18
	s_cbranch_scc1 main_kernel_stg_4
	s_add_u32 s29, s4, 16
	s_lshl_b32 s30, s29, 17
	s_add_u32 s30, s30, s28
	s_add_u32 s30, s30, 2359296
	s_lshl_b32 s31, s29, 12
	s_add_u32 s31, s31, 90112
	s_mov_b32 m0, s31
	s_nop 0
	buffer_load_dwordx4 v3, s[12:15], s30 offen lds
	s_add_u32 s30, s30, 32768
	s_add_u32 s31, s31, 1024
	s_mov_b32 m0, s31
	s_nop 0
	buffer_load_dwordx4 v4, s[12:15], s30 offen lds
	s_add_u32 s30, s30, 32768
	s_add_u32 s31, s31, 1024
	s_mov_b32 m0, s31
	s_nop 0
	buffer_load_dwordx4 v3, s[12:15], s30 offen lds
	s_add_u32 s30, s30, 32768
	s_add_u32 s31, s31, 1024
	s_mov_b32 m0, s31
	s_nop 0
	buffer_load_dwordx4 v4, s[12:15], s30 offen lds
main_kernel_stg_4:
	s_waitcnt vmcnt(0)
	s_barrier
	v_lshrrev_b32 v1, 4, v0
	v_and_b32 v2, 1, v1
	v_lshrrev_b32 v1, 1, v1
	v_lshlrev_b32 v1, 3, v1
	v_lshl_add_u32 v1, v2, 2, v1
	v_lshrrev_b32 v3, 2, v0
	v_and_b32 v4, 1, v3
	v_add_u32 v1, v1, v4
	v_lshlrev_b32 v1, 8, v1
	v_bfe_u32 v3, v0, 3, 1
	v_mul_u32_u24 v4, 73728, v3
	v_add_u32 v1, v1, v4
	v_lshlrev_b32 v2, 3, v2
	v_lshl_add_u32 v2, v3, 2, v2
	v_and_b32 v3, 3, v0
	s_lshl_b32 s28, s4, 2
	v_add_u32 v3, s28, v3
	v_xor_b32 v3, v3, v2
	v_lshl_add_u32 v1, v3, 4, v1
	v_add_u32 v1, 16384, v1
	ds_read_b64_tr_b16 v[184:185], v1 offset:0
	ds_read_b64_tr_b16 v[186:187], v1 offset:512
	ds_read_b64_tr_b16 v[188:189], v1 offset:4096
	ds_read_b64_tr_b16 v[190:191], v1 offset:4608
	ds_read_b64_tr_b16 v[48:49], v1 offset:8
	ds_read_b64_tr_b16 v[50:51], v1 offset:520
	ds_read_b64_tr_b16 v[52:53], v1 offset:4104
	ds_read_b64_tr_b16 v[54:55], v1 offset:4616
	ds_read_b64_tr_b16 v[192:193], v1 offset:8192
	ds_read_b64_tr_b16 v[194:195], v1 offset:8704
	ds_read_b64_tr_b16 v[196:197], v1 offset:12288
	ds_read_b64_tr_b16 v[198:199], v1 offset:12800
	ds_read_b64_tr_b16 v[200:201], v1 offset:8200
	ds_read_b64_tr_b16 v[202:203], v1 offset:8712
	ds_read_b64_tr_b16 v[204:205], v1 offset:12296
	ds_read_b64_tr_b16 v[206:207], v1 offset:12808
	ds_read_b64_tr_b16 v[208:209], v1 offset:16384
	ds_read_b64_tr_b16 v[210:211], v1 offset:16896
	ds_read_b64_tr_b16 v[212:213], v1 offset:20480
	ds_read_b64_tr_b16 v[214:215], v1 offset:20992
	ds_read_b64_tr_b16 v[56:57], v1 offset:16392
	ds_read_b64_tr_b16 v[58:59], v1 offset:16904
	ds_read_b64_tr_b16 v[60:61], v1 offset:20488
	ds_read_b64_tr_b16 v[62:63], v1 offset:21000
	ds_read_b64_tr_b16 v[216:217], v1 offset:24576
	ds_read_b64_tr_b16 v[218:219], v1 offset:25088
	ds_read_b64_tr_b16 v[220:221], v1 offset:28672
	ds_read_b64_tr_b16 v[222:223], v1 offset:29184
	ds_read_b64_tr_b16 v[224:225], v1 offset:24584
	ds_read_b64_tr_b16 v[226:227], v1 offset:25096
	ds_read_b64_tr_b16 v[228:229], v1 offset:28680
	ds_read_b64_tr_b16 v[230:231], v1 offset:29192
	ds_read_b64_tr_b16 v[232:233], v1 offset:32768
	ds_read_b64_tr_b16 v[234:235], v1 offset:33280
	ds_read_b64_tr_b16 v[236:237], v1 offset:36864
	ds_read_b64_tr_b16 v[238:239], v1 offset:37376
	ds_read_b64_tr_b16 v[64:65], v1 offset:32776
	ds_read_b64_tr_b16 v[66:67], v1 offset:33288
	ds_read_b64_tr_b16 v[68:69], v1 offset:36872
	ds_read_b64_tr_b16 v[70:71], v1 offset:37384
	v_add_u32 v1, 40960, v1
	ds_read_b64_tr_b16 v[240:241], v1 offset:0
	ds_read_b64_tr_b16 v[242:243], v1 offset:512
	ds_read_b64_tr_b16 v[244:245], v1 offset:4096
	ds_read_b64_tr_b16 v[246:247], v1 offset:4608
	ds_read_b64_tr_b16 v[248:249], v1 offset:8
	ds_read_b64_tr_b16 v[250:251], v1 offset:520
	ds_read_b64_tr_b16 v[252:253], v1 offset:4104
	ds_read_b64_tr_b16 v[254:255], v1 offset:4616
	ds_read_b64_tr_b16 a[0:1], v1 offset:8192
	ds_read_b64_tr_b16 a[2:3], v1 offset:8704
	ds_read_b64_tr_b16 a[4:5], v1 offset:12288
	ds_read_b64_tr_b16 a[6:7], v1 offset:12800
	ds_read_b64_tr_b16 v[72:73], v1 offset:8200
	ds_read_b64_tr_b16 v[74:75], v1 offset:8712
	ds_read_b64_tr_b16 v[76:77], v1 offset:12296
	ds_read_b64_tr_b16 v[78:79], v1 offset:12808
	ds_read_b64_tr_b16 a[8:9], v1 offset:16384
	ds_read_b64_tr_b16 a[10:11], v1 offset:16896
	ds_read_b64_tr_b16 a[12:13], v1 offset:20480
	ds_read_b64_tr_b16 a[14:15], v1 offset:20992
	ds_read_b64_tr_b16 a[16:17], v1 offset:16392
	ds_read_b64_tr_b16 a[18:19], v1 offset:16904
	ds_read_b64_tr_b16 a[20:21], v1 offset:20488
	ds_read_b64_tr_b16 a[22:23], v1 offset:21000
	ds_read_b64_tr_b16 a[24:25], v1 offset:24576
	ds_read_b64_tr_b16 a[26:27], v1 offset:25088
	ds_read_b64_tr_b16 a[28:29], v1 offset:28672
	ds_read_b64_tr_b16 a[30:31], v1 offset:29184
	ds_read_b64_tr_b16 a[32:33], v1 offset:24584
	ds_read_b64_tr_b16 a[34:35], v1 offset:25096
	ds_read_b64_tr_b16 a[36:37], v1 offset:28680
	ds_read_b64_tr_b16 a[38:39], v1 offset:29192
	s_waitcnt lgkmcnt(0)
	s_barrier
	s_load_dwordx2 s[12:13], s[0:1], 32
	s_mov_b32 s14, 4718592
	v_lshrrev_b32 v1, 4, v0
	v_lshlrev_b32 v1, 13, v1
	v_and_b32 v2, 15, v0
	s_lshl_b32 s28, s3, 8
	s_waitcnt lgkmcnt(0)
	v_xor_b32 v3, 0, v2
	v_lshlrev_b32 v3, 4, v3
	v_add_u32 v3, v3, v1
	v_xor_b32 v4, 4, v2
	v_lshlrev_b32 v4, 4, v4
	v_add_u32 v4, v4, v1
	v_xor_b32 v5, 8, v2
	v_lshlrev_b32 v5, 4, v5
	v_add_u32 v5, v5, v1
	v_xor_b32 v6, 12, v2
	v_lshlrev_b32 v6, 4, v6
	v_add_u32 v6, v6, v1
	s_add_u32 s29, s4, 0
	s_lshl_b32 s30, s29, 17
	s_add_u32 s30, s30, s28
	s_add_u32 s30, s30, 0
	s_lshl_b32 s31, s29, 12
	s_add_u32 s31, s31, 16384
	s_mov_b32 m0, s31
	s_nop 0
	buffer_load_dwordx4 v3, s[12:15], s30 offen lds
	s_add_u32 s30, s30, 32768
	s_add_u32 s31, s31, 1024
	s_mov_b32 m0, s31
	s_nop 0
	buffer_load_dwordx4 v4, s[12:15], s30 offen lds
	s_add_u32 s30, s30, 32768
	s_add_u32 s31, s31, 1024
	s_mov_b32 m0, s31
	s_nop 0
	buffer_load_dwordx4 v5, s[12:15], s30 offen lds
	s_add_u32 s30, s30, 32768
	s_add_u32 s31, s31, 1024
	s_mov_b32 m0, s31
	s_nop 0
	buffer_load_dwordx4 v6, s[12:15], s30 offen lds
	s_add_u32 s29, s4, 4
	s_lshl_b32 s30, s29, 17
	s_add_u32 s30, s30, s28
	s_add_u32 s30, s30, 0
	s_lshl_b32 s31, s29, 12
	s_add_u32 s31, s31, 16384
	s_mov_b32 m0, s31
	s_nop 0
	buffer_load_dwordx4 v3, s[12:15], s30 offen lds
	s_add_u32 s30, s30, 32768
	s_add_u32 s31, s31, 1024
	s_mov_b32 m0, s31
	s_nop 0
	buffer_load_dwordx4 v4, s[12:15], s30 offen lds
	s_add_u32 s30, s30, 32768
	s_add_u32 s31, s31, 1024
	s_mov_b32 m0, s31
	s_nop 0
	buffer_load_dwordx4 v5, s[12:15], s30 offen lds
	s_add_u32 s30, s30, 32768
	s_add_u32 s31, s31, 1024
	s_mov_b32 m0, s31
	s_nop 0
	buffer_load_dwordx4 v6, s[12:15], s30 offen lds
	s_add_u32 s29, s4, 8
	s_lshl_b32 s30, s29, 17
	s_add_u32 s30, s30, s28
	s_add_u32 s30, s30, 0
	s_lshl_b32 s31, s29, 12
	s_add_u32 s31, s31, 16384
	s_mov_b32 m0, s31
	s_nop 0
	buffer_load_dwordx4 v3, s[12:15], s30 offen lds
	s_add_u32 s30, s30, 32768
	s_add_u32 s31, s31, 1024
	s_mov_b32 m0, s31
	s_nop 0
	buffer_load_dwordx4 v4, s[12:15], s30 offen lds
	s_add_u32 s30, s30, 32768
	s_add_u32 s31, s31, 1024
	s_mov_b32 m0, s31
	s_nop 0
	buffer_load_dwordx4 v5, s[12:15], s30 offen lds
	s_add_u32 s30, s30, 32768
	s_add_u32 s31, s31, 1024
	s_mov_b32 m0, s31
	s_nop 0
	buffer_load_dwordx4 v6, s[12:15], s30 offen lds
	s_add_u32 s29, s4, 12
	s_lshl_b32 s30, s29, 17
	s_add_u32 s30, s30, s28
	s_add_u32 s30, s30, 0
	s_lshl_b32 s31, s29, 12
	s_add_u32 s31, s31, 16384
	s_mov_b32 m0, s31
	s_nop 0
	buffer_load_dwordx4 v3, s[12:15], s30 offen lds
	s_add_u32 s30, s30, 32768
	s_add_u32 s31, s31, 1024
	s_mov_b32 m0, s31
	s_nop 0
	buffer_load_dwordx4 v4, s[12:15], s30 offen lds
	s_add_u32 s30, s30, 32768
	s_add_u32 s31, s31, 1024
	s_mov_b32 m0, s31
	s_nop 0
	buffer_load_dwordx4 v5, s[12:15], s30 offen lds
	s_add_u32 s30, s30, 32768
	s_add_u32 s31, s31, 1024
	s_mov_b32 m0, s31
	s_nop 0
	buffer_load_dwordx4 v6, s[12:15], s30 offen lds
	s_add_u32 s29, s4, 16
	s_lshl_b32 s30, s29, 17
	s_add_u32 s30, s30, s28
	s_add_u32 s30, s30, 0
	s_lshl_b32 s31, s29, 12
	s_add_u32 s31, s31, 16384
	s_mov_b32 m0, s31
	s_nop 0
	buffer_load_dwordx4 v3, s[12:15], s30 offen lds
	s_add_u32 s30, s30, 32768
	s_add_u32 s31, s31, 1024
	s_mov_b32 m0, s31
	s_nop 0
	buffer_load_dwordx4 v4, s[12:15], s30 offen lds
	s_add_u32 s30, s30, 32768
	s_add_u32 s31, s31, 1024
	s_mov_b32 m0, s31
	s_nop 0
	buffer_load_dwordx4 v5, s[12:15], s30 offen lds
	s_add_u32 s30, s30, 32768
	s_add_u32 s31, s31, 1024
	s_mov_b32 m0, s31
	s_nop 0
	buffer_load_dwordx4 v6, s[12:15], s30 offen lds
	s_add_u32 s29, s4, 20
	s_lshl_b32 s30, s29, 17
	s_add_u32 s30, s30, s28
	s_add_u32 s30, s30, 0
	s_lshl_b32 s31, s29, 12
	s_add_u32 s31, s31, 16384
	s_mov_b32 m0, s31
	s_nop 0
	buffer_load_dwordx4 v3, s[12:15], s30 offen lds
	s_add_u32 s30, s30, 32768
	s_add_u32 s31, s31, 1024
	s_mov_b32 m0, s31
	s_nop 0
	buffer_load_dwordx4 v4, s[12:15], s30 offen lds
	s_add_u32 s30, s30, 32768
	s_add_u32 s31, s31, 1024
	s_mov_b32 m0, s31
	s_nop 0
	buffer_load_dwordx4 v5, s[12:15], s30 offen lds
	s_add_u32 s30, s30, 32768
	s_add_u32 s31, s31, 1024
	s_mov_b32 m0, s31
	s_nop 0
	buffer_load_dwordx4 v6, s[12:15], s30 offen lds
	s_add_u32 s29, s4, 24
	s_lshl_b32 s30, s29, 17
	s_add_u32 s30, s30, s28
	s_add_u32 s30, s30, 0
	s_lshl_b32 s31, s29, 12
	s_add_u32 s31, s31, 16384
	s_mov_b32 m0, s31
	s_nop 0
	buffer_load_dwordx4 v3, s[12:15], s30 offen lds
	s_add_u32 s30, s30, 32768
	s_add_u32 s31, s31, 1024
	s_mov_b32 m0, s31
	s_nop 0
	buffer_load_dwordx4 v4, s[12:15], s30 offen lds
	s_add_u32 s30, s30, 32768
	s_add_u32 s31, s31, 1024
	s_mov_b32 m0, s31
	s_nop 0
	buffer_load_dwordx4 v5, s[12:15], s30 offen lds
	s_add_u32 s30, s30, 32768
	s_add_u32 s31, s31, 1024
	s_mov_b32 m0, s31
	s_nop 0
	buffer_load_dwordx4 v6, s[12:15], s30 offen lds
	s_add_u32 s29, s4, 28
	s_lshl_b32 s30, s29, 17
	s_add_u32 s30, s30, s28
	s_add_u32 s30, s30, 0
	s_lshl_b32 s31, s29, 12
	s_add_u32 s31, s31, 16384
	s_mov_b32 m0, s31
	s_nop 0
	buffer_load_dwordx4 v3, s[12:15], s30 offen lds
	s_add_u32 s30, s30, 32768
	s_add_u32 s31, s31, 1024
	s_mov_b32 m0, s31
	s_nop 0
	buffer_load_dwordx4 v4, s[12:15], s30 offen lds
	s_add_u32 s30, s30, 32768
	s_add_u32 s31, s31, 1024
	s_mov_b32 m0, s31
	s_nop 0
	buffer_load_dwordx4 v5, s[12:15], s30 offen lds
	s_add_u32 s30, s30, 32768
	s_add_u32 s31, s31, 1024
	s_mov_b32 m0, s31
	s_nop 0
	buffer_load_dwordx4 v6, s[12:15], s30 offen lds
	s_add_u32 s29, s4, 32
	s_lshl_b32 s30, s29, 17
	s_add_u32 s30, s30, s28
	s_add_u32 s30, s30, 0
	s_lshl_b32 s31, s29, 12
	s_add_u32 s31, s31, 16384
	s_mov_b32 m0, s31
	s_nop 0
	buffer_load_dwordx4 v3, s[12:15], s30 offen lds
	s_add_u32 s30, s30, 32768
	s_add_u32 s31, s31, 1024
	s_mov_b32 m0, s31
	s_nop 0
	buffer_load_dwordx4 v4, s[12:15], s30 offen lds
	s_add_u32 s30, s30, 32768
	s_add_u32 s31, s31, 1024
	s_mov_b32 m0, s31
	s_nop 0
	buffer_load_dwordx4 v5, s[12:15], s30 offen lds
	s_add_u32 s30, s30, 32768
	s_add_u32 s31, s31, 1024
	s_mov_b32 m0, s31
	s_nop 0
	buffer_load_dwordx4 v6, s[12:15], s30 offen lds
	s_waitcnt vmcnt(0)
	s_barrier
	v_lshrrev_b32 v1, 4, v0
	v_and_b32 v2, 1, v1
	v_lshrrev_b32 v1, 1, v1
	v_lshlrev_b32 v1, 4, v1
	v_lshl_add_u32 v1, v2, 2, v1
	v_bfe_u32 v4, v0, 2, 1
	v_add_u32 v1, v1, v4
	v_bfe_u32 v3, v0, 3, 1
	v_lshl_add_u32 v1, v3, 3, v1
	v_lshlrev_b32 v1, 8, v1
	v_lshl_add_u32 v2, v3, 1, v2
	v_lshlrev_b32 v2, 2, v2
	v_and_b32 v3, 3, v0
	s_lshl_b32 s28, s4, 2
	v_add_u32 v3, s28, v3
	v_xor_b32 v3, v3, v2
	v_lshl_add_u32 v1, v3, 4, v1
	v_add_u32 v1, 16384, v1
	ds_read_b64_tr_b16 a[40:41], v1 offset:0
	ds_read_b64_tr_b16 a[42:43], v1 offset:512
	ds_read_b64_tr_b16 a[44:45], v1 offset:8192
	ds_read_b64_tr_b16 a[46:47], v1 offset:8704
	ds_read_b64_tr_b16 a[48:49], v1 offset:8
	ds_read_b64_tr_b16 a[50:51], v1 offset:520
	ds_read_b64_tr_b16 a[52:53], v1 offset:8200
	ds_read_b64_tr_b16 a[54:55], v1 offset:8712
	ds_read_b64_tr_b16 a[56:57], v1 offset:16384
	ds_read_b64_tr_b16 a[58:59], v1 offset:16896
	ds_read_b64_tr_b16 a[60:61], v1 offset:24576
	ds_read_b64_tr_b16 a[62:63], v1 offset:25088
	ds_read_b64_tr_b16 a[160:161], v1 offset:16392
	ds_read_b64_tr_b16 a[162:163], v1 offset:16904
	ds_read_b64_tr_b16 a[164:165], v1 offset:24584
	ds_read_b64_tr_b16 a[166:167], v1 offset:25096
	ds_read_b64_tr_b16 a[64:65], v1 offset:32768
	ds_read_b64_tr_b16 a[66:67], v1 offset:33280
	ds_read_b64_tr_b16 a[68:69], v1 offset:40960
	ds_read_b64_tr_b16 a[70:71], v1 offset:41472
	ds_read_b64_tr_b16 a[72:73], v1 offset:32776
	ds_read_b64_tr_b16 a[74:75], v1 offset:33288
	ds_read_b64_tr_b16 a[76:77], v1 offset:40968
	ds_read_b64_tr_b16 a[78:79], v1 offset:41480
	v_add_u32 v1, 49152, v1
	ds_read_b64_tr_b16 a[80:81], v1 offset:0
	ds_read_b64_tr_b16 a[82:83], v1 offset:512
	ds_read_b64_tr_b16 a[84:85], v1 offset:8192
	ds_read_b64_tr_b16 a[86:87], v1 offset:8704
	ds_read_b64_tr_b16 a[88:89], v1 offset:8
	ds_read_b64_tr_b16 a[90:91], v1 offset:520
	ds_read_b64_tr_b16 a[92:93], v1 offset:8200
	ds_read_b64_tr_b16 a[94:95], v1 offset:8712
	ds_read_b64_tr_b16 a[96:97], v1 offset:16384
	ds_read_b64_tr_b16 a[98:99], v1 offset:16896
	ds_read_b64_tr_b16 a[100:101], v1 offset:24576
	ds_read_b64_tr_b16 a[102:103], v1 offset:25088
	ds_read_b64_tr_b16 a[104:105], v1 offset:16392
	ds_read_b64_tr_b16 a[106:107], v1 offset:16904
	ds_read_b64_tr_b16 a[108:109], v1 offset:24584
	ds_read_b64_tr_b16 a[110:111], v1 offset:25096
	ds_read_b64_tr_b16 a[112:113], v1 offset:32768
	ds_read_b64_tr_b16 a[114:115], v1 offset:33280
	ds_read_b64_tr_b16 a[116:117], v1 offset:40960
	ds_read_b64_tr_b16 a[118:119], v1 offset:41472
	ds_read_b64_tr_b16 a[168:169], v1 offset:32776
	ds_read_b64_tr_b16 a[170:171], v1 offset:33288
	ds_read_b64_tr_b16 a[172:173], v1 offset:40968
	ds_read_b64_tr_b16 a[174:175], v1 offset:41480
	v_add_u32 v1, 49152, v1
	ds_read_b64_tr_b16 a[120:121], v1 offset:0
	ds_read_b64_tr_b16 a[122:123], v1 offset:512
	ds_read_b64_tr_b16 a[124:125], v1 offset:8192
	ds_read_b64_tr_b16 a[126:127], v1 offset:8704
	ds_read_b64_tr_b16 a[128:129], v1 offset:8
	ds_read_b64_tr_b16 a[130:131], v1 offset:520
	ds_read_b64_tr_b16 a[132:133], v1 offset:8200
	ds_read_b64_tr_b16 a[134:135], v1 offset:8712
	ds_read_b64_tr_b16 a[136:137], v1 offset:16384
	ds_read_b64_tr_b16 a[138:139], v1 offset:16896
	ds_read_b64_tr_b16 a[140:141], v1 offset:24576
	ds_read_b64_tr_b16 a[142:143], v1 offset:25088
	ds_read_b64_tr_b16 a[144:145], v1 offset:16392
	ds_read_b64_tr_b16 a[146:147], v1 offset:16904
	ds_read_b64_tr_b16 a[148:149], v1 offset:24584
	ds_read_b64_tr_b16 a[150:151], v1 offset:25096
	ds_read_b64_tr_b16 a[152:153], v1 offset:32768
	ds_read_b64_tr_b16 a[154:155], v1 offset:33280
	ds_read_b64_tr_b16 a[156:157], v1 offset:40960
	ds_read_b64_tr_b16 a[158:159], v1 offset:41472
	ds_read_b64_tr_b16 a[176:177], v1 offset:32776
	ds_read_b64_tr_b16 a[178:179], v1 offset:33288
	ds_read_b64_tr_b16 a[180:181], v1 offset:40968
	ds_read_b64_tr_b16 a[182:183], v1 offset:41480
	s_waitcnt lgkmcnt(0)
	s_barrier
	s_load_dwordx2 s[12:13], s[0:1], 40
	s_mov_b32 s14, 4718592
	s_mul_i32 s28, s3, 147456
	s_waitcnt lgkmcnt(0)
	s_add_u32 s29, s4, 0
	s_lshl_b32 s30, s29, 6
	v_add_u32 v1, s30, v0
	v_mul_u32_u24 v2, 58255, v1
	v_lshrrev_b32 v2, 22, v2
	v_and_b32 v3, 4, v2
	v_and_b32 v2, 8, v2
	v_lshrrev_b32 v2, 2, v2
	v_or_b32 v2, v2, v3
	v_xor_b32 v1, v1, v2
	v_lshlrev_b32 v1, 4, v1
	s_lshl_b32 s31, s29, 10
	s_add_u32 s31, s31, 16384
	s_mov_b32 m0, s31
	s_nop 0
	buffer_load_dwordx4 v1, s[12:15], s28 offen lds
	s_add_u32 s29, s4, 4
	s_lshl_b32 s30, s29, 6
	v_add_u32 v1, s30, v0
	v_mul_u32_u24 v2, 58255, v1
	v_lshrrev_b32 v2, 22, v2
	v_and_b32 v3, 4, v2
	v_and_b32 v2, 8, v2
	v_lshrrev_b32 v2, 2, v2
	v_or_b32 v2, v2, v3
	v_xor_b32 v1, v1, v2
	v_lshlrev_b32 v1, 4, v1
	s_lshl_b32 s31, s29, 10
	s_add_u32 s31, s31, 16384
	s_mov_b32 m0, s31
	s_nop 0
	buffer_load_dwordx4 v1, s[12:15], s28 offen lds
	s_add_u32 s29, s4, 8
	s_lshl_b32 s30, s29, 6
	v_add_u32 v1, s30, v0
	v_mul_u32_u24 v2, 58255, v1
	v_lshrrev_b32 v2, 22, v2
	v_and_b32 v3, 4, v2
	v_and_b32 v2, 8, v2
	v_lshrrev_b32 v2, 2, v2
	v_or_b32 v2, v2, v3
	v_xor_b32 v1, v1, v2
	v_lshlrev_b32 v1, 4, v1
	s_lshl_b32 s31, s29, 10
	s_add_u32 s31, s31, 16384
	s_mov_b32 m0, s31
	s_nop 0
	buffer_load_dwordx4 v1, s[12:15], s28 offen lds
	s_add_u32 s29, s4, 12
	s_lshl_b32 s30, s29, 6
	v_add_u32 v1, s30, v0
	v_mul_u32_u24 v2, 58255, v1
	v_lshrrev_b32 v2, 22, v2
	v_and_b32 v3, 4, v2
	v_and_b32 v2, 8, v2
	v_lshrrev_b32 v2, 2, v2
	v_or_b32 v2, v2, v3
	v_xor_b32 v1, v1, v2
	v_lshlrev_b32 v1, 4, v1
	s_lshl_b32 s31, s29, 10
	s_add_u32 s31, s31, 16384
	s_mov_b32 m0, s31
	s_nop 0
	buffer_load_dwordx4 v1, s[12:15], s28 offen lds
	s_add_u32 s29, s4, 16
	s_lshl_b32 s30, s29, 6
	v_add_u32 v1, s30, v0
	v_mul_u32_u24 v2, 58255, v1
	v_lshrrev_b32 v2, 22, v2
	v_and_b32 v3, 4, v2
	v_and_b32 v2, 8, v2
	v_lshrrev_b32 v2, 2, v2
	v_or_b32 v2, v2, v3
	v_xor_b32 v1, v1, v2
	v_lshlrev_b32 v1, 4, v1
	s_lshl_b32 s31, s29, 10
	s_add_u32 s31, s31, 16384
	s_mov_b32 m0, s31
	s_nop 0
	buffer_load_dwordx4 v1, s[12:15], s28 offen lds
	s_add_u32 s29, s4, 20
	s_lshl_b32 s30, s29, 6
	v_add_u32 v1, s30, v0
	v_mul_u32_u24 v2, 58255, v1
	v_lshrrev_b32 v2, 22, v2
	v_and_b32 v3, 4, v2
	v_and_b32 v2, 8, v2
	v_lshrrev_b32 v2, 2, v2
	v_or_b32 v2, v2, v3
	v_xor_b32 v1, v1, v2
	v_lshlrev_b32 v1, 4, v1
	s_lshl_b32 s31, s29, 10
	s_add_u32 s31, s31, 16384
	s_mov_b32 m0, s31
	s_nop 0
	buffer_load_dwordx4 v1, s[12:15], s28 offen lds
	s_add_u32 s29, s4, 24
	s_lshl_b32 s30, s29, 6
	v_add_u32 v1, s30, v0
	v_mul_u32_u24 v2, 58255, v1
	v_lshrrev_b32 v2, 22, v2
	v_and_b32 v3, 4, v2
	v_and_b32 v2, 8, v2
	v_lshrrev_b32 v2, 2, v2
	v_or_b32 v2, v2, v3
	v_xor_b32 v1, v1, v2
	v_lshlrev_b32 v1, 4, v1
	s_lshl_b32 s31, s29, 10
	s_add_u32 s31, s31, 16384
	s_mov_b32 m0, s31
	s_nop 0
	buffer_load_dwordx4 v1, s[12:15], s28 offen lds
	s_add_u32 s29, s4, 28
	s_lshl_b32 s30, s29, 6
	v_add_u32 v1, s30, v0
	v_mul_u32_u24 v2, 58255, v1
	v_lshrrev_b32 v2, 22, v2
	v_and_b32 v3, 4, v2
	v_and_b32 v2, 8, v2
	v_lshrrev_b32 v2, 2, v2
	v_or_b32 v2, v2, v3
	v_xor_b32 v1, v1, v2
	v_lshlrev_b32 v1, 4, v1
	s_lshl_b32 s31, s29, 10
	s_add_u32 s31, s31, 16384
	s_mov_b32 m0, s31
	s_nop 0
	buffer_load_dwordx4 v1, s[12:15], s28 offen lds
	s_add_u32 s29, s4, 32
	s_lshl_b32 s30, s29, 6
	v_add_u32 v1, s30, v0
	v_mul_u32_u24 v2, 58255, v1
	v_lshrrev_b32 v2, 22, v2
	v_and_b32 v3, 4, v2
	v_and_b32 v2, 8, v2
	v_lshrrev_b32 v2, 2, v2
	v_or_b32 v2, v2, v3
	v_xor_b32 v1, v1, v2
	v_lshlrev_b32 v1, 4, v1
	s_lshl_b32 s31, s29, 10
	s_add_u32 s31, s31, 16384
	s_mov_b32 m0, s31
	s_nop 0
	buffer_load_dwordx4 v1, s[12:15], s28 offen lds
	s_add_u32 s29, s4, 36
	s_lshl_b32 s30, s29, 6
	v_add_u32 v1, s30, v0
	v_mul_u32_u24 v2, 58255, v1
	v_lshrrev_b32 v2, 22, v2
	v_and_b32 v3, 4, v2
	v_and_b32 v2, 8, v2
	v_lshrrev_b32 v2, 2, v2
	v_or_b32 v2, v2, v3
	v_xor_b32 v1, v1, v2
	v_lshlrev_b32 v1, 4, v1
	s_lshl_b32 s31, s29, 10
	s_add_u32 s31, s31, 16384
	s_mov_b32 m0, s31
	s_nop 0
	buffer_load_dwordx4 v1, s[12:15], s28 offen lds
	s_add_u32 s29, s4, 40
	s_lshl_b32 s30, s29, 6
	v_add_u32 v1, s30, v0
	v_mul_u32_u24 v2, 58255, v1
	v_lshrrev_b32 v2, 22, v2
	v_and_b32 v3, 4, v2
	v_and_b32 v2, 8, v2
	v_lshrrev_b32 v2, 2, v2
	v_or_b32 v2, v2, v3
	v_xor_b32 v1, v1, v2
	v_lshlrev_b32 v1, 4, v1
	s_lshl_b32 s31, s29, 10
	s_add_u32 s31, s31, 16384
	s_mov_b32 m0, s31
	s_nop 0
	buffer_load_dwordx4 v1, s[12:15], s28 offen lds
	s_add_u32 s29, s4, 44
	s_lshl_b32 s30, s29, 6
	v_add_u32 v1, s30, v0
	v_mul_u32_u24 v2, 58255, v1
	v_lshrrev_b32 v2, 22, v2
	v_and_b32 v3, 4, v2
	v_and_b32 v2, 8, v2
	v_lshrrev_b32 v2, 2, v2
	v_or_b32 v2, v2, v3
	v_xor_b32 v1, v1, v2
	v_lshlrev_b32 v1, 4, v1
	s_lshl_b32 s31, s29, 10
	s_add_u32 s31, s31, 16384
	s_mov_b32 m0, s31
	s_nop 0
	buffer_load_dwordx4 v1, s[12:15], s28 offen lds
	s_add_u32 s29, s4, 48
	s_lshl_b32 s30, s29, 6
	v_add_u32 v1, s30, v0
	v_mul_u32_u24 v2, 58255, v1
	v_lshrrev_b32 v2, 22, v2
	v_and_b32 v3, 4, v2
	v_and_b32 v2, 8, v2
	v_lshrrev_b32 v2, 2, v2
	v_or_b32 v2, v2, v3
	v_xor_b32 v1, v1, v2
	v_lshlrev_b32 v1, 4, v1
	s_lshl_b32 s31, s29, 10
	s_add_u32 s31, s31, 16384
	s_mov_b32 m0, s31
	s_nop 0
	buffer_load_dwordx4 v1, s[12:15], s28 offen lds
	s_add_u32 s29, s4, 52
	s_lshl_b32 s30, s29, 6
	v_add_u32 v1, s30, v0
	v_mul_u32_u24 v2, 58255, v1
	v_lshrrev_b32 v2, 22, v2
	v_and_b32 v3, 4, v2
	v_and_b32 v2, 8, v2
	v_lshrrev_b32 v2, 2, v2
	v_or_b32 v2, v2, v3
	v_xor_b32 v1, v1, v2
	v_lshlrev_b32 v1, 4, v1
	s_lshl_b32 s31, s29, 10
	s_add_u32 s31, s31, 16384
	s_mov_b32 m0, s31
	s_nop 0
	buffer_load_dwordx4 v1, s[12:15], s28 offen lds
	s_add_u32 s29, s4, 56
	s_lshl_b32 s30, s29, 6
	v_add_u32 v1, s30, v0
	v_mul_u32_u24 v2, 58255, v1
	v_lshrrev_b32 v2, 22, v2
	v_and_b32 v3, 4, v2
	v_and_b32 v2, 8, v2
	v_lshrrev_b32 v2, 2, v2
	v_or_b32 v2, v2, v3
	v_xor_b32 v1, v1, v2
	v_lshlrev_b32 v1, 4, v1
	s_lshl_b32 s31, s29, 10
	s_add_u32 s31, s31, 16384
	s_mov_b32 m0, s31
	s_nop 0
	buffer_load_dwordx4 v1, s[12:15], s28 offen lds
	s_add_u32 s29, s4, 60
	s_lshl_b32 s30, s29, 6
	v_add_u32 v1, s30, v0
	v_mul_u32_u24 v2, 58255, v1
	v_lshrrev_b32 v2, 22, v2
	v_and_b32 v3, 4, v2
	v_and_b32 v2, 8, v2
	v_lshrrev_b32 v2, 2, v2
	v_or_b32 v2, v2, v3
	v_xor_b32 v1, v1, v2
	v_lshlrev_b32 v1, 4, v1
	s_lshl_b32 s31, s29, 10
	s_add_u32 s31, s31, 16384
	s_mov_b32 m0, s31
	s_nop 0
	buffer_load_dwordx4 v1, s[12:15], s28 offen lds
	s_add_u32 s29, s4, 64
	s_lshl_b32 s30, s29, 6
	v_add_u32 v1, s30, v0
	v_mul_u32_u24 v2, 58255, v1
	v_lshrrev_b32 v2, 22, v2
	v_and_b32 v3, 4, v2
	v_and_b32 v2, 8, v2
	v_lshrrev_b32 v2, 2, v2
	v_or_b32 v2, v2, v3
	v_xor_b32 v1, v1, v2
	v_lshlrev_b32 v1, 4, v1
	s_lshl_b32 s31, s29, 10
	s_add_u32 s31, s31, 16384
	s_mov_b32 m0, s31
	s_nop 0
	buffer_load_dwordx4 v1, s[12:15], s28 offen lds
	s_add_u32 s29, s4, 68
	s_lshl_b32 s30, s29, 6
	v_add_u32 v1, s30, v0
	v_mul_u32_u24 v2, 58255, v1
	v_lshrrev_b32 v2, 22, v2
	v_and_b32 v3, 4, v2
	v_and_b32 v2, 8, v2
	v_lshrrev_b32 v2, 2, v2
	v_or_b32 v2, v2, v3
	v_xor_b32 v1, v1, v2
	v_lshlrev_b32 v1, 4, v1
	s_lshl_b32 s31, s29, 10
	s_add_u32 s31, s31, 16384
	s_mov_b32 m0, s31
	s_nop 0
	buffer_load_dwordx4 v1, s[12:15], s28 offen lds
	s_add_u32 s29, s4, 72
	s_lshl_b32 s30, s29, 6
	v_add_u32 v1, s30, v0
	v_mul_u32_u24 v2, 58255, v1
	v_lshrrev_b32 v2, 22, v2
	v_and_b32 v3, 4, v2
	v_and_b32 v2, 8, v2
	v_lshrrev_b32 v2, 2, v2
	v_or_b32 v2, v2, v3
	v_xor_b32 v1, v1, v2
	v_lshlrev_b32 v1, 4, v1
	s_lshl_b32 s31, s29, 10
	s_add_u32 s31, s31, 16384
	s_mov_b32 m0, s31
	s_nop 0
	buffer_load_dwordx4 v1, s[12:15], s28 offen lds
	s_add_u32 s29, s4, 76
	s_lshl_b32 s30, s29, 6
	v_add_u32 v1, s30, v0
	v_mul_u32_u24 v2, 58255, v1
	v_lshrrev_b32 v2, 22, v2
	v_and_b32 v3, 4, v2
	v_and_b32 v2, 8, v2
	v_lshrrev_b32 v2, 2, v2
	v_or_b32 v2, v2, v3
	v_xor_b32 v1, v1, v2
	v_lshlrev_b32 v1, 4, v1
	s_lshl_b32 s31, s29, 10
	s_add_u32 s31, s31, 16384
	s_mov_b32 m0, s31
	s_nop 0
	buffer_load_dwordx4 v1, s[12:15], s28 offen lds
	s_add_u32 s29, s4, 80
	s_lshl_b32 s30, s29, 6
	v_add_u32 v1, s30, v0
	v_mul_u32_u24 v2, 58255, v1
	v_lshrrev_b32 v2, 22, v2
	v_and_b32 v3, 4, v2
	v_and_b32 v2, 8, v2
	v_lshrrev_b32 v2, 2, v2
	v_or_b32 v2, v2, v3
	v_xor_b32 v1, v1, v2
	v_lshlrev_b32 v1, 4, v1
	s_lshl_b32 s31, s29, 10
	s_add_u32 s31, s31, 16384
	s_mov_b32 m0, s31
	s_nop 0
	buffer_load_dwordx4 v1, s[12:15], s28 offen lds
	s_add_u32 s29, s4, 84
	s_lshl_b32 s30, s29, 6
	v_add_u32 v1, s30, v0
	v_mul_u32_u24 v2, 58255, v1
	v_lshrrev_b32 v2, 22, v2
	v_and_b32 v3, 4, v2
	v_and_b32 v2, 8, v2
	v_lshrrev_b32 v2, 2, v2
	v_or_b32 v2, v2, v3
	v_xor_b32 v1, v1, v2
	v_lshlrev_b32 v1, 4, v1
	s_lshl_b32 s31, s29, 10
	s_add_u32 s31, s31, 16384
	s_mov_b32 m0, s31
	s_nop 0
	buffer_load_dwordx4 v1, s[12:15], s28 offen lds
	s_add_u32 s29, s4, 88
	s_lshl_b32 s30, s29, 6
	v_add_u32 v1, s30, v0
	v_mul_u32_u24 v2, 58255, v1
	v_lshrrev_b32 v2, 22, v2
	v_and_b32 v3, 4, v2
	v_and_b32 v2, 8, v2
	v_lshrrev_b32 v2, 2, v2
	v_or_b32 v2, v2, v3
	v_xor_b32 v1, v1, v2
	v_lshlrev_b32 v1, 4, v1
	s_lshl_b32 s31, s29, 10
	s_add_u32 s31, s31, 16384
	s_mov_b32 m0, s31
	s_nop 0
	buffer_load_dwordx4 v1, s[12:15], s28 offen lds
	s_add_u32 s29, s4, 92
	s_lshl_b32 s30, s29, 6
	v_add_u32 v1, s30, v0
	v_mul_u32_u24 v2, 58255, v1
	v_lshrrev_b32 v2, 22, v2
	v_and_b32 v3, 4, v2
	v_and_b32 v2, 8, v2
	v_lshrrev_b32 v2, 2, v2
	v_or_b32 v2, v2, v3
	v_xor_b32 v1, v1, v2
	v_lshlrev_b32 v1, 4, v1
	s_lshl_b32 s31, s29, 10
	s_add_u32 s31, s31, 16384
	s_mov_b32 m0, s31
	s_nop 0
	buffer_load_dwordx4 v1, s[12:15], s28 offen lds
	s_add_u32 s29, s4, 96
	s_lshl_b32 s30, s29, 6
	v_add_u32 v1, s30, v0
	v_mul_u32_u24 v2, 58255, v1
	v_lshrrev_b32 v2, 22, v2
	v_and_b32 v3, 4, v2
	v_and_b32 v2, 8, v2
	v_lshrrev_b32 v2, 2, v2
	v_or_b32 v2, v2, v3
	v_xor_b32 v1, v1, v2
	v_lshlrev_b32 v1, 4, v1
	s_lshl_b32 s31, s29, 10
	s_add_u32 s31, s31, 16384
	s_mov_b32 m0, s31
	s_nop 0
	buffer_load_dwordx4 v1, s[12:15], s28 offen lds
	s_add_u32 s29, s4, 100
	s_lshl_b32 s30, s29, 6
	v_add_u32 v1, s30, v0
	v_mul_u32_u24 v2, 58255, v1
	v_lshrrev_b32 v2, 22, v2
	v_and_b32 v3, 4, v2
	v_and_b32 v2, 8, v2
	v_lshrrev_b32 v2, 2, v2
	v_or_b32 v2, v2, v3
	v_xor_b32 v1, v1, v2
	v_lshlrev_b32 v1, 4, v1
	s_lshl_b32 s31, s29, 10
	s_add_u32 s31, s31, 16384
	s_mov_b32 m0, s31
	s_nop 0
	buffer_load_dwordx4 v1, s[12:15], s28 offen lds
	s_add_u32 s29, s4, 104
	s_lshl_b32 s30, s29, 6
	v_add_u32 v1, s30, v0
	v_mul_u32_u24 v2, 58255, v1
	v_lshrrev_b32 v2, 22, v2
	v_and_b32 v3, 4, v2
	v_and_b32 v2, 8, v2
	v_lshrrev_b32 v2, 2, v2
	v_or_b32 v2, v2, v3
	v_xor_b32 v1, v1, v2
	v_lshlrev_b32 v1, 4, v1
	s_lshl_b32 s31, s29, 10
	s_add_u32 s31, s31, 16384
	s_mov_b32 m0, s31
	s_nop 0
	buffer_load_dwordx4 v1, s[12:15], s28 offen lds
	s_add_u32 s29, s4, 108
	s_lshl_b32 s30, s29, 6
	v_add_u32 v1, s30, v0
	v_mul_u32_u24 v2, 58255, v1
	v_lshrrev_b32 v2, 22, v2
	v_and_b32 v3, 4, v2
	v_and_b32 v2, 8, v2
	v_lshrrev_b32 v2, 2, v2
	v_or_b32 v2, v2, v3
	v_xor_b32 v1, v1, v2
	v_lshlrev_b32 v1, 4, v1
	s_lshl_b32 s31, s29, 10
	s_add_u32 s31, s31, 16384
	s_mov_b32 m0, s31
	s_nop 0
	buffer_load_dwordx4 v1, s[12:15], s28 offen lds
	s_add_u32 s29, s4, 112
	s_lshl_b32 s30, s29, 6
	v_add_u32 v1, s30, v0
	v_mul_u32_u24 v2, 58255, v1
	v_lshrrev_b32 v2, 22, v2
	v_and_b32 v3, 4, v2
	v_and_b32 v2, 8, v2
	v_lshrrev_b32 v2, 2, v2
	v_or_b32 v2, v2, v3
	v_xor_b32 v1, v1, v2
	v_lshlrev_b32 v1, 4, v1
	s_lshl_b32 s31, s29, 10
	s_add_u32 s31, s31, 16384
	s_mov_b32 m0, s31
	s_nop 0
	buffer_load_dwordx4 v1, s[12:15], s28 offen lds
	s_add_u32 s29, s4, 116
	s_lshl_b32 s30, s29, 6
	v_add_u32 v1, s30, v0
	v_mul_u32_u24 v2, 58255, v1
	v_lshrrev_b32 v2, 22, v2
	v_and_b32 v3, 4, v2
	v_and_b32 v2, 8, v2
	v_lshrrev_b32 v2, 2, v2
	v_or_b32 v2, v2, v3
	v_xor_b32 v1, v1, v2
	v_lshlrev_b32 v1, 4, v1
	s_lshl_b32 s31, s29, 10
	s_add_u32 s31, s31, 16384
	s_mov_b32 m0, s31
	s_nop 0
	buffer_load_dwordx4 v1, s[12:15], s28 offen lds
	s_add_u32 s29, s4, 120
	s_lshl_b32 s30, s29, 6
	v_add_u32 v1, s30, v0
	v_mul_u32_u24 v2, 58255, v1
	v_lshrrev_b32 v2, 22, v2
	v_and_b32 v3, 4, v2
	v_and_b32 v2, 8, v2
	v_lshrrev_b32 v2, 2, v2
	v_or_b32 v2, v2, v3
	v_xor_b32 v1, v1, v2
	v_lshlrev_b32 v1, 4, v1
	s_lshl_b32 s31, s29, 10
	s_add_u32 s31, s31, 16384
	s_mov_b32 m0, s31
	s_nop 0
	buffer_load_dwordx4 v1, s[12:15], s28 offen lds
	s_add_u32 s29, s4, 124
	s_lshl_b32 s30, s29, 6
	v_add_u32 v1, s30, v0
	v_mul_u32_u24 v2, 58255, v1
	v_lshrrev_b32 v2, 22, v2
	v_and_b32 v3, 4, v2
	v_and_b32 v2, 8, v2
	v_lshrrev_b32 v2, 2, v2
	v_or_b32 v2, v2, v3
	v_xor_b32 v1, v1, v2
	v_lshlrev_b32 v1, 4, v1
	s_lshl_b32 s31, s29, 10
	s_add_u32 s31, s31, 16384
	s_mov_b32 m0, s31
	s_nop 0
	buffer_load_dwordx4 v1, s[12:15], s28 offen lds
	s_add_u32 s29, s4, 128
	s_lshl_b32 s30, s29, 6
	v_add_u32 v1, s30, v0
	v_mul_u32_u24 v2, 58255, v1
	v_lshrrev_b32 v2, 22, v2
	v_and_b32 v3, 4, v2
	v_and_b32 v2, 8, v2
	v_lshrrev_b32 v2, 2, v2
	v_or_b32 v2, v2, v3
	v_xor_b32 v1, v1, v2
	v_lshlrev_b32 v1, 4, v1
	s_lshl_b32 s31, s29, 10
	s_add_u32 s31, s31, 16384
	s_mov_b32 m0, s31
	s_nop 0
	buffer_load_dwordx4 v1, s[12:15], s28 offen lds
	s_add_u32 s29, s4, 132
	s_lshl_b32 s30, s29, 6
	v_add_u32 v1, s30, v0
	v_mul_u32_u24 v2, 58255, v1
	v_lshrrev_b32 v2, 22, v2
	v_and_b32 v3, 4, v2
	v_and_b32 v2, 8, v2
	v_lshrrev_b32 v2, 2, v2
	v_or_b32 v2, v2, v3
	v_xor_b32 v1, v1, v2
	v_lshlrev_b32 v1, 4, v1
	s_lshl_b32 s31, s29, 10
	s_add_u32 s31, s31, 16384
	s_mov_b32 m0, s31
	s_nop 0
	buffer_load_dwordx4 v1, s[12:15], s28 offen lds
	s_add_u32 s29, s4, 136
	s_lshl_b32 s30, s29, 6
	v_add_u32 v1, s30, v0
	v_mul_u32_u24 v2, 58255, v1
	v_lshrrev_b32 v2, 22, v2
	v_and_b32 v3, 4, v2
	v_and_b32 v2, 8, v2
	v_lshrrev_b32 v2, 2, v2
	v_or_b32 v2, v2, v3
	v_xor_b32 v1, v1, v2
	v_lshlrev_b32 v1, 4, v1
	s_lshl_b32 s31, s29, 10
	s_add_u32 s31, s31, 16384
	s_mov_b32 m0, s31
	s_nop 0
	buffer_load_dwordx4 v1, s[12:15], s28 offen lds
	s_add_u32 s29, s4, 140
	s_lshl_b32 s30, s29, 6
	v_add_u32 v1, s30, v0
	v_mul_u32_u24 v2, 58255, v1
	v_lshrrev_b32 v2, 22, v2
	v_and_b32 v3, 4, v2
	v_and_b32 v2, 8, v2
	v_lshrrev_b32 v2, 2, v2
	v_or_b32 v2, v2, v3
	v_xor_b32 v1, v1, v2
	v_lshlrev_b32 v1, 4, v1
	s_lshl_b32 s31, s29, 10
	s_add_u32 s31, s31, 16384
	s_mov_b32 m0, s31
	s_nop 0
	buffer_load_dwordx4 v1, s[12:15], s28 offen lds
	s_waitcnt vmcnt(0)
	s_barrier
	v_lshrrev_b32 v1, 4, v0
	v_and_b32 v2, 1, v1
	v_lshrrev_b32 v1, 1, v1
	v_lshlrev_b32 v1, 4, v1
	v_lshl_add_u32 v1, v2, 2, v1
	v_bfe_u32 v4, v0, 2, 1
	v_add_u32 v1, v1, v4
	v_bfe_u32 v4, v0, 3, 1
	v_lshl_add_u32 v1, v4, 3, v1
	v_mul_u32_u24 v1, 1152, v1
	v_lshlrev_b32 v3, 1, v4
	v_lshl_add_u32 v3, v2, 2, v3
	s_mul_i32 s28, s4, 18
	v_bfe_u32 v2, v0, 1, 1
	v_add_u32 v4, s28, v2
	v_xor_b32 v4, v4, v3
	v_lshl_add_u32 v1, v4, 4, v1
	v_and_b32 v2, 1, v0
	v_lshl_add_u32 v1, v2, 3, v1
	v_add_u32 v1, 16384, v1
	v_add_u32 v5, 73728, v1
	ds_read_b64_tr_b16 a[184:185], v5 offset:0
	v_add_u32 v5, 73728, v1
	ds_read_b64_tr_b16 a[186:187], v5 offset:2304
	v_add_u32 v5, 73728, v1
	ds_read_b64_tr_b16 a[188:189], v5 offset:36864
	v_add_u32 v5, 73728, v1
	ds_read_b64_tr_b16 a[190:191], v5 offset:39168
	v_lshrrev_b32 v1, 4, v0
	v_and_b32 v2, 1, v1
	v_lshrrev_b32 v1, 1, v1
	v_lshlrev_b32 v3, 1, v1
	v_lshl_add_u32 v3, v2, 2, v3
	v_lshlrev_b32 v1, 3, v1
	v_lshl_add_u32 v1, v2, 2, v1
	v_bfe_u32 v4, v0, 2, 1
	v_add_u32 v1, v1, v4
	v_mul_u32_u24 v1, 1152, v1
	s_mul_i32 s28, s4, 18
	s_add_u32 s28, s28, 2
	v_bfe_u32 v4, v0, 3, 1
	v_lshlrev_b32 v4, 1, v4
	v_bfe_u32 v2, v0, 1, 1
	v_add3_u32 v4, v4, v2, s28
	v_xor_b32 v4, v4, v3
	v_lshl_add_u32 v1, v4, 4, v1
	v_and_b32 v2, 1, v0
	v_lshl_add_u32 v1, v2, 3, v1
	v_add_u32 v1, 16384, v1
	v_add_u32 v5, 73728, v1
	ds_read_b64_tr_b16 a[192:193], v5 offset:0
	v_add_u32 v5, 73728, v1
	ds_read_b64_tr_b16 a[194:195], v5 offset:2304
	v_add_u32 v5, 73728, v1
	ds_read_b64_tr_b16 a[196:197], v5 offset:18432
	v_add_u32 v5, 73728, v1
	ds_read_b64_tr_b16 a[198:199], v5 offset:20736
	v_add_u32 v5, 73728, v1
	ds_read_b64_tr_b16 a[232:233], v5 offset:36864
	v_add_u32 v5, 73728, v1
	ds_read_b64_tr_b16 a[234:235], v5 offset:39168
	v_add_u32 v5, 73728, v1
	ds_read_b64_tr_b16 a[236:237], v5 offset:55296
	v_add_u32 v5, 73728, v1
	ds_read_b64_tr_b16 a[238:239], v5 offset:57600
	v_lshrrev_b32 v1, 4, v0
	v_and_b32 v2, 1, v1
	v_lshrrev_b32 v1, 1, v1
	v_lshlrev_b32 v3, 1, v1
	v_lshl_add_u32 v3, v2, 2, v3
	v_lshlrev_b32 v1, 3, v1
	v_lshl_add_u32 v1, v2, 2, v1
	v_bfe_u32 v4, v0, 2, 1
	v_add_u32 v1, v1, v4
	v_mul_u32_u24 v1, 1152, v1
	s_mul_i32 s28, s4, 18
	s_add_u32 s28, s28, 6
	v_bfe_u32 v4, v0, 3, 1
	v_lshlrev_b32 v4, 1, v4
	v_bfe_u32 v2, v0, 1, 1
	v_add3_u32 v4, v4, v2, s28
	v_xor_b32 v4, v4, v3
	v_lshl_add_u32 v1, v4, 4, v1
	v_and_b32 v2, 1, v0
	v_lshl_add_u32 v1, v2, 3, v1
	v_add_u32 v1, 16384, v1
	v_add_u32 v5, 73728, v1
	ds_read_b64_tr_b16 a[200:201], v5 offset:0
	v_add_u32 v5, 73728, v1
	ds_read_b64_tr_b16 a[202:203], v5 offset:2304
	v_add_u32 v5, 73728, v1
	ds_read_b64_tr_b16 a[204:205], v5 offset:18432
	v_add_u32 v5, 73728, v1
	ds_read_b64_tr_b16 a[206:207], v5 offset:20736
	v_add_u32 v5, 73728, v1
	ds_read_b64_tr_b16 a[208:209], v5 offset:36864
	v_add_u32 v5, 73728, v1
	ds_read_b64_tr_b16 a[210:211], v5 offset:39168
	v_add_u32 v5, 73728, v1
	ds_read_b64_tr_b16 a[212:213], v5 offset:55296
	v_add_u32 v5, 73728, v1
	ds_read_b64_tr_b16 a[214:215], v5 offset:57600
	v_lshrrev_b32 v1, 4, v0
	v_and_b32 v2, 1, v1
	v_lshrrev_b32 v1, 1, v1
	v_lshlrev_b32 v3, 1, v1
	v_lshl_add_u32 v3, v2, 2, v3
	v_lshlrev_b32 v1, 3, v1
	v_lshl_add_u32 v1, v2, 2, v1
	v_bfe_u32 v4, v0, 2, 1
	v_add_u32 v1, v1, v4
	v_mul_u32_u24 v1, 1152, v1
	s_mul_i32 s28, s4, 18
	s_add_u32 s28, s28, 10
	v_bfe_u32 v4, v0, 3, 1
	v_lshlrev_b32 v4, 1, v4
	v_bfe_u32 v2, v0, 1, 1
	v_add3_u32 v4, v4, v2, s28
	v_xor_b32 v4, v4, v3
	v_lshl_add_u32 v1, v4, 4, v1
	v_and_b32 v2, 1, v0
	v_lshl_add_u32 v1, v2, 3, v1
	v_add_u32 v1, 16384, v1
	v_add_u32 v5, 73728, v1
	ds_read_b64_tr_b16 a[240:241], v5 offset:0
	v_add_u32 v5, 73728, v1
	ds_read_b64_tr_b16 a[242:243], v5 offset:2304
	v_add_u32 v5, 73728, v1
	ds_read_b64_tr_b16 a[244:245], v5 offset:18432
	v_add_u32 v5, 73728, v1
	ds_read_b64_tr_b16 a[246:247], v5 offset:20736
	v_add_u32 v5, 73728, v1
	ds_read_b64_tr_b16 a[216:217], v5 offset:36864
	v_add_u32 v5, 73728, v1
	ds_read_b64_tr_b16 a[218:219], v5 offset:39168
	v_add_u32 v5, 73728, v1
	ds_read_b64_tr_b16 a[220:221], v5 offset:55296
	v_add_u32 v5, 73728, v1
	ds_read_b64_tr_b16 a[222:223], v5 offset:57600
	v_lshrrev_b32 v1, 4, v0
	v_and_b32 v2, 1, v1
	v_lshrrev_b32 v1, 1, v1
	v_lshlrev_b32 v3, 1, v1
	v_lshl_add_u32 v3, v2, 2, v3
	v_lshlrev_b32 v1, 3, v1
	v_lshl_add_u32 v1, v2, 2, v1
	v_bfe_u32 v4, v0, 2, 1
	v_add_u32 v1, v1, v4
	v_mul_u32_u24 v1, 1152, v1
	s_mul_i32 s28, s4, 18
	s_add_u32 s28, s28, 14
	v_bfe_u32 v4, v0, 3, 1
	v_lshlrev_b32 v4, 1, v4
	v_bfe_u32 v2, v0, 1, 1
	v_add3_u32 v4, v4, v2, s28
	v_xor_b32 v4, v4, v3
	v_lshl_add_u32 v1, v4, 4, v1
	v_and_b32 v2, 1, v0
	v_lshl_add_u32 v1, v2, 3, v1
	v_add_u32 v1, 16384, v1
	v_add_u32 v5, 73728, v1
	ds_read_b64_tr_b16 a[224:225], v5 offset:0
	v_add_u32 v5, 73728, v1
	ds_read_b64_tr_b16 a[226:227], v5 offset:2304
	v_add_u32 v5, 73728, v1
	ds_read_b64_tr_b16 a[228:229], v5 offset:18432
	v_add_u32 v5, 73728, v1
	ds_read_b64_tr_b16 a[230:231], v5 offset:20736
	v_add_u32 v5, 73728, v1
	ds_read_b64_tr_b16 a[248:249], v5 offset:36864
	v_add_u32 v5, 73728, v1
	ds_read_b64_tr_b16 a[250:251], v5 offset:39168
	v_add_u32 v5, 73728, v1
	ds_read_b64_tr_b16 a[252:253], v5 offset:55296
	v_add_u32 v5, 73728, v1
	ds_read_b64_tr_b16 a[254:255], v5 offset:57600
	s_waitcnt lgkmcnt(0)
	s_barrier
	s_mul_i32 s28, s4, 18432
	s_add_u32 s28, s28, 16384
	v_lshlrev_b32 v7, 4, v0
	v_add_u32 v7, s28, v7
	v_add_u32 v6, 73728, v7
	ds_write_b128 v6, a[160:163] offset:0
	ds_write_b128 v6, a[164:167] offset:1024
	ds_write_b128 v6, a[168:171] offset:2048
	ds_write_b128 v6, a[172:175] offset:3072
	ds_write_b128 v6, a[176:179] offset:4096
	ds_write_b128 v6, a[180:183] offset:5120
	ds_write_b128 v6, a[232:235] offset:6144
	ds_write_b128 v6, a[236:239] offset:7168
	ds_write_b128 v6, a[240:243] offset:8192
	ds_write_b128 v6, a[244:247] offset:9216
	ds_write_b128 v6, a[248:251] offset:10240
	ds_write_b128 v6, a[252:255] offset:11264
	ds_write_b128 v6, v[8:11] offset:12288
	ds_write_b128 v6, v[12:15] offset:13312
	ds_write_b128 v6, v[16:19] offset:14336
	ds_write_b128 v6, v[20:23] offset:15360
	ds_write_b128 v6, v[24:27] offset:16384
	ds_write_b128 v6, v[28:31] offset:17408
	s_waitcnt lgkmcnt(0)
	v_lshrrev_b32 v1, 4, v0
	v_and_b32 v2, 1, v1
	v_lshrrev_b32 v1, 1, v1
	v_lshlrev_b32 v1, 4, v1
	v_lshl_add_u32 v1, v2, 2, v1
	v_bfe_u32 v4, v0, 2, 1
	v_add_u32 v1, v1, v4
	v_bfe_u32 v4, v0, 3, 1
	v_lshl_add_u32 v1, v4, 3, v1
	v_mul_u32_u24 v1, 1152, v1
	v_lshlrev_b32 v3, 1, v4
	v_lshl_add_u32 v3, v2, 2, v3
	s_mul_i32 s28, s4, 18
	v_bfe_u32 v2, v0, 1, 1
	v_add_u32 v4, s28, v2
	v_xor_b32 v4, v4, v3
	v_lshl_add_u32 v1, v4, 4, v1
	v_and_b32 v2, 1, v0
	v_lshl_add_u32 v1, v2, 3, v1
	v_add_u32 v1, 16384, v1
	ds_read_b64_tr_b16 a[160:161], v1 offset:0
	ds_read_b64_tr_b16 a[162:163], v1 offset:2304
	ds_read_b64_tr_b16 a[164:165], v1 offset:36864
	ds_read_b64_tr_b16 a[166:167], v1 offset:39168
	v_lshrrev_b32 v1, 4, v0
	v_and_b32 v2, 1, v1
	v_lshrrev_b32 v1, 1, v1
	v_lshlrev_b32 v3, 1, v1
	v_lshl_add_u32 v3, v2, 2, v3
	v_lshlrev_b32 v1, 3, v1
	v_lshl_add_u32 v1, v2, 2, v1
	v_bfe_u32 v4, v0, 2, 1
	v_add_u32 v1, v1, v4
	v_mul_u32_u24 v1, 1152, v1
	s_mul_i32 s28, s4, 18
	s_add_u32 s28, s28, 2
	v_bfe_u32 v4, v0, 3, 1
	v_lshlrev_b32 v4, 1, v4
	v_bfe_u32 v2, v0, 1, 1
	v_add3_u32 v4, v4, v2, s28
	v_xor_b32 v4, v4, v3
	v_lshl_add_u32 v1, v4, 4, v1
	v_and_b32 v2, 1, v0
	v_lshl_add_u32 v1, v2, 3, v1
	v_add_u32 v1, 16384, v1
	ds_read_b64_tr_b16 v[8:9], v1 offset:0
	ds_read_b64_tr_b16 v[10:11], v1 offset:2304
	ds_read_b64_tr_b16 v[12:13], v1 offset:18432
	ds_read_b64_tr_b16 v[14:15], v1 offset:20736
	ds_read_b64_tr_b16 a[168:169], v1 offset:36864
	ds_read_b64_tr_b16 a[170:171], v1 offset:39168
	ds_read_b64_tr_b16 a[172:173], v1 offset:55296
	ds_read_b64_tr_b16 a[174:175], v1 offset:57600
	v_lshrrev_b32 v1, 4, v0
	v_and_b32 v2, 1, v1
	v_lshrrev_b32 v1, 1, v1
	v_lshlrev_b32 v3, 1, v1
	v_lshl_add_u32 v3, v2, 2, v3
	v_lshlrev_b32 v1, 3, v1
	v_lshl_add_u32 v1, v2, 2, v1
	v_bfe_u32 v4, v0, 2, 1
	v_add_u32 v1, v1, v4
	v_mul_u32_u24 v1, 1152, v1
	s_mul_i32 s28, s4, 18
	s_add_u32 s28, s28, 6
	v_bfe_u32 v4, v0, 3, 1
	v_lshlrev_b32 v4, 1, v4
	v_bfe_u32 v2, v0, 1, 1
	v_add3_u32 v4, v4, v2, s28
	v_xor_b32 v4, v4, v3
	v_lshl_add_u32 v1, v4, 4, v1
	v_and_b32 v2, 1, v0
	v_lshl_add_u32 v1, v2, 3, v1
	v_add_u32 v1, 16384, v1
	ds_read_b64_tr_b16 a[176:177], v1 offset:0
	ds_read_b64_tr_b16 a[178:179], v1 offset:2304
	ds_read_b64_tr_b16 a[180:181], v1 offset:18432
	ds_read_b64_tr_b16 a[182:183], v1 offset:20736
	ds_read_b64_tr_b16 v[16:17], v1 offset:36864
	ds_read_b64_tr_b16 v[18:19], v1 offset:39168
	ds_read_b64_tr_b16 v[20:21], v1 offset:55296
	ds_read_b64_tr_b16 v[22:23], v1 offset:57600
	v_lshrrev_b32 v1, 4, v0
	v_and_b32 v2, 1, v1
	v_lshrrev_b32 v1, 1, v1
	v_lshlrev_b32 v3, 1, v1
	v_lshl_add_u32 v3, v2, 2, v3
	v_lshlrev_b32 v1, 3, v1
	v_lshl_add_u32 v1, v2, 2, v1
	v_bfe_u32 v4, v0, 2, 1
	v_add_u32 v1, v1, v4
	v_mul_u32_u24 v1, 1152, v1
	s_mul_i32 s28, s4, 18
	s_add_u32 s28, s28, 10
	v_bfe_u32 v4, v0, 3, 1
	v_lshlrev_b32 v4, 1, v4
	v_bfe_u32 v2, v0, 1, 1
	v_add3_u32 v4, v4, v2, s28
	v_xor_b32 v4, v4, v3
	v_lshl_add_u32 v1, v4, 4, v1
	v_and_b32 v2, 1, v0
	v_lshl_add_u32 v1, v2, 3, v1
	v_add_u32 v1, 16384, v1
	ds_read_b64_tr_b16 a[232:233], v1 offset:0
	ds_read_b64_tr_b16 a[234:235], v1 offset:2304
	ds_read_b64_tr_b16 a[236:237], v1 offset:18432
	ds_read_b64_tr_b16 a[238:239], v1 offset:20736
	ds_read_b64_tr_b16 a[240:241], v1 offset:36864
	ds_read_b64_tr_b16 a[242:243], v1 offset:39168
	ds_read_b64_tr_b16 a[244:245], v1 offset:55296
	ds_read_b64_tr_b16 a[246:247], v1 offset:57600
	v_lshrrev_b32 v1, 4, v0
	v_and_b32 v2, 1, v1
	v_lshrrev_b32 v1, 1, v1
	v_lshlrev_b32 v3, 1, v1
	v_lshl_add_u32 v3, v2, 2, v3
	v_lshlrev_b32 v1, 3, v1
	v_lshl_add_u32 v1, v2, 2, v1
	v_bfe_u32 v4, v0, 2, 1
	v_add_u32 v1, v1, v4
	v_mul_u32_u24 v1, 1152, v1
	s_mul_i32 s28, s4, 18
	s_add_u32 s28, s28, 14
	v_bfe_u32 v4, v0, 3, 1
	v_lshlrev_b32 v4, 1, v4
	v_bfe_u32 v2, v0, 1, 1
	v_add3_u32 v4, v4, v2, s28
	v_xor_b32 v4, v4, v3
	v_lshl_add_u32 v1, v4, 4, v1
	v_and_b32 v2, 1, v0
	v_lshl_add_u32 v1, v2, 3, v1
	v_add_u32 v1, 16384, v1
	ds_read_b64_tr_b16 v[24:25], v1 offset:0
	ds_read_b64_tr_b16 v[26:27], v1 offset:2304
	ds_read_b64_tr_b16 v[28:29], v1 offset:18432
	ds_read_b64_tr_b16 v[30:31], v1 offset:20736
	ds_read_b64_tr_b16 a[248:249], v1 offset:36864
	ds_read_b64_tr_b16 a[250:251], v1 offset:39168
	ds_read_b64_tr_b16 a[252:253], v1 offset:55296
	ds_read_b64_tr_b16 a[254:255], v1 offset:57600
	s_waitcnt lgkmcnt(0)
	s_barrier
	s_mul_i32 s28, s4, 21792
	s_add_u32 s28, s28, 3328
	v_lshlrev_b32 v7, 4, v0
	v_add_u32 v7, s28, v7
	ds_write_b128 v7, v[32:35] offset:0
	ds_write_b128 v7, v[36:39] offset:1024
	ds_write_b128 v7, v[40:43] offset:2048
	ds_write_b128 v7, v[44:47] offset:3072
	ds_write_b128 v7, v[48:51] offset:4096
	ds_write_b128 v7, v[52:55] offset:5120
	ds_write_b128 v7, v[56:59] offset:6144
	ds_write_b128 v7, v[60:63] offset:7168
	ds_write_b128 v7, v[64:67] offset:8192
	ds_write_b128 v7, v[68:71] offset:9216
	ds_write_b128 v7, v[72:75] offset:10240
	ds_write_b128 v7, v[76:79] offset:11264
	ds_write_b128 v7, v[8:11] offset:12288
	ds_write_b128 v7, v[12:15] offset:13312
	ds_write_b128 v7, v[16:19] offset:14336
	ds_write_b128 v7, v[20:23] offset:15360
	ds_write_b128 v7, v[24:27] offset:16384
	ds_write_b128 v7, v[28:31] offset:17408
	s_waitcnt lgkmcnt(0)
	v_lshrrev_b32 v40, 4, v0
	v_and_b32 v41, 15, v0
	v_lshlrev_b32 v5, 4, v0
	s_mul_i32 s28, s4, 21792
	v_add_u32 v4, s28, v5
	s_mul_i32 s28, s4, 18432
	s_add_u32 s28, s28, 90112
	v_add_u32 v17, s28, v5
	v_mov_b32 v42, 0x44444444
	v_mov_b32 v43, 0xeeeeeeee
	v_cmp_gt_u32 vcc, 8, v41
	s_nop 1
	v_cndmask_b32 v1, v43, v42, vcc
	v_bfe_u32 v42, v41, 1, 2
	v_mul_u32_u24 v45, 21792, v42
	v_and_b32 v42, 1, v41
	v_mul_u32_u24 v42, 1152, v42
	v_add_u32 v45, v45, v42
	v_add_u32 v45, 1024, v45
	v_lshl_add_u32 v2, v40, 4, v45
	v_lshrrev_b32 v44, 3, v41
	v_lshl_add_u32 v44, v40, 1, v44
	v_lshl_add_u32 v3, v44, 4, v45
	s_lshl_b32 s28, s4, 6
	v_add_u32 v8, s28, v2
	v_and_b32 v44, 1, v40
	v_lshlrev_b32 v44, 5, v44
	v_add_u32 v44, v44, v41
	v_lshlrev_b32 v44, 4, v44
	s_lshl_b32 s28, s4, 2
	s_add_u32 s28, s28, 87168
	v_add_u32 v6, s28, v44
	v_and_b32 v44, 1, v40
	v_lshlrev_b32 v44, 2, v44
	v_lshrrev_b32 v43, 1, v40
	v_lshl_add_u32 v44, v43, 1, v44
	v_lshrrev_b32 v43, 3, v41
	v_add_u32 v44, v44, v43
	v_and_b32 v43, 7, v41
	v_lshl_add_u32 v44, v44, 3, v43
	v_lshlrev_b32 v44, 4, v44
	v_add_u32 v7, 87168, v44
	v_lshrrev_b32 v42, 2, v41
	v_lshlrev_b32 v42, 3, v42
	v_and_b32 v43, 3, v41
	v_add_u32 v42, v42, v43
	v_lshlrev_b32 v43, 4, v40
	v_lshl_add_u32 v9, v42, 13, v43
	v_lshl_add_u32 v10, v42, 6, v43
	v_lshlrev_b32 v43, 3, v40
	v_lshl_add_u32 v16, v42, 5, v43
	v_and_b32 v42, 7, v41
	v_lshlrev_b32 v43, 4, v40
	v_lshl_add_u32 v15, v42, 8, v43
	v_mov_b32 v43, 0x80000000
	v_cmp_gt_u32 vcc, 8, v41
	s_nop 1
	v_cndmask_b32 v15, v15, v43, vcc
	v_and_b32 v42, 1, v40
	v_lshlrev_b32 v42, 3, v42
	v_lshl_add_u32 v42, v41, 4, v42
	v_lshrrev_b32 v43, 1, v40
	v_lshl_add_u32 v12, v43, 31, v42
	v_lshl_add_u32 v11, v43, 8, v42
	v_add_u32 v11, 256, v11
	v_lshlrev_b32 v42, 2, v40
	v_sub_u32 v42, v41, v42
	v_mov_b32 v43, 0x3f80
	v_mov_b32 v44, 0x3f800000
	v_cmp_eq_u32 vcc, 0, v42
	s_nop 1
	v_cndmask_b32 v18, 0, v43, vcc
	v_cmp_eq_u32 vcc, 1, v42
	s_nop 1
	v_cndmask_b32 v18, v18, v44, vcc
	v_cmp_eq_u32 vcc, 2, v42
	s_nop 1
	v_cndmask_b32 v19, 0, v43, vcc
	v_cmp_eq_u32 vcc, 3, v42
	s_nop 1
	v_cndmask_b32 v19, v19, v44, vcc
	s_lshl_b32 s39, s3, 1
	s_add_u32 s39, s39, s4
	s_mov_b32 s40, 1
	s_cmp_lt_u32 s4, 2
	s_cbranch_scc1 main_kernel_role_done
	s_add_u32 s39, s3, 64
	s_cmp_eq_u32 s4, 2
	s_cselect_b32 s40, 1, 0
	s_cmp_lt_u32 s3, 8
	s_cselect_b32 s40, s40, 0
	s_cmp_eq_u32 s40, 0
	s_cselect_b32 s39, 0, s39
main_kernel_role_done:
	v_lshrrev_b32 v42, 3, v41
	v_lshl_add_u32 v42, v42, 4, v40
	v_mul_u32_u24 v42, 9216, v42
	v_and_b32 v43, 7, v41
	v_lshl_add_u32 v42, v43, 4, v42
	s_lshl_b32 s28, s39, 7
	v_add_u32 v13, s28, v42
	v_mul_u32_u24 v43, 1152, v43
	s_lshl_b32 s28, s39, 4
	v_add_u32 v42, s28, v43
	v_and_b32 v43, 1, v40
	v_lshl_add_u32 v42, v43, 3, v42
	v_lshrrev_b32 v43, 1, v40
	v_lshl_add_u32 v14, v43, 2, v42
	v_mov_b32 v43, 0x80000000
	v_cmp_lt_u32 vcc, 7, v41
	s_nop 1
	v_cndmask_b32 v14, v14, v43, vcc
	s_cmp_eq_u32 s40, 0
	s_cselect_b32 s28, 0x80000000, 0
	v_or_b32 v14, s28, v14
	v_or_b32 v13, s28, v13
	s_mov_b32 s5, 0
	s_mov_b32 s55, 0
	s_mov_b32 s20, 103809024
	s_mov_b32 s21, 103825408
	s_mov_b32 s22, 103841792
	s_mul_i32 s42, s4, 0xffffb3e0
	s_mul_i32 s23, s3, 9216
	s_mul_i32 s28, s4, 2304
	s_add_u32 s23, s23, s28
	s_add_u32 s23, s23, 102760448
	s_mov_b32 s52, 102760448
	s_mov_b32 s54, 294912
	s_lshl_b32 s24, s3, 8
	s_lshl_b32 s28, s4, 6
	s_add_u32 s24, s24, s28
	s_add_u32 s24, s24, 20971520
	s_lshl_b32 s25, s3, 13
	s_lshl_b32 s28, s4, 11
	s_add_u32 s25, s25, s28
	s_add_u32 s25, s25, 37748736
	s_lshl_b32 s26, s3, 11
	s_lshl_b32 s28, s4, 6
	s_add_u32 s26, s26, s28
	s_add_u32 s26, s26, 90177536
	s_lshl_b32 s27, s3, 12
	s_lshl_b32 s28, s4, 10
	s_add_u32 s27, s27, s28
	s_add_u32 s27, s27, 94371840
	s_load_dwordx2 s[12:13], s[0:1], 8
	s_mov_b32 s14, 9216
	s_mul_i32 s29, s4, 2304
	v_add_u32 v44, s29, v5
	v_lshrrev_b32 v45, 2, v5
	v_add_u32 v45, s29, v45
	v_mov_b32 v43, 0
	s_waitcnt lgkmcnt(0)
	buffer_load_dwordx4 v[56:59], v44, s[12:15], 0 offen
	buffer_load_dwordx4 v[60:63], v44, s[12:15], 0 offen offset:1024
	buffer_load_dword v64, v45, s[12:15], 0 offen offset:2048
	buffer_load_dwordx2 v[54:55], v43, s[44:47], 0 offen sc1
	s_mov_b32 s85, 0
	s_mov_b32 s86, 0
	s_cmp_lt_u32 s86, s85
	s_cbranch_scc1 main_kernel_kvok_5
main_kernel_kvp_6:
	v_lshrrev_b32 v42, 2, v5
	buffer_load_dword v42, v42, s[44:47], 0 offen offset:16 sc1
	s_waitcnt vmcnt(0)
	v_cmp_le_u32 vcc, 128, v42
	s_nop 0
	s_and_b32 s85, vcc_lo, 0xff
	s_not_b32 s85, s85
	s_ff1_i32_b32 s85, s85
	s_sub_u32 s6, s6, 1
	s_cbranch_scc1 main_kernel_exit
	s_cmp_lt_u32 s86, s85
	s_cbranch_scc1 main_kernel_kvok_5
	s_sleep 8
	s_branch main_kernel_kvp_6
main_kernel_kvok_5:
	s_add_u32 s28, s24, 32768
	buffer_load_dwordx4 v[20:23], v9, s[8:11], s24 offen sc1
	buffer_load_dwordx4 v[24:27], v9, s[8:11], s28 offen sc1
	s_add_u32 s24, s24, 262144
	v_lshrrev_b32 v44, 2, v5
	v_sub_u32 v45, v4, v5
	v_add_u32 v45, v45, v44
	s_waitcnt vmcnt(5)
	ds_write_b128 v4, v[56:59] offset:1024
	s_waitcnt vmcnt(4)
	ds_write_b128 v4, v[60:63] offset:2048
	s_waitcnt vmcnt(3)
	ds_write_b32 v45, v64 offset:3072
	s_waitcnt vmcnt(2)
	v_mov_b32 v42, v54
	s_branch main_kernel_xcc_chk
main_kernel_xcc_poll:
	v_mov_b32 v42, 0
	buffer_load_dwordx2 v[54:55], v42, s[44:47], 0 offen sc1
	s_waitcnt vmcnt(0) lgkmcnt(0)
main_kernel_xcc_chk:
	v_readfirstlane_b32 s28, v55
	v_readfirstlane_b32 s29, v54
	s_sub_u32 s6, s6, 1
	s_cmp_eq_u32 s6, 0
	s_cbranch_scc1 main_kernel_exit
	s_cmp_lt_u32 s28, 32
	s_cbranch_scc1 main_kernel_xcc_poll
	s_bcnt1_i32_b32 s29, s29
	s_cmp_eq_u32 s29, 1
	s_cbranch_scc0 main_kernel_slow_pre
main_kernel_fast_pre:
	s_lshl_b32 s87, s3, 7
	s_add_u32 s87, s87, 111149056
	s_add_u32 s28, s20, s42
	buffer_load_dword v0, v4, s[8:11], s28 offen offset:0 sc1
	buffer_load_dword v0, v4, s[8:11], s28 offen offset:1024 sc1
	buffer_load_dword v0, v4, s[8:11], s28 offen offset:2048 sc1
	s_add_u32 s28, s21, s42
	buffer_load_dword v0, v4, s[8:11], s28 offen offset:0 sc1
	buffer_load_dword v0, v4, s[8:11], s28 offen offset:1024 sc1
	buffer_load_dword v0, v4, s[8:11], s28 offen offset:2048 sc1
	s_add_u32 s28, s22, s42
	buffer_load_dword v0, v4, s[8:11], s28 offen offset:0 sc1
	buffer_load_dword v0, v4, s[8:11], s28 offen offset:1024 sc1
	buffer_load_dword v0, v4, s[8:11], s28 offen offset:2048 sc1
	s_cmp_eq_u32 s40, 0
	s_cbranch_scc1 main_kernel_fast_pt_7
	s_add_u32 s28, s52, 0
	buffer_load_dword v0, v13, s[8:11], s28 offen sc1
	s_add_u32 s28, s52, 36864
	buffer_load_dword v0, v13, s[8:11], s28 offen sc1
	s_add_u32 s28, s52, 73728
	buffer_load_dword v0, v13, s[8:11], s28 offen sc1
	s_add_u32 s28, s52, 110592
	buffer_load_dword v0, v13, s[8:11], s28 offen sc1
	s_add_u32 s28, s52, 0
	s_add_u32 s28, s28, s54
	buffer_load_dword v0, v13, s[8:11], s28 offen sc1
	s_add_u32 s28, s52, 36864
	s_add_u32 s28, s28, s54
	buffer_load_dword v0, v13, s[8:11], s28 offen sc1
	s_add_u32 s28, s52, 73728
	s_add_u32 s28, s28, s54
	buffer_load_dword v0, v13, s[8:11], s28 offen sc1
	s_add_u32 s28, s52, 110592
	s_add_u32 s28, s28, s54
	buffer_load_dword v0, v13, s[8:11], s28 offen sc1
main_kernel_fast_pt_7:
	buffer_load_dword v0, v10, s[8:11], s25 offen
	buffer_load_dword v0, v10, s[8:11], s25 offen offset:256
	s_add_u32 s86, s5, 1
	s_lshr_b32 s86, s86, 3
	s_min_u32 s86, s86, 7
	s_cmp_lt_u32 s86, s85
	s_cbranch_scc1 main_kernel_kvok_8
main_kernel_kvp_9:
	v_lshrrev_b32 v0, 2, v5
	buffer_load_dword v0, v0, s[44:47], 0 offen offset:16 sc1
	s_waitcnt vmcnt(0)
	v_cmp_le_u32 vcc, 128, v0
	s_nop 0
	s_and_b32 s85, vcc_lo, 0xff
	s_not_b32 s85, s85
	s_ff1_i32_b32 s85, s85
	s_sub_u32 s6, s6, 1
	s_cbranch_scc1 main_kernel_exit
	s_cmp_lt_u32 s86, s85
	s_cbranch_scc1 main_kernel_kvok_8
	s_sleep 8
	s_branch main_kernel_kvp_9
main_kernel_kvok_8:
	ds_read_b128 v[28:31], v17 offset:12288
	ds_read_b128 v[32:35], v17 offset:13312
	ds_read_b128 v[36:39], v17 offset:14336
	ds_read_b128 v[40:43], v17 offset:15360
	ds_read_b128 v[44:47], v17 offset:16384
	ds_read_b128 v[48:51], v17 offset:17408
	v_mov_b64 v[52:53], 0
	v_mov_b64 v[54:55], 0
	v_mov_b64 v[56:57], 0
	v_mov_b64 v[58:59], 0
	s_cmp_eq_u32 s4, 3
	s_cselect_b32 s31, 0, 0x80000000
	s_cselect_b32 s30, 0, 0x80000000
	s_cmp_ge_u32 s5, 63
	s_cselect_b32 s31, 0x80000000, s31
	v_lshrrev_b32 v79, 5, v5
	v_lshlrev_b32 v79, 13, v79
	v_and_b32 v78, 16, v5
	v_lshl_add_u32 v79, v78, 3, v79
	v_lshlrev_b32 v78, 3, v5
	v_or_b32 v79, s31, v79
	v_or_b32 v78, s31, v78
	s_add_u32 s28, s24, 0xffffff40
	s_add_u32 s29, s25, 0x3e800
	s_cmp_eq_u32 s5, 0
	s_cselect_b32 s30, 0x80000000, s30
	v_mov_b32 v77, s5
	v_mov_b32 v76, 0x80000000
	v_mov_b32 v75, s30
	v_cmp_eq_u32 vcc, 0, v5
	s_nop 1
	v_cndmask_b32 v76, v76, v75, vcc
	s_branch main_kernel_fast_mem_ready
main_kernel_fast_top:
	s_add_u32 s86, s5, 1
	s_lshr_b32 s86, s86, 3
	s_min_u32 s86, s86, 7
	s_cmp_lt_u32 s86, s85
	s_cbranch_scc1 main_kernel_kvok_10
main_kernel_kvp_11:
	v_lshrrev_b32 v0, 2, v5
	buffer_load_dword v0, v0, s[44:47], 0 offen offset:16 sc1
	s_waitcnt vmcnt(0)
	v_cmp_le_u32 vcc, 128, v0
	s_nop 0
	s_and_b32 s85, vcc_lo, 0xff
	s_not_b32 s85, s85
	s_ff1_i32_b32 s85, s85
	s_sub_u32 s6, s6, 1
	s_cbranch_scc1 main_kernel_exit
	s_cmp_lt_u32 s86, s85
	s_cbranch_scc1 main_kernel_kvok_10
	s_sleep 8
	s_branch main_kernel_kvp_11
main_kernel_kvok_10:
	v_lshrrev_b32 v74, 2, v5
	v_sub_u32 v73, v4, v5
	v_add_u32 v73, v73, v74
	s_add_u32 s43, s20, s42
	s_sleep 2
	buffer_load_dwordx4 v[60:63], v4, s[8:11], s43 offen sc1
	buffer_load_dwordx4 v[64:67], v4, s[8:11], s43 offen offset:1024 sc1
	buffer_load_dword v68, v73, s[8:11], s43 offen offset:2048 sc1
	ds_read_b128 v[28:31], v17 offset:12288
	ds_read_b128 v[32:35], v17 offset:13312
	ds_read_b128 v[36:39], v17 offset:14336
	ds_read_b128 v[40:43], v17 offset:15360
	ds_read_b128 v[44:47], v17 offset:16384
	ds_read_b128 v[48:51], v17 offset:17408
	v_mov_b64 v[52:53], 0
	v_mov_b64 v[54:55], 0
	v_mov_b64 v[56:57], 0
	v_mov_b64 v[58:59], 0
	s_cmp_eq_u32 s4, 3
	s_cselect_b32 s31, 0, 0x80000000
	s_cselect_b32 s30, 0, 0x80000000
	s_cmp_ge_u32 s5, 63
	s_cselect_b32 s31, 0x80000000, s31
	v_lshrrev_b32 v79, 5, v5
	v_lshlrev_b32 v79, 13, v79
	v_and_b32 v78, 16, v5
	v_lshl_add_u32 v79, v78, 3, v79
	v_lshlrev_b32 v78, 3, v5
	v_or_b32 v79, s31, v79
	v_or_b32 v78, s31, v78
	s_add_u32 s28, s24, 0xffffff40
	s_add_u32 s29, s25, 0x3e800
	s_cmp_eq_u32 s5, 0
	s_cselect_b32 s30, 0x80000000, s30
	v_mov_b32 v77, s5
	v_mov_b32 v76, 0x80000000
	v_mov_b32 v75, s30
	v_cmp_eq_u32 vcc, 0, v5
	s_nop 1
	v_cndmask_b32 v76, v76, v75, vcc
main_kernel_fast_mchk:
	s_sub_u32 s6, s6, 1
	s_cbranch_scc1 main_kernel_exit
	s_waitcnt vmcnt(2)
	v_max3_u32 v75, v60, v61, v62
	s_waitcnt vmcnt(1)
	v_max3_u32 v74, v64, v65, v66
	v_max_u32 v75, v75, v63
	v_max_u32 v74, v74, v67
	s_waitcnt vmcnt(0)
	v_max3_u32 v72, v75, v74, v68
	v_cmp_eq_u32 vcc, -1, v72
	s_nop 0
	s_cbranch_vccz main_kernel_fast_mok
	v_cmp_eq_u32 s[76:77], -1, v75
	v_cmp_eq_u32 s[78:79], -1, v74
	v_cmp_eq_u32 s[80:81], -1, v68
	s_mov_b64 exec, s[76:77]
	buffer_load_dwordx4 v[60:63], v4, s[8:11], s43 offen sc1
	s_mov_b64 exec, s[78:79]
	buffer_load_dwordx4 v[64:67], v4, s[8:11], s43 offen offset:1024 sc1
	s_mov_b64 exec, s[80:81]
	buffer_load_dword v68, v73, s[8:11], s43 offen offset:2048 sc1
	s_mov_b64 exec, -1
	s_branch main_kernel_fast_mchk
main_kernel_fast_mok:
	ds_write_b128 v4, v[60:63] offset:1024
	ds_write_b128 v4, v[64:67] offset:2048
	ds_write_b32 v73, v68 offset:3072
main_kernel_fast_mem_ready:
	s_waitcnt lgkmcnt(0)
	s_barrier
	ds_read_b128 v[60:63], v2 offset:0
	ds_read_b128 v[64:67], v2 offset:64
	ds_read_b128 v[68:71], v2 offset:128
	ds_read_b128 v[72:75], v2 offset:192
	buffer_load_dword v0, v79, s[8:11], s28 offen
	buffer_load_dword v0, v78, s[8:11], s29 offen
	buffer_store_dword v77, v76, s[8:11], s87 offen sc1
	ds_read_b128 v[76:79], v2 offset:256
	s_waitcnt lgkmcnt(4)
	v_smfmac_f32_16x16x64_bf16 v[52:55], v[60:63], v[80:87], v1
	v_smfmac_f32_16x16x64_bf16 v[56:59], v[60:63], v[28:35], v1
	ds_read_b128 v[28:31], v4 offset:3328
	ds_read_b128 v[32:35], v4 offset:4352
	ds_read_b128 v[60:63], v2 offset:320
	s_waitcnt lgkmcnt(6)
	v_smfmac_f32_16x16x64_bf16 v[52:55], v[64:67], v[88:95], v1
	v_smfmac_f32_16x16x64_bf16 v[56:59], v[64:67], v[36:43], v1
	ds_read_b128 v[36:39], v4 offset:5376
	ds_read_b128 v[40:43], v4 offset:6400
	ds_read_b128 v[64:67], v2 offset:384
	s_waitcnt lgkmcnt(8)
	v_smfmac_f32_16x16x64_bf16 v[52:55], v[68:71], v[96:103], v1
	v_smfmac_f32_16x16x64_bf16 v[56:59], v[68:71], v[44:51], v1
	ds_read_b128 v[44:47], v4 offset:7424
	ds_read_b128 v[48:51], v4 offset:8448
	ds_read_b128 v[68:71], v2 offset:448
	s_waitcnt lgkmcnt(10)
	v_smfmac_f32_16x16x64_bf16 v[52:55], v[72:75], v[104:111], v1
	v_smfmac_f32_16x16x64_bf16 v[56:59], v[72:75], v[112:119], v1
	ds_read_b128 v[72:75], v2 offset:512
	s_waitcnt lgkmcnt(10)
	v_smfmac_f32_16x16x64_bf16 v[52:55], v[76:79], v[120:127], v1
	v_smfmac_f32_16x16x64_bf16 v[56:59], v[76:79], v[128:135], v1
	ds_read_b128 v[76:79], v2 offset:576
	s_waitcnt lgkmcnt(8)
	v_smfmac_f32_16x16x64_bf16 v[52:55], v[60:63], v[136:143], v1
	v_smfmac_f32_16x16x64_bf16 v[56:59], v[60:63], v[28:35], v1
	ds_read_b128 v[28:31], v4 offset:9472
	ds_read_b128 v[32:35], v4 offset:10496
	ds_read_b128 v[60:63], v2 offset:640
	s_waitcnt lgkmcnt(8)
	v_smfmac_f32_16x16x64_bf16 v[52:55], v[64:67], v[144:151], v1
	v_smfmac_f32_16x16x64_bf16 v[56:59], v[64:67], v[152:159], v1
	ds_read_b128 v[64:67], v2 offset:704
	s_waitcnt lgkmcnt(6)
	v_smfmac_f32_16x16x64_bf16 v[52:55], v[68:71], v[160:167], v1
	v_smfmac_f32_16x16x64_bf16 v[56:59], v[68:71], v[36:43], v1
	ds_read_b128 v[36:39], v4 offset:11520
	ds_read_b128 v[40:43], v4 offset:12544
	ds_read_b128 v[68:71], v2 offset:768
	s_waitcnt lgkmcnt(8)
	v_smfmac_f32_16x16x64_bf16 v[52:55], v[72:75], v[168:175], v1
	v_smfmac_f32_16x16x64_bf16 v[56:59], v[72:75], v[176:183], v1
	ds_read_b128 v[72:75], v2 offset:832
	s_waitcnt lgkmcnt(8)
	v_smfmac_f32_16x16x64_bf16 v[52:55], v[76:79], v[184:191], v1
	v_smfmac_f32_16x16x64_bf16 v[56:59], v[76:79], v[44:51], v1
	ds_read_b128 v[44:47], v4 offset:13568
	ds_read_b128 v[48:51], v4 offset:14592
	ds_read_b128 v[76:79], v2 offset:896
	s_waitcnt lgkmcnt(8)
	v_smfmac_f32_16x16x64_bf16 v[52:55], v[60:63], v[192:199], v1
	v_smfmac_f32_16x16x64_bf16 v[56:59], v[60:63], v[200:207], v1
	ds_read_b128 v[60:63], v2 offset:960
	s_waitcnt lgkmcnt(8)
	v_smfmac_f32_16x16x64_bf16 v[52:55], v[64:67], v[208:215], v1
	v_smfmac_f32_16x16x64_bf16 v[56:59], v[64:67], v[28:35], v1
	ds_read_b128 v[28:31], v2 offset:1024
	s_waitcnt lgkmcnt(6)
	v_smfmac_f32_16x16x64_bf16 v[52:55], v[68:71], v[216:223], v1
	v_smfmac_f32_16x16x64_bf16 v[56:59], v[68:71], v[224:231], v1
	ds_read_b128 v[32:35], v2 offset:1088
	s_waitcnt lgkmcnt(6)
	v_smfmac_f32_16x16x64_bf16 v[52:55], v[72:75], v[232:239], v1
	v_smfmac_f32_16x16x64_bf16 v[56:59], v[72:75], v[36:43], v1
	ds_read_b128 v[36:39], v3 offset:0
	v_mov_b64 v[40:41], 0
	v_mov_b64 v[42:43], 0
	s_waitcnt lgkmcnt(4)
	v_smfmac_f32_16x16x64_bf16 v[52:55], v[76:79], v[240:247], v1
	v_smfmac_f32_16x16x64_bf16 v[56:59], v[76:79], v[248:255], v1
	ds_read_b128 v[64:67], v3 offset:128
	v_mov_b64 v[68:69], 0
	v_mov_b64 v[70:71], 0
	s_waitcnt lgkmcnt(4)
	v_smfmac_f32_16x16x64_bf16 v[52:55], v[60:63], a[0:7], v1
	v_smfmac_f32_16x16x64_bf16 v[56:59], v[60:63], v[44:51], v1
	ds_read_b128 v[44:47], v3 offset:256
	s_waitcnt lgkmcnt(4)
	v_smfmac_f32_16x16x64_bf16 v[52:55], v[28:31], a[8:15], v1
	v_smfmac_f32_16x16x64_bf16 v[56:59], v[28:31], a[16:23], v1
	ds_read_b128 v[72:75], v17 offset:0
	ds_read_b128 v[76:79], v17 offset:1024
	s_waitcnt lgkmcnt(5)
	v_smfmac_f32_16x16x64_bf16 v[52:55], v[32:35], a[24:31], v1
	v_smfmac_f32_16x16x64_bf16 v[56:59], v[32:35], a[32:39], v1
	s_waitcnt lgkmcnt(4)
	v_smfmac_f32_16x16x64_bf16 v[40:43], v[36:39], a[40:47], v1
	v_smfmac_f32_16x16x64_bf16 v[68:71], v[36:39], a[48:55], v1
	ds_read_b128 v[28:31], v3 offset:384
	s_nop 2
	v_cvt_pk_bf16_f32 v32, v52, v53
	v_cvt_pk_bf16_f32 v33, v54, v55
	v_cvt_pk_bf16_f32 v34, v56, v57
	v_cvt_pk_bf16_f32 v35, v58, v59
	v_mfma_f32_16x16x16_bf16 v[36:39], v[32:33], v[18:19], 0
	s_nop 0
	v_mfma_f32_16x16x16_bf16 v[48:51], v[34:35], v[18:19], 0
	s_waitcnt lgkmcnt(4)
	v_smfmac_f32_16x16x64_bf16 v[40:43], v[64:67], a[56:63], v1
	s_waitcnt lgkmcnt(1)
	v_smfmac_f32_16x16x64_bf16 v[68:71], v[64:67], v[72:79], v1
	ds_read_b128 v[52:55], v17 offset:2048
	ds_read_b128 v[56:59], v17 offset:3072
	ds_read_b128 v[32:35], v3 offset:512
	v_cvt_pk_bf16_f32 v60, v36, v37
	v_cvt_pk_bf16_f32 v61, v38, v39
	v_cvt_pk_bf16_f32 v62, v48, v49
	v_cvt_pk_bf16_f32 v63, v50, v51
	s_waitcnt vmcnt(15)
	s_nop 0
	v_mfma_f32_16x16x32_bf16 v[36:39], v[20:23], v[60:63], 0
	s_waitcnt vmcnt(14)
	v_mfma_f32_16x16x32_bf16 v[48:51], v[24:27], v[60:63], 0
	v_mfma_f32_16x16x32_bf16 v[64:67], v[60:63], v[60:63], 0
	buffer_load_dwordx4 v[20:23], v10, s[8:11], s25 offen sc1
	buffer_load_dwordx4 v[24:27], v10, s[8:11], s25 offen offset:256 sc1
	s_add_u32 s25, s25, 262144
	v_smfmac_f32_16x16x64_bf16 v[40:43], v[44:47], a[64:71], v1
	v_smfmac_f32_16x16x64_bf16 v[68:71], v[44:47], a[72:79], v1
	ds_read_b128 v[44:47], v3 offset:640
	s_mov_b64 exec, s[32:33]
	ds_write_b128 v4, v[36:39]
	ds_write_b128 v4, v[48:51] offset:128
	s_mov_b64 exec, s[36:37]
	ds_write2_b32 v6, v64, v65 offset0:0 offset1:32
	ds_write2_b32 v6, v66, v67 offset0:64 offset1:96
	s_mov_b64 exec, -1
	buffer_store_dwordx4 v[60:63], v15, s[8:11], s26 offen sc1
	s_add_u32 s26, s26, 65536
	s_waitcnt lgkmcnt(8)
	v_smfmac_f32_16x16x64_bf16 v[40:43], v[28:31], a[80:87], v1
	v_smfmac_f32_16x16x64_bf16 v[68:71], v[28:31], a[88:95], v1
	ds_read_b128 v[28:31], v3 offset:768
	s_waitcnt lgkmcnt(6)
	v_smfmac_f32_16x16x64_bf16 v[40:43], v[32:35], a[96:103], v1
	v_smfmac_f32_16x16x64_bf16 v[68:71], v[32:35], a[104:111], v1
	ds_read_b128 v[32:35], v3 offset:896
	s_waitcnt lgkmcnt(0)
	s_barrier
	ds_read_b128 v[36:39], v5 offset:0
	ds_read_b128 v[48:51], v5 offset:21792
	ds_read_b128 v[60:63], v5 offset:43584
	ds_read_b128 v[64:67], v5 offset:65376
	ds_read_b128 v[72:75], v7
	v_smfmac_f32_16x16x64_bf16 v[40:43], v[44:47], a[112:119], v1
	v_smfmac_f32_16x16x64_bf16 v[68:71], v[44:47], v[52:59], v1
	ds_read_b128 v[52:55], v17 offset:4096
	ds_read_b128 v[56:59], v17 offset:5120
	ds_read_b128 v[44:47], v3 offset:1024
	v_smfmac_f32_16x16x64_bf16 v[40:43], v[28:31], a[120:127], v1
	v_smfmac_f32_16x16x64_bf16 v[68:71], v[28:31], a[128:135], v1
	v_smfmac_f32_16x16x64_bf16 v[40:43], v[32:35], a[136:143], v1
	v_smfmac_f32_16x16x64_bf16 v[68:71], v[32:35], a[144:151], v1
	s_waitcnt lgkmcnt(0)
	v_smfmac_f32_16x16x64_bf16 v[40:43], v[44:47], a[152:159], v1
	v_smfmac_f32_16x16x64_bf16 v[68:71], v[44:47], v[52:59], v1
	v_add_f32 v36, v36, v48
	v_add_f32 v37, v37, v49
	v_add_f32 v38, v38, v50
	v_add_f32 v39, v39, v51
	v_add_f32 v60, v60, v64
	v_add_f32 v61, v61, v65
	v_add_f32 v62, v62, v66
	v_add_f32 v63, v63, v67
	v_add_f32 v79, v72, v73
	v_add_f32 v74, v74, v75
	v_add_f32 v36, v36, v60
	v_add_f32 v37, v37, v61
	v_add_f32 v38, v38, v62
	v_add_f32 v39, v39, v63
	v_add_f32 v79, v79, v74
	v_max3_f32 v78, v36, v37, v38
	v_max3_f32 v78, v78, v39, v79
	v_cvt_pk_bf16_f32 v28, v40, v41
	v_cvt_pk_bf16_f32 v29, v42, v43
	v_max_f32_dpp v78, v78, v78 row_ror:8 row_mask:0xf bank_mask:0xf
	v_mov_b32 v77, v78
	v_cvt_pk_bf16_f32 v30, v68, v69
	v_cvt_pk_bf16_f32 v31, v70, v71
	v_permlane16_swap_b32 v78, v77
	v_max_f32 v78, v78, v77
	v_mov_b32 v77, v78
	buffer_store_dwordx2 v[28:29], v16, s[8:11], s27 offen sc1
	buffer_store_dwordx2 v[30:31], v16, s[8:11], s27 offen offset:128 sc1
	v_permlane32_swap_b32 v78, v77
	v_max_f32 v78, v78, v77
	v_mul_f32 v78, s38, v78
	v_fma_f32 v79, v79, s38, -v78
	v_fma_f32 v36, v36, s38, -v78
	v_fma_f32 v37, v37, s38, -v78
	v_fma_f32 v38, v38, s38, -v78
	v_fma_f32 v39, v39, s38, -v78
	v_exp_f32 v79, v79
	v_exp_f32 v36, v36
	v_exp_f32 v37, v37
	v_mov_b32_dpp v78, v79 row_ror:8 row_mask:0xf bank_mask:0xf
	v_exp_f32 v38, v38
	v_exp_f32 v39, v39
	v_cvt_pk_bf16_f32 v76, v79, v78
	v_cvt_pk_bf16_f32 v32, v36, v37
	v_add_f32 v78, v36, v37
	v_mov_b32 v77, v76
	v_cvt_pk_bf16_f32 v33, v38, v39
	v_add_f32 v75, v38, v39
	v_permlane32_swap_b32 v76, v77
	v_mov_b32_dpp v34, v32 row_ror:8 row_mask:0xf bank_mask:0xf
	v_mov_b32_dpp v35, v33 row_ror:8 row_mask:0xf bank_mask:0xf
	v_add_f32 v78, v78, v79
	v_add_f32 v78, v78, v75
	s_waitcnt vmcnt(4)
	v_mfma_f32_16x16x32_bf16 v[36:39], v[20:23], v[32:35], 0
	s_waitcnt vmcnt(3)
	v_mfma_f32_16x16x32_bf16 v[40:43], v[24:27], v[32:35], 0
	v_add_f32_dpp v78, v78, v78 row_ror:8 row_mask:0xf bank_mask:0xf
	v_mov_b32 v75, v78
	ds_read_b128 v[44:47], v4 offset:15616
	ds_read_b128 v[48:51], v4 offset:16640
	v_permlane16_swap_b32 v78, v75
	v_mfma_f32_16x16x16_bf16 v[36:39], v[28:29], v[76:77], v[36:39]
	v_mfma_f32_16x16x16_bf16 v[40:43], v[30:31], v[76:77], v[40:43]
	v_add_f32 v78, v78, v75
	v_mov_b32 v75, v78
	ds_read_b128 v[28:31], v4 offset:17664
	ds_read_b128 v[32:35], v4 offset:18688
	v_permlane32_swap_b32 v78, v75
	v_add_f32 v78, v78, v75
	v_rcp_f32 v78, v78
	s_add_u32 s27, s27, 131072
	s_cmp_eq_u32 s5, 63
	s_cbranch_scc1 main_kernel_fast_fin
	v_mul_f32 v36, v36, v78
	v_mul_f32 v37, v37, v78
	v_mul_f32 v38, v38, v78
	v_mul_f32 v39, v39, v78
	v_mul_f32 v40, v40, v78
	v_mul_f32 v41, v41, v78
	v_mul_f32 v42, v42, v78
	v_mul_f32 v43, v43, v78
	v_cvt_pk_bf16_f32 v52, v36, v37
	v_cvt_pk_bf16_f32 v53, v38, v39
	v_cvt_pk_bf16_f32 v54, v40, v41
	v_cvt_pk_bf16_f32 v55, v42, v43
	s_mov_b64 exec, s[32:33]
	ds_write_b128 v8, v[52:55]
	s_mov_b64 exec, -1
	s_add_u32 s28, s24, 32768
	buffer_load_dwordx4 v[20:23], v9, s[8:11], s24 offen sc1
	buffer_load_dwordx4 v[24:27], v9, s[8:11], s28 offen sc1
	s_add_u32 s24, s24, 262144
	v_mov_b64 v[36:37], 0
	v_mov_b64 v[38:39], 0
	v_mov_b64 v[40:41], 0
	v_mov_b64 v[42:43], 0
	v_mov_b64 v[52:53], 0
	v_mov_b64 v[54:55], 0
	s_waitcnt lgkmcnt(0)
	s_barrier
	ds_read_b128 v[56:59], v3 offset:0
	ds_read_b128 v[60:63], v2 offset:0
	ds_read_b128 v[64:67], v3 offset:128
	ds_read_b128 v[68:71], v2 offset:64
	ds_read_b128 v[72:75], v2 offset:128
	ds_read_b128 v[76:79], v2 offset:192
	s_waitcnt lgkmcnt(5)
	v_smfmac_f32_16x16x64_bf16 v[36:39], v[56:59], a[160:167], v1
	s_waitcnt lgkmcnt(4)
	v_smfmac_f32_16x16x64_bf16 v[40:43], v[60:63], v[44:51], v1
	ds_read_b128 v[44:47], v17 offset:6144
	ds_read_b128 v[48:51], v17 offset:7168
	s_waitcnt lgkmcnt(5)
	v_smfmac_f32_16x16x64_bf16 v[36:39], v[64:67], a[184:191], v1
	v_smfmac_f32_16x16x64_bf16 v[52:55], v[60:63], a[176:183], v1
	v_mov_b64 v[56:57], 0
	v_mov_b64 v[58:59], 0
	s_waitcnt lgkmcnt(4)
	v_smfmac_f32_16x16x64_bf16 v[40:43], v[68:71], a[168:175], v1
	v_smfmac_f32_16x16x64_bf16 v[52:55], v[68:71], v[28:35], v1
	ds_read_b128 v[28:31], v4 offset:19712
	ds_read_b128 v[32:35], v4 offset:20736
	v_mov_b64 v[64:65], 0
	v_mov_b64 v[66:67], 0
	s_waitcnt lgkmcnt(5)
	v_smfmac_f32_16x16x64_bf16 v[40:43], v[72:75], a[192:199], v1
	v_permlane32_swap_b32 v36, v38
	v_permlane32_swap_b32 v37, v39
	v_smfmac_f32_16x16x64_bf16 v[52:55], v[72:75], a[200:207], v1
	v_add_f32 v36, v36, v38
	v_add_f32 v37, v37, v39
	s_waitcnt lgkmcnt(2)
	v_smfmac_f32_16x16x64_bf16 v[40:43], v[76:79], v[44:51], v1
	ds_read_b128 v[44:47], v17 offset:8192
	ds_read_b128 v[48:51], v17 offset:9216
	v_cvt_pk_bf16_f32 v36, v36, v37
	v_mov_b32 v37, v36
	v_smfmac_f32_16x16x64_bf16 v[52:55], v[76:79], a[208:215], v1
	v_smfmac_f32_16x16x64_bf16 v[56:59], v[60:63], a[232:239], v1
	v_permlane32_swap_b32 v36, v37
	v_bfi_b32 v37, 1, s55, v37
	buffer_store_dwordx2 v[36:37], v12, s[8:11], s23 offen
	s_waitcnt lgkmcnt(2)
	v_smfmac_f32_16x16x64_bf16 v[64:67], v[60:63], v[28:35], v1
	ds_read_b128 v[28:31], v17 offset:10240
	ds_read_b128 v[32:35], v17 offset:11264
	v_smfmac_f32_16x16x64_bf16 v[56:59], v[68:71], a[240:247], v1
	v_smfmac_f32_16x16x64_bf16 v[64:67], v[68:71], a[248:255], v1
	v_cvt_pk_bf16_f32 v40, v40, v41
	v_cvt_pk_bf16_f32 v41, v42, v43
	v_bfi_b32 v41, 1, s55, v41
	buffer_store_dwordx2 v[40:41], v11, s[8:11], s23 offen offset:0
	s_waitcnt lgkmcnt(2)
	v_smfmac_f32_16x16x64_bf16 v[56:59], v[72:75], v[44:51], v1
	v_smfmac_f32_16x16x64_bf16 v[64:67], v[72:75], a[224:231], v1
	v_cvt_pk_bf16_f32 v52, v52, v53
	v_cvt_pk_bf16_f32 v53, v54, v55
	v_bfi_b32 v53, 1, s55, v53
	buffer_store_dwordx2 v[52:53], v11, s[8:11], s23 offen offset:512
	v_smfmac_f32_16x16x64_bf16 v[56:59], v[76:79], a[216:223], v1
	s_waitcnt lgkmcnt(0)
	v_smfmac_f32_16x16x64_bf16 v[64:67], v[76:79], v[28:35], v1
	s_nop 5
	v_cvt_pk_bf16_f32 v56, v56, v57
	v_cvt_pk_bf16_f32 v57, v58, v59
	v_bfi_b32 v57, 1, s55, v57
	buffer_store_dwordx2 v[56:57], v11, s[8:11], s23 offen offset:1024
	v_cvt_pk_bf16_f32 v64, v64, v65
	v_cvt_pk_bf16_f32 v65, v66, v67
	v_bfi_b32 v65, 1, s55, v65
	buffer_store_dwordx2 v[64:65], v11, s[8:11], s23 offen offset:1536
	s_cmp_eq_u32 s40, 0
	s_cbranch_scc1 main_kernel_fast_nored
	s_add_u32 s28, s52, 36864
	s_add_u32 s29, s52, 73728
	s_add_u32 s30, s52, 110592
	s_sleep 5
	buffer_load_dwordx4 v[28:31], v13, s[8:11], s52 offen sc1
	buffer_load_dwordx4 v[32:35], v13, s[8:11], s28 offen sc1
	buffer_load_dwordx4 v[36:39], v13, s[8:11], s29 offen sc1
	buffer_load_dwordx4 v[40:43], v13, s[8:11], s30 offen sc1
	v_bfe_u32 v79, v5, 4, 1
	v_bfe_u32 v78, v5, 5, 2
	v_lshlrev_b32 v79, 4, v79
	v_mov_b32 v77, 0x3f80
	v_lshlrev_b32 v77, v79, v77
	v_cmp_eq_u32 vcc, 0, v78
	s_nop 1
	v_cndmask_b32 v44, 0, v77, vcc
	v_cmp_eq_u32 vcc, 1, v78
	s_nop 1
	v_cndmask_b32 v45, 0, v77, vcc
	v_cmp_eq_u32 vcc, 2, v78
	s_nop 1
	v_cndmask_b32 v46, 0, v77, vcc
	v_cmp_eq_u32 vcc, 3, v78
	s_nop 1
	v_cndmask_b32 v47, 0, v77, vcc
main_kernel_fast_rchk:
	s_sub_u32 s6, s6, 1
	s_cbranch_scc1 main_kernel_exit
	s_waitcnt vmcnt(3)
	v_bitop3_b32 v48, v29, v31, s55 bitop3:0x7e
	s_waitcnt vmcnt(2)
	v_bitop3_b32 v49, v33, v35, s55 bitop3:0x7e
	s_waitcnt vmcnt(1)
	v_bitop3_b32 v50, v37, v39, s55 bitop3:0x7e
	s_waitcnt vmcnt(0)
	v_bitop3_b32 v51, v41, v43, s55 bitop3:0x7e
	v_or3_b32 v79, v48, v49, v50
	v_or_b32 v79, v79, v51
	v_and_b32 v79, 1, v79
	v_cmp_ne_u32 vcc, 0, v79
	s_nop 0
	s_cbranch_vccz main_kernel_fast_rok
	v_and_b32 v48, 1, v48
	v_cmp_ne_u32 s[76:77], 0, v48
	v_and_b32 v49, 1, v49
	v_cmp_ne_u32 s[78:79], 0, v49
	v_and_b32 v50, 1, v50
	v_cmp_ne_u32 s[80:81], 0, v50
	v_and_b32 v51, 1, v51
	v_cmp_ne_u32 s[82:83], 0, v51
	s_mov_b64 exec, s[76:77]
	buffer_load_dwordx4 v[28:31], v13, s[8:11], s52 offen sc1
	s_mov_b64 exec, s[78:79]
	buffer_load_dwordx4 v[32:35], v13, s[8:11], s28 offen sc1
	s_mov_b64 exec, s[80:81]
	buffer_load_dwordx4 v[36:39], v13, s[8:11], s29 offen sc1
	s_mov_b64 exec, s[82:83]
	buffer_load_dwordx4 v[40:43], v13, s[8:11], s30 offen sc1
	s_mov_b64 exec, -1
	s_branch main_kernel_fast_rchk
main_kernel_fast_rok:
	v_mfma_f32_16x16x32_bf16 v[48:51], v[28:31], v[44:47], 0
	v_mfma_f32_16x16x32_bf16 v[48:51], v[32:35], v[44:47], v[48:51]
	v_mfma_f32_16x16x32_bf16 v[48:51], v[36:39], v[44:47], v[48:51]
	v_mfma_f32_16x16x32_bf16 v[48:51], v[40:43], v[44:47], v[48:51]
	v_mov_b32 v78, -1
	s_nop 6
	v_permlane32_swap_b32 v48, v50
	v_permlane32_swap_b32 v49, v51
	v_add_f32 v48, v48, v50
	v_add_f32 v49, v49, v51
	v_cvt_pk_bf16_f32 v79, v48, v49
	buffer_store_dword v79, v14, s[8:11], s21 offen
	buffer_store_dword v78, v14, s[8:11], s20 offen
main_kernel_fast_nored:
	s_barrier
	s_mov_b32 s91, s20
	s_mov_b32 s20, s21
	s_mov_b32 s21, s22
	s_mov_b32 s22, s91
	s_add_u32 s23, s23, s54
	s_add_u32 s52, s52, s54
	s_sub_u32 s54, 0, s54
	s_add_u32 s5, s5, 1
	s_bfe_u32 s55, s5, 0x10001
	s_branch main_kernel_fast_top
main_kernel_fast_fin:
	s_waitcnt vmcnt(0)
	s_barrier
	s_cmp_lg_u32 s4, 3
	s_cbranch_scc1 main_kernel_exit
	v_mov_b32 v79, 64
	v_mov_b32 v78, 0
	s_mov_b64 exec, 1
	buffer_store_dword v79, v78, s[8:11], s87 offen sc1
	s_mov_b64 exec, -1
	s_branch main_kernel_exit
main_kernel_fast_end:
main_kernel_slow_pre:
	s_lshl_b32 s87, s3, 7
	s_add_u32 s87, s87, 111149056
	s_add_u32 s28, s20, s42
	buffer_load_dword v0, v4, s[8:11], s28 offen offset:0 sc1
	buffer_load_dword v0, v4, s[8:11], s28 offen offset:1024 sc1
	buffer_load_dword v0, v4, s[8:11], s28 offen offset:2048 sc1
	s_add_u32 s28, s21, s42
	buffer_load_dword v0, v4, s[8:11], s28 offen offset:0 sc1
	buffer_load_dword v0, v4, s[8:11], s28 offen offset:1024 sc1
	buffer_load_dword v0, v4, s[8:11], s28 offen offset:2048 sc1
	s_add_u32 s28, s22, s42
	buffer_load_dword v0, v4, s[8:11], s28 offen offset:0 sc1
	buffer_load_dword v0, v4, s[8:11], s28 offen offset:1024 sc1
	buffer_load_dword v0, v4, s[8:11], s28 offen offset:2048 sc1
	s_cmp_eq_u32 s40, 0
	s_cbranch_scc1 main_kernel_slow_pt_12
	s_add_u32 s28, s52, 0
	buffer_load_dword v0, v13, s[8:11], s28 offen sc1
	s_add_u32 s28, s52, 36864
	buffer_load_dword v0, v13, s[8:11], s28 offen sc1
	s_add_u32 s28, s52, 73728
	buffer_load_dword v0, v13, s[8:11], s28 offen sc1
	s_add_u32 s28, s52, 110592
	buffer_load_dword v0, v13, s[8:11], s28 offen sc1
	s_add_u32 s28, s52, 0
	s_add_u32 s28, s28, s54
	buffer_load_dword v0, v13, s[8:11], s28 offen sc1
	s_add_u32 s28, s52, 36864
	s_add_u32 s28, s28, s54
	buffer_load_dword v0, v13, s[8:11], s28 offen sc1
	s_add_u32 s28, s52, 73728
	s_add_u32 s28, s28, s54
	buffer_load_dword v0, v13, s[8:11], s28 offen sc1
	s_add_u32 s28, s52, 110592
	s_add_u32 s28, s28, s54
	buffer_load_dword v0, v13, s[8:11], s28 offen sc1
main_kernel_slow_pt_12:
	buffer_load_dword v0, v10, s[8:11], s25 offen
	buffer_load_dword v0, v10, s[8:11], s25 offen offset:256
	s_add_u32 s86, s5, 1
	s_lshr_b32 s86, s86, 3
	s_min_u32 s86, s86, 7
	s_cmp_lt_u32 s86, s85
	s_cbranch_scc1 main_kernel_kvok_13
main_kernel_kvp_14:
	v_lshrrev_b32 v0, 2, v5
	buffer_load_dword v0, v0, s[44:47], 0 offen offset:16 sc1
	s_waitcnt vmcnt(0)
	v_cmp_le_u32 vcc, 128, v0
	s_nop 0
	s_and_b32 s85, vcc_lo, 0xff
	s_not_b32 s85, s85
	s_ff1_i32_b32 s85, s85
	s_sub_u32 s6, s6, 1
	s_cbranch_scc1 main_kernel_exit
	s_cmp_lt_u32 s86, s85
	s_cbranch_scc1 main_kernel_kvok_13
	s_sleep 8
	s_branch main_kernel_kvp_14
main_kernel_kvok_13:
	ds_read_b128 v[28:31], v17 offset:12288
	ds_read_b128 v[32:35], v17 offset:13312
	ds_read_b128 v[36:39], v17 offset:14336
	ds_read_b128 v[40:43], v17 offset:15360
	ds_read_b128 v[44:47], v17 offset:16384
	ds_read_b128 v[48:51], v17 offset:17408
	v_mov_b64 v[52:53], 0
	v_mov_b64 v[54:55], 0
	v_mov_b64 v[56:57], 0
	v_mov_b64 v[58:59], 0
	s_cmp_eq_u32 s4, 3
	s_cselect_b32 s31, 0, 0x80000000
	s_cselect_b32 s30, 0, 0x80000000
	s_cmp_ge_u32 s5, 63
	s_cselect_b32 s31, 0x80000000, s31
	v_lshrrev_b32 v79, 5, v5
	v_lshlrev_b32 v79, 13, v79
	v_and_b32 v78, 16, v5
	v_lshl_add_u32 v79, v78, 3, v79
	v_lshlrev_b32 v78, 3, v5
	v_or_b32 v79, s31, v79
	v_or_b32 v78, s31, v78
	s_add_u32 s28, s24, 0xffffff40
	s_add_u32 s29, s25, 0x3e800
	s_cmp_eq_u32 s5, 0
	s_cselect_b32 s30, 0x80000000, s30
	v_mov_b32 v77, s5
	v_mov_b32 v76, 0x80000000
	v_mov_b32 v75, s30
	v_cmp_eq_u32 vcc, 0, v5
	s_nop 1
	v_cndmask_b32 v76, v76, v75, vcc
	s_branch main_kernel_slow_mem_ready
main_kernel_slow_top:
	s_add_u32 s86, s5, 1
	s_lshr_b32 s86, s86, 3
	s_min_u32 s86, s86, 7
	s_cmp_lt_u32 s86, s85
	s_cbranch_scc1 main_kernel_kvok_15
main_kernel_kvp_16:
	v_lshrrev_b32 v0, 2, v5
	buffer_load_dword v0, v0, s[44:47], 0 offen offset:16 sc1
	s_waitcnt vmcnt(0)
	v_cmp_le_u32 vcc, 128, v0
	s_nop 0
	s_and_b32 s85, vcc_lo, 0xff
	s_not_b32 s85, s85
	s_ff1_i32_b32 s85, s85
	s_sub_u32 s6, s6, 1
	s_cbranch_scc1 main_kernel_exit
	s_cmp_lt_u32 s86, s85
	s_cbranch_scc1 main_kernel_kvok_15
	s_sleep 8
	s_branch main_kernel_kvp_16
main_kernel_kvok_15:
	v_lshrrev_b32 v74, 2, v5
	v_sub_u32 v73, v4, v5
	v_add_u32 v73, v73, v74
	s_add_u32 s43, s20, s42
	s_sleep 2
	buffer_load_dwordx4 v[60:63], v4, s[8:11], s43 offen sc1
	buffer_load_dwordx4 v[64:67], v4, s[8:11], s43 offen offset:1024 sc1
	buffer_load_dword v68, v73, s[8:11], s43 offen offset:2048 sc1
	ds_read_b128 v[28:31], v17 offset:12288
	ds_read_b128 v[32:35], v17 offset:13312
	ds_read_b128 v[36:39], v17 offset:14336
	ds_read_b128 v[40:43], v17 offset:15360
	ds_read_b128 v[44:47], v17 offset:16384
	ds_read_b128 v[48:51], v17 offset:17408
	v_mov_b64 v[52:53], 0
	v_mov_b64 v[54:55], 0
	v_mov_b64 v[56:57], 0
	v_mov_b64 v[58:59], 0
	s_cmp_eq_u32 s4, 3
	s_cselect_b32 s31, 0, 0x80000000
	s_cselect_b32 s30, 0, 0x80000000
	s_cmp_ge_u32 s5, 63
	s_cselect_b32 s31, 0x80000000, s31
	v_lshrrev_b32 v79, 5, v5
	v_lshlrev_b32 v79, 13, v79
	v_and_b32 v78, 16, v5
	v_lshl_add_u32 v79, v78, 3, v79
	v_lshlrev_b32 v78, 3, v5
	v_or_b32 v79, s31, v79
	v_or_b32 v78, s31, v78
	s_add_u32 s28, s24, 0xffffff40
	s_add_u32 s29, s25, 0x3e800
	s_cmp_eq_u32 s5, 0
	s_cselect_b32 s30, 0x80000000, s30
	v_mov_b32 v77, s5
	v_mov_b32 v76, 0x80000000
	v_mov_b32 v75, s30
	v_cmp_eq_u32 vcc, 0, v5
	s_nop 1
	v_cndmask_b32 v76, v76, v75, vcc
main_kernel_slow_mchk:
	s_sub_u32 s6, s6, 1
	s_cbranch_scc1 main_kernel_exit
	s_waitcnt vmcnt(2)
	v_max3_u32 v75, v60, v61, v62
	s_waitcnt vmcnt(1)
	v_max3_u32 v74, v64, v65, v66
	v_max_u32 v75, v75, v63
	v_max_u32 v74, v74, v67
	s_waitcnt vmcnt(0)
	v_max3_u32 v72, v75, v74, v68
	v_cmp_eq_u32 vcc, -1, v72
	s_nop 0
	s_cbranch_vccz main_kernel_slow_mok
	v_cmp_eq_u32 s[76:77], -1, v75
	v_cmp_eq_u32 s[78:79], -1, v74
	v_cmp_eq_u32 s[80:81], -1, v68
	s_mov_b64 exec, s[76:77]
	buffer_load_dwordx4 v[60:63], v4, s[8:11], s43 offen sc1
	s_mov_b64 exec, s[78:79]
	buffer_load_dwordx4 v[64:67], v4, s[8:11], s43 offen offset:1024 sc1
	s_mov_b64 exec, s[80:81]
	buffer_load_dword v68, v73, s[8:11], s43 offen offset:2048 sc1
	s_mov_b64 exec, -1
	s_branch main_kernel_slow_mchk
main_kernel_slow_mok:
	ds_write_b128 v4, v[60:63] offset:1024
	ds_write_b128 v4, v[64:67] offset:2048
	ds_write_b32 v73, v68 offset:3072
main_kernel_slow_mem_ready:
	s_waitcnt lgkmcnt(0)
	s_barrier
	ds_read_b128 v[60:63], v2 offset:0
	ds_read_b128 v[64:67], v2 offset:64
	ds_read_b128 v[68:71], v2 offset:128
	ds_read_b128 v[72:75], v2 offset:192
	buffer_load_dword v0, v79, s[8:11], s28 offen
	buffer_load_dword v0, v78, s[8:11], s29 offen
	buffer_store_dword v77, v76, s[8:11], s87 offen sc1
	ds_read_b128 v[76:79], v2 offset:256
	s_waitcnt lgkmcnt(4)
	v_smfmac_f32_16x16x64_bf16 v[52:55], v[60:63], v[80:87], v1
	v_smfmac_f32_16x16x64_bf16 v[56:59], v[60:63], v[28:35], v1
	ds_read_b128 v[28:31], v4 offset:3328
	ds_read_b128 v[32:35], v4 offset:4352
	ds_read_b128 v[60:63], v2 offset:320
	s_waitcnt lgkmcnt(6)
	v_smfmac_f32_16x16x64_bf16 v[52:55], v[64:67], v[88:95], v1
	v_smfmac_f32_16x16x64_bf16 v[56:59], v[64:67], v[36:43], v1
	ds_read_b128 v[36:39], v4 offset:5376
	ds_read_b128 v[40:43], v4 offset:6400
	ds_read_b128 v[64:67], v2 offset:384
	s_waitcnt lgkmcnt(8)
	v_smfmac_f32_16x16x64_bf16 v[52:55], v[68:71], v[96:103], v1
	v_smfmac_f32_16x16x64_bf16 v[56:59], v[68:71], v[44:51], v1
	ds_read_b128 v[44:47], v4 offset:7424
	ds_read_b128 v[48:51], v4 offset:8448
	ds_read_b128 v[68:71], v2 offset:448
	s_waitcnt lgkmcnt(10)
	v_smfmac_f32_16x16x64_bf16 v[52:55], v[72:75], v[104:111], v1
	v_smfmac_f32_16x16x64_bf16 v[56:59], v[72:75], v[112:119], v1
	ds_read_b128 v[72:75], v2 offset:512
	s_waitcnt lgkmcnt(10)
	v_smfmac_f32_16x16x64_bf16 v[52:55], v[76:79], v[120:127], v1
	v_smfmac_f32_16x16x64_bf16 v[56:59], v[76:79], v[128:135], v1
	ds_read_b128 v[76:79], v2 offset:576
	s_waitcnt lgkmcnt(8)
	v_smfmac_f32_16x16x64_bf16 v[52:55], v[60:63], v[136:143], v1
	v_smfmac_f32_16x16x64_bf16 v[56:59], v[60:63], v[28:35], v1
	ds_read_b128 v[28:31], v4 offset:9472
	ds_read_b128 v[32:35], v4 offset:10496
	ds_read_b128 v[60:63], v2 offset:640
	s_waitcnt lgkmcnt(8)
	v_smfmac_f32_16x16x64_bf16 v[52:55], v[64:67], v[144:151], v1
	v_smfmac_f32_16x16x64_bf16 v[56:59], v[64:67], v[152:159], v1
	ds_read_b128 v[64:67], v2 offset:704
	s_waitcnt lgkmcnt(6)
	v_smfmac_f32_16x16x64_bf16 v[52:55], v[68:71], v[160:167], v1
	v_smfmac_f32_16x16x64_bf16 v[56:59], v[68:71], v[36:43], v1
	ds_read_b128 v[36:39], v4 offset:11520
	ds_read_b128 v[40:43], v4 offset:12544
	ds_read_b128 v[68:71], v2 offset:768
	s_waitcnt lgkmcnt(8)
	v_smfmac_f32_16x16x64_bf16 v[52:55], v[72:75], v[168:175], v1
	v_smfmac_f32_16x16x64_bf16 v[56:59], v[72:75], v[176:183], v1
	ds_read_b128 v[72:75], v2 offset:832
	s_waitcnt lgkmcnt(8)
	v_smfmac_f32_16x16x64_bf16 v[52:55], v[76:79], v[184:191], v1
	v_smfmac_f32_16x16x64_bf16 v[56:59], v[76:79], v[44:51], v1
	ds_read_b128 v[44:47], v4 offset:13568
	ds_read_b128 v[48:51], v4 offset:14592
	ds_read_b128 v[76:79], v2 offset:896
	s_waitcnt lgkmcnt(8)
	v_smfmac_f32_16x16x64_bf16 v[52:55], v[60:63], v[192:199], v1
	v_smfmac_f32_16x16x64_bf16 v[56:59], v[60:63], v[200:207], v1
	ds_read_b128 v[60:63], v2 offset:960
	s_waitcnt lgkmcnt(8)
	v_smfmac_f32_16x16x64_bf16 v[52:55], v[64:67], v[208:215], v1
	v_smfmac_f32_16x16x64_bf16 v[56:59], v[64:67], v[28:35], v1
	ds_read_b128 v[28:31], v2 offset:1024
	s_waitcnt lgkmcnt(6)
	v_smfmac_f32_16x16x64_bf16 v[52:55], v[68:71], v[216:223], v1
	v_smfmac_f32_16x16x64_bf16 v[56:59], v[68:71], v[224:231], v1
	ds_read_b128 v[32:35], v2 offset:1088
	s_waitcnt lgkmcnt(6)
	v_smfmac_f32_16x16x64_bf16 v[52:55], v[72:75], v[232:239], v1
	v_smfmac_f32_16x16x64_bf16 v[56:59], v[72:75], v[36:43], v1
	ds_read_b128 v[36:39], v3 offset:0
	v_mov_b64 v[40:41], 0
	v_mov_b64 v[42:43], 0
	s_waitcnt lgkmcnt(4)
	v_smfmac_f32_16x16x64_bf16 v[52:55], v[76:79], v[240:247], v1
	v_smfmac_f32_16x16x64_bf16 v[56:59], v[76:79], v[248:255], v1
	ds_read_b128 v[64:67], v3 offset:128
	v_mov_b64 v[68:69], 0
	v_mov_b64 v[70:71], 0
	s_waitcnt lgkmcnt(4)
	v_smfmac_f32_16x16x64_bf16 v[52:55], v[60:63], a[0:7], v1
	v_smfmac_f32_16x16x64_bf16 v[56:59], v[60:63], v[44:51], v1
	ds_read_b128 v[44:47], v3 offset:256
	s_waitcnt lgkmcnt(4)
	v_smfmac_f32_16x16x64_bf16 v[52:55], v[28:31], a[8:15], v1
	v_smfmac_f32_16x16x64_bf16 v[56:59], v[28:31], a[16:23], v1
	ds_read_b128 v[72:75], v17 offset:0
	ds_read_b128 v[76:79], v17 offset:1024
	s_waitcnt lgkmcnt(5)
	v_smfmac_f32_16x16x64_bf16 v[52:55], v[32:35], a[24:31], v1
	v_smfmac_f32_16x16x64_bf16 v[56:59], v[32:35], a[32:39], v1
	s_waitcnt lgkmcnt(4)
	v_smfmac_f32_16x16x64_bf16 v[40:43], v[36:39], a[40:47], v1
	v_smfmac_f32_16x16x64_bf16 v[68:71], v[36:39], a[48:55], v1
	ds_read_b128 v[28:31], v3 offset:384
	s_nop 2
	v_cvt_pk_bf16_f32 v32, v52, v53
	v_cvt_pk_bf16_f32 v33, v54, v55
	v_cvt_pk_bf16_f32 v34, v56, v57
	v_cvt_pk_bf16_f32 v35, v58, v59
	v_mfma_f32_16x16x16_bf16 v[36:39], v[32:33], v[18:19], 0
	s_nop 0
	v_mfma_f32_16x16x16_bf16 v[48:51], v[34:35], v[18:19], 0
	s_waitcnt lgkmcnt(4)
	v_smfmac_f32_16x16x64_bf16 v[40:43], v[64:67], a[56:63], v1
	s_waitcnt lgkmcnt(1)
	v_smfmac_f32_16x16x64_bf16 v[68:71], v[64:67], v[72:79], v1
	ds_read_b128 v[52:55], v17 offset:2048
	ds_read_b128 v[56:59], v17 offset:3072
	ds_read_b128 v[32:35], v3 offset:512
	v_cvt_pk_bf16_f32 v60, v36, v37
	v_cvt_pk_bf16_f32 v61, v38, v39
	v_cvt_pk_bf16_f32 v62, v48, v49
	v_cvt_pk_bf16_f32 v63, v50, v51
	s_waitcnt vmcnt(15)
	s_nop 0
	v_mfma_f32_16x16x32_bf16 v[36:39], v[20:23], v[60:63], 0
	s_waitcnt vmcnt(14)
	v_mfma_f32_16x16x32_bf16 v[48:51], v[24:27], v[60:63], 0
	v_mfma_f32_16x16x32_bf16 v[64:67], v[60:63], v[60:63], 0
	buffer_load_dwordx4 v[20:23], v10, s[8:11], s25 offen sc1
	buffer_load_dwordx4 v[24:27], v10, s[8:11], s25 offen offset:256 sc1
	s_add_u32 s25, s25, 262144
	v_smfmac_f32_16x16x64_bf16 v[40:43], v[44:47], a[64:71], v1
	v_smfmac_f32_16x16x64_bf16 v[68:71], v[44:47], a[72:79], v1
	ds_read_b128 v[44:47], v3 offset:640
	s_mov_b64 exec, s[32:33]
	ds_write_b128 v4, v[36:39]
	ds_write_b128 v4, v[48:51] offset:128
	s_mov_b64 exec, s[36:37]
	ds_write2_b32 v6, v64, v65 offset0:0 offset1:32
	ds_write2_b32 v6, v66, v67 offset0:64 offset1:96
	s_mov_b64 exec, -1
	buffer_store_dwordx4 v[60:63], v15, s[8:11], s26 offen sc1
	s_add_u32 s26, s26, 65536
	s_waitcnt lgkmcnt(8)
	v_smfmac_f32_16x16x64_bf16 v[40:43], v[28:31], a[80:87], v1
	v_smfmac_f32_16x16x64_bf16 v[68:71], v[28:31], a[88:95], v1
	ds_read_b128 v[28:31], v3 offset:768
	s_waitcnt lgkmcnt(6)
	v_smfmac_f32_16x16x64_bf16 v[40:43], v[32:35], a[96:103], v1
	v_smfmac_f32_16x16x64_bf16 v[68:71], v[32:35], a[104:111], v1
	ds_read_b128 v[32:35], v3 offset:896
	s_waitcnt lgkmcnt(0)
	s_barrier
	ds_read_b128 v[36:39], v5 offset:0
	ds_read_b128 v[48:51], v5 offset:21792
	ds_read_b128 v[60:63], v5 offset:43584
	ds_read_b128 v[64:67], v5 offset:65376
	ds_read_b128 v[72:75], v7
	v_smfmac_f32_16x16x64_bf16 v[40:43], v[44:47], a[112:119], v1
	v_smfmac_f32_16x16x64_bf16 v[68:71], v[44:47], v[52:59], v1
	ds_read_b128 v[52:55], v17 offset:4096
	ds_read_b128 v[56:59], v17 offset:5120
	ds_read_b128 v[44:47], v3 offset:1024
	v_smfmac_f32_16x16x64_bf16 v[40:43], v[28:31], a[120:127], v1
	v_smfmac_f32_16x16x64_bf16 v[68:71], v[28:31], a[128:135], v1
	v_smfmac_f32_16x16x64_bf16 v[40:43], v[32:35], a[136:143], v1
	v_smfmac_f32_16x16x64_bf16 v[68:71], v[32:35], a[144:151], v1
	s_waitcnt lgkmcnt(0)
	v_smfmac_f32_16x16x64_bf16 v[40:43], v[44:47], a[152:159], v1
	v_smfmac_f32_16x16x64_bf16 v[68:71], v[44:47], v[52:59], v1
	v_add_f32 v36, v36, v48
	v_add_f32 v37, v37, v49
	v_add_f32 v38, v38, v50
	v_add_f32 v39, v39, v51
	v_add_f32 v60, v60, v64
	v_add_f32 v61, v61, v65
	v_add_f32 v62, v62, v66
	v_add_f32 v63, v63, v67
	v_add_f32 v79, v72, v73
	v_add_f32 v74, v74, v75
	v_add_f32 v36, v36, v60
	v_add_f32 v37, v37, v61
	v_add_f32 v38, v38, v62
	v_add_f32 v39, v39, v63
	v_add_f32 v79, v79, v74
	v_max3_f32 v78, v36, v37, v38
	v_max3_f32 v78, v78, v39, v79
	v_cvt_pk_bf16_f32 v28, v40, v41
	v_cvt_pk_bf16_f32 v29, v42, v43
	v_max_f32_dpp v78, v78, v78 row_ror:8 row_mask:0xf bank_mask:0xf
	v_mov_b32 v77, v78
	v_cvt_pk_bf16_f32 v30, v68, v69
	v_cvt_pk_bf16_f32 v31, v70, v71
	v_permlane16_swap_b32 v78, v77
	v_max_f32 v78, v78, v77
	v_mov_b32 v77, v78
	buffer_store_dwordx2 v[28:29], v16, s[8:11], s27 offen sc1
	buffer_store_dwordx2 v[30:31], v16, s[8:11], s27 offen offset:128 sc1
	v_permlane32_swap_b32 v78, v77
	v_max_f32 v78, v78, v77
	v_mul_f32 v78, s38, v78
	v_fma_f32 v79, v79, s38, -v78
	v_fma_f32 v36, v36, s38, -v78
	v_fma_f32 v37, v37, s38, -v78
	v_fma_f32 v38, v38, s38, -v78
	v_fma_f32 v39, v39, s38, -v78
	v_exp_f32 v79, v79
	v_exp_f32 v36, v36
	v_exp_f32 v37, v37
	v_mov_b32_dpp v78, v79 row_ror:8 row_mask:0xf bank_mask:0xf
	v_exp_f32 v38, v38
	v_exp_f32 v39, v39
	v_cvt_pk_bf16_f32 v76, v79, v78
	v_cvt_pk_bf16_f32 v32, v36, v37
	v_add_f32 v78, v36, v37
	v_mov_b32 v77, v76
	v_cvt_pk_bf16_f32 v33, v38, v39
	v_add_f32 v75, v38, v39
	v_permlane32_swap_b32 v76, v77
	v_mov_b32_dpp v34, v32 row_ror:8 row_mask:0xf bank_mask:0xf
	v_mov_b32_dpp v35, v33 row_ror:8 row_mask:0xf bank_mask:0xf
	v_add_f32 v78, v78, v79
	v_add_f32 v78, v78, v75
	s_waitcnt vmcnt(4)
	v_mfma_f32_16x16x32_bf16 v[36:39], v[20:23], v[32:35], 0
	s_waitcnt vmcnt(3)
	v_mfma_f32_16x16x32_bf16 v[40:43], v[24:27], v[32:35], 0
	v_add_f32_dpp v78, v78, v78 row_ror:8 row_mask:0xf bank_mask:0xf
	v_mov_b32 v75, v78
	ds_read_b128 v[44:47], v4 offset:15616
	ds_read_b128 v[48:51], v4 offset:16640
	v_permlane16_swap_b32 v78, v75
	v_mfma_f32_16x16x16_bf16 v[36:39], v[28:29], v[76:77], v[36:39]
	v_mfma_f32_16x16x16_bf16 v[40:43], v[30:31], v[76:77], v[40:43]
	v_add_f32 v78, v78, v75
	v_mov_b32 v75, v78
	ds_read_b128 v[28:31], v4 offset:17664
	ds_read_b128 v[32:35], v4 offset:18688
	v_permlane32_swap_b32 v78, v75
	v_add_f32 v78, v78, v75
	v_rcp_f32 v78, v78
	s_add_u32 s27, s27, 131072
	s_cmp_eq_u32 s5, 63
	s_cbranch_scc1 main_kernel_slow_fin
	v_mul_f32 v36, v36, v78
	v_mul_f32 v37, v37, v78
	v_mul_f32 v38, v38, v78
	v_mul_f32 v39, v39, v78
	v_mul_f32 v40, v40, v78
	v_mul_f32 v41, v41, v78
	v_mul_f32 v42, v42, v78
	v_mul_f32 v43, v43, v78
	v_cvt_pk_bf16_f32 v52, v36, v37
	v_cvt_pk_bf16_f32 v53, v38, v39
	v_cvt_pk_bf16_f32 v54, v40, v41
	v_cvt_pk_bf16_f32 v55, v42, v43
	s_mov_b64 exec, s[32:33]
	ds_write_b128 v8, v[52:55]
	s_mov_b64 exec, -1
	s_add_u32 s28, s24, 32768
	buffer_load_dwordx4 v[20:23], v9, s[8:11], s24 offen sc1
	buffer_load_dwordx4 v[24:27], v9, s[8:11], s28 offen sc1
	s_add_u32 s24, s24, 262144
	v_mov_b64 v[36:37], 0
	v_mov_b64 v[38:39], 0
	v_mov_b64 v[40:41], 0
	v_mov_b64 v[42:43], 0
	v_mov_b64 v[52:53], 0
	v_mov_b64 v[54:55], 0
	s_waitcnt lgkmcnt(0)
	s_barrier
	ds_read_b128 v[56:59], v3 offset:0
	ds_read_b128 v[60:63], v2 offset:0
	ds_read_b128 v[64:67], v3 offset:128
	ds_read_b128 v[68:71], v2 offset:64
	ds_read_b128 v[72:75], v2 offset:128
	ds_read_b128 v[76:79], v2 offset:192
	s_waitcnt lgkmcnt(5)
	v_smfmac_f32_16x16x64_bf16 v[36:39], v[56:59], a[160:167], v1
	s_waitcnt lgkmcnt(4)
	v_smfmac_f32_16x16x64_bf16 v[40:43], v[60:63], v[44:51], v1
	ds_read_b128 v[44:47], v17 offset:6144
	ds_read_b128 v[48:51], v17 offset:7168
	s_waitcnt lgkmcnt(5)
	v_smfmac_f32_16x16x64_bf16 v[36:39], v[64:67], a[184:191], v1
	v_smfmac_f32_16x16x64_bf16 v[52:55], v[60:63], a[176:183], v1
	v_mov_b64 v[56:57], 0
	v_mov_b64 v[58:59], 0
	s_waitcnt lgkmcnt(4)
	v_smfmac_f32_16x16x64_bf16 v[40:43], v[68:71], a[168:175], v1
	v_smfmac_f32_16x16x64_bf16 v[52:55], v[68:71], v[28:35], v1
	ds_read_b128 v[28:31], v4 offset:19712
	ds_read_b128 v[32:35], v4 offset:20736
	v_mov_b64 v[64:65], 0
	v_mov_b64 v[66:67], 0
	s_waitcnt lgkmcnt(5)
	v_smfmac_f32_16x16x64_bf16 v[40:43], v[72:75], a[192:199], v1
	v_permlane32_swap_b32 v36, v38
	v_permlane32_swap_b32 v37, v39
	v_smfmac_f32_16x16x64_bf16 v[52:55], v[72:75], a[200:207], v1
	v_add_f32 v36, v36, v38
	v_add_f32 v37, v37, v39
	s_waitcnt lgkmcnt(2)
	v_smfmac_f32_16x16x64_bf16 v[40:43], v[76:79], v[44:51], v1
	ds_read_b128 v[44:47], v17 offset:8192
	ds_read_b128 v[48:51], v17 offset:9216
	v_cvt_pk_bf16_f32 v36, v36, v37
	v_mov_b32 v37, v36
	v_smfmac_f32_16x16x64_bf16 v[52:55], v[76:79], a[208:215], v1
	v_smfmac_f32_16x16x64_bf16 v[56:59], v[60:63], a[232:239], v1
	v_permlane32_swap_b32 v36, v37
	v_bfi_b32 v37, 1, s55, v37
	buffer_store_dwordx2 v[36:37], v12, s[8:11], s23 offen sc1
	s_waitcnt lgkmcnt(2)
	v_smfmac_f32_16x16x64_bf16 v[64:67], v[60:63], v[28:35], v1
	ds_read_b128 v[28:31], v17 offset:10240
	ds_read_b128 v[32:35], v17 offset:11264
	v_smfmac_f32_16x16x64_bf16 v[56:59], v[68:71], a[240:247], v1
	v_smfmac_f32_16x16x64_bf16 v[64:67], v[68:71], a[248:255], v1
	v_cvt_pk_bf16_f32 v40, v40, v41
	v_cvt_pk_bf16_f32 v41, v42, v43
	v_bfi_b32 v41, 1, s55, v41
	buffer_store_dwordx2 v[40:41], v11, s[8:11], s23 offen offset:0 sc1
	s_waitcnt lgkmcnt(2)
	v_smfmac_f32_16x16x64_bf16 v[56:59], v[72:75], v[44:51], v1
	v_smfmac_f32_16x16x64_bf16 v[64:67], v[72:75], a[224:231], v1
	v_cvt_pk_bf16_f32 v52, v52, v53
	v_cvt_pk_bf16_f32 v53, v54, v55
	v_bfi_b32 v53, 1, s55, v53
	buffer_store_dwordx2 v[52:53], v11, s[8:11], s23 offen offset:512 sc1
	v_smfmac_f32_16x16x64_bf16 v[56:59], v[76:79], a[216:223], v1
	s_waitcnt lgkmcnt(0)
	v_smfmac_f32_16x16x64_bf16 v[64:67], v[76:79], v[28:35], v1
	s_nop 5
	v_cvt_pk_bf16_f32 v56, v56, v57
	v_cvt_pk_bf16_f32 v57, v58, v59
	v_bfi_b32 v57, 1, s55, v57
	buffer_store_dwordx2 v[56:57], v11, s[8:11], s23 offen offset:1024 sc1
	v_cvt_pk_bf16_f32 v64, v64, v65
	v_cvt_pk_bf16_f32 v65, v66, v67
	v_bfi_b32 v65, 1, s55, v65
	buffer_store_dwordx2 v[64:65], v11, s[8:11], s23 offen offset:1536 sc1
	s_cmp_eq_u32 s40, 0
	s_cbranch_scc1 main_kernel_slow_nored
	s_add_u32 s28, s52, 36864
	s_add_u32 s29, s52, 73728
	s_add_u32 s30, s52, 110592
	s_sleep 5
	buffer_load_dwordx4 v[28:31], v13, s[8:11], s52 offen sc1
	buffer_load_dwordx4 v[32:35], v13, s[8:11], s28 offen sc1
	buffer_load_dwordx4 v[36:39], v13, s[8:11], s29 offen sc1
	buffer_load_dwordx4 v[40:43], v13, s[8:11], s30 offen sc1
	v_bfe_u32 v79, v5, 4, 1
	v_bfe_u32 v78, v5, 5, 2
	v_lshlrev_b32 v79, 4, v79
	v_mov_b32 v77, 0x3f80
	v_lshlrev_b32 v77, v79, v77
	v_cmp_eq_u32 vcc, 0, v78
	s_nop 1
	v_cndmask_b32 v44, 0, v77, vcc
	v_cmp_eq_u32 vcc, 1, v78
	s_nop 1
	v_cndmask_b32 v45, 0, v77, vcc
	v_cmp_eq_u32 vcc, 2, v78
	s_nop 1
	v_cndmask_b32 v46, 0, v77, vcc
	v_cmp_eq_u32 vcc, 3, v78
	s_nop 1
	v_cndmask_b32 v47, 0, v77, vcc
main_kernel_slow_rchk:
	s_sub_u32 s6, s6, 1
	s_cbranch_scc1 main_kernel_exit
	s_waitcnt vmcnt(3)
	v_bitop3_b32 v48, v29, v31, s55 bitop3:0x7e
	s_waitcnt vmcnt(2)
	v_bitop3_b32 v49, v33, v35, s55 bitop3:0x7e
	s_waitcnt vmcnt(1)
	v_bitop3_b32 v50, v37, v39, s55 bitop3:0x7e
	s_waitcnt vmcnt(0)
	v_bitop3_b32 v51, v41, v43, s55 bitop3:0x7e
	v_or3_b32 v79, v48, v49, v50
	v_or_b32 v79, v79, v51
	v_and_b32 v79, 1, v79
	v_cmp_ne_u32 vcc, 0, v79
	s_nop 0
	s_cbranch_vccz main_kernel_slow_rok
	v_and_b32 v48, 1, v48
	v_cmp_ne_u32 s[76:77], 0, v48
	v_and_b32 v49, 1, v49
	v_cmp_ne_u32 s[78:79], 0, v49
	v_and_b32 v50, 1, v50
	v_cmp_ne_u32 s[80:81], 0, v50
	v_and_b32 v51, 1, v51
	v_cmp_ne_u32 s[82:83], 0, v51
	s_mov_b64 exec, s[76:77]
	buffer_load_dwordx4 v[28:31], v13, s[8:11], s52 offen sc1
	s_mov_b64 exec, s[78:79]
	buffer_load_dwordx4 v[32:35], v13, s[8:11], s28 offen sc1
	s_mov_b64 exec, s[80:81]
	buffer_load_dwordx4 v[36:39], v13, s[8:11], s29 offen sc1
	s_mov_b64 exec, s[82:83]
	buffer_load_dwordx4 v[40:43], v13, s[8:11], s30 offen sc1
	s_mov_b64 exec, -1
	s_branch main_kernel_slow_rchk
main_kernel_slow_rok:
	v_mfma_f32_16x16x32_bf16 v[48:51], v[28:31], v[44:47], 0
	v_mfma_f32_16x16x32_bf16 v[48:51], v[32:35], v[44:47], v[48:51]
	v_mfma_f32_16x16x32_bf16 v[48:51], v[36:39], v[44:47], v[48:51]
	v_mfma_f32_16x16x32_bf16 v[48:51], v[40:43], v[44:47], v[48:51]
	v_mov_b32 v78, -1
	s_nop 6
	v_permlane32_swap_b32 v48, v50
	v_permlane32_swap_b32 v49, v51
	v_add_f32 v48, v48, v50
	v_add_f32 v49, v49, v51
	v_cvt_pk_bf16_f32 v79, v48, v49
	buffer_store_dword v79, v14, s[8:11], s21 offen sc1
	buffer_store_dword v78, v14, s[8:11], s20 offen sc1
main_kernel_slow_nored:
	s_barrier
	s_mov_b32 s91, s20
	s_mov_b32 s20, s21
	s_mov_b32 s21, s22
	s_mov_b32 s22, s91
	s_add_u32 s23, s23, s54
	s_add_u32 s52, s52, s54
	s_sub_u32 s54, 0, s54
	s_add_u32 s5, s5, 1
	s_bfe_u32 s55, s5, 0x10001
	s_branch main_kernel_slow_top
main_kernel_slow_fin:
	s_waitcnt vmcnt(0)
	s_barrier
	s_cmp_lg_u32 s4, 3
	s_cbranch_scc1 main_kernel_exit
	v_mov_b32 v79, 64
	v_mov_b32 v78, 0
	s_mov_b64 exec, 1
	buffer_store_dword v79, v78, s[8:11], s87 offen sc1
	s_mov_b64 exec, -1
	s_branch main_kernel_exit
main_kernel_slow_end:
main_kernel_exit:
	s_endpgm
main_kernel_worker:
	s_cmp_ge_u32 s2, 256
	s_cbranch_scc1 main_kernel_wexit
	s_load_dwordx2 s[8:9], s[0:1], 112
	v_lshrrev_b32 v1, 6, v0
	s_nop 0
	v_readfirstlane_b32 s4, v1
	v_and_b32 v0, 63, v0
	s_mov_b32 s10, 268435456
	s_mov_b32 s11, 0x20000
	s_mov_b32 s15, 0x20000
	s_mov_b32 s35, 0x20000
	s_mov_b32 s39, 0x20000
	s_load_dwordx2 s[96:97], s[0:1], 104
	s_mov_b32 s98, 256
	s_mov_b32 s99, 0x20000
	s_and_b32 s88, s2, 7
	s_sub_u32 s88, s88, 1
	s_lshr_b32 s89, s2, 3
	s_mov_b32 s90, 0
	s_mov_b32 s94, 200000
	s_add_u32 s91, s89, 16
	s_mov_b32 s92, s88
	s_waitcnt lgkmcnt(0)
	s_lshl_b32 s16, s88, 5
	s_add_u32 s16, s16, 3
	s_mul_i32 s17, s16, 9363
	s_lshr_b32 s17, s17, 16
	s_add_u32 s16, s16, 32
	s_mul_i32 s16, s16, 9363
	s_lshr_b32 s16, s16, 16
	s_lshr_b32 s91, s89, 2
	s_add_u32 s91, s91, s17
	s_and_b32 s92, s89, 3
	s_cmp_lt_u32 s91, s16
	s_cselect_b32 s101, 1, 0
	s_add_u32 s91, s91, 16
	s_load_dwordx2 s[36:37], s[0:1], 0
	s_mov_b32 s38, 2359296
	s_lshl_b32 s16, s88, 8
	s_lshl_b32 s17, s89, 3
	s_add_u32 s16, s16, s17
	s_cmp_eq_u32 s4, 0
	s_cbranch_scc1 main_kernel_lngo
	s_cmp_eq_u32 s4, 1
	s_cbranch_scc0 main_kernel_lnskip
	s_cmp_eq_u32 s88, 0
	s_cbranch_scc0 main_kernel_lnskip
	s_add_u32 s16, s17, 1792
main_kernel_lngo:
	s_waitcnt lgkmcnt(0)
	v_lshrrev_b32 v2, 3, v0
	v_add_u32 v2, s16, v2
	v_mul_u32_u24 v2, 1152, v2
	v_and_b32 v3, 7, v0
	v_lshl_add_u32 v6, v3, 4, v2
	buffer_load_dwordx4 v[16:19], v6, s[36:39], 0 offen offset:0
	buffer_load_dwordx4 v[20:23], v6, s[36:39], 0 offen offset:128
	buffer_load_dwordx4 v[24:27], v6, s[36:39], 0 offen offset:256
	buffer_load_dwordx4 v[28:31], v6, s[36:39], 0 offen offset:384
	buffer_load_dwordx4 v[32:35], v6, s[36:39], 0 offen offset:512
	buffer_load_dwordx4 v[36:39], v6, s[36:39], 0 offen offset:640
	buffer_load_dwordx4 v[40:43], v6, s[36:39], 0 offen offset:768
	buffer_load_dwordx4 v[44:47], v6, s[36:39], 0 offen offset:896
	buffer_load_dwordx4 v[48:51], v6, s[36:39], 0 offen offset:1024
	s_waitcnt vmcnt(8)
	v_lshlrev_b32 v52, 16, v16
	v_and_b32 v53, 0xffff0000, v16
	v_lshlrev_b32 v54, 16, v17
	v_and_b32 v55, 0xffff0000, v17
	v_lshlrev_b32 v56, 16, v18
	v_and_b32 v57, 0xffff0000, v18
	v_lshlrev_b32 v58, 16, v19
	v_and_b32 v59, 0xffff0000, v19
	s_waitcnt vmcnt(7)
	v_lshlrev_b32 v60, 16, v20
	v_and_b32 v61, 0xffff0000, v20
	v_lshlrev_b32 v62, 16, v21
	v_and_b32 v63, 0xffff0000, v21
	v_lshlrev_b32 v64, 16, v22
	v_and_b32 v65, 0xffff0000, v22
	v_lshlrev_b32 v66, 16, v23
	v_and_b32 v67, 0xffff0000, v23
	s_waitcnt vmcnt(6)
	v_lshlrev_b32 v68, 16, v24
	v_and_b32 v69, 0xffff0000, v24
	v_lshlrev_b32 v70, 16, v25
	v_and_b32 v71, 0xffff0000, v25
	v_lshlrev_b32 v72, 16, v26
	v_and_b32 v73, 0xffff0000, v26
	v_lshlrev_b32 v74, 16, v27
	v_and_b32 v75, 0xffff0000, v27
	s_waitcnt vmcnt(5)
	v_lshlrev_b32 v76, 16, v28
	v_and_b32 v77, 0xffff0000, v28
	v_lshlrev_b32 v78, 16, v29
	v_and_b32 v79, 0xffff0000, v29
	v_lshlrev_b32 v80, 16, v30
	v_and_b32 v81, 0xffff0000, v30
	v_lshlrev_b32 v82, 16, v31
	v_and_b32 v83, 0xffff0000, v31
	s_waitcnt vmcnt(4)
	v_lshlrev_b32 v84, 16, v32
	v_and_b32 v85, 0xffff0000, v32
	v_lshlrev_b32 v86, 16, v33
	v_and_b32 v87, 0xffff0000, v33
	v_lshlrev_b32 v88, 16, v34
	v_and_b32 v89, 0xffff0000, v34
	v_lshlrev_b32 v90, 16, v35
	v_and_b32 v91, 0xffff0000, v35
	s_waitcnt vmcnt(3)
	v_lshlrev_b32 v92, 16, v36
	v_and_b32 v93, 0xffff0000, v36
	v_lshlrev_b32 v94, 16, v37
	v_and_b32 v95, 0xffff0000, v37
	v_lshlrev_b32 v96, 16, v38
	v_and_b32 v97, 0xffff0000, v38
	v_lshlrev_b32 v98, 16, v39
	v_and_b32 v99, 0xffff0000, v39
	s_waitcnt vmcnt(2)
	v_lshlrev_b32 v100, 16, v40
	v_and_b32 v101, 0xffff0000, v40
	v_lshlrev_b32 v102, 16, v41
	v_and_b32 v103, 0xffff0000, v41
	v_lshlrev_b32 v104, 16, v42
	v_and_b32 v105, 0xffff0000, v42
	v_lshlrev_b32 v106, 16, v43
	v_and_b32 v107, 0xffff0000, v43
	s_waitcnt vmcnt(1)
	v_lshlrev_b32 v108, 16, v44
	v_and_b32 v109, 0xffff0000, v44
	v_lshlrev_b32 v110, 16, v45
	v_and_b32 v111, 0xffff0000, v45
	v_lshlrev_b32 v112, 16, v46
	v_and_b32 v113, 0xffff0000, v46
	v_lshlrev_b32 v114, 16, v47
	v_and_b32 v115, 0xffff0000, v47
	s_waitcnt vmcnt(0)
	v_lshlrev_b32 v116, 16, v48
	v_and_b32 v117, 0xffff0000, v48
	v_lshlrev_b32 v118, 16, v49
	v_and_b32 v119, 0xffff0000, v49
	v_lshlrev_b32 v120, 16, v50
	v_and_b32 v121, 0xffff0000, v50
	v_lshlrev_b32 v122, 16, v51
	v_and_b32 v123, 0xffff0000, v51
	v_add_f32 v2, v52, v53
	v_add_f32 v3, v54, v55
	v_add_f32 v2, v2, v56
	v_add_f32 v3, v3, v57
	v_add_f32 v2, v2, v58
	v_add_f32 v3, v3, v59
	v_add_f32 v2, v2, v60
	v_add_f32 v3, v3, v61
	v_add_f32 v2, v2, v62
	v_add_f32 v3, v3, v63
	v_add_f32 v2, v2, v64
	v_add_f32 v3, v3, v65
	v_add_f32 v2, v2, v66
	v_add_f32 v3, v3, v67
	v_add_f32 v2, v2, v68
	v_add_f32 v3, v3, v69
	v_add_f32 v2, v2, v70
	v_add_f32 v3, v3, v71
	v_add_f32 v2, v2, v72
	v_add_f32 v3, v3, v73
	v_add_f32 v2, v2, v74
	v_add_f32 v3, v3, v75
	v_add_f32 v2, v2, v76
	v_add_f32 v3, v3, v77
	v_add_f32 v2, v2, v78
	v_add_f32 v3, v3, v79
	v_add_f32 v2, v2, v80
	v_add_f32 v3, v3, v81
	v_add_f32 v2, v2, v82
	v_add_f32 v3, v3, v83
	v_add_f32 v2, v2, v84
	v_add_f32 v3, v3, v85
	v_add_f32 v2, v2, v86
	v_add_f32 v3, v3, v87
	v_add_f32 v2, v2, v88
	v_add_f32 v3, v3, v89
	v_add_f32 v2, v2, v90
	v_add_f32 v3, v3, v91
	v_add_f32 v2, v2, v92
	v_add_f32 v3, v3, v93
	v_add_f32 v2, v2, v94
	v_add_f32 v3, v3, v95
	v_add_f32 v2, v2, v96
	v_add_f32 v3, v3, v97
	v_add_f32 v2, v2, v98
	v_add_f32 v3, v3, v99
	v_add_f32 v2, v2, v100
	v_add_f32 v3, v3, v101
	v_add_f32 v2, v2, v102
	v_add_f32 v3, v3, v103
	v_add_f32 v2, v2, v104
	v_add_f32 v3, v3, v105
	v_add_f32 v2, v2, v106
	v_add_f32 v3, v3, v107
	v_add_f32 v2, v2, v108
	v_add_f32 v3, v3, v109
	v_add_f32 v2, v2, v110
	v_add_f32 v3, v3, v111
	v_add_f32 v2, v2, v112
	v_add_f32 v3, v3, v113
	v_add_f32 v2, v2, v114
	v_add_f32 v3, v3, v115
	v_add_f32 v2, v2, v116
	v_add_f32 v3, v3, v117
	v_add_f32 v2, v2, v118
	v_add_f32 v3, v3, v119
	v_add_f32 v2, v2, v120
	v_add_f32 v3, v3, v121
	v_add_f32 v2, v2, v122
	v_add_f32 v3, v3, v123
	v_add_f32 v2, v2, v3
	s_nop 1
	v_add_f32_dpp v2, v2, v2 quad_perm:[1,0,3,2] row_mask:0xf bank_mask:0xf
	s_nop 1
	v_add_f32_dpp v2, v2, v2 quad_perm:[2,3,0,1] row_mask:0xf bank_mask:0xf
	s_nop 1
	v_add_f32_dpp v2, v2, v2 row_half_mirror row_mask:0xf bank_mask:0xf
	v_mul_f32 v2, 0x3ae38e39, v2
	v_mov_b32 v3, 0
	v_mov_b32 v4, 0
	v_sub_f32 v5, v52, v2
	v_fma_f32 v3, v5, v5, v3
	v_sub_f32 v7, v53, v2
	v_fma_f32 v4, v7, v7, v4
	v_sub_f32 v5, v54, v2
	v_fma_f32 v3, v5, v5, v3
	v_sub_f32 v7, v55, v2
	v_fma_f32 v4, v7, v7, v4
	v_sub_f32 v5, v56, v2
	v_fma_f32 v3, v5, v5, v3
	v_sub_f32 v7, v57, v2
	v_fma_f32 v4, v7, v7, v4
	v_sub_f32 v5, v58, v2
	v_fma_f32 v3, v5, v5, v3
	v_sub_f32 v7, v59, v2
	v_fma_f32 v4, v7, v7, v4
	v_sub_f32 v5, v60, v2
	v_fma_f32 v3, v5, v5, v3
	v_sub_f32 v7, v61, v2
	v_fma_f32 v4, v7, v7, v4
	v_sub_f32 v5, v62, v2
	v_fma_f32 v3, v5, v5, v3
	v_sub_f32 v7, v63, v2
	v_fma_f32 v4, v7, v7, v4
	v_sub_f32 v5, v64, v2
	v_fma_f32 v3, v5, v5, v3
	v_sub_f32 v7, v65, v2
	v_fma_f32 v4, v7, v7, v4
	v_sub_f32 v5, v66, v2
	v_fma_f32 v3, v5, v5, v3
	v_sub_f32 v7, v67, v2
	v_fma_f32 v4, v7, v7, v4
	v_sub_f32 v5, v68, v2
	v_fma_f32 v3, v5, v5, v3
	v_sub_f32 v7, v69, v2
	v_fma_f32 v4, v7, v7, v4
	v_sub_f32 v5, v70, v2
	v_fma_f32 v3, v5, v5, v3
	v_sub_f32 v7, v71, v2
	v_fma_f32 v4, v7, v7, v4
	v_sub_f32 v5, v72, v2
	v_fma_f32 v3, v5, v5, v3
	v_sub_f32 v7, v73, v2
	v_fma_f32 v4, v7, v7, v4
	v_sub_f32 v5, v74, v2
	v_fma_f32 v3, v5, v5, v3
	v_sub_f32 v7, v75, v2
	v_fma_f32 v4, v7, v7, v4
	v_sub_f32 v5, v76, v2
	v_fma_f32 v3, v5, v5, v3
	v_sub_f32 v7, v77, v2
	v_fma_f32 v4, v7, v7, v4
	v_sub_f32 v5, v78, v2
	v_fma_f32 v3, v5, v5, v3
	v_sub_f32 v7, v79, v2
	v_fma_f32 v4, v7, v7, v4
	v_sub_f32 v5, v80, v2
	v_fma_f32 v3, v5, v5, v3
	v_sub_f32 v7, v81, v2
	v_fma_f32 v4, v7, v7, v4
	v_sub_f32 v5, v82, v2
	v_fma_f32 v3, v5, v5, v3
	v_sub_f32 v7, v83, v2
	v_fma_f32 v4, v7, v7, v4
	v_sub_f32 v5, v84, v2
	v_fma_f32 v3, v5, v5, v3
	v_sub_f32 v7, v85, v2
	v_fma_f32 v4, v7, v7, v4
	v_sub_f32 v5, v86, v2
	v_fma_f32 v3, v5, v5, v3
	v_sub_f32 v7, v87, v2
	v_fma_f32 v4, v7, v7, v4
	v_sub_f32 v5, v88, v2
	v_fma_f32 v3, v5, v5, v3
	v_sub_f32 v7, v89, v2
	v_fma_f32 v4, v7, v7, v4
	v_sub_f32 v5, v90, v2
	v_fma_f32 v3, v5, v5, v3
	v_sub_f32 v7, v91, v2
	v_fma_f32 v4, v7, v7, v4
	v_sub_f32 v5, v92, v2
	v_fma_f32 v3, v5, v5, v3
	v_sub_f32 v7, v93, v2
	v_fma_f32 v4, v7, v7, v4
	v_sub_f32 v5, v94, v2
	v_fma_f32 v3, v5, v5, v3
	v_sub_f32 v7, v95, v2
	v_fma_f32 v4, v7, v7, v4
	v_sub_f32 v5, v96, v2
	v_fma_f32 v3, v5, v5, v3
	v_sub_f32 v7, v97, v2
	v_fma_f32 v4, v7, v7, v4
	v_sub_f32 v5, v98, v2
	v_fma_f32 v3, v5, v5, v3
	v_sub_f32 v7, v99, v2
	v_fma_f32 v4, v7, v7, v4
	v_sub_f32 v5, v100, v2
	v_fma_f32 v3, v5, v5, v3
	v_sub_f32 v7, v101, v2
	v_fma_f32 v4, v7, v7, v4
	v_sub_f32 v5, v102, v2
	v_fma_f32 v3, v5, v5, v3
	v_sub_f32 v7, v103, v2
	v_fma_f32 v4, v7, v7, v4
	v_sub_f32 v5, v104, v2
	v_fma_f32 v3, v5, v5, v3
	v_sub_f32 v7, v105, v2
	v_fma_f32 v4, v7, v7, v4
	v_sub_f32 v5, v106, v2
	v_fma_f32 v3, v5, v5, v3
	v_sub_f32 v7, v107, v2
	v_fma_f32 v4, v7, v7, v4
	v_sub_f32 v5, v108, v2
	v_fma_f32 v3, v5, v5, v3
	v_sub_f32 v7, v109, v2
	v_fma_f32 v4, v7, v7, v4
	v_sub_f32 v5, v110, v2
	v_fma_f32 v3, v5, v5, v3
	v_sub_f32 v7, v111, v2
	v_fma_f32 v4, v7, v7, v4
	v_sub_f32 v5, v112, v2
	v_fma_f32 v3, v5, v5, v3
	v_sub_f32 v7, v113, v2
	v_fma_f32 v4, v7, v7, v4
	v_sub_f32 v5, v114, v2
	v_fma_f32 v3, v5, v5, v3
	v_sub_f32 v7, v115, v2
	v_fma_f32 v4, v7, v7, v4
	v_sub_f32 v5, v116, v2
	v_fma_f32 v3, v5, v5, v3
	v_sub_f32 v7, v117, v2
	v_fma_f32 v4, v7, v7, v4
	v_sub_f32 v5, v118, v2
	v_fma_f32 v3, v5, v5, v3
	v_sub_f32 v7, v119, v2
	v_fma_f32 v4, v7, v7, v4
	v_sub_f32 v5, v120, v2
	v_fma_f32 v3, v5, v5, v3
	v_sub_f32 v7, v121, v2
	v_fma_f32 v4, v7, v7, v4
	v_sub_f32 v5, v122, v2
	v_fma_f32 v3, v5, v5, v3
	v_sub_f32 v7, v123, v2
	v_fma_f32 v4, v7, v7, v4
	v_add_f32 v3, v3, v4
	s_nop 1
	v_add_f32_dpp v3, v3, v3 quad_perm:[1,0,3,2] row_mask:0xf bank_mask:0xf
	s_nop 1
	v_add_f32_dpp v3, v3, v3 quad_perm:[2,3,0,1] row_mask:0xf bank_mask:0xf
	s_nop 1
	v_add_f32_dpp v3, v3, v3 row_half_mirror row_mask:0xf bank_mask:0xf
	v_mul_f32 v3, 0x3ae38e39, v3
	v_cvt_pk_bf16_f32 v2, v2, v2
	v_lshlrev_b32 v2, 16, v2
	v_cvt_pk_bf16_f32 v3, v3, v3
	v_lshlrev_b32 v3, 16, v3
	v_add_f32 v3, 0x3727c5ac, v3
	v_cvt_pk_bf16_f32 v3, v3, v3
	v_lshlrev_b32 v3, 16, v3
	v_sqrt_f32 v3, v3
	s_nop 0
	v_cvt_pk_bf16_f32 v3, v3, v3
	v_lshlrev_b32 v3, 16, v3
	v_rcp_f32 v3, v3
	v_sub_f32 v52, v52, v2
	v_sub_f32 v53, v53, v2
	v_cvt_pk_bf16_f32 v4, v52, v53
	v_lshlrev_b32 v52, 16, v4
	v_and_b32 v53, 0xffff0000, v4
	v_mul_f32 v52, v52, v3
	v_mul_f32 v53, v53, v3
	v_cvt_pk_bf16_f32 v16, v52, v53
	v_sub_f32 v54, v54, v2
	v_sub_f32 v55, v55, v2
	v_cvt_pk_bf16_f32 v4, v54, v55
	v_lshlrev_b32 v54, 16, v4
	v_and_b32 v55, 0xffff0000, v4
	v_mul_f32 v54, v54, v3
	v_mul_f32 v55, v55, v3
	v_cvt_pk_bf16_f32 v17, v54, v55
	v_sub_f32 v56, v56, v2
	v_sub_f32 v57, v57, v2
	v_cvt_pk_bf16_f32 v4, v56, v57
	v_lshlrev_b32 v56, 16, v4
	v_and_b32 v57, 0xffff0000, v4
	v_mul_f32 v56, v56, v3
	v_mul_f32 v57, v57, v3
	v_cvt_pk_bf16_f32 v18, v56, v57
	v_sub_f32 v58, v58, v2
	v_sub_f32 v59, v59, v2
	v_cvt_pk_bf16_f32 v4, v58, v59
	v_lshlrev_b32 v58, 16, v4
	v_and_b32 v59, 0xffff0000, v4
	v_mul_f32 v58, v58, v3
	v_mul_f32 v59, v59, v3
	v_cvt_pk_bf16_f32 v19, v58, v59
	v_sub_f32 v60, v60, v2
	v_sub_f32 v61, v61, v2
	v_cvt_pk_bf16_f32 v4, v60, v61
	v_lshlrev_b32 v60, 16, v4
	v_and_b32 v61, 0xffff0000, v4
	v_mul_f32 v60, v60, v3
	v_mul_f32 v61, v61, v3
	v_cvt_pk_bf16_f32 v20, v60, v61
	v_sub_f32 v62, v62, v2
	v_sub_f32 v63, v63, v2
	v_cvt_pk_bf16_f32 v4, v62, v63
	v_lshlrev_b32 v62, 16, v4
	v_and_b32 v63, 0xffff0000, v4
	v_mul_f32 v62, v62, v3
	v_mul_f32 v63, v63, v3
	v_cvt_pk_bf16_f32 v21, v62, v63
	v_sub_f32 v64, v64, v2
	v_sub_f32 v65, v65, v2
	v_cvt_pk_bf16_f32 v4, v64, v65
	v_lshlrev_b32 v64, 16, v4
	v_and_b32 v65, 0xffff0000, v4
	v_mul_f32 v64, v64, v3
	v_mul_f32 v65, v65, v3
	v_cvt_pk_bf16_f32 v22, v64, v65
	v_sub_f32 v66, v66, v2
	v_sub_f32 v67, v67, v2
	v_cvt_pk_bf16_f32 v4, v66, v67
	v_lshlrev_b32 v66, 16, v4
	v_and_b32 v67, 0xffff0000, v4
	v_mul_f32 v66, v66, v3
	v_mul_f32 v67, v67, v3
	v_cvt_pk_bf16_f32 v23, v66, v67
	v_sub_f32 v68, v68, v2
	v_sub_f32 v69, v69, v2
	v_cvt_pk_bf16_f32 v4, v68, v69
	v_lshlrev_b32 v68, 16, v4
	v_and_b32 v69, 0xffff0000, v4
	v_mul_f32 v68, v68, v3
	v_mul_f32 v69, v69, v3
	v_cvt_pk_bf16_f32 v24, v68, v69
	v_sub_f32 v70, v70, v2
	v_sub_f32 v71, v71, v2
	v_cvt_pk_bf16_f32 v4, v70, v71
	v_lshlrev_b32 v70, 16, v4
	v_and_b32 v71, 0xffff0000, v4
	v_mul_f32 v70, v70, v3
	v_mul_f32 v71, v71, v3
	v_cvt_pk_bf16_f32 v25, v70, v71
	v_sub_f32 v72, v72, v2
	v_sub_f32 v73, v73, v2
	v_cvt_pk_bf16_f32 v4, v72, v73
	v_lshlrev_b32 v72, 16, v4
	v_and_b32 v73, 0xffff0000, v4
	v_mul_f32 v72, v72, v3
	v_mul_f32 v73, v73, v3
	v_cvt_pk_bf16_f32 v26, v72, v73
	v_sub_f32 v74, v74, v2
	v_sub_f32 v75, v75, v2
	v_cvt_pk_bf16_f32 v4, v74, v75
	v_lshlrev_b32 v74, 16, v4
	v_and_b32 v75, 0xffff0000, v4
	v_mul_f32 v74, v74, v3
	v_mul_f32 v75, v75, v3
	v_cvt_pk_bf16_f32 v27, v74, v75
	v_sub_f32 v76, v76, v2
	v_sub_f32 v77, v77, v2
	v_cvt_pk_bf16_f32 v4, v76, v77
	v_lshlrev_b32 v76, 16, v4
	v_and_b32 v77, 0xffff0000, v4
	v_mul_f32 v76, v76, v3
	v_mul_f32 v77, v77, v3
	v_cvt_pk_bf16_f32 v28, v76, v77
	v_sub_f32 v78, v78, v2
	v_sub_f32 v79, v79, v2
	v_cvt_pk_bf16_f32 v4, v78, v79
	v_lshlrev_b32 v78, 16, v4
	v_and_b32 v79, 0xffff0000, v4
	v_mul_f32 v78, v78, v3
	v_mul_f32 v79, v79, v3
	v_cvt_pk_bf16_f32 v29, v78, v79
	v_sub_f32 v80, v80, v2
	v_sub_f32 v81, v81, v2
	v_cvt_pk_bf16_f32 v4, v80, v81
	v_lshlrev_b32 v80, 16, v4
	v_and_b32 v81, 0xffff0000, v4
	v_mul_f32 v80, v80, v3
	v_mul_f32 v81, v81, v3
	v_cvt_pk_bf16_f32 v30, v80, v81
	v_sub_f32 v82, v82, v2
	v_sub_f32 v83, v83, v2
	v_cvt_pk_bf16_f32 v4, v82, v83
	v_lshlrev_b32 v82, 16, v4
	v_and_b32 v83, 0xffff0000, v4
	v_mul_f32 v82, v82, v3
	v_mul_f32 v83, v83, v3
	v_cvt_pk_bf16_f32 v31, v82, v83
	v_sub_f32 v84, v84, v2
	v_sub_f32 v85, v85, v2
	v_cvt_pk_bf16_f32 v4, v84, v85
	v_lshlrev_b32 v84, 16, v4
	v_and_b32 v85, 0xffff0000, v4
	v_mul_f32 v84, v84, v3
	v_mul_f32 v85, v85, v3
	v_cvt_pk_bf16_f32 v32, v84, v85
	v_sub_f32 v86, v86, v2
	v_sub_f32 v87, v87, v2
	v_cvt_pk_bf16_f32 v4, v86, v87
	v_lshlrev_b32 v86, 16, v4
	v_and_b32 v87, 0xffff0000, v4
	v_mul_f32 v86, v86, v3
	v_mul_f32 v87, v87, v3
	v_cvt_pk_bf16_f32 v33, v86, v87
	v_sub_f32 v88, v88, v2
	v_sub_f32 v89, v89, v2
	v_cvt_pk_bf16_f32 v4, v88, v89
	v_lshlrev_b32 v88, 16, v4
	v_and_b32 v89, 0xffff0000, v4
	v_mul_f32 v88, v88, v3
	v_mul_f32 v89, v89, v3
	v_cvt_pk_bf16_f32 v34, v88, v89
	v_sub_f32 v90, v90, v2
	v_sub_f32 v91, v91, v2
	v_cvt_pk_bf16_f32 v4, v90, v91
	v_lshlrev_b32 v90, 16, v4
	v_and_b32 v91, 0xffff0000, v4
	v_mul_f32 v90, v90, v3
	v_mul_f32 v91, v91, v3
	v_cvt_pk_bf16_f32 v35, v90, v91
	v_sub_f32 v92, v92, v2
	v_sub_f32 v93, v93, v2
	v_cvt_pk_bf16_f32 v4, v92, v93
	v_lshlrev_b32 v92, 16, v4
	v_and_b32 v93, 0xffff0000, v4
	v_mul_f32 v92, v92, v3
	v_mul_f32 v93, v93, v3
	v_cvt_pk_bf16_f32 v36, v92, v93
	v_sub_f32 v94, v94, v2
	v_sub_f32 v95, v95, v2
	v_cvt_pk_bf16_f32 v4, v94, v95
	v_lshlrev_b32 v94, 16, v4
	v_and_b32 v95, 0xffff0000, v4
	v_mul_f32 v94, v94, v3
	v_mul_f32 v95, v95, v3
	v_cvt_pk_bf16_f32 v37, v94, v95
	v_sub_f32 v96, v96, v2
	v_sub_f32 v97, v97, v2
	v_cvt_pk_bf16_f32 v4, v96, v97
	v_lshlrev_b32 v96, 16, v4
	v_and_b32 v97, 0xffff0000, v4
	v_mul_f32 v96, v96, v3
	v_mul_f32 v97, v97, v3
	v_cvt_pk_bf16_f32 v38, v96, v97
	v_sub_f32 v98, v98, v2
	v_sub_f32 v99, v99, v2
	v_cvt_pk_bf16_f32 v4, v98, v99
	v_lshlrev_b32 v98, 16, v4
	v_and_b32 v99, 0xffff0000, v4
	v_mul_f32 v98, v98, v3
	v_mul_f32 v99, v99, v3
	v_cvt_pk_bf16_f32 v39, v98, v99
	v_sub_f32 v100, v100, v2
	v_sub_f32 v101, v101, v2
	v_cvt_pk_bf16_f32 v4, v100, v101
	v_lshlrev_b32 v100, 16, v4
	v_and_b32 v101, 0xffff0000, v4
	v_mul_f32 v100, v100, v3
	v_mul_f32 v101, v101, v3
	v_cvt_pk_bf16_f32 v40, v100, v101
	v_sub_f32 v102, v102, v2
	v_sub_f32 v103, v103, v2
	v_cvt_pk_bf16_f32 v4, v102, v103
	v_lshlrev_b32 v102, 16, v4
	v_and_b32 v103, 0xffff0000, v4
	v_mul_f32 v102, v102, v3
	v_mul_f32 v103, v103, v3
	v_cvt_pk_bf16_f32 v41, v102, v103
	v_sub_f32 v104, v104, v2
	v_sub_f32 v105, v105, v2
	v_cvt_pk_bf16_f32 v4, v104, v105
	v_lshlrev_b32 v104, 16, v4
	v_and_b32 v105, 0xffff0000, v4
	v_mul_f32 v104, v104, v3
	v_mul_f32 v105, v105, v3
	v_cvt_pk_bf16_f32 v42, v104, v105
	v_sub_f32 v106, v106, v2
	v_sub_f32 v107, v107, v2
	v_cvt_pk_bf16_f32 v4, v106, v107
	v_lshlrev_b32 v106, 16, v4
	v_and_b32 v107, 0xffff0000, v4
	v_mul_f32 v106, v106, v3
	v_mul_f32 v107, v107, v3
	v_cvt_pk_bf16_f32 v43, v106, v107
	v_sub_f32 v108, v108, v2
	v_sub_f32 v109, v109, v2
	v_cvt_pk_bf16_f32 v4, v108, v109
	v_lshlrev_b32 v108, 16, v4
	v_and_b32 v109, 0xffff0000, v4
	v_mul_f32 v108, v108, v3
	v_mul_f32 v109, v109, v3
	v_cvt_pk_bf16_f32 v44, v108, v109
	v_sub_f32 v110, v110, v2
	v_sub_f32 v111, v111, v2
	v_cvt_pk_bf16_f32 v4, v110, v111
	v_lshlrev_b32 v110, 16, v4
	v_and_b32 v111, 0xffff0000, v4
	v_mul_f32 v110, v110, v3
	v_mul_f32 v111, v111, v3
	v_cvt_pk_bf16_f32 v45, v110, v111
	v_sub_f32 v112, v112, v2
	v_sub_f32 v113, v113, v2
	v_cvt_pk_bf16_f32 v4, v112, v113
	v_lshlrev_b32 v112, 16, v4
	v_and_b32 v113, 0xffff0000, v4
	v_mul_f32 v112, v112, v3
	v_mul_f32 v113, v113, v3
	v_cvt_pk_bf16_f32 v46, v112, v113
	v_sub_f32 v114, v114, v2
	v_sub_f32 v115, v115, v2
	v_cvt_pk_bf16_f32 v4, v114, v115
	v_lshlrev_b32 v114, 16, v4
	v_and_b32 v115, 0xffff0000, v4
	v_mul_f32 v114, v114, v3
	v_mul_f32 v115, v115, v3
	v_cvt_pk_bf16_f32 v47, v114, v115
	v_sub_f32 v116, v116, v2
	v_sub_f32 v117, v117, v2
	v_cvt_pk_bf16_f32 v4, v116, v117
	v_lshlrev_b32 v116, 16, v4
	v_and_b32 v117, 0xffff0000, v4
	v_mul_f32 v116, v116, v3
	v_mul_f32 v117, v117, v3
	v_cvt_pk_bf16_f32 v48, v116, v117
	v_sub_f32 v118, v118, v2
	v_sub_f32 v119, v119, v2
	v_cvt_pk_bf16_f32 v4, v118, v119
	v_lshlrev_b32 v118, 16, v4
	v_and_b32 v119, 0xffff0000, v4
	v_mul_f32 v118, v118, v3
	v_mul_f32 v119, v119, v3
	v_cvt_pk_bf16_f32 v49, v118, v119
	v_sub_f32 v120, v120, v2
	v_sub_f32 v121, v121, v2
	v_cvt_pk_bf16_f32 v4, v120, v121
	v_lshlrev_b32 v120, 16, v4
	v_and_b32 v121, 0xffff0000, v4
	v_mul_f32 v120, v120, v3
	v_mul_f32 v121, v121, v3
	v_cvt_pk_bf16_f32 v50, v120, v121
	v_sub_f32 v122, v122, v2
	v_sub_f32 v123, v123, v2
	v_cvt_pk_bf16_f32 v4, v122, v123
	v_lshlrev_b32 v122, 16, v4
	v_and_b32 v123, 0xffff0000, v4
	v_mul_f32 v122, v122, v3
	v_mul_f32 v123, v123, v3
	v_cvt_pk_bf16_f32 v51, v122, v123
	buffer_store_dwordx4 v[16:19], v6, s[8:11], 0 offen offset:0 sc1
	buffer_store_dwordx4 v[20:23], v6, s[8:11], 0 offen offset:128 sc1
	buffer_store_dwordx4 v[24:27], v6, s[8:11], 0 offen offset:256 sc1
	buffer_store_dwordx4 v[28:31], v6, s[8:11], 0 offen offset:384 sc1
	buffer_store_dwordx4 v[32:35], v6, s[8:11], 0 offen offset:512 sc1
	buffer_store_dwordx4 v[36:39], v6, s[8:11], 0 offen offset:640 sc1
	buffer_store_dwordx4 v[40:43], v6, s[8:11], 0 offen offset:768 sc1
	buffer_store_dwordx4 v[44:47], v6, s[8:11], 0 offen offset:896 sc1
	buffer_store_dwordx4 v[48:51], v6, s[8:11], 0 offen offset:1024 sc1
	s_waitcnt vmcnt(0)
	s_branch main_kernel_lnbar
main_kernel_lnskip:
main_kernel_lnbar:
	s_waitcnt lgkmcnt(0)
	s_barrier
	s_lshl_b32 s93, s88, 2
	s_add_u32 s93, s93, 112
	s_cmp_lg_u32 s4, 0
	s_cbranch_scc1 main_kernel_lnsig
	s_mov_b64 exec, 1
	v_mov_b32 v13, 1
	v_mov_b32 v14, s93
	buffer_atomic_add v13, v14, s[96:99], 0 offen sc1
	s_cmp_lg_u32 s88, 0
	s_cbranch_scc1 main_kernel_lnsig2
	v_mov_b32 v14, 140
	buffer_atomic_add v13, v14, s[96:99], 0 offen sc1
main_kernel_lnsig2:
	s_mov_b64 exec, -1
main_kernel_lnsig:
	s_cmp_eq_u32 s101, 0
	s_cbranch_scc1 main_kernel_lnbig
	s_mov_b32 s93, 112
	s_cmp_lg_u32 s4, 0
	s_cbranch_scc1 main_kernel_lnacq0_go
	v_mov_b32 v14, s93
main_kernel_lnacq0_poll:
	buffer_load_dword v13, v14, s[96:99], 0 offen sc1
	s_waitcnt vmcnt(0)
	v_readfirstlane_b32 s95, v13
	s_sub_u32 s94, s94, 1
	s_cbranch_scc1 main_kernel_lnacq0_got
	s_cmp_ge_u32 s95, 32
	s_cbranch_scc1 main_kernel_lnacq0_got
	s_sleep 4
	s_branch main_kernel_lnacq0_poll
main_kernel_lnacq0_got:
	buffer_inv sc1
	s_waitcnt vmcnt(0)
main_kernel_lnacq0_go:
	s_barrier
	s_lshr_b32 s21, s91, 4
	s_min_u32 s21, s21, 3
	s_lshl_b32 s22, s21, 3
	s_add_u32 s22, s22, 16
	s_cmp_eq_u32 s21, 3
	s_cselect_b32 s22, 64, s22
	s_load_dwordx2 s[12:13], s[0:1], s22
	s_load_dwordx2 s[32:33], s[0:1], 72
	s_mov_b32 s34, 9216
	s_mov_b32 s18, 8192
	s_cselect_b32 s18, 9216, s18
	s_mul_i32 s14, s18, 576
	s_lshl_b32 s40, s21, 4
	s_sub_u32 s27, s91, s40
	s_lshl_b32 s27, s27, 8
	s_lshl_b32 s17, s27, 1
	s_mul_i32 s28, s92, 64
	s_mul_i32 s16, s28, 1152
	s_add_u32 s16, s16, 0
	s_mov_b32 s43, s21
	s_waitcnt lgkmcnt(0)
	v_lshrrev_b32 v13, 4, v0
	s_and_b32 s21, s4, 1
	s_lshl_b32 s21, s21, 2
	v_add_u32 v13, s21, v13
	v_and_b32 v14, 7, v0
	v_xor_b32 v13, v13, v14
	v_lshlrev_b32 v13, 4, v13
	v_lshrrev_b32 v14, 3, v0
	s_lshl_b32 s21, s4, 3
	v_add_u32 v14, s21, v14
	s_mov_b32 s21, 1152
	v_mul_lo_u32 v14, v14, s21
	v_add_u32 v1, v13, v14
	v_lshrrev_b32 v13, 5, v0
	s_and_b32 s21, s4, 1
	s_lshl_b32 s21, s21, 1
	v_add_u32 v14, s21, v13
	v_lshlrev_b32 v14, 2, v14
	v_and_b32 v15, 31, v0
	v_xor_b32 v14, v14, v15
	v_lshlrev_b32 v14, 4, v14
	s_lshl_b32 s21, s4, 1
	v_add_u32 v13, s21, v13
	v_mul_lo_u32 v13, v13, s18
	v_add_u32 v2, v13, v14
	s_lshl_b32 s24, s18, 3
	v_and_b32 v13, 31, v0
	v_bfe_u32 v14, v0, 1, 3
	v_lshrrev_b32 v15, 5, v0
	v_xor_b32 v14, v14, v15
	v_lshlrev_b32 v14, 4, v14
	s_lshr_b32 s21, s4, 1
	s_mul_i32 s21, s21, 32
	v_add_u32 v13, s21, v13
	v_lshl_add_u32 v5, v13, 7, v14
	v_xor_b32 v6, 32, v5
	v_xor_b32 v7, 64, v5
	v_xor_b32 v8, 96, v5
	v_bfe_u32 v15, v0, 2, 2
	v_lshrrev_b32 v13, 5, v0
	v_lshl_add_u32 v13, v13, 3, v15
	v_mul_u32_u24 v13, 512, v13
	v_and_b32 v14, 1, v0
	v_lshl_add_u32 v13, v14, 3, v13
	v_add_u32 v13, 8192, v13
	v_lshlrev_b32 v15, 2, v15
	v_bfe_u32 v14, v0, 4, 1
	v_lshlrev_b32 v14, 1, v14
	v_bfe_u32 v9, v0, 1, 1
	v_add_u32 v14, v14, v9
	s_and_b32 s21, s4, 1
	s_mul_i32 s21, s21, 16
	s_add_u32 s21, s21, 0
	v_add_u32 v14, s21, v14
	v_xor_b32 v14, v14, v15
	v_lshl_add_u32 v9, v14, 4, v13
	v_bfe_u32 v14, v0, 4, 1
	v_lshlrev_b32 v14, 1, v14
	v_bfe_u32 v10, v0, 1, 1
	v_add_u32 v14, v14, v10
	s_and_b32 s21, s4, 1
	s_mul_i32 s21, s21, 16
	s_add_u32 s21, s21, 4
	v_add_u32 v14, s21, v14
	v_xor_b32 v14, v14, v15
	v_lshl_add_u32 v10, v14, 4, v13
	v_bfe_u32 v14, v0, 4, 1
	v_lshlrev_b32 v14, 1, v14
	v_bfe_u32 v11, v0, 1, 1
	v_add_u32 v14, v14, v11
	s_and_b32 s21, s4, 1
	s_mul_i32 s21, s21, 16
	s_add_u32 s21, s21, 8
	v_add_u32 v14, s21, v14
	v_xor_b32 v14, v14, v15
	v_lshl_add_u32 v11, v14, 4, v13
	v_bfe_u32 v14, v0, 4, 1
	v_lshlrev_b32 v14, 1, v14
	v_bfe_u32 v12, v0, 1, 1
	v_add_u32 v14, v14, v12
	s_and_b32 s21, s4, 1
	s_mul_i32 s21, s21, 16
	s_add_u32 s21, s21, 12
	v_add_u32 v14, s21, v14
	v_xor_b32 v14, v14, v15
	v_lshl_add_u32 v12, v14, 4, v13
	s_cmp_eq_u32 s43, 2
	s_cbranch_scc1 main_kernel_g1x_vt
	s_lshl_b32 s40, s4, 10
	s_mul_i32 s41, s4, 6144
	s_lshl_b32 s42, s18, 6
	s_mov_b32 s19, s16
	s_mov_b32 s20, s17
	s_add_u32 m0, s40, 0
	s_add_u32 s21, s19, 0
	buffer_load_dwordx4 v1, s[8:11], s21 offen lds
	s_add_u32 m0, s40, 4096
	s_add_u32 s21, s19, 36864
	buffer_load_dwordx4 v1, s[8:11], s21 offen lds
	s_add_u32 m0, s40, 8192
	s_mov_b32 s22, s20
	buffer_load_dwordx4 v2, s[12:15], s22 offen lds
	s_add_u32 m0, s40, 12288
	s_add_u32 s22, s22, s24
	buffer_load_dwordx4 v2, s[12:15], s22 offen lds
	s_add_u32 m0, s40, 16384
	s_add_u32 s22, s22, s24
	buffer_load_dwordx4 v2, s[12:15], s22 offen lds
	s_add_u32 m0, s40, 20480
	s_add_u32 s22, s22, s24
	buffer_load_dwordx4 v2, s[12:15], s22 offen lds
	s_add_u32 m0, s40, 24576
	s_add_u32 s22, s22, s24
	buffer_load_dwordx4 v2, s[12:15], s22 offen lds
	s_add_u32 m0, s40, 28672
	s_add_u32 s22, s22, s24
	buffer_load_dwordx4 v2, s[12:15], s22 offen lds
	s_add_u32 m0, s40, 32768
	s_add_u32 s22, s22, s24
	buffer_load_dwordx4 v2, s[12:15], s22 offen lds
	s_add_u32 m0, s40, 36864
	s_add_u32 s22, s22, s24
	buffer_load_dwordx4 v2, s[12:15], s22 offen lds
	s_add_u32 s19, s19, 128
	s_add_u32 s20, s20, s42
	s_add_u32 m0, s40, 40960
	s_add_u32 s21, s19, 0
	buffer_load_dwordx4 v1, s[8:11], s21 offen lds
	s_add_u32 m0, s40, 45056
	s_add_u32 s21, s19, 36864
	buffer_load_dwordx4 v1, s[8:11], s21 offen lds
	s_add_u32 m0, s40, 49152
	s_mov_b32 s22, s20
	buffer_load_dwordx4 v2, s[12:15], s22 offen lds
	s_add_u32 m0, s40, 53248
	s_add_u32 s22, s22, s24
	buffer_load_dwordx4 v2, s[12:15], s22 offen lds
	s_add_u32 m0, s40, 57344
	s_add_u32 s22, s22, s24
	buffer_load_dwordx4 v2, s[12:15], s22 offen lds
	s_add_u32 m0, s40, 61440
	s_add_u32 s22, s22, s24
	buffer_load_dwordx4 v2, s[12:15], s22 offen lds
	s_add_u32 m0, s40, 65536
	s_add_u32 s22, s22, s24
	buffer_load_dwordx4 v2, s[12:15], s22 offen lds
	s_add_u32 m0, s40, 69632
	s_add_u32 s22, s22, s24
	buffer_load_dwordx4 v2, s[12:15], s22 offen lds
	s_add_u32 m0, s40, 73728
	s_add_u32 s22, s22, s24
	buffer_load_dwordx4 v2, s[12:15], s22 offen lds
	s_add_u32 m0, s40, 77824
	s_add_u32 s22, s22, s24
	buffer_load_dwordx4 v2, s[12:15], s22 offen lds
	s_add_u32 s19, s19, 128
	s_add_u32 s20, s20, s42
	s_add_u32 m0, s40, 81920
	s_add_u32 s21, s19, 0
	buffer_load_dwordx4 v1, s[8:11], s21 offen lds
	s_add_u32 m0, s40, 86016
	s_add_u32 s21, s19, 36864
	buffer_load_dwordx4 v1, s[8:11], s21 offen lds
	s_add_u32 m0, s40, 90112
	s_mov_b32 s22, s20
	buffer_load_dwordx4 v2, s[12:15], s22 offen lds
	s_add_u32 m0, s40, 94208
	s_add_u32 s22, s22, s24
	buffer_load_dwordx4 v2, s[12:15], s22 offen lds
	s_add_u32 m0, s40, 98304
	s_add_u32 s22, s22, s24
	buffer_load_dwordx4 v2, s[12:15], s22 offen lds
	s_add_u32 m0, s40, 102400
	s_add_u32 s22, s22, s24
	buffer_load_dwordx4 v2, s[12:15], s22 offen lds
	s_add_u32 m0, s40, 106496
	s_add_u32 s22, s22, s24
	buffer_load_dwordx4 v2, s[12:15], s22 offen lds
	s_add_u32 m0, s40, 110592
	s_add_u32 s22, s22, s24
	buffer_load_dwordx4 v2, s[12:15], s22 offen lds
	s_add_u32 m0, s40, 114688
	s_add_u32 s22, s22, s24
	buffer_load_dwordx4 v2, s[12:15], s22 offen lds
	s_add_u32 m0, s40, 118784
	s_add_u32 s22, s22, s24
	buffer_load_dwordx4 v2, s[12:15], s22 offen lds
	s_add_u32 s19, s19, 128
	s_add_u32 s20, s20, s42
	s_waitcnt vmcnt(20)
	s_barrier
	ds_read_b64_tr_b16 v[16:17], v9 offset:0
	ds_read_b64_tr_b16 v[18:19], v9 offset:2048
	ds_read_b128 v[32:35], v5 offset:0
	ds_read_b64_tr_b16 v[20:21], v10 offset:0
	ds_read_b64_tr_b16 v[22:23], v10 offset:2048
	ds_read_b64_tr_b16 v[24:25], v11 offset:0
	ds_read_b64_tr_b16 v[26:27], v11 offset:2048
	ds_read_b64_tr_b16 v[28:29], v12 offset:0
	ds_read_b64_tr_b16 v[30:31], v12 offset:2048
	s_waitcnt lgkmcnt(6)
	v_mfma_f32_32x32x16_bf16 a[0:15], v[16:19], v[32:35], 0
	ds_read_b64_tr_b16 v[36:37], v9 offset:8192
	ds_read_b64_tr_b16 v[38:39], v9 offset:10240
	ds_read_b128 v[52:55], v6 offset:0
	s_waitcnt lgkmcnt(7)
	v_mfma_f32_32x32x16_bf16 a[16:31], v[20:23], v[32:35], 0
	ds_read_b64_tr_b16 v[40:41], v10 offset:8192
	ds_read_b64_tr_b16 v[42:43], v10 offset:10240
	s_waitcnt lgkmcnt(7)
	v_mfma_f32_32x32x16_bf16 a[32:47], v[24:27], v[32:35], 0
	ds_read_b64_tr_b16 v[44:45], v11 offset:8192
	ds_read_b64_tr_b16 v[46:47], v11 offset:10240
	s_waitcnt lgkmcnt(7)
	v_mfma_f32_32x32x16_bf16 a[48:63], v[28:31], v[32:35], 0
	ds_read_b64_tr_b16 v[48:49], v12 offset:8192
	ds_read_b64_tr_b16 v[50:51], v12 offset:10240
	s_waitcnt lgkmcnt(6)
	v_mfma_f32_32x32x16_bf16 a[0:15], v[36:39], v[52:55], a[0:15]
	ds_read_b64_tr_b16 v[16:17], v9 offset:16384
	ds_read_b64_tr_b16 v[18:19], v9 offset:18432
	ds_read_b128 v[32:35], v7 offset:0
	s_waitcnt lgkmcnt(7)
	v_mfma_f32_32x32x16_bf16 a[16:31], v[40:43], v[52:55], a[16:31]
	ds_read_b64_tr_b16 v[20:21], v10 offset:16384
	ds_read_b64_tr_b16 v[22:23], v10 offset:18432
	s_waitcnt lgkmcnt(7)
	v_mfma_f32_32x32x16_bf16 a[32:47], v[44:47], v[52:55], a[32:47]
	ds_read_b64_tr_b16 v[24:25], v11 offset:16384
	ds_read_b64_tr_b16 v[26:27], v11 offset:18432
	s_waitcnt lgkmcnt(7)
	v_mfma_f32_32x32x16_bf16 a[48:63], v[48:51], v[52:55], a[48:63]
	ds_read_b64_tr_b16 v[28:29], v12 offset:16384
	ds_read_b64_tr_b16 v[30:31], v12 offset:18432
	s_waitcnt lgkmcnt(6)
	v_mfma_f32_32x32x16_bf16 a[0:15], v[16:19], v[32:35], a[0:15]
	ds_read_b64_tr_b16 v[36:37], v9 offset:24576
	ds_read_b64_tr_b16 v[38:39], v9 offset:26624
	ds_read_b128 v[52:55], v8 offset:0
	s_waitcnt lgkmcnt(7)
	v_mfma_f32_32x32x16_bf16 a[16:31], v[20:23], v[32:35], a[16:31]
	ds_read_b64_tr_b16 v[40:41], v10 offset:24576
	ds_read_b64_tr_b16 v[42:43], v10 offset:26624
	s_waitcnt lgkmcnt(7)
	v_mfma_f32_32x32x16_bf16 a[32:47], v[24:27], v[32:35], a[32:47]
	ds_read_b64_tr_b16 v[44:45], v11 offset:24576
	ds_read_b64_tr_b16 v[46:47], v11 offset:26624
	s_waitcnt lgkmcnt(7)
	v_mfma_f32_32x32x16_bf16 a[48:63], v[28:31], v[32:35], a[48:63]
	ds_read_b64_tr_b16 v[48:49], v12 offset:24576
	ds_read_b64_tr_b16 v[50:51], v12 offset:26624
	s_waitcnt vmcnt(10) lgkmcnt(0)
	s_barrier
	v_add_u32 v5, 0xa000, v5
	v_add_u32 v6, 0xa000, v6
	v_add_u32 v7, 0xa000, v7
	v_add_u32 v8, 0xa000, v8
	v_add_u32 v9, 0xa000, v9
	v_add_u32 v10, 0xa000, v10
	v_add_u32 v11, 0xa000, v11
	v_add_u32 v12, 0xa000, v12
	v_mfma_f32_32x32x16_bf16 a[0:15], v[36:39], v[52:55], a[0:15]
	ds_read_b64_tr_b16 v[16:17], v9 offset:0
	ds_read_b64_tr_b16 v[18:19], v9 offset:2048
	ds_read_b128 v[32:35], v5 offset:0
	s_add_u32 m0, s40, 0
	s_add_u32 s21, s19, 0
	buffer_load_dwordx4 v1, s[8:11], s21 offen lds
	s_add_u32 m0, s40, 4096
	s_add_u32 s21, s19, 36864
	buffer_load_dwordx4 v1, s[8:11], s21 offen lds
	v_mfma_f32_32x32x16_bf16 a[16:31], v[40:43], v[52:55], a[16:31]
	s_add_u32 m0, s40, 8192
	s_mov_b32 s22, s20
	buffer_load_dwordx4 v2, s[12:15], s22 offen lds
	s_add_u32 m0, s40, 12288
	s_add_u32 s22, s22, s24
	buffer_load_dwordx4 v2, s[12:15], s22 offen lds
	ds_read_b64_tr_b16 v[20:21], v10 offset:0
	ds_read_b64_tr_b16 v[22:23], v10 offset:2048
	ds_read_b64_tr_b16 v[24:25], v11 offset:0
	v_mfma_f32_32x32x16_bf16 a[32:47], v[44:47], v[52:55], a[32:47]
	ds_read_b64_tr_b16 v[26:27], v11 offset:2048
	ds_read_b64_tr_b16 v[28:29], v12 offset:0
	ds_read_b64_tr_b16 v[30:31], v12 offset:2048
	s_add_u32 m0, s40, 16384
	s_add_u32 s22, s22, s24
	buffer_load_dwordx4 v2, s[12:15], s22 offen lds
	s_add_u32 m0, s40, 20480
	s_add_u32 s22, s22, s24
	buffer_load_dwordx4 v2, s[12:15], s22 offen lds
	v_mfma_f32_32x32x16_bf16 a[48:63], v[48:51], v[52:55], a[48:63]
	s_add_u32 m0, s40, 24576
	s_add_u32 s22, s22, s24
	buffer_load_dwordx4 v2, s[12:15], s22 offen lds
	s_add_u32 m0, s40, 28672
	s_add_u32 s22, s22, s24
	buffer_load_dwordx4 v2, s[12:15], s22 offen lds
	s_add_u32 m0, s40, 32768
	s_add_u32 s22, s22, s24
	buffer_load_dwordx4 v2, s[12:15], s22 offen lds
	s_add_u32 m0, s40, 36864
	s_add_u32 s22, s22, s24
	buffer_load_dwordx4 v2, s[12:15], s22 offen lds
	s_add_u32 s19, s19, 128
	s_add_u32 s20, s20, s42
	s_waitcnt lgkmcnt(6)
	v_mfma_f32_32x32x16_bf16 a[0:15], v[16:19], v[32:35], a[0:15]
	ds_read_b64_tr_b16 v[36:37], v9 offset:8192
	ds_read_b64_tr_b16 v[38:39], v9 offset:10240
	ds_read_b128 v[52:55], v6 offset:0
	s_waitcnt lgkmcnt(7)
	v_mfma_f32_32x32x16_bf16 a[16:31], v[20:23], v[32:35], a[16:31]
	ds_read_b64_tr_b16 v[40:41], v10 offset:8192
	ds_read_b64_tr_b16 v[42:43], v10 offset:10240
	s_waitcnt lgkmcnt(7)
	v_mfma_f32_32x32x16_bf16 a[32:47], v[24:27], v[32:35], a[32:47]
	ds_read_b64_tr_b16 v[44:45], v11 offset:8192
	ds_read_b64_tr_b16 v[46:47], v11 offset:10240
	s_waitcnt lgkmcnt(7)
	v_mfma_f32_32x32x16_bf16 a[48:63], v[28:31], v[32:35], a[48:63]
	ds_read_b64_tr_b16 v[48:49], v12 offset:8192
	ds_read_b64_tr_b16 v[50:51], v12 offset:10240
	s_waitcnt lgkmcnt(6)
	v_mfma_f32_32x32x16_bf16 a[0:15], v[36:39], v[52:55], a[0:15]
	ds_read_b64_tr_b16 v[16:17], v9 offset:16384
	ds_read_b64_tr_b16 v[18:19], v9 offset:18432
	ds_read_b128 v[32:35], v7 offset:0
	s_waitcnt lgkmcnt(7)
	v_mfma_f32_32x32x16_bf16 a[16:31], v[40:43], v[52:55], a[16:31]
	ds_read_b64_tr_b16 v[20:21], v10 offset:16384
	ds_read_b64_tr_b16 v[22:23], v10 offset:18432
	s_waitcnt lgkmcnt(7)
	v_mfma_f32_32x32x16_bf16 a[32:47], v[44:47], v[52:55], a[32:47]
	ds_read_b64_tr_b16 v[24:25], v11 offset:16384
	ds_read_b64_tr_b16 v[26:27], v11 offset:18432
	s_waitcnt lgkmcnt(7)
	v_mfma_f32_32x32x16_bf16 a[48:63], v[48:51], v[52:55], a[48:63]
	ds_read_b64_tr_b16 v[28:29], v12 offset:16384
	ds_read_b64_tr_b16 v[30:31], v12 offset:18432
	s_waitcnt lgkmcnt(6)
	v_mfma_f32_32x32x16_bf16 a[0:15], v[16:19], v[32:35], a[0:15]
	ds_read_b64_tr_b16 v[36:37], v9 offset:24576
	ds_read_b64_tr_b16 v[38:39], v9 offset:26624
	ds_read_b128 v[52:55], v8 offset:0
	s_waitcnt lgkmcnt(7)
	v_mfma_f32_32x32x16_bf16 a[16:31], v[20:23], v[32:35], a[16:31]
	ds_read_b64_tr_b16 v[40:41], v10 offset:24576
	ds_read_b64_tr_b16 v[42:43], v10 offset:26624
	s_waitcnt lgkmcnt(7)
	v_mfma_f32_32x32x16_bf16 a[32:47], v[24:27], v[32:35], a[32:47]
	ds_read_b64_tr_b16 v[44:45], v11 offset:24576
	ds_read_b64_tr_b16 v[46:47], v11 offset:26624
	s_waitcnt lgkmcnt(7)
	v_mfma_f32_32x32x16_bf16 a[48:63], v[28:31], v[32:35], a[48:63]
	ds_read_b64_tr_b16 v[48:49], v12 offset:24576
	ds_read_b64_tr_b16 v[50:51], v12 offset:26624
	s_waitcnt vmcnt(10) lgkmcnt(0)
	s_barrier
	v_add_u32 v5, 0xa000, v5
	v_add_u32 v6, 0xa000, v6
	v_add_u32 v7, 0xa000, v7
	v_add_u32 v8, 0xa000, v8
	v_add_u32 v9, 0xa000, v9
	v_add_u32 v10, 0xa000, v10
	v_add_u32 v11, 0xa000, v11
	v_add_u32 v12, 0xa000, v12
	v_mfma_f32_32x32x16_bf16 a[0:15], v[36:39], v[52:55], a[0:15]
	ds_read_b64_tr_b16 v[16:17], v9 offset:0
	ds_read_b64_tr_b16 v[18:19], v9 offset:2048
	ds_read_b128 v[32:35], v5 offset:0
	s_add_u32 m0, s40, 40960
	s_add_u32 s21, s19, 0
	buffer_load_dwordx4 v1, s[8:11], s21 offen lds
	s_add_u32 m0, s40, 45056
	s_add_u32 s21, s19, 36864
	buffer_load_dwordx4 v1, s[8:11], s21 offen lds
	v_mfma_f32_32x32x16_bf16 a[16:31], v[40:43], v[52:55], a[16:31]
	s_add_u32 m0, s40, 49152
	s_mov_b32 s22, s20
	buffer_load_dwordx4 v2, s[12:15], s22 offen lds
	s_add_u32 m0, s40, 53248
	s_add_u32 s22, s22, s24
	buffer_load_dwordx4 v2, s[12:15], s22 offen lds
	ds_read_b64_tr_b16 v[20:21], v10 offset:0
	ds_read_b64_tr_b16 v[22:23], v10 offset:2048
	ds_read_b64_tr_b16 v[24:25], v11 offset:0
	v_mfma_f32_32x32x16_bf16 a[32:47], v[44:47], v[52:55], a[32:47]
	ds_read_b64_tr_b16 v[26:27], v11 offset:2048
	ds_read_b64_tr_b16 v[28:29], v12 offset:0
	ds_read_b64_tr_b16 v[30:31], v12 offset:2048
	s_add_u32 m0, s40, 57344
	s_add_u32 s22, s22, s24
	buffer_load_dwordx4 v2, s[12:15], s22 offen lds
	s_add_u32 m0, s40, 61440
	s_add_u32 s22, s22, s24
	buffer_load_dwordx4 v2, s[12:15], s22 offen lds
	v_mfma_f32_32x32x16_bf16 a[48:63], v[48:51], v[52:55], a[48:63]
	s_add_u32 m0, s40, 65536
	s_add_u32 s22, s22, s24
	buffer_load_dwordx4 v2, s[12:15], s22 offen lds
	s_add_u32 m0, s40, 69632
	s_add_u32 s22, s22, s24
	buffer_load_dwordx4 v2, s[12:15], s22 offen lds
	s_add_u32 m0, s40, 73728
	s_add_u32 s22, s22, s24
	buffer_load_dwordx4 v2, s[12:15], s22 offen lds
	s_add_u32 m0, s40, 77824
	s_add_u32 s22, s22, s24
	buffer_load_dwordx4 v2, s[12:15], s22 offen lds
	s_add_u32 s19, s19, 128
	s_add_u32 s20, s20, s42
	s_waitcnt lgkmcnt(6)
	v_mfma_f32_32x32x16_bf16 a[0:15], v[16:19], v[32:35], a[0:15]
	ds_read_b64_tr_b16 v[36:37], v9 offset:8192
	ds_read_b64_tr_b16 v[38:39], v9 offset:10240
	ds_read_b128 v[52:55], v6 offset:0
	s_waitcnt lgkmcnt(7)
	v_mfma_f32_32x32x16_bf16 a[16:31], v[20:23], v[32:35], a[16:31]
	ds_read_b64_tr_b16 v[40:41], v10 offset:8192
	ds_read_b64_tr_b16 v[42:43], v10 offset:10240
	s_waitcnt lgkmcnt(7)
	v_mfma_f32_32x32x16_bf16 a[32:47], v[24:27], v[32:35], a[32:47]
	ds_read_b64_tr_b16 v[44:45], v11 offset:8192
	ds_read_b64_tr_b16 v[46:47], v11 offset:10240
	s_waitcnt lgkmcnt(7)
	v_mfma_f32_32x32x16_bf16 a[48:63], v[28:31], v[32:35], a[48:63]
	ds_read_b64_tr_b16 v[48:49], v12 offset:8192
	ds_read_b64_tr_b16 v[50:51], v12 offset:10240
	s_waitcnt lgkmcnt(6)
	v_mfma_f32_32x32x16_bf16 a[0:15], v[36:39], v[52:55], a[0:15]
	ds_read_b64_tr_b16 v[16:17], v9 offset:16384
	ds_read_b64_tr_b16 v[18:19], v9 offset:18432
	ds_read_b128 v[32:35], v7 offset:0
	s_waitcnt lgkmcnt(7)
	v_mfma_f32_32x32x16_bf16 a[16:31], v[40:43], v[52:55], a[16:31]
	ds_read_b64_tr_b16 v[20:21], v10 offset:16384
	ds_read_b64_tr_b16 v[22:23], v10 offset:18432
	s_waitcnt lgkmcnt(7)
	v_mfma_f32_32x32x16_bf16 a[32:47], v[44:47], v[52:55], a[32:47]
	ds_read_b64_tr_b16 v[24:25], v11 offset:16384
	ds_read_b64_tr_b16 v[26:27], v11 offset:18432
	s_waitcnt lgkmcnt(7)
	v_mfma_f32_32x32x16_bf16 a[48:63], v[48:51], v[52:55], a[48:63]
	ds_read_b64_tr_b16 v[28:29], v12 offset:16384
	ds_read_b64_tr_b16 v[30:31], v12 offset:18432
	s_waitcnt lgkmcnt(6)
	v_mfma_f32_32x32x16_bf16 a[0:15], v[16:19], v[32:35], a[0:15]
	ds_read_b64_tr_b16 v[36:37], v9 offset:24576
	ds_read_b64_tr_b16 v[38:39], v9 offset:26624
	ds_read_b128 v[52:55], v8 offset:0
	s_waitcnt lgkmcnt(7)
	v_mfma_f32_32x32x16_bf16 a[16:31], v[20:23], v[32:35], a[16:31]
	ds_read_b64_tr_b16 v[40:41], v10 offset:24576
	ds_read_b64_tr_b16 v[42:43], v10 offset:26624
	s_waitcnt lgkmcnt(7)
	v_mfma_f32_32x32x16_bf16 a[32:47], v[24:27], v[32:35], a[32:47]
	ds_read_b64_tr_b16 v[44:45], v11 offset:24576
	ds_read_b64_tr_b16 v[46:47], v11 offset:26624
	s_waitcnt lgkmcnt(7)
	v_mfma_f32_32x32x16_bf16 a[48:63], v[28:31], v[32:35], a[48:63]
	ds_read_b64_tr_b16 v[48:49], v12 offset:24576
	ds_read_b64_tr_b16 v[50:51], v12 offset:26624
	s_waitcnt vmcnt(10) lgkmcnt(0)
	s_barrier
	v_add_u32 v5, 0xfffec000, v5
	v_add_u32 v6, 0xfffec000, v6
	v_add_u32 v7, 0xfffec000, v7
	v_add_u32 v8, 0xfffec000, v8
	v_add_u32 v9, 0xfffec000, v9
	v_add_u32 v10, 0xfffec000, v10
	v_add_u32 v11, 0xfffec000, v11
	v_add_u32 v12, 0xfffec000, v12
	v_mfma_f32_32x32x16_bf16 a[0:15], v[36:39], v[52:55], a[0:15]
	ds_read_b64_tr_b16 v[16:17], v9 offset:0
	ds_read_b64_tr_b16 v[18:19], v9 offset:2048
	ds_read_b128 v[32:35], v5 offset:0
	s_add_u32 m0, s40, 81920
	s_add_u32 s21, s19, 0
	buffer_load_dwordx4 v1, s[8:11], s21 offen lds
	s_add_u32 m0, s40, 86016
	s_add_u32 s21, s19, 36864
	buffer_load_dwordx4 v1, s[8:11], s21 offen lds
	v_mfma_f32_32x32x16_bf16 a[16:31], v[40:43], v[52:55], a[16:31]
	s_add_u32 m0, s40, 90112
	s_mov_b32 s22, s20
	buffer_load_dwordx4 v2, s[12:15], s22 offen lds
	s_add_u32 m0, s40, 94208
	s_add_u32 s22, s22, s24
	buffer_load_dwordx4 v2, s[12:15], s22 offen lds
	ds_read_b64_tr_b16 v[20:21], v10 offset:0
	ds_read_b64_tr_b16 v[22:23], v10 offset:2048
	ds_read_b64_tr_b16 v[24:25], v11 offset:0
	v_mfma_f32_32x32x16_bf16 a[32:47], v[44:47], v[52:55], a[32:47]
	ds_read_b64_tr_b16 v[26:27], v11 offset:2048
	ds_read_b64_tr_b16 v[28:29], v12 offset:0
	ds_read_b64_tr_b16 v[30:31], v12 offset:2048
	s_add_u32 m0, s40, 98304
	s_add_u32 s22, s22, s24
	buffer_load_dwordx4 v2, s[12:15], s22 offen lds
	s_add_u32 m0, s40, 102400
	s_add_u32 s22, s22, s24
	buffer_load_dwordx4 v2, s[12:15], s22 offen lds
	v_mfma_f32_32x32x16_bf16 a[48:63], v[48:51], v[52:55], a[48:63]
	s_add_u32 m0, s40, 106496
	s_add_u32 s22, s22, s24
	buffer_load_dwordx4 v2, s[12:15], s22 offen lds
	s_add_u32 m0, s40, 110592
	s_add_u32 s22, s22, s24
	buffer_load_dwordx4 v2, s[12:15], s22 offen lds
	s_add_u32 m0, s40, 114688
	s_add_u32 s22, s22, s24
	buffer_load_dwordx4 v2, s[12:15], s22 offen lds
	s_add_u32 m0, s40, 118784
	s_add_u32 s22, s22, s24
	buffer_load_dwordx4 v2, s[12:15], s22 offen lds
	s_add_u32 s19, s19, 128
	s_add_u32 s20, s20, s42
	s_waitcnt lgkmcnt(6)
	v_mfma_f32_32x32x16_bf16 a[0:15], v[16:19], v[32:35], a[0:15]
	ds_read_b64_tr_b16 v[36:37], v9 offset:8192
	ds_read_b64_tr_b16 v[38:39], v9 offset:10240
	ds_read_b128 v[52:55], v6 offset:0
	s_waitcnt lgkmcnt(7)
	v_mfma_f32_32x32x16_bf16 a[16:31], v[20:23], v[32:35], a[16:31]
	ds_read_b64_tr_b16 v[40:41], v10 offset:8192
	ds_read_b64_tr_b16 v[42:43], v10 offset:10240
	s_waitcnt lgkmcnt(7)
	v_mfma_f32_32x32x16_bf16 a[32:47], v[24:27], v[32:35], a[32:47]
	ds_read_b64_tr_b16 v[44:45], v11 offset:8192
	ds_read_b64_tr_b16 v[46:47], v11 offset:10240
	s_waitcnt lgkmcnt(7)
	v_mfma_f32_32x32x16_bf16 a[48:63], v[28:31], v[32:35], a[48:63]
	ds_read_b64_tr_b16 v[48:49], v12 offset:8192
	ds_read_b64_tr_b16 v[50:51], v12 offset:10240
	s_waitcnt lgkmcnt(6)
	v_mfma_f32_32x32x16_bf16 a[0:15], v[36:39], v[52:55], a[0:15]
	ds_read_b64_tr_b16 v[16:17], v9 offset:16384
	ds_read_b64_tr_b16 v[18:19], v9 offset:18432
	ds_read_b128 v[32:35], v7 offset:0
	s_waitcnt lgkmcnt(7)
	v_mfma_f32_32x32x16_bf16 a[16:31], v[40:43], v[52:55], a[16:31]
	ds_read_b64_tr_b16 v[20:21], v10 offset:16384
	ds_read_b64_tr_b16 v[22:23], v10 offset:18432
	s_waitcnt lgkmcnt(7)
	v_mfma_f32_32x32x16_bf16 a[32:47], v[44:47], v[52:55], a[32:47]
	ds_read_b64_tr_b16 v[24:25], v11 offset:16384
	ds_read_b64_tr_b16 v[26:27], v11 offset:18432
	s_waitcnt lgkmcnt(7)
	v_mfma_f32_32x32x16_bf16 a[48:63], v[48:51], v[52:55], a[48:63]
	ds_read_b64_tr_b16 v[28:29], v12 offset:16384
	ds_read_b64_tr_b16 v[30:31], v12 offset:18432
	s_waitcnt lgkmcnt(6)
	v_mfma_f32_32x32x16_bf16 a[0:15], v[16:19], v[32:35], a[0:15]
	ds_read_b64_tr_b16 v[36:37], v9 offset:24576
	ds_read_b64_tr_b16 v[38:39], v9 offset:26624
	ds_read_b128 v[52:55], v8 offset:0
	s_waitcnt lgkmcnt(7)
	v_mfma_f32_32x32x16_bf16 a[16:31], v[20:23], v[32:35], a[16:31]
	ds_read_b64_tr_b16 v[40:41], v10 offset:24576
	ds_read_b64_tr_b16 v[42:43], v10 offset:26624
	s_waitcnt lgkmcnt(7)
	v_mfma_f32_32x32x16_bf16 a[32:47], v[24:27], v[32:35], a[32:47]
	ds_read_b64_tr_b16 v[44:45], v11 offset:24576
	ds_read_b64_tr_b16 v[46:47], v11 offset:26624
	s_waitcnt lgkmcnt(7)
	v_mfma_f32_32x32x16_bf16 a[48:63], v[28:31], v[32:35], a[48:63]
	ds_read_b64_tr_b16 v[48:49], v12 offset:24576
	ds_read_b64_tr_b16 v[50:51], v12 offset:26624
	s_waitcnt vmcnt(10) lgkmcnt(0)
	s_barrier
	v_add_u32 v5, 0xa000, v5
	v_add_u32 v6, 0xa000, v6
	v_add_u32 v7, 0xa000, v7
	v_add_u32 v8, 0xa000, v8
	v_add_u32 v9, 0xa000, v9
	v_add_u32 v10, 0xa000, v10
	v_add_u32 v11, 0xa000, v11
	v_add_u32 v12, 0xa000, v12
	v_mfma_f32_32x32x16_bf16 a[0:15], v[36:39], v[52:55], a[0:15]
	ds_read_b64_tr_b16 v[16:17], v9 offset:0
	ds_read_b64_tr_b16 v[18:19], v9 offset:2048
	ds_read_b128 v[32:35], v5 offset:0
	s_add_u32 m0, s40, 0
	s_add_u32 s21, s19, 0
	buffer_load_dwordx4 v1, s[8:11], s21 offen lds
	s_add_u32 m0, s40, 4096
	s_add_u32 s21, s19, 36864
	buffer_load_dwordx4 v1, s[8:11], s21 offen lds
	v_mfma_f32_32x32x16_bf16 a[16:31], v[40:43], v[52:55], a[16:31]
	s_add_u32 m0, s40, 8192
	s_mov_b32 s22, s20
	buffer_load_dwordx4 v2, s[12:15], s22 offen lds
	s_add_u32 m0, s40, 12288
	s_add_u32 s22, s22, s24
	buffer_load_dwordx4 v2, s[12:15], s22 offen lds
	ds_read_b64_tr_b16 v[20:21], v10 offset:0
	ds_read_b64_tr_b16 v[22:23], v10 offset:2048
	ds_read_b64_tr_b16 v[24:25], v11 offset:0
	v_mfma_f32_32x32x16_bf16 a[32:47], v[44:47], v[52:55], a[32:47]
	ds_read_b64_tr_b16 v[26:27], v11 offset:2048
	ds_read_b64_tr_b16 v[28:29], v12 offset:0
	ds_read_b64_tr_b16 v[30:31], v12 offset:2048
	s_add_u32 m0, s40, 16384
	s_add_u32 s22, s22, s24
	buffer_load_dwordx4 v2, s[12:15], s22 offen lds
	s_add_u32 m0, s40, 20480
	s_add_u32 s22, s22, s24
	buffer_load_dwordx4 v2, s[12:15], s22 offen lds
	v_mfma_f32_32x32x16_bf16 a[48:63], v[48:51], v[52:55], a[48:63]
	s_add_u32 m0, s40, 24576
	s_add_u32 s22, s22, s24
	buffer_load_dwordx4 v2, s[12:15], s22 offen lds
	s_add_u32 m0, s40, 28672
	s_add_u32 s22, s22, s24
	buffer_load_dwordx4 v2, s[12:15], s22 offen lds
	s_add_u32 m0, s40, 32768
	s_add_u32 s22, s22, s24
	buffer_load_dwordx4 v2, s[12:15], s22 offen lds
	s_add_u32 m0, s40, 36864
	s_add_u32 s22, s22, s24
	buffer_load_dwordx4 v2, s[12:15], s22 offen lds
	s_add_u32 s19, s19, 128
	s_add_u32 s20, s20, s42
	s_waitcnt lgkmcnt(6)
	v_mfma_f32_32x32x16_bf16 a[0:15], v[16:19], v[32:35], a[0:15]
	ds_read_b64_tr_b16 v[36:37], v9 offset:8192
	ds_read_b64_tr_b16 v[38:39], v9 offset:10240
	ds_read_b128 v[52:55], v6 offset:0
	s_waitcnt lgkmcnt(7)
	v_mfma_f32_32x32x16_bf16 a[16:31], v[20:23], v[32:35], a[16:31]
	ds_read_b64_tr_b16 v[40:41], v10 offset:8192
	ds_read_b64_tr_b16 v[42:43], v10 offset:10240
	s_waitcnt lgkmcnt(7)
	v_mfma_f32_32x32x16_bf16 a[32:47], v[24:27], v[32:35], a[32:47]
	ds_read_b64_tr_b16 v[44:45], v11 offset:8192
	ds_read_b64_tr_b16 v[46:47], v11 offset:10240
	s_waitcnt lgkmcnt(7)
	v_mfma_f32_32x32x16_bf16 a[48:63], v[28:31], v[32:35], a[48:63]
	ds_read_b64_tr_b16 v[48:49], v12 offset:8192
	ds_read_b64_tr_b16 v[50:51], v12 offset:10240
	s_waitcnt lgkmcnt(6)
	v_mfma_f32_32x32x16_bf16 a[0:15], v[36:39], v[52:55], a[0:15]
	ds_read_b64_tr_b16 v[16:17], v9 offset:16384
	ds_read_b64_tr_b16 v[18:19], v9 offset:18432
	ds_read_b128 v[32:35], v7 offset:0
	s_waitcnt lgkmcnt(7)
	v_mfma_f32_32x32x16_bf16 a[16:31], v[40:43], v[52:55], a[16:31]
	ds_read_b64_tr_b16 v[20:21], v10 offset:16384
	ds_read_b64_tr_b16 v[22:23], v10 offset:18432
	s_waitcnt lgkmcnt(7)
	v_mfma_f32_32x32x16_bf16 a[32:47], v[44:47], v[52:55], a[32:47]
	ds_read_b64_tr_b16 v[24:25], v11 offset:16384
	ds_read_b64_tr_b16 v[26:27], v11 offset:18432
	s_waitcnt lgkmcnt(7)
	v_mfma_f32_32x32x16_bf16 a[48:63], v[48:51], v[52:55], a[48:63]
	ds_read_b64_tr_b16 v[28:29], v12 offset:16384
	ds_read_b64_tr_b16 v[30:31], v12 offset:18432
	s_waitcnt lgkmcnt(6)
	v_mfma_f32_32x32x16_bf16 a[0:15], v[16:19], v[32:35], a[0:15]
	ds_read_b64_tr_b16 v[36:37], v9 offset:24576
	ds_read_b64_tr_b16 v[38:39], v9 offset:26624
	ds_read_b128 v[52:55], v8 offset:0
	s_waitcnt lgkmcnt(7)
	v_mfma_f32_32x32x16_bf16 a[16:31], v[20:23], v[32:35], a[16:31]
	ds_read_b64_tr_b16 v[40:41], v10 offset:24576
	ds_read_b64_tr_b16 v[42:43], v10 offset:26624
	s_waitcnt lgkmcnt(7)
	v_mfma_f32_32x32x16_bf16 a[32:47], v[24:27], v[32:35], a[32:47]
	ds_read_b64_tr_b16 v[44:45], v11 offset:24576
	ds_read_b64_tr_b16 v[46:47], v11 offset:26624
	s_waitcnt lgkmcnt(7)
	v_mfma_f32_32x32x16_bf16 a[48:63], v[28:31], v[32:35], a[48:63]
	ds_read_b64_tr_b16 v[48:49], v12 offset:24576
	ds_read_b64_tr_b16 v[50:51], v12 offset:26624
	s_waitcnt vmcnt(10) lgkmcnt(0)
	s_barrier
	v_add_u32 v5, 0xa000, v5
	v_add_u32 v6, 0xa000, v6
	v_add_u32 v7, 0xa000, v7
	v_add_u32 v8, 0xa000, v8
	v_add_u32 v9, 0xa000, v9
	v_add_u32 v10, 0xa000, v10
	v_add_u32 v11, 0xa000, v11
	v_add_u32 v12, 0xa000, v12
	v_mfma_f32_32x32x16_bf16 a[0:15], v[36:39], v[52:55], a[0:15]
	ds_read_b64_tr_b16 v[16:17], v9 offset:0
	ds_read_b64_tr_b16 v[18:19], v9 offset:2048
	ds_read_b128 v[32:35], v5 offset:0
	s_add_u32 m0, s40, 40960
	s_add_u32 s21, s19, 0
	buffer_load_dwordx4 v1, s[8:11], s21 offen lds
	s_add_u32 m0, s40, 45056
	s_add_u32 s21, s19, 36864
	buffer_load_dwordx4 v1, s[8:11], s21 offen lds
	v_mfma_f32_32x32x16_bf16 a[16:31], v[40:43], v[52:55], a[16:31]
	s_add_u32 m0, s40, 49152
	s_mov_b32 s22, s20
	buffer_load_dwordx4 v2, s[12:15], s22 offen lds
	s_add_u32 m0, s40, 53248
	s_add_u32 s22, s22, s24
	buffer_load_dwordx4 v2, s[12:15], s22 offen lds
	ds_read_b64_tr_b16 v[20:21], v10 offset:0
	ds_read_b64_tr_b16 v[22:23], v10 offset:2048
	ds_read_b64_tr_b16 v[24:25], v11 offset:0
	v_mfma_f32_32x32x16_bf16 a[32:47], v[44:47], v[52:55], a[32:47]
	ds_read_b64_tr_b16 v[26:27], v11 offset:2048
	ds_read_b64_tr_b16 v[28:29], v12 offset:0
	ds_read_b64_tr_b16 v[30:31], v12 offset:2048
	s_add_u32 m0, s40, 57344
	s_add_u32 s22, s22, s24
	buffer_load_dwordx4 v2, s[12:15], s22 offen lds
	s_add_u32 m0, s40, 61440
	s_add_u32 s22, s22, s24
	buffer_load_dwordx4 v2, s[12:15], s22 offen lds
	v_mfma_f32_32x32x16_bf16 a[48:63], v[48:51], v[52:55], a[48:63]
	s_add_u32 m0, s40, 65536
	s_add_u32 s22, s22, s24
	buffer_load_dwordx4 v2, s[12:15], s22 offen lds
	s_add_u32 m0, s40, 69632
	s_add_u32 s22, s22, s24
	buffer_load_dwordx4 v2, s[12:15], s22 offen lds
	s_add_u32 m0, s40, 73728
	s_add_u32 s22, s22, s24
	buffer_load_dwordx4 v2, s[12:15], s22 offen lds
	s_add_u32 m0, s40, 77824
	s_add_u32 s22, s22, s24
	buffer_load_dwordx4 v2, s[12:15], s22 offen lds
	s_add_u32 s19, s19, 128
	s_add_u32 s20, s20, s42
	s_waitcnt lgkmcnt(6)
	v_mfma_f32_32x32x16_bf16 a[0:15], v[16:19], v[32:35], a[0:15]
	ds_read_b64_tr_b16 v[36:37], v9 offset:8192
	ds_read_b64_tr_b16 v[38:39], v9 offset:10240
	ds_read_b128 v[52:55], v6 offset:0
	s_waitcnt lgkmcnt(7)
	v_mfma_f32_32x32x16_bf16 a[16:31], v[20:23], v[32:35], a[16:31]
	ds_read_b64_tr_b16 v[40:41], v10 offset:8192
	ds_read_b64_tr_b16 v[42:43], v10 offset:10240
	s_waitcnt lgkmcnt(7)
	v_mfma_f32_32x32x16_bf16 a[32:47], v[24:27], v[32:35], a[32:47]
	ds_read_b64_tr_b16 v[44:45], v11 offset:8192
	ds_read_b64_tr_b16 v[46:47], v11 offset:10240
	s_waitcnt lgkmcnt(7)
	v_mfma_f32_32x32x16_bf16 a[48:63], v[28:31], v[32:35], a[48:63]
	ds_read_b64_tr_b16 v[48:49], v12 offset:8192
	ds_read_b64_tr_b16 v[50:51], v12 offset:10240
	s_waitcnt lgkmcnt(6)
	v_mfma_f32_32x32x16_bf16 a[0:15], v[36:39], v[52:55], a[0:15]
	ds_read_b64_tr_b16 v[16:17], v9 offset:16384
	ds_read_b64_tr_b16 v[18:19], v9 offset:18432
	ds_read_b128 v[32:35], v7 offset:0
	s_waitcnt lgkmcnt(7)
	v_mfma_f32_32x32x16_bf16 a[16:31], v[40:43], v[52:55], a[16:31]
	ds_read_b64_tr_b16 v[20:21], v10 offset:16384
	ds_read_b64_tr_b16 v[22:23], v10 offset:18432
	s_waitcnt lgkmcnt(7)
	v_mfma_f32_32x32x16_bf16 a[32:47], v[44:47], v[52:55], a[32:47]
	ds_read_b64_tr_b16 v[24:25], v11 offset:16384
	ds_read_b64_tr_b16 v[26:27], v11 offset:18432
	s_waitcnt lgkmcnt(7)
	v_mfma_f32_32x32x16_bf16 a[48:63], v[48:51], v[52:55], a[48:63]
	ds_read_b64_tr_b16 v[28:29], v12 offset:16384
	ds_read_b64_tr_b16 v[30:31], v12 offset:18432
	s_waitcnt lgkmcnt(6)
	v_mfma_f32_32x32x16_bf16 a[0:15], v[16:19], v[32:35], a[0:15]
	ds_read_b64_tr_b16 v[36:37], v9 offset:24576
	ds_read_b64_tr_b16 v[38:39], v9 offset:26624
	ds_read_b128 v[52:55], v8 offset:0
	s_waitcnt lgkmcnt(7)
	v_mfma_f32_32x32x16_bf16 a[16:31], v[20:23], v[32:35], a[16:31]
	ds_read_b64_tr_b16 v[40:41], v10 offset:24576
	ds_read_b64_tr_b16 v[42:43], v10 offset:26624
	s_waitcnt lgkmcnt(7)
	v_mfma_f32_32x32x16_bf16 a[32:47], v[24:27], v[32:35], a[32:47]
	ds_read_b64_tr_b16 v[44:45], v11 offset:24576
	ds_read_b64_tr_b16 v[46:47], v11 offset:26624
	s_waitcnt lgkmcnt(7)
	v_mfma_f32_32x32x16_bf16 a[48:63], v[28:31], v[32:35], a[48:63]
	ds_read_b64_tr_b16 v[48:49], v12 offset:24576
	ds_read_b64_tr_b16 v[50:51], v12 offset:26624
	s_waitcnt vmcnt(10) lgkmcnt(0)
	s_barrier
	v_add_u32 v5, 0xfffec000, v5
	v_add_u32 v6, 0xfffec000, v6
	v_add_u32 v7, 0xfffec000, v7
	v_add_u32 v8, 0xfffec000, v8
	v_add_u32 v9, 0xfffec000, v9
	v_add_u32 v10, 0xfffec000, v10
	v_add_u32 v11, 0xfffec000, v11
	v_add_u32 v12, 0xfffec000, v12
	v_mfma_f32_32x32x16_bf16 a[0:15], v[36:39], v[52:55], a[0:15]
	ds_read_b64_tr_b16 v[16:17], v9 offset:0
	ds_read_b64_tr_b16 v[18:19], v9 offset:2048
	ds_read_b128 v[32:35], v5 offset:0
	s_add_u32 m0, s40, 81920
	s_add_u32 s21, s19, 0
	buffer_load_dwordx4 v1, s[8:11], s21 offen lds
	s_add_u32 m0, s40, 86016
	s_add_u32 s21, s19, 36864
	buffer_load_dwordx4 v1, s[8:11], s21 offen lds
	v_mfma_f32_32x32x16_bf16 a[16:31], v[40:43], v[52:55], a[16:31]
	s_add_u32 m0, s40, 90112
	s_mov_b32 s22, s20
	buffer_load_dwordx4 v2, s[12:15], s22 offen lds
	s_add_u32 m0, s40, 94208
	s_add_u32 s22, s22, s24
	buffer_load_dwordx4 v2, s[12:15], s22 offen lds
	ds_read_b64_tr_b16 v[20:21], v10 offset:0
	ds_read_b64_tr_b16 v[22:23], v10 offset:2048
	ds_read_b64_tr_b16 v[24:25], v11 offset:0
	v_mfma_f32_32x32x16_bf16 a[32:47], v[44:47], v[52:55], a[32:47]
	ds_read_b64_tr_b16 v[26:27], v11 offset:2048
	ds_read_b64_tr_b16 v[28:29], v12 offset:0
	ds_read_b64_tr_b16 v[30:31], v12 offset:2048
	s_add_u32 m0, s40, 98304
	s_add_u32 s22, s22, s24
	buffer_load_dwordx4 v2, s[12:15], s22 offen lds
	s_add_u32 m0, s40, 102400
	s_add_u32 s22, s22, s24
	buffer_load_dwordx4 v2, s[12:15], s22 offen lds
	v_mfma_f32_32x32x16_bf16 a[48:63], v[48:51], v[52:55], a[48:63]
	s_add_u32 m0, s40, 106496
	s_add_u32 s22, s22, s24
	buffer_load_dwordx4 v2, s[12:15], s22 offen lds
	s_add_u32 m0, s40, 110592
	s_add_u32 s22, s22, s24
	buffer_load_dwordx4 v2, s[12:15], s22 offen lds
	s_add_u32 m0, s40, 114688
	s_add_u32 s22, s22, s24
	buffer_load_dwordx4 v2, s[12:15], s22 offen lds
	s_add_u32 m0, s40, 118784
	s_add_u32 s22, s22, s24
	buffer_load_dwordx4 v2, s[12:15], s22 offen lds
	s_add_u32 s19, s19, 128
	s_add_u32 s20, s20, s42
	s_waitcnt lgkmcnt(6)
	v_mfma_f32_32x32x16_bf16 a[0:15], v[16:19], v[32:35], a[0:15]
	ds_read_b64_tr_b16 v[36:37], v9 offset:8192
	ds_read_b64_tr_b16 v[38:39], v9 offset:10240
	ds_read_b128 v[52:55], v6 offset:0
	s_waitcnt lgkmcnt(7)
	v_mfma_f32_32x32x16_bf16 a[16:31], v[20:23], v[32:35], a[16:31]
	ds_read_b64_tr_b16 v[40:41], v10 offset:8192
	ds_read_b64_tr_b16 v[42:43], v10 offset:10240
	s_waitcnt lgkmcnt(7)
	v_mfma_f32_32x32x16_bf16 a[32:47], v[24:27], v[32:35], a[32:47]
	ds_read_b64_tr_b16 v[44:45], v11 offset:8192
	ds_read_b64_tr_b16 v[46:47], v11 offset:10240
	s_waitcnt lgkmcnt(7)
	v_mfma_f32_32x32x16_bf16 a[48:63], v[28:31], v[32:35], a[48:63]
	ds_read_b64_tr_b16 v[48:49], v12 offset:8192
	ds_read_b64_tr_b16 v[50:51], v12 offset:10240
	s_waitcnt lgkmcnt(6)
	v_mfma_f32_32x32x16_bf16 a[0:15], v[36:39], v[52:55], a[0:15]
	ds_read_b64_tr_b16 v[16:17], v9 offset:16384
	ds_read_b64_tr_b16 v[18:19], v9 offset:18432
	ds_read_b128 v[32:35], v7 offset:0
	s_waitcnt lgkmcnt(7)
	v_mfma_f32_32x32x16_bf16 a[16:31], v[40:43], v[52:55], a[16:31]
	ds_read_b64_tr_b16 v[20:21], v10 offset:16384
	ds_read_b64_tr_b16 v[22:23], v10 offset:18432
	s_waitcnt lgkmcnt(7)
	v_mfma_f32_32x32x16_bf16 a[32:47], v[44:47], v[52:55], a[32:47]
	ds_read_b64_tr_b16 v[24:25], v11 offset:16384
	ds_read_b64_tr_b16 v[26:27], v11 offset:18432
	s_waitcnt lgkmcnt(7)
	v_mfma_f32_32x32x16_bf16 a[48:63], v[48:51], v[52:55], a[48:63]
	ds_read_b64_tr_b16 v[28:29], v12 offset:16384
	ds_read_b64_tr_b16 v[30:31], v12 offset:18432
	s_waitcnt lgkmcnt(6)
	v_mfma_f32_32x32x16_bf16 a[0:15], v[16:19], v[32:35], a[0:15]
	ds_read_b64_tr_b16 v[36:37], v9 offset:24576
	ds_read_b64_tr_b16 v[38:39], v9 offset:26624
	ds_read_b128 v[52:55], v8 offset:0
	s_waitcnt lgkmcnt(7)
	v_mfma_f32_32x32x16_bf16 a[16:31], v[20:23], v[32:35], a[16:31]
	ds_read_b64_tr_b16 v[40:41], v10 offset:24576
	ds_read_b64_tr_b16 v[42:43], v10 offset:26624
	s_waitcnt lgkmcnt(7)
	v_mfma_f32_32x32x16_bf16 a[32:47], v[24:27], v[32:35], a[32:47]
	ds_read_b64_tr_b16 v[44:45], v11 offset:24576
	ds_read_b64_tr_b16 v[46:47], v11 offset:26624
	s_waitcnt lgkmcnt(7)
	v_mfma_f32_32x32x16_bf16 a[48:63], v[28:31], v[32:35], a[48:63]
	ds_read_b64_tr_b16 v[48:49], v12 offset:24576
	ds_read_b64_tr_b16 v[50:51], v12 offset:26624
	s_waitcnt vmcnt(10) lgkmcnt(0)
	s_barrier
	v_add_u32 v5, 0xa000, v5
	v_add_u32 v6, 0xa000, v6
	v_add_u32 v7, 0xa000, v7
	v_add_u32 v8, 0xa000, v8
	v_add_u32 v9, 0xa000, v9
	v_add_u32 v10, 0xa000, v10
	v_add_u32 v11, 0xa000, v11
	v_add_u32 v12, 0xa000, v12
	v_mfma_f32_32x32x16_bf16 a[0:15], v[36:39], v[52:55], a[0:15]
	ds_read_b64_tr_b16 v[16:17], v9 offset:0
	ds_read_b64_tr_b16 v[18:19], v9 offset:2048
	ds_read_b128 v[32:35], v5 offset:0
	v_mfma_f32_32x32x16_bf16 a[16:31], v[40:43], v[52:55], a[16:31]
	ds_read_b64_tr_b16 v[20:21], v10 offset:0
	ds_read_b64_tr_b16 v[22:23], v10 offset:2048
	v_mfma_f32_32x32x16_bf16 a[32:47], v[44:47], v[52:55], a[32:47]
	ds_read_b64_tr_b16 v[24:25], v11 offset:0
	ds_read_b64_tr_b16 v[26:27], v11 offset:2048
	v_mfma_f32_32x32x16_bf16 a[48:63], v[48:51], v[52:55], a[48:63]
	ds_read_b64_tr_b16 v[28:29], v12 offset:0
	ds_read_b64_tr_b16 v[30:31], v12 offset:2048
	s_waitcnt lgkmcnt(6)
	v_mfma_f32_32x32x16_bf16 a[0:15], v[16:19], v[32:35], a[0:15]
	ds_read_b64_tr_b16 v[36:37], v9 offset:8192
	ds_read_b64_tr_b16 v[38:39], v9 offset:10240
	ds_read_b128 v[52:55], v6 offset:0
	s_waitcnt lgkmcnt(7)
	v_mfma_f32_32x32x16_bf16 a[16:31], v[20:23], v[32:35], a[16:31]
	ds_read_b64_tr_b16 v[40:41], v10 offset:8192
	ds_read_b64_tr_b16 v[42:43], v10 offset:10240
	s_waitcnt lgkmcnt(7)
	v_mfma_f32_32x32x16_bf16 a[32:47], v[24:27], v[32:35], a[32:47]
	ds_read_b64_tr_b16 v[44:45], v11 offset:8192
	ds_read_b64_tr_b16 v[46:47], v11 offset:10240
	s_waitcnt lgkmcnt(7)
	v_mfma_f32_32x32x16_bf16 a[48:63], v[28:31], v[32:35], a[48:63]
	ds_read_b64_tr_b16 v[48:49], v12 offset:8192
	ds_read_b64_tr_b16 v[50:51], v12 offset:10240
	s_waitcnt lgkmcnt(6)
	v_mfma_f32_32x32x16_bf16 a[0:15], v[36:39], v[52:55], a[0:15]
	ds_read_b64_tr_b16 v[16:17], v9 offset:16384
	ds_read_b64_tr_b16 v[18:19], v9 offset:18432
	ds_read_b128 v[32:35], v7 offset:0
	s_waitcnt lgkmcnt(7)
	v_mfma_f32_32x32x16_bf16 a[16:31], v[40:43], v[52:55], a[16:31]
	ds_read_b64_tr_b16 v[20:21], v10 offset:16384
	ds_read_b64_tr_b16 v[22:23], v10 offset:18432
	s_waitcnt lgkmcnt(7)
	v_mfma_f32_32x32x16_bf16 a[32:47], v[44:47], v[52:55], a[32:47]
	ds_read_b64_tr_b16 v[24:25], v11 offset:16384
	ds_read_b64_tr_b16 v[26:27], v11 offset:18432
	s_waitcnt lgkmcnt(7)
	v_mfma_f32_32x32x16_bf16 a[48:63], v[48:51], v[52:55], a[48:63]
	ds_read_b64_tr_b16 v[28:29], v12 offset:16384
	ds_read_b64_tr_b16 v[30:31], v12 offset:18432
	s_waitcnt lgkmcnt(6)
	v_mfma_f32_32x32x16_bf16 a[0:15], v[16:19], v[32:35], a[0:15]
	ds_read_b64_tr_b16 v[36:37], v9 offset:24576
	ds_read_b64_tr_b16 v[38:39], v9 offset:26624
	ds_read_b128 v[52:55], v8 offset:0
	s_waitcnt lgkmcnt(7)
	v_mfma_f32_32x32x16_bf16 a[16:31], v[20:23], v[32:35], a[16:31]
	ds_read_b64_tr_b16 v[40:41], v10 offset:24576
	ds_read_b64_tr_b16 v[42:43], v10 offset:26624
	s_waitcnt lgkmcnt(7)
	v_mfma_f32_32x32x16_bf16 a[32:47], v[24:27], v[32:35], a[32:47]
	ds_read_b64_tr_b16 v[44:45], v11 offset:24576
	ds_read_b64_tr_b16 v[46:47], v11 offset:26624
	s_waitcnt lgkmcnt(7)
	v_mfma_f32_32x32x16_bf16 a[48:63], v[28:31], v[32:35], a[48:63]
	ds_read_b64_tr_b16 v[48:49], v12 offset:24576
	ds_read_b64_tr_b16 v[50:51], v12 offset:26624
	s_waitcnt vmcnt(0) lgkmcnt(0)
	s_barrier
	v_add_u32 v5, 0xa000, v5
	v_add_u32 v6, 0xa000, v6
	v_add_u32 v7, 0xa000, v7
	v_add_u32 v8, 0xa000, v8
	v_add_u32 v9, 0xa000, v9
	v_add_u32 v10, 0xa000, v10
	v_add_u32 v11, 0xa000, v11
	v_add_u32 v12, 0xa000, v12
	v_mfma_f32_32x32x16_bf16 a[0:15], v[36:39], v[52:55], a[0:15]
	ds_read_b64_tr_b16 v[16:17], v9 offset:0
	ds_read_b64_tr_b16 v[18:19], v9 offset:2048
	ds_read_b128 v[32:35], v5 offset:0
	v_mfma_f32_32x32x16_bf16 a[16:31], v[40:43], v[52:55], a[16:31]
	ds_read_b64_tr_b16 v[20:21], v10 offset:0
	ds_read_b64_tr_b16 v[22:23], v10 offset:2048
	v_mfma_f32_32x32x16_bf16 a[32:47], v[44:47], v[52:55], a[32:47]
	ds_read_b64_tr_b16 v[24:25], v11 offset:0
	ds_read_b64_tr_b16 v[26:27], v11 offset:2048
	v_mfma_f32_32x32x16_bf16 a[48:63], v[48:51], v[52:55], a[48:63]
	ds_read_b64_tr_b16 v[28:29], v12 offset:0
	ds_read_b64_tr_b16 v[30:31], v12 offset:2048
	s_waitcnt lgkmcnt(6)
	v_mfma_f32_32x32x16_bf16 a[0:15], v[16:19], v[32:35], a[0:15]
	ds_read_b64_tr_b16 v[36:37], v9 offset:8192
	ds_read_b64_tr_b16 v[38:39], v9 offset:10240
	ds_read_b128 v[52:55], v6 offset:0
	s_waitcnt lgkmcnt(7)
	v_mfma_f32_32x32x16_bf16 a[16:31], v[20:23], v[32:35], a[16:31]
	ds_read_b64_tr_b16 v[40:41], v10 offset:8192
	ds_read_b64_tr_b16 v[42:43], v10 offset:10240
	s_waitcnt lgkmcnt(7)
	v_mfma_f32_32x32x16_bf16 a[32:47], v[24:27], v[32:35], a[32:47]
	ds_read_b64_tr_b16 v[44:45], v11 offset:8192
	ds_read_b64_tr_b16 v[46:47], v11 offset:10240
	s_waitcnt lgkmcnt(7)
	v_mfma_f32_32x32x16_bf16 a[48:63], v[28:31], v[32:35], a[48:63]
	ds_read_b64_tr_b16 v[48:49], v12 offset:8192
	ds_read_b64_tr_b16 v[50:51], v12 offset:10240
	s_waitcnt lgkmcnt(6)
	v_mfma_f32_32x32x16_bf16 a[0:15], v[36:39], v[52:55], a[0:15]
	ds_read_b64_tr_b16 v[16:17], v9 offset:16384
	ds_read_b64_tr_b16 v[18:19], v9 offset:18432
	ds_read_b128 v[32:35], v7 offset:0
	s_waitcnt lgkmcnt(7)
	v_mfma_f32_32x32x16_bf16 a[16:31], v[40:43], v[52:55], a[16:31]
	ds_read_b64_tr_b16 v[20:21], v10 offset:16384
	ds_read_b64_tr_b16 v[22:23], v10 offset:18432
	s_waitcnt lgkmcnt(7)
	v_mfma_f32_32x32x16_bf16 a[32:47], v[44:47], v[52:55], a[32:47]
	ds_read_b64_tr_b16 v[24:25], v11 offset:16384
	ds_read_b64_tr_b16 v[26:27], v11 offset:18432
	s_waitcnt lgkmcnt(7)
	v_mfma_f32_32x32x16_bf16 a[48:63], v[48:51], v[52:55], a[48:63]
	ds_read_b64_tr_b16 v[28:29], v12 offset:16384
	ds_read_b64_tr_b16 v[30:31], v12 offset:18432
	s_waitcnt lgkmcnt(6)
	v_mfma_f32_32x32x16_bf16 a[0:15], v[16:19], v[32:35], a[0:15]
	ds_read_b64_tr_b16 v[36:37], v9 offset:24576
	ds_read_b64_tr_b16 v[38:39], v9 offset:26624
	ds_read_b128 v[52:55], v8 offset:0
	s_waitcnt lgkmcnt(7)
	v_mfma_f32_32x32x16_bf16 a[16:31], v[20:23], v[32:35], a[16:31]
	ds_read_b64_tr_b16 v[40:41], v10 offset:24576
	ds_read_b64_tr_b16 v[42:43], v10 offset:26624
	s_waitcnt lgkmcnt(7)
	v_mfma_f32_32x32x16_bf16 a[32:47], v[24:27], v[32:35], a[32:47]
	ds_read_b64_tr_b16 v[44:45], v11 offset:24576
	ds_read_b64_tr_b16 v[46:47], v11 offset:26624
	s_waitcnt lgkmcnt(7)
	v_mfma_f32_32x32x16_bf16 a[48:63], v[28:31], v[32:35], a[48:63]
	ds_read_b64_tr_b16 v[48:49], v12 offset:24576
	ds_read_b64_tr_b16 v[50:51], v12 offset:26624
	s_waitcnt lgkmcnt(6)
	v_mfma_f32_32x32x16_bf16 a[0:15], v[36:39], v[52:55], a[0:15]
	s_waitcnt lgkmcnt(4)
	v_mfma_f32_32x32x16_bf16 a[16:31], v[40:43], v[52:55], a[16:31]
	s_waitcnt lgkmcnt(2)
	v_mfma_f32_32x32x16_bf16 a[32:47], v[44:47], v[52:55], a[32:47]
	s_waitcnt lgkmcnt(0)
	v_mfma_f32_32x32x16_bf16 a[48:63], v[48:51], v[52:55], a[48:63]
	v_add_u32 v5, 0xfffec000, v5
	v_add_u32 v6, 0xfffec000, v6
	v_add_u32 v7, 0xfffec000, v7
	v_add_u32 v8, 0xfffec000, v8
	v_add_u32 v9, 0xfffec000, v9
	v_add_u32 v10, 0xfffec000, v10
	v_add_u32 v11, 0xfffec000, v11
	v_add_u32 v12, 0xfffec000, v12
	s_barrier
	s_lshl_b32 s25, s43, 24
	s_add_u32 s25, s25, 4194304
	s_mov_b32 s26, 8192
	s_lshl_b32 s21, s28, 13
	s_add_u32 s25, s25, s21
	s_add_u32 s25, s25, s17
	s_lshr_b32 s21, s4, 1
	s_and_b32 s22, s4, 1
	s_mul_i32 s21, s21, 32
	s_mul_i32 s22, s22, 256
	v_and_b32 v13, 15, v0
	v_add_u32 v13, s21, v13
	v_mul_lo_u32 v13, v13, s26
	v_bfe_u32 v14, v0, 4, 1
	v_lshl_add_u32 v13, v14, 5, v13
	v_lshrrev_b32 v14, 5, v0
	v_lshl_add_u32 v13, v14, 4, v13
	v_add_u32 v15, s22, v13
	s_lshl_b32 s22, s26, 4
	v_add_u32 v157, s22, v15
	s_lshl_b32 s22, s26, 5
	s_lshr_b32 s23, s4, 1
	s_mul_i32 s23, s23, 32
	v_and_b32 v13, 7, v0
	v_add_u32 v13, s23, v13
	v_mul_lo_u32 v13, v13, s26
	v_bfe_u32 v189, v0, 3, 1
	v_lshl_add_u32 v13, v189, 6, v13
	v_bfe_u32 v189, v0, 4, 1
	v_lshl_add_u32 v13, v189, 5, v13
	v_lshrrev_b32 v189, 5, v0
	v_lshl_add_u32 v13, v189, 4, v13
	s_and_b32 s23, s4, 1
	s_mul_i32 s23, s23, 256
	v_add_u32 v188, s23, v13
	s_lshl_b32 s23, s26, 3
	v_add_u32 v189, s23, v188
	v_add_u32 v190, s23, v189
	v_add_u32 v191, s23, v190
	v_accvgpr_read_b32 v80, a0
	v_accvgpr_read_b32 v81, a1
	v_accvgpr_read_b32 v82, a2
	v_accvgpr_read_b32 v83, a3
	v_accvgpr_read_b32 v84, a4
	v_accvgpr_read_b32 v85, a5
	v_accvgpr_read_b32 v86, a6
	v_accvgpr_read_b32 v87, a7
	v_accvgpr_read_b32 v88, a8
	v_accvgpr_read_b32 v89, a9
	v_accvgpr_read_b32 v90, a10
	v_accvgpr_read_b32 v91, a11
	v_accvgpr_read_b32 v92, a12
	v_accvgpr_read_b32 v93, a13
	v_accvgpr_read_b32 v94, a14
	v_accvgpr_read_b32 v95, a15
	v_cvt_pk_bf16_f32 v80, v80, v81
	v_cvt_pk_bf16_f32 v81, v82, v83
	v_cvt_pk_bf16_f32 v82, v84, v85
	v_cvt_pk_bf16_f32 v83, v86, v87
	s_nop 0
	v_permlane32_swap_b32 v80, v82
	v_permlane32_swap_b32 v81, v83
	v_cvt_pk_bf16_f32 v88, v88, v89
	v_cvt_pk_bf16_f32 v89, v90, v91
	v_cvt_pk_bf16_f32 v90, v92, v93
	v_cvt_pk_bf16_f32 v91, v94, v95
	s_nop 0
	v_permlane32_swap_b32 v88, v90
	v_permlane32_swap_b32 v89, v91
	s_nop 0
	v_permlane16_swap_b32 v80, v88
	v_permlane16_swap_b32 v81, v89
	v_permlane16_swap_b32 v82, v90
	v_permlane16_swap_b32 v83, v91
	v_accvgpr_read_b32 v100, a16
	v_accvgpr_read_b32 v101, a17
	v_accvgpr_read_b32 v102, a18
	v_accvgpr_read_b32 v103, a19
	v_accvgpr_read_b32 v104, a20
	v_accvgpr_read_b32 v105, a21
	v_accvgpr_read_b32 v106, a22
	v_accvgpr_read_b32 v107, a23
	v_accvgpr_read_b32 v108, a24
	v_accvgpr_read_b32 v109, a25
	v_accvgpr_read_b32 v110, a26
	v_accvgpr_read_b32 v111, a27
	v_accvgpr_read_b32 v112, a28
	v_accvgpr_read_b32 v113, a29
	v_accvgpr_read_b32 v114, a30
	v_accvgpr_read_b32 v115, a31
	v_cvt_pk_bf16_f32 v100, v100, v101
	v_cvt_pk_bf16_f32 v101, v102, v103
	v_cvt_pk_bf16_f32 v102, v104, v105
	v_cvt_pk_bf16_f32 v103, v106, v107
	s_nop 0
	v_permlane32_swap_b32 v100, v102
	v_permlane32_swap_b32 v101, v103
	v_cvt_pk_bf16_f32 v108, v108, v109
	v_cvt_pk_bf16_f32 v109, v110, v111
	v_cvt_pk_bf16_f32 v110, v112, v113
	v_cvt_pk_bf16_f32 v111, v114, v115
	s_nop 0
	v_permlane32_swap_b32 v108, v110
	v_permlane32_swap_b32 v109, v111
	s_nop 0
	v_permlane16_swap_b32 v100, v108
	v_permlane16_swap_b32 v101, v109
	v_permlane16_swap_b32 v102, v110
	v_permlane16_swap_b32 v103, v111
	v_mov_b32 v232, v80
	v_mov_b32 v233, v81
	v_mov_b32 v234, v82
	v_mov_b32 v235, v83
	v_mov_b32_dpp v80, v100 row_ror:8 row_mask:0xf bank_mask:0xc
	v_mov_b32_dpp v81, v101 row_ror:8 row_mask:0xf bank_mask:0xc
	v_mov_b32_dpp v82, v102 row_ror:8 row_mask:0xf bank_mask:0xc
	v_mov_b32_dpp v83, v103 row_ror:8 row_mask:0xf bank_mask:0xc
	v_mov_b32_dpp v100, v232 row_ror:8 row_mask:0xf bank_mask:0x3
	v_mov_b32_dpp v101, v233 row_ror:8 row_mask:0xf bank_mask:0x3
	v_mov_b32_dpp v102, v234 row_ror:8 row_mask:0xf bank_mask:0x3
	v_mov_b32_dpp v103, v235 row_ror:8 row_mask:0xf bank_mask:0x3
	v_mov_b32 v232, v88
	v_mov_b32 v233, v89
	v_mov_b32 v234, v90
	v_mov_b32 v235, v91
	v_mov_b32_dpp v88, v108 row_ror:8 row_mask:0xf bank_mask:0xc
	v_mov_b32_dpp v89, v109 row_ror:8 row_mask:0xf bank_mask:0xc
	v_mov_b32_dpp v90, v110 row_ror:8 row_mask:0xf bank_mask:0xc
	v_mov_b32_dpp v91, v111 row_ror:8 row_mask:0xf bank_mask:0xc
	v_mov_b32_dpp v108, v232 row_ror:8 row_mask:0xf bank_mask:0x3
	v_mov_b32_dpp v109, v233 row_ror:8 row_mask:0xf bank_mask:0x3
	v_mov_b32_dpp v110, v234 row_ror:8 row_mask:0xf bank_mask:0x3
	v_mov_b32_dpp v111, v235 row_ror:8 row_mask:0xf bank_mask:0x3
	s_mov_b32 s23, s25
	buffer_store_dwordx4 v[80:83], v188, s[8:11], s23 offen offset:0 sc1
	buffer_store_dwordx4 v[100:103], v189, s[8:11], s23 offen offset:0 sc1
	buffer_store_dwordx4 v[88:91], v190, s[8:11], s23 offen offset:0 sc1
	buffer_store_dwordx4 v[108:111], v191, s[8:11], s23 offen offset:0 sc1
	v_accvgpr_read_b32 v192, a32
	v_accvgpr_read_b32 v193, a33
	v_accvgpr_read_b32 v194, a34
	v_accvgpr_read_b32 v195, a35
	v_accvgpr_read_b32 v196, a36
	v_accvgpr_read_b32 v197, a37
	v_accvgpr_read_b32 v198, a38
	v_accvgpr_read_b32 v199, a39
	v_accvgpr_read_b32 v200, a40
	v_accvgpr_read_b32 v201, a41
	v_accvgpr_read_b32 v202, a42
	v_accvgpr_read_b32 v203, a43
	v_accvgpr_read_b32 v204, a44
	v_accvgpr_read_b32 v205, a45
	v_accvgpr_read_b32 v206, a46
	v_accvgpr_read_b32 v207, a47
	v_cvt_pk_bf16_f32 v192, v192, v193
	v_cvt_pk_bf16_f32 v193, v194, v195
	v_cvt_pk_bf16_f32 v194, v196, v197
	v_cvt_pk_bf16_f32 v195, v198, v199
	s_nop 0
	v_permlane32_swap_b32 v192, v194
	v_permlane32_swap_b32 v193, v195
	v_cvt_pk_bf16_f32 v200, v200, v201
	v_cvt_pk_bf16_f32 v201, v202, v203
	v_cvt_pk_bf16_f32 v202, v204, v205
	v_cvt_pk_bf16_f32 v203, v206, v207
	s_nop 0
	v_permlane32_swap_b32 v200, v202
	v_permlane32_swap_b32 v201, v203
	s_nop 0
	v_permlane16_swap_b32 v192, v200
	v_permlane16_swap_b32 v193, v201
	v_permlane16_swap_b32 v194, v202
	v_permlane16_swap_b32 v195, v203
	v_accvgpr_read_b32 v212, a48
	v_accvgpr_read_b32 v213, a49
	v_accvgpr_read_b32 v214, a50
	v_accvgpr_read_b32 v215, a51
	v_accvgpr_read_b32 v216, a52
	v_accvgpr_read_b32 v217, a53
	v_accvgpr_read_b32 v218, a54
	v_accvgpr_read_b32 v219, a55
	v_accvgpr_read_b32 v220, a56
	v_accvgpr_read_b32 v221, a57
	v_accvgpr_read_b32 v222, a58
	v_accvgpr_read_b32 v223, a59
	v_accvgpr_read_b32 v224, a60
	v_accvgpr_read_b32 v225, a61
	v_accvgpr_read_b32 v226, a62
	v_accvgpr_read_b32 v227, a63
	v_cvt_pk_bf16_f32 v212, v212, v213
	v_cvt_pk_bf16_f32 v213, v214, v215
	v_cvt_pk_bf16_f32 v214, v216, v217
	v_cvt_pk_bf16_f32 v215, v218, v219
	s_nop 0
	v_permlane32_swap_b32 v212, v214
	v_permlane32_swap_b32 v213, v215
	v_cvt_pk_bf16_f32 v220, v220, v221
	v_cvt_pk_bf16_f32 v221, v222, v223
	v_cvt_pk_bf16_f32 v222, v224, v225
	v_cvt_pk_bf16_f32 v223, v226, v227
	s_nop 0
	v_permlane32_swap_b32 v220, v222
	v_permlane32_swap_b32 v221, v223
	s_nop 0
	v_permlane16_swap_b32 v212, v220
	v_permlane16_swap_b32 v213, v221
	v_permlane16_swap_b32 v214, v222
	v_permlane16_swap_b32 v215, v223
	v_mov_b32 v232, v192
	v_mov_b32 v233, v193
	v_mov_b32 v234, v194
	v_mov_b32 v235, v195
	v_mov_b32_dpp v192, v212 row_ror:8 row_mask:0xf bank_mask:0xc
	v_mov_b32_dpp v193, v213 row_ror:8 row_mask:0xf bank_mask:0xc
	v_mov_b32_dpp v194, v214 row_ror:8 row_mask:0xf bank_mask:0xc
	v_mov_b32_dpp v195, v215 row_ror:8 row_mask:0xf bank_mask:0xc
	v_mov_b32_dpp v212, v232 row_ror:8 row_mask:0xf bank_mask:0x3
	v_mov_b32_dpp v213, v233 row_ror:8 row_mask:0xf bank_mask:0x3
	v_mov_b32_dpp v214, v234 row_ror:8 row_mask:0xf bank_mask:0x3
	v_mov_b32_dpp v215, v235 row_ror:8 row_mask:0xf bank_mask:0x3
	v_mov_b32 v232, v200
	v_mov_b32 v233, v201
	v_mov_b32 v234, v202
	v_mov_b32 v235, v203
	v_mov_b32_dpp v200, v220 row_ror:8 row_mask:0xf bank_mask:0xc
	v_mov_b32_dpp v201, v221 row_ror:8 row_mask:0xf bank_mask:0xc
	v_mov_b32_dpp v202, v222 row_ror:8 row_mask:0xf bank_mask:0xc
	v_mov_b32_dpp v203, v223 row_ror:8 row_mask:0xf bank_mask:0xc
	v_mov_b32_dpp v220, v232 row_ror:8 row_mask:0xf bank_mask:0x3
	v_mov_b32_dpp v221, v233 row_ror:8 row_mask:0xf bank_mask:0x3
	v_mov_b32_dpp v222, v234 row_ror:8 row_mask:0xf bank_mask:0x3
	v_mov_b32_dpp v223, v235 row_ror:8 row_mask:0xf bank_mask:0x3
	s_mov_b32 s23, s25
	buffer_store_dwordx4 v[192:195], v188, s[8:11], s23 offen offset:128 sc1
	buffer_store_dwordx4 v[212:215], v189, s[8:11], s23 offen offset:128 sc1
	buffer_store_dwordx4 v[200:203], v190, s[8:11], s23 offen offset:128 sc1
	buffer_store_dwordx4 v[220:223], v191, s[8:11], s23 offen offset:128 sc1
	s_branch main_kernel_g1x_done
main_kernel_g1x_vt:
	s_lshl_b32 s40, s4, 10
	s_mul_i32 s41, s4, 6144
	s_lshl_b32 s42, s18, 6
	s_mov_b32 s19, s16
	s_mov_b32 s20, s17
	s_add_u32 m0, s40, 0
	s_add_u32 s21, s19, 0
	buffer_load_dwordx4 v1, s[8:11], s21 offen lds
	s_add_u32 m0, s40, 4096
	s_add_u32 s21, s19, 36864
	buffer_load_dwordx4 v1, s[8:11], s21 offen lds
	s_add_u32 m0, s40, 8192
	s_mov_b32 s22, s20
	buffer_load_dwordx4 v2, s[12:15], s22 offen lds
	s_add_u32 m0, s40, 12288
	s_add_u32 s22, s22, s24
	buffer_load_dwordx4 v2, s[12:15], s22 offen lds
	s_add_u32 m0, s40, 16384
	s_add_u32 s22, s22, s24
	buffer_load_dwordx4 v2, s[12:15], s22 offen lds
	s_add_u32 m0, s40, 20480
	s_add_u32 s22, s22, s24
	buffer_load_dwordx4 v2, s[12:15], s22 offen lds
	s_add_u32 m0, s40, 24576
	s_add_u32 s22, s22, s24
	buffer_load_dwordx4 v2, s[12:15], s22 offen lds
	s_add_u32 m0, s40, 28672
	s_add_u32 s22, s22, s24
	buffer_load_dwordx4 v2, s[12:15], s22 offen lds
	s_add_u32 m0, s40, 32768
	s_add_u32 s22, s22, s24
	buffer_load_dwordx4 v2, s[12:15], s22 offen lds
	s_add_u32 m0, s40, 36864
	s_add_u32 s22, s22, s24
	buffer_load_dwordx4 v2, s[12:15], s22 offen lds
	s_add_u32 s19, s19, 128
	s_add_u32 s20, s20, s42
	s_add_u32 m0, s40, 40960
	s_add_u32 s21, s19, 0
	buffer_load_dwordx4 v1, s[8:11], s21 offen lds
	s_add_u32 m0, s40, 45056
	s_add_u32 s21, s19, 36864
	buffer_load_dwordx4 v1, s[8:11], s21 offen lds
	s_add_u32 m0, s40, 49152
	s_mov_b32 s22, s20
	buffer_load_dwordx4 v2, s[12:15], s22 offen lds
	s_add_u32 m0, s40, 53248
	s_add_u32 s22, s22, s24
	buffer_load_dwordx4 v2, s[12:15], s22 offen lds
	s_add_u32 m0, s40, 57344
	s_add_u32 s22, s22, s24
	buffer_load_dwordx4 v2, s[12:15], s22 offen lds
	s_add_u32 m0, s40, 61440
	s_add_u32 s22, s22, s24
	buffer_load_dwordx4 v2, s[12:15], s22 offen lds
	s_add_u32 m0, s40, 65536
	s_add_u32 s22, s22, s24
	buffer_load_dwordx4 v2, s[12:15], s22 offen lds
	s_add_u32 m0, s40, 69632
	s_add_u32 s22, s22, s24
	buffer_load_dwordx4 v2, s[12:15], s22 offen lds
	s_add_u32 m0, s40, 73728
	s_add_u32 s22, s22, s24
	buffer_load_dwordx4 v2, s[12:15], s22 offen lds
	s_add_u32 m0, s40, 77824
	s_add_u32 s22, s22, s24
	buffer_load_dwordx4 v2, s[12:15], s22 offen lds
	s_add_u32 s19, s19, 128
	s_add_u32 s20, s20, s42
	s_add_u32 m0, s40, 81920
	s_add_u32 s21, s19, 0
	buffer_load_dwordx4 v1, s[8:11], s21 offen lds
	s_add_u32 m0, s40, 86016
	s_add_u32 s21, s19, 36864
	buffer_load_dwordx4 v1, s[8:11], s21 offen lds
	s_add_u32 m0, s40, 90112
	s_mov_b32 s22, s20
	buffer_load_dwordx4 v2, s[12:15], s22 offen lds
	s_add_u32 m0, s40, 94208
	s_add_u32 s22, s22, s24
	buffer_load_dwordx4 v2, s[12:15], s22 offen lds
	s_add_u32 m0, s40, 98304
	s_add_u32 s22, s22, s24
	buffer_load_dwordx4 v2, s[12:15], s22 offen lds
	s_add_u32 m0, s40, 102400
	s_add_u32 s22, s22, s24
	buffer_load_dwordx4 v2, s[12:15], s22 offen lds
	s_add_u32 m0, s40, 106496
	s_add_u32 s22, s22, s24
	buffer_load_dwordx4 v2, s[12:15], s22 offen lds
	s_add_u32 m0, s40, 110592
	s_add_u32 s22, s22, s24
	buffer_load_dwordx4 v2, s[12:15], s22 offen lds
	s_add_u32 m0, s40, 114688
	s_add_u32 s22, s22, s24
	buffer_load_dwordx4 v2, s[12:15], s22 offen lds
	s_add_u32 m0, s40, 118784
	s_add_u32 s22, s22, s24
	buffer_load_dwordx4 v2, s[12:15], s22 offen lds
	s_add_u32 s19, s19, 128
	s_add_u32 s20, s20, s42
	s_waitcnt vmcnt(20)
	s_barrier
	ds_read_b64_tr_b16 v[16:17], v9 offset:0
	ds_read_b64_tr_b16 v[18:19], v9 offset:2048
	ds_read_b128 v[32:35], v5 offset:0
	ds_read_b64_tr_b16 v[20:21], v10 offset:0
	ds_read_b64_tr_b16 v[22:23], v10 offset:2048
	ds_read_b64_tr_b16 v[24:25], v11 offset:0
	ds_read_b64_tr_b16 v[26:27], v11 offset:2048
	ds_read_b64_tr_b16 v[28:29], v12 offset:0
	ds_read_b64_tr_b16 v[30:31], v12 offset:2048
	s_waitcnt lgkmcnt(6)
	v_mfma_f32_32x32x16_bf16 a[0:15], v[32:35], v[16:19], 0
	ds_read_b64_tr_b16 v[36:37], v9 offset:8192
	ds_read_b64_tr_b16 v[38:39], v9 offset:10240
	ds_read_b128 v[52:55], v6 offset:0
	s_waitcnt lgkmcnt(7)
	v_mfma_f32_32x32x16_bf16 a[16:31], v[32:35], v[20:23], 0
	ds_read_b64_tr_b16 v[40:41], v10 offset:8192
	ds_read_b64_tr_b16 v[42:43], v10 offset:10240
	s_waitcnt lgkmcnt(7)
	v_mfma_f32_32x32x16_bf16 a[32:47], v[32:35], v[24:27], 0
	ds_read_b64_tr_b16 v[44:45], v11 offset:8192
	ds_read_b64_tr_b16 v[46:47], v11 offset:10240
	s_waitcnt lgkmcnt(7)
	v_mfma_f32_32x32x16_bf16 a[48:63], v[32:35], v[28:31], 0
	ds_read_b64_tr_b16 v[48:49], v12 offset:8192
	ds_read_b64_tr_b16 v[50:51], v12 offset:10240
	s_waitcnt lgkmcnt(6)
	v_mfma_f32_32x32x16_bf16 a[0:15], v[52:55], v[36:39], a[0:15]
	ds_read_b64_tr_b16 v[16:17], v9 offset:16384
	ds_read_b64_tr_b16 v[18:19], v9 offset:18432
	ds_read_b128 v[32:35], v7 offset:0
	s_waitcnt lgkmcnt(7)
	v_mfma_f32_32x32x16_bf16 a[16:31], v[52:55], v[40:43], a[16:31]
	ds_read_b64_tr_b16 v[20:21], v10 offset:16384
	ds_read_b64_tr_b16 v[22:23], v10 offset:18432
	s_waitcnt lgkmcnt(7)
	v_mfma_f32_32x32x16_bf16 a[32:47], v[52:55], v[44:47], a[32:47]
	ds_read_b64_tr_b16 v[24:25], v11 offset:16384
	ds_read_b64_tr_b16 v[26:27], v11 offset:18432
	s_waitcnt lgkmcnt(7)
	v_mfma_f32_32x32x16_bf16 a[48:63], v[52:55], v[48:51], a[48:63]
	ds_read_b64_tr_b16 v[28:29], v12 offset:16384
	ds_read_b64_tr_b16 v[30:31], v12 offset:18432
	s_waitcnt lgkmcnt(6)
	v_mfma_f32_32x32x16_bf16 a[0:15], v[32:35], v[16:19], a[0:15]
	ds_read_b64_tr_b16 v[36:37], v9 offset:24576
	ds_read_b64_tr_b16 v[38:39], v9 offset:26624
	ds_read_b128 v[52:55], v8 offset:0
	s_waitcnt lgkmcnt(7)
	v_mfma_f32_32x32x16_bf16 a[16:31], v[32:35], v[20:23], a[16:31]
	ds_read_b64_tr_b16 v[40:41], v10 offset:24576
	ds_read_b64_tr_b16 v[42:43], v10 offset:26624
	s_waitcnt lgkmcnt(7)
	v_mfma_f32_32x32x16_bf16 a[32:47], v[32:35], v[24:27], a[32:47]
	ds_read_b64_tr_b16 v[44:45], v11 offset:24576
	ds_read_b64_tr_b16 v[46:47], v11 offset:26624
	s_waitcnt lgkmcnt(7)
	v_mfma_f32_32x32x16_bf16 a[48:63], v[32:35], v[28:31], a[48:63]
	ds_read_b64_tr_b16 v[48:49], v12 offset:24576
	ds_read_b64_tr_b16 v[50:51], v12 offset:26624
	s_waitcnt vmcnt(10) lgkmcnt(0)
	s_barrier
	v_add_u32 v5, 0xa000, v5
	v_add_u32 v6, 0xa000, v6
	v_add_u32 v7, 0xa000, v7
	v_add_u32 v8, 0xa000, v8
	v_add_u32 v9, 0xa000, v9
	v_add_u32 v10, 0xa000, v10
	v_add_u32 v11, 0xa000, v11
	v_add_u32 v12, 0xa000, v12
	v_mfma_f32_32x32x16_bf16 a[0:15], v[52:55], v[36:39], a[0:15]
	ds_read_b64_tr_b16 v[16:17], v9 offset:0
	ds_read_b64_tr_b16 v[18:19], v9 offset:2048
	ds_read_b128 v[32:35], v5 offset:0
	s_add_u32 m0, s40, 0
	s_add_u32 s21, s19, 0
	buffer_load_dwordx4 v1, s[8:11], s21 offen lds
	s_add_u32 m0, s40, 4096
	s_add_u32 s21, s19, 36864
	buffer_load_dwordx4 v1, s[8:11], s21 offen lds
	v_mfma_f32_32x32x16_bf16 a[16:31], v[52:55], v[40:43], a[16:31]
	s_add_u32 m0, s40, 8192
	s_mov_b32 s22, s20
	buffer_load_dwordx4 v2, s[12:15], s22 offen lds
	s_add_u32 m0, s40, 12288
	s_add_u32 s22, s22, s24
	buffer_load_dwordx4 v2, s[12:15], s22 offen lds
	ds_read_b64_tr_b16 v[20:21], v10 offset:0
	ds_read_b64_tr_b16 v[22:23], v10 offset:2048
	ds_read_b64_tr_b16 v[24:25], v11 offset:0
	v_mfma_f32_32x32x16_bf16 a[32:47], v[52:55], v[44:47], a[32:47]
	ds_read_b64_tr_b16 v[26:27], v11 offset:2048
	ds_read_b64_tr_b16 v[28:29], v12 offset:0
	ds_read_b64_tr_b16 v[30:31], v12 offset:2048
	s_add_u32 m0, s40, 16384
	s_add_u32 s22, s22, s24
	buffer_load_dwordx4 v2, s[12:15], s22 offen lds
	s_add_u32 m0, s40, 20480
	s_add_u32 s22, s22, s24
	buffer_load_dwordx4 v2, s[12:15], s22 offen lds
	v_mfma_f32_32x32x16_bf16 a[48:63], v[52:55], v[48:51], a[48:63]
	s_add_u32 m0, s40, 24576
	s_add_u32 s22, s22, s24
	buffer_load_dwordx4 v2, s[12:15], s22 offen lds
	s_add_u32 m0, s40, 28672
	s_add_u32 s22, s22, s24
	buffer_load_dwordx4 v2, s[12:15], s22 offen lds
	s_add_u32 m0, s40, 32768
	s_add_u32 s22, s22, s24
	buffer_load_dwordx4 v2, s[12:15], s22 offen lds
	s_add_u32 m0, s40, 36864
	s_add_u32 s22, s22, s24
	buffer_load_dwordx4 v2, s[12:15], s22 offen lds
	s_add_u32 s19, s19, 128
	s_add_u32 s20, s20, s42
	s_waitcnt lgkmcnt(6)
	v_mfma_f32_32x32x16_bf16 a[0:15], v[32:35], v[16:19], a[0:15]
	ds_read_b64_tr_b16 v[36:37], v9 offset:8192
	ds_read_b64_tr_b16 v[38:39], v9 offset:10240
	ds_read_b128 v[52:55], v6 offset:0
	s_waitcnt lgkmcnt(7)
	v_mfma_f32_32x32x16_bf16 a[16:31], v[32:35], v[20:23], a[16:31]
	ds_read_b64_tr_b16 v[40:41], v10 offset:8192
	ds_read_b64_tr_b16 v[42:43], v10 offset:10240
	s_waitcnt lgkmcnt(7)
	v_mfma_f32_32x32x16_bf16 a[32:47], v[32:35], v[24:27], a[32:47]
	ds_read_b64_tr_b16 v[44:45], v11 offset:8192
	ds_read_b64_tr_b16 v[46:47], v11 offset:10240
	s_waitcnt lgkmcnt(7)
	v_mfma_f32_32x32x16_bf16 a[48:63], v[32:35], v[28:31], a[48:63]
	ds_read_b64_tr_b16 v[48:49], v12 offset:8192
	ds_read_b64_tr_b16 v[50:51], v12 offset:10240
	s_waitcnt lgkmcnt(6)
	v_mfma_f32_32x32x16_bf16 a[0:15], v[52:55], v[36:39], a[0:15]
	ds_read_b64_tr_b16 v[16:17], v9 offset:16384
	ds_read_b64_tr_b16 v[18:19], v9 offset:18432
	ds_read_b128 v[32:35], v7 offset:0
	s_waitcnt lgkmcnt(7)
	v_mfma_f32_32x32x16_bf16 a[16:31], v[52:55], v[40:43], a[16:31]
	ds_read_b64_tr_b16 v[20:21], v10 offset:16384
	ds_read_b64_tr_b16 v[22:23], v10 offset:18432
	s_waitcnt lgkmcnt(7)
	v_mfma_f32_32x32x16_bf16 a[32:47], v[52:55], v[44:47], a[32:47]
	ds_read_b64_tr_b16 v[24:25], v11 offset:16384
	ds_read_b64_tr_b16 v[26:27], v11 offset:18432
	s_waitcnt lgkmcnt(7)
	v_mfma_f32_32x32x16_bf16 a[48:63], v[52:55], v[48:51], a[48:63]
	ds_read_b64_tr_b16 v[28:29], v12 offset:16384
	ds_read_b64_tr_b16 v[30:31], v12 offset:18432
	s_waitcnt lgkmcnt(6)
	v_mfma_f32_32x32x16_bf16 a[0:15], v[32:35], v[16:19], a[0:15]
	ds_read_b64_tr_b16 v[36:37], v9 offset:24576
	ds_read_b64_tr_b16 v[38:39], v9 offset:26624
	ds_read_b128 v[52:55], v8 offset:0
	s_waitcnt lgkmcnt(7)
	v_mfma_f32_32x32x16_bf16 a[16:31], v[32:35], v[20:23], a[16:31]
	ds_read_b64_tr_b16 v[40:41], v10 offset:24576
	ds_read_b64_tr_b16 v[42:43], v10 offset:26624
	s_waitcnt lgkmcnt(7)
	v_mfma_f32_32x32x16_bf16 a[32:47], v[32:35], v[24:27], a[32:47]
	ds_read_b64_tr_b16 v[44:45], v11 offset:24576
	ds_read_b64_tr_b16 v[46:47], v11 offset:26624
	s_waitcnt lgkmcnt(7)
	v_mfma_f32_32x32x16_bf16 a[48:63], v[32:35], v[28:31], a[48:63]
	ds_read_b64_tr_b16 v[48:49], v12 offset:24576
	ds_read_b64_tr_b16 v[50:51], v12 offset:26624
	s_waitcnt vmcnt(10) lgkmcnt(0)
	s_barrier
	v_add_u32 v5, 0xa000, v5
	v_add_u32 v6, 0xa000, v6
	v_add_u32 v7, 0xa000, v7
	v_add_u32 v8, 0xa000, v8
	v_add_u32 v9, 0xa000, v9
	v_add_u32 v10, 0xa000, v10
	v_add_u32 v11, 0xa000, v11
	v_add_u32 v12, 0xa000, v12
	v_mfma_f32_32x32x16_bf16 a[0:15], v[52:55], v[36:39], a[0:15]
	ds_read_b64_tr_b16 v[16:17], v9 offset:0
	ds_read_b64_tr_b16 v[18:19], v9 offset:2048
	ds_read_b128 v[32:35], v5 offset:0
	s_add_u32 m0, s40, 40960
	s_add_u32 s21, s19, 0
	buffer_load_dwordx4 v1, s[8:11], s21 offen lds
	s_add_u32 m0, s40, 45056
	s_add_u32 s21, s19, 36864
	buffer_load_dwordx4 v1, s[8:11], s21 offen lds
	v_mfma_f32_32x32x16_bf16 a[16:31], v[52:55], v[40:43], a[16:31]
	s_add_u32 m0, s40, 49152
	s_mov_b32 s22, s20
	buffer_load_dwordx4 v2, s[12:15], s22 offen lds
	s_add_u32 m0, s40, 53248
	s_add_u32 s22, s22, s24
	buffer_load_dwordx4 v2, s[12:15], s22 offen lds
	ds_read_b64_tr_b16 v[20:21], v10 offset:0
	ds_read_b64_tr_b16 v[22:23], v10 offset:2048
	ds_read_b64_tr_b16 v[24:25], v11 offset:0
	v_mfma_f32_32x32x16_bf16 a[32:47], v[52:55], v[44:47], a[32:47]
	ds_read_b64_tr_b16 v[26:27], v11 offset:2048
	ds_read_b64_tr_b16 v[28:29], v12 offset:0
	ds_read_b64_tr_b16 v[30:31], v12 offset:2048
	s_add_u32 m0, s40, 57344
	s_add_u32 s22, s22, s24
	buffer_load_dwordx4 v2, s[12:15], s22 offen lds
	s_add_u32 m0, s40, 61440
	s_add_u32 s22, s22, s24
	buffer_load_dwordx4 v2, s[12:15], s22 offen lds
	v_mfma_f32_32x32x16_bf16 a[48:63], v[52:55], v[48:51], a[48:63]
	s_add_u32 m0, s40, 65536
	s_add_u32 s22, s22, s24
	buffer_load_dwordx4 v2, s[12:15], s22 offen lds
	s_add_u32 m0, s40, 69632
	s_add_u32 s22, s22, s24
	buffer_load_dwordx4 v2, s[12:15], s22 offen lds
	s_add_u32 m0, s40, 73728
	s_add_u32 s22, s22, s24
	buffer_load_dwordx4 v2, s[12:15], s22 offen lds
	s_add_u32 m0, s40, 77824
	s_add_u32 s22, s22, s24
	buffer_load_dwordx4 v2, s[12:15], s22 offen lds
	s_add_u32 s19, s19, 128
	s_add_u32 s20, s20, s42
	s_waitcnt lgkmcnt(6)
	v_mfma_f32_32x32x16_bf16 a[0:15], v[32:35], v[16:19], a[0:15]
	ds_read_b64_tr_b16 v[36:37], v9 offset:8192
	ds_read_b64_tr_b16 v[38:39], v9 offset:10240
	ds_read_b128 v[52:55], v6 offset:0
	s_waitcnt lgkmcnt(7)
	v_mfma_f32_32x32x16_bf16 a[16:31], v[32:35], v[20:23], a[16:31]
	ds_read_b64_tr_b16 v[40:41], v10 offset:8192
	ds_read_b64_tr_b16 v[42:43], v10 offset:10240
	s_waitcnt lgkmcnt(7)
	v_mfma_f32_32x32x16_bf16 a[32:47], v[32:35], v[24:27], a[32:47]
	ds_read_b64_tr_b16 v[44:45], v11 offset:8192
	ds_read_b64_tr_b16 v[46:47], v11 offset:10240
	s_waitcnt lgkmcnt(7)
	v_mfma_f32_32x32x16_bf16 a[48:63], v[32:35], v[28:31], a[48:63]
	ds_read_b64_tr_b16 v[48:49], v12 offset:8192
	ds_read_b64_tr_b16 v[50:51], v12 offset:10240
	s_waitcnt lgkmcnt(6)
	v_mfma_f32_32x32x16_bf16 a[0:15], v[52:55], v[36:39], a[0:15]
	ds_read_b64_tr_b16 v[16:17], v9 offset:16384
	ds_read_b64_tr_b16 v[18:19], v9 offset:18432
	ds_read_b128 v[32:35], v7 offset:0
	s_waitcnt lgkmcnt(7)
	v_mfma_f32_32x32x16_bf16 a[16:31], v[52:55], v[40:43], a[16:31]
	ds_read_b64_tr_b16 v[20:21], v10 offset:16384
	ds_read_b64_tr_b16 v[22:23], v10 offset:18432
	s_waitcnt lgkmcnt(7)
	v_mfma_f32_32x32x16_bf16 a[32:47], v[52:55], v[44:47], a[32:47]
	ds_read_b64_tr_b16 v[24:25], v11 offset:16384
	ds_read_b64_tr_b16 v[26:27], v11 offset:18432
	s_waitcnt lgkmcnt(7)
	v_mfma_f32_32x32x16_bf16 a[48:63], v[52:55], v[48:51], a[48:63]
	ds_read_b64_tr_b16 v[28:29], v12 offset:16384
	ds_read_b64_tr_b16 v[30:31], v12 offset:18432
	s_waitcnt lgkmcnt(6)
	v_mfma_f32_32x32x16_bf16 a[0:15], v[32:35], v[16:19], a[0:15]
	ds_read_b64_tr_b16 v[36:37], v9 offset:24576
	ds_read_b64_tr_b16 v[38:39], v9 offset:26624
	ds_read_b128 v[52:55], v8 offset:0
	s_waitcnt lgkmcnt(7)
	v_mfma_f32_32x32x16_bf16 a[16:31], v[32:35], v[20:23], a[16:31]
	ds_read_b64_tr_b16 v[40:41], v10 offset:24576
	ds_read_b64_tr_b16 v[42:43], v10 offset:26624
	s_waitcnt lgkmcnt(7)
	v_mfma_f32_32x32x16_bf16 a[32:47], v[32:35], v[24:27], a[32:47]
	ds_read_b64_tr_b16 v[44:45], v11 offset:24576
	ds_read_b64_tr_b16 v[46:47], v11 offset:26624
	s_waitcnt lgkmcnt(7)
	v_mfma_f32_32x32x16_bf16 a[48:63], v[32:35], v[28:31], a[48:63]
	ds_read_b64_tr_b16 v[48:49], v12 offset:24576
	ds_read_b64_tr_b16 v[50:51], v12 offset:26624
	s_waitcnt vmcnt(10) lgkmcnt(0)
	s_barrier
	v_add_u32 v5, 0xfffec000, v5
	v_add_u32 v6, 0xfffec000, v6
	v_add_u32 v7, 0xfffec000, v7
	v_add_u32 v8, 0xfffec000, v8
	v_add_u32 v9, 0xfffec000, v9
	v_add_u32 v10, 0xfffec000, v10
	v_add_u32 v11, 0xfffec000, v11
	v_add_u32 v12, 0xfffec000, v12
	v_mfma_f32_32x32x16_bf16 a[0:15], v[52:55], v[36:39], a[0:15]
	ds_read_b64_tr_b16 v[16:17], v9 offset:0
	ds_read_b64_tr_b16 v[18:19], v9 offset:2048
	ds_read_b128 v[32:35], v5 offset:0
	s_add_u32 m0, s40, 81920
	s_add_u32 s21, s19, 0
	buffer_load_dwordx4 v1, s[8:11], s21 offen lds
	s_add_u32 m0, s40, 86016
	s_add_u32 s21, s19, 36864
	buffer_load_dwordx4 v1, s[8:11], s21 offen lds
	v_mfma_f32_32x32x16_bf16 a[16:31], v[52:55], v[40:43], a[16:31]
	s_add_u32 m0, s40, 90112
	s_mov_b32 s22, s20
	buffer_load_dwordx4 v2, s[12:15], s22 offen lds
	s_add_u32 m0, s40, 94208
	s_add_u32 s22, s22, s24
	buffer_load_dwordx4 v2, s[12:15], s22 offen lds
	ds_read_b64_tr_b16 v[20:21], v10 offset:0
	ds_read_b64_tr_b16 v[22:23], v10 offset:2048
	ds_read_b64_tr_b16 v[24:25], v11 offset:0
	v_mfma_f32_32x32x16_bf16 a[32:47], v[52:55], v[44:47], a[32:47]
	ds_read_b64_tr_b16 v[26:27], v11 offset:2048
	ds_read_b64_tr_b16 v[28:29], v12 offset:0
	ds_read_b64_tr_b16 v[30:31], v12 offset:2048
	s_add_u32 m0, s40, 98304
	s_add_u32 s22, s22, s24
	buffer_load_dwordx4 v2, s[12:15], s22 offen lds
	s_add_u32 m0, s40, 102400
	s_add_u32 s22, s22, s24
	buffer_load_dwordx4 v2, s[12:15], s22 offen lds
	v_mfma_f32_32x32x16_bf16 a[48:63], v[52:55], v[48:51], a[48:63]
	s_add_u32 m0, s40, 106496
	s_add_u32 s22, s22, s24
	buffer_load_dwordx4 v2, s[12:15], s22 offen lds
	s_add_u32 m0, s40, 110592
	s_add_u32 s22, s22, s24
	buffer_load_dwordx4 v2, s[12:15], s22 offen lds
	s_add_u32 m0, s40, 114688
	s_add_u32 s22, s22, s24
	buffer_load_dwordx4 v2, s[12:15], s22 offen lds
	s_add_u32 m0, s40, 118784
	s_add_u32 s22, s22, s24
	buffer_load_dwordx4 v2, s[12:15], s22 offen lds
	s_add_u32 s19, s19, 128
	s_add_u32 s20, s20, s42
	s_waitcnt lgkmcnt(6)
	v_mfma_f32_32x32x16_bf16 a[0:15], v[32:35], v[16:19], a[0:15]
	ds_read_b64_tr_b16 v[36:37], v9 offset:8192
	ds_read_b64_tr_b16 v[38:39], v9 offset:10240
	ds_read_b128 v[52:55], v6 offset:0
	s_waitcnt lgkmcnt(7)
	v_mfma_f32_32x32x16_bf16 a[16:31], v[32:35], v[20:23], a[16:31]
	ds_read_b64_tr_b16 v[40:41], v10 offset:8192
	ds_read_b64_tr_b16 v[42:43], v10 offset:10240
	s_waitcnt lgkmcnt(7)
	v_mfma_f32_32x32x16_bf16 a[32:47], v[32:35], v[24:27], a[32:47]
	ds_read_b64_tr_b16 v[44:45], v11 offset:8192
	ds_read_b64_tr_b16 v[46:47], v11 offset:10240
	s_waitcnt lgkmcnt(7)
	v_mfma_f32_32x32x16_bf16 a[48:63], v[32:35], v[28:31], a[48:63]
	ds_read_b64_tr_b16 v[48:49], v12 offset:8192
	ds_read_b64_tr_b16 v[50:51], v12 offset:10240
	s_waitcnt lgkmcnt(6)
	v_mfma_f32_32x32x16_bf16 a[0:15], v[52:55], v[36:39], a[0:15]
	ds_read_b64_tr_b16 v[16:17], v9 offset:16384
	ds_read_b64_tr_b16 v[18:19], v9 offset:18432
	ds_read_b128 v[32:35], v7 offset:0
	s_waitcnt lgkmcnt(7)
	v_mfma_f32_32x32x16_bf16 a[16:31], v[52:55], v[40:43], a[16:31]
	ds_read_b64_tr_b16 v[20:21], v10 offset:16384
	ds_read_b64_tr_b16 v[22:23], v10 offset:18432
	s_waitcnt lgkmcnt(7)
	v_mfma_f32_32x32x16_bf16 a[32:47], v[52:55], v[44:47], a[32:47]
	ds_read_b64_tr_b16 v[24:25], v11 offset:16384
	ds_read_b64_tr_b16 v[26:27], v11 offset:18432
	s_waitcnt lgkmcnt(7)
	v_mfma_f32_32x32x16_bf16 a[48:63], v[52:55], v[48:51], a[48:63]
	ds_read_b64_tr_b16 v[28:29], v12 offset:16384
	ds_read_b64_tr_b16 v[30:31], v12 offset:18432
	s_waitcnt lgkmcnt(6)
	v_mfma_f32_32x32x16_bf16 a[0:15], v[32:35], v[16:19], a[0:15]
	ds_read_b64_tr_b16 v[36:37], v9 offset:24576
	ds_read_b64_tr_b16 v[38:39], v9 offset:26624
	ds_read_b128 v[52:55], v8 offset:0
	s_waitcnt lgkmcnt(7)
	v_mfma_f32_32x32x16_bf16 a[16:31], v[32:35], v[20:23], a[16:31]
	ds_read_b64_tr_b16 v[40:41], v10 offset:24576
	ds_read_b64_tr_b16 v[42:43], v10 offset:26624
	s_waitcnt lgkmcnt(7)
	v_mfma_f32_32x32x16_bf16 a[32:47], v[32:35], v[24:27], a[32:47]
	ds_read_b64_tr_b16 v[44:45], v11 offset:24576
	ds_read_b64_tr_b16 v[46:47], v11 offset:26624
	s_waitcnt lgkmcnt(7)
	v_mfma_f32_32x32x16_bf16 a[48:63], v[32:35], v[28:31], a[48:63]
	ds_read_b64_tr_b16 v[48:49], v12 offset:24576
	ds_read_b64_tr_b16 v[50:51], v12 offset:26624
	s_waitcnt vmcnt(10) lgkmcnt(0)
	s_barrier
	v_add_u32 v5, 0xa000, v5
	v_add_u32 v6, 0xa000, v6
	v_add_u32 v7, 0xa000, v7
	v_add_u32 v8, 0xa000, v8
	v_add_u32 v9, 0xa000, v9
	v_add_u32 v10, 0xa000, v10
	v_add_u32 v11, 0xa000, v11
	v_add_u32 v12, 0xa000, v12
	v_mfma_f32_32x32x16_bf16 a[0:15], v[52:55], v[36:39], a[0:15]
	ds_read_b64_tr_b16 v[16:17], v9 offset:0
	ds_read_b64_tr_b16 v[18:19], v9 offset:2048
	ds_read_b128 v[32:35], v5 offset:0
	s_add_u32 m0, s40, 0
	s_add_u32 s21, s19, 0
	buffer_load_dwordx4 v1, s[8:11], s21 offen lds
	s_add_u32 m0, s40, 4096
	s_add_u32 s21, s19, 36864
	buffer_load_dwordx4 v1, s[8:11], s21 offen lds
	v_mfma_f32_32x32x16_bf16 a[16:31], v[52:55], v[40:43], a[16:31]
	s_add_u32 m0, s40, 8192
	s_mov_b32 s22, s20
	buffer_load_dwordx4 v2, s[12:15], s22 offen lds
	s_add_u32 m0, s40, 12288
	s_add_u32 s22, s22, s24
	buffer_load_dwordx4 v2, s[12:15], s22 offen lds
	ds_read_b64_tr_b16 v[20:21], v10 offset:0
	ds_read_b64_tr_b16 v[22:23], v10 offset:2048
	ds_read_b64_tr_b16 v[24:25], v11 offset:0
	v_mfma_f32_32x32x16_bf16 a[32:47], v[52:55], v[44:47], a[32:47]
	ds_read_b64_tr_b16 v[26:27], v11 offset:2048
	ds_read_b64_tr_b16 v[28:29], v12 offset:0
	ds_read_b64_tr_b16 v[30:31], v12 offset:2048
	s_add_u32 m0, s40, 16384
	s_add_u32 s22, s22, s24
	buffer_load_dwordx4 v2, s[12:15], s22 offen lds
	s_add_u32 m0, s40, 20480
	s_add_u32 s22, s22, s24
	buffer_load_dwordx4 v2, s[12:15], s22 offen lds
	v_mfma_f32_32x32x16_bf16 a[48:63], v[52:55], v[48:51], a[48:63]
	s_add_u32 m0, s40, 24576
	s_add_u32 s22, s22, s24
	buffer_load_dwordx4 v2, s[12:15], s22 offen lds
	s_add_u32 m0, s40, 28672
	s_add_u32 s22, s22, s24
	buffer_load_dwordx4 v2, s[12:15], s22 offen lds
	s_add_u32 m0, s40, 32768
	s_add_u32 s22, s22, s24
	buffer_load_dwordx4 v2, s[12:15], s22 offen lds
	s_add_u32 m0, s40, 36864
	s_add_u32 s22, s22, s24
	buffer_load_dwordx4 v2, s[12:15], s22 offen lds
	s_add_u32 s19, s19, 128
	s_add_u32 s20, s20, s42
	s_waitcnt lgkmcnt(6)
	v_mfma_f32_32x32x16_bf16 a[0:15], v[32:35], v[16:19], a[0:15]
	ds_read_b64_tr_b16 v[36:37], v9 offset:8192
	ds_read_b64_tr_b16 v[38:39], v9 offset:10240
	ds_read_b128 v[52:55], v6 offset:0
	s_waitcnt lgkmcnt(7)
	v_mfma_f32_32x32x16_bf16 a[16:31], v[32:35], v[20:23], a[16:31]
	ds_read_b64_tr_b16 v[40:41], v10 offset:8192
	ds_read_b64_tr_b16 v[42:43], v10 offset:10240
	s_waitcnt lgkmcnt(7)
	v_mfma_f32_32x32x16_bf16 a[32:47], v[32:35], v[24:27], a[32:47]
	ds_read_b64_tr_b16 v[44:45], v11 offset:8192
	ds_read_b64_tr_b16 v[46:47], v11 offset:10240
	s_waitcnt lgkmcnt(7)
	v_mfma_f32_32x32x16_bf16 a[48:63], v[32:35], v[28:31], a[48:63]
	ds_read_b64_tr_b16 v[48:49], v12 offset:8192
	ds_read_b64_tr_b16 v[50:51], v12 offset:10240
	s_waitcnt lgkmcnt(6)
	v_mfma_f32_32x32x16_bf16 a[0:15], v[52:55], v[36:39], a[0:15]
	ds_read_b64_tr_b16 v[16:17], v9 offset:16384
	ds_read_b64_tr_b16 v[18:19], v9 offset:18432
	ds_read_b128 v[32:35], v7 offset:0
	s_waitcnt lgkmcnt(7)
	v_mfma_f32_32x32x16_bf16 a[16:31], v[52:55], v[40:43], a[16:31]
	ds_read_b64_tr_b16 v[20:21], v10 offset:16384
	ds_read_b64_tr_b16 v[22:23], v10 offset:18432
	s_waitcnt lgkmcnt(7)
	v_mfma_f32_32x32x16_bf16 a[32:47], v[52:55], v[44:47], a[32:47]
	ds_read_b64_tr_b16 v[24:25], v11 offset:16384
	ds_read_b64_tr_b16 v[26:27], v11 offset:18432
	s_waitcnt lgkmcnt(7)
	v_mfma_f32_32x32x16_bf16 a[48:63], v[52:55], v[48:51], a[48:63]
	ds_read_b64_tr_b16 v[28:29], v12 offset:16384
	ds_read_b64_tr_b16 v[30:31], v12 offset:18432
	s_waitcnt lgkmcnt(6)
	v_mfma_f32_32x32x16_bf16 a[0:15], v[32:35], v[16:19], a[0:15]
	ds_read_b64_tr_b16 v[36:37], v9 offset:24576
	ds_read_b64_tr_b16 v[38:39], v9 offset:26624
	ds_read_b128 v[52:55], v8 offset:0
	s_waitcnt lgkmcnt(7)
	v_mfma_f32_32x32x16_bf16 a[16:31], v[32:35], v[20:23], a[16:31]
	ds_read_b64_tr_b16 v[40:41], v10 offset:24576
	ds_read_b64_tr_b16 v[42:43], v10 offset:26624
	s_waitcnt lgkmcnt(7)
	v_mfma_f32_32x32x16_bf16 a[32:47], v[32:35], v[24:27], a[32:47]
	ds_read_b64_tr_b16 v[44:45], v11 offset:24576
	ds_read_b64_tr_b16 v[46:47], v11 offset:26624
	s_waitcnt lgkmcnt(7)
	v_mfma_f32_32x32x16_bf16 a[48:63], v[32:35], v[28:31], a[48:63]
	ds_read_b64_tr_b16 v[48:49], v12 offset:24576
	ds_read_b64_tr_b16 v[50:51], v12 offset:26624
	s_waitcnt vmcnt(10) lgkmcnt(0)
	s_barrier
	v_add_u32 v5, 0xa000, v5
	v_add_u32 v6, 0xa000, v6
	v_add_u32 v7, 0xa000, v7
	v_add_u32 v8, 0xa000, v8
	v_add_u32 v9, 0xa000, v9
	v_add_u32 v10, 0xa000, v10
	v_add_u32 v11, 0xa000, v11
	v_add_u32 v12, 0xa000, v12
	v_mfma_f32_32x32x16_bf16 a[0:15], v[52:55], v[36:39], a[0:15]
	ds_read_b64_tr_b16 v[16:17], v9 offset:0
	ds_read_b64_tr_b16 v[18:19], v9 offset:2048
	ds_read_b128 v[32:35], v5 offset:0
	s_add_u32 m0, s40, 40960
	s_add_u32 s21, s19, 0
	buffer_load_dwordx4 v1, s[8:11], s21 offen lds
	s_add_u32 m0, s40, 45056
	s_add_u32 s21, s19, 36864
	buffer_load_dwordx4 v1, s[8:11], s21 offen lds
	v_mfma_f32_32x32x16_bf16 a[16:31], v[52:55], v[40:43], a[16:31]
	s_add_u32 m0, s40, 49152
	s_mov_b32 s22, s20
	buffer_load_dwordx4 v2, s[12:15], s22 offen lds
	s_add_u32 m0, s40, 53248
	s_add_u32 s22, s22, s24
	buffer_load_dwordx4 v2, s[12:15], s22 offen lds
	ds_read_b64_tr_b16 v[20:21], v10 offset:0
	ds_read_b64_tr_b16 v[22:23], v10 offset:2048
	ds_read_b64_tr_b16 v[24:25], v11 offset:0
	v_mfma_f32_32x32x16_bf16 a[32:47], v[52:55], v[44:47], a[32:47]
	ds_read_b64_tr_b16 v[26:27], v11 offset:2048
	ds_read_b64_tr_b16 v[28:29], v12 offset:0
	ds_read_b64_tr_b16 v[30:31], v12 offset:2048
	s_add_u32 m0, s40, 57344
	s_add_u32 s22, s22, s24
	buffer_load_dwordx4 v2, s[12:15], s22 offen lds
	s_add_u32 m0, s40, 61440
	s_add_u32 s22, s22, s24
	buffer_load_dwordx4 v2, s[12:15], s22 offen lds
	v_mfma_f32_32x32x16_bf16 a[48:63], v[52:55], v[48:51], a[48:63]
	s_add_u32 m0, s40, 65536
	s_add_u32 s22, s22, s24
	buffer_load_dwordx4 v2, s[12:15], s22 offen lds
	s_add_u32 m0, s40, 69632
	s_add_u32 s22, s22, s24
	buffer_load_dwordx4 v2, s[12:15], s22 offen lds
	s_add_u32 m0, s40, 73728
	s_add_u32 s22, s22, s24
	buffer_load_dwordx4 v2, s[12:15], s22 offen lds
	s_add_u32 m0, s40, 77824
	s_add_u32 s22, s22, s24
	buffer_load_dwordx4 v2, s[12:15], s22 offen lds
	s_add_u32 s19, s19, 128
	s_add_u32 s20, s20, s42
	s_waitcnt lgkmcnt(6)
	v_mfma_f32_32x32x16_bf16 a[0:15], v[32:35], v[16:19], a[0:15]
	ds_read_b64_tr_b16 v[36:37], v9 offset:8192
	ds_read_b64_tr_b16 v[38:39], v9 offset:10240
	ds_read_b128 v[52:55], v6 offset:0
	s_waitcnt lgkmcnt(7)
	v_mfma_f32_32x32x16_bf16 a[16:31], v[32:35], v[20:23], a[16:31]
	ds_read_b64_tr_b16 v[40:41], v10 offset:8192
	ds_read_b64_tr_b16 v[42:43], v10 offset:10240
	s_waitcnt lgkmcnt(7)
	v_mfma_f32_32x32x16_bf16 a[32:47], v[32:35], v[24:27], a[32:47]
	ds_read_b64_tr_b16 v[44:45], v11 offset:8192
	ds_read_b64_tr_b16 v[46:47], v11 offset:10240
	s_waitcnt lgkmcnt(7)
	v_mfma_f32_32x32x16_bf16 a[48:63], v[32:35], v[28:31], a[48:63]
	ds_read_b64_tr_b16 v[48:49], v12 offset:8192
	ds_read_b64_tr_b16 v[50:51], v12 offset:10240
	s_waitcnt lgkmcnt(6)
	v_mfma_f32_32x32x16_bf16 a[0:15], v[52:55], v[36:39], a[0:15]
	ds_read_b64_tr_b16 v[16:17], v9 offset:16384
	ds_read_b64_tr_b16 v[18:19], v9 offset:18432
	ds_read_b128 v[32:35], v7 offset:0
	s_waitcnt lgkmcnt(7)
	v_mfma_f32_32x32x16_bf16 a[16:31], v[52:55], v[40:43], a[16:31]
	ds_read_b64_tr_b16 v[20:21], v10 offset:16384
	ds_read_b64_tr_b16 v[22:23], v10 offset:18432
	s_waitcnt lgkmcnt(7)
	v_mfma_f32_32x32x16_bf16 a[32:47], v[52:55], v[44:47], a[32:47]
	ds_read_b64_tr_b16 v[24:25], v11 offset:16384
	ds_read_b64_tr_b16 v[26:27], v11 offset:18432
	s_waitcnt lgkmcnt(7)
	v_mfma_f32_32x32x16_bf16 a[48:63], v[52:55], v[48:51], a[48:63]
	ds_read_b64_tr_b16 v[28:29], v12 offset:16384
	ds_read_b64_tr_b16 v[30:31], v12 offset:18432
	s_waitcnt lgkmcnt(6)
	v_mfma_f32_32x32x16_bf16 a[0:15], v[32:35], v[16:19], a[0:15]
	ds_read_b64_tr_b16 v[36:37], v9 offset:24576
	ds_read_b64_tr_b16 v[38:39], v9 offset:26624
	ds_read_b128 v[52:55], v8 offset:0
	s_waitcnt lgkmcnt(7)
	v_mfma_f32_32x32x16_bf16 a[16:31], v[32:35], v[20:23], a[16:31]
	ds_read_b64_tr_b16 v[40:41], v10 offset:24576
	ds_read_b64_tr_b16 v[42:43], v10 offset:26624
	s_waitcnt lgkmcnt(7)
	v_mfma_f32_32x32x16_bf16 a[32:47], v[32:35], v[24:27], a[32:47]
	ds_read_b64_tr_b16 v[44:45], v11 offset:24576
	ds_read_b64_tr_b16 v[46:47], v11 offset:26624
	s_waitcnt lgkmcnt(7)
	v_mfma_f32_32x32x16_bf16 a[48:63], v[32:35], v[28:31], a[48:63]
	ds_read_b64_tr_b16 v[48:49], v12 offset:24576
	ds_read_b64_tr_b16 v[50:51], v12 offset:26624
	s_waitcnt vmcnt(10) lgkmcnt(0)
	s_barrier
	v_add_u32 v5, 0xfffec000, v5
	v_add_u32 v6, 0xfffec000, v6
	v_add_u32 v7, 0xfffec000, v7
	v_add_u32 v8, 0xfffec000, v8
	v_add_u32 v9, 0xfffec000, v9
	v_add_u32 v10, 0xfffec000, v10
	v_add_u32 v11, 0xfffec000, v11
	v_add_u32 v12, 0xfffec000, v12
	v_mfma_f32_32x32x16_bf16 a[0:15], v[52:55], v[36:39], a[0:15]
	ds_read_b64_tr_b16 v[16:17], v9 offset:0
	ds_read_b64_tr_b16 v[18:19], v9 offset:2048
	ds_read_b128 v[32:35], v5 offset:0
	s_add_u32 m0, s40, 81920
	s_add_u32 s21, s19, 0
	buffer_load_dwordx4 v1, s[8:11], s21 offen lds
	s_add_u32 m0, s40, 86016
	s_add_u32 s21, s19, 36864
	buffer_load_dwordx4 v1, s[8:11], s21 offen lds
	v_mfma_f32_32x32x16_bf16 a[16:31], v[52:55], v[40:43], a[16:31]
	s_add_u32 m0, s40, 90112
	s_mov_b32 s22, s20
	buffer_load_dwordx4 v2, s[12:15], s22 offen lds
	s_add_u32 m0, s40, 94208
	s_add_u32 s22, s22, s24
	buffer_load_dwordx4 v2, s[12:15], s22 offen lds
	ds_read_b64_tr_b16 v[20:21], v10 offset:0
	ds_read_b64_tr_b16 v[22:23], v10 offset:2048
	ds_read_b64_tr_b16 v[24:25], v11 offset:0
	v_mfma_f32_32x32x16_bf16 a[32:47], v[52:55], v[44:47], a[32:47]
	ds_read_b64_tr_b16 v[26:27], v11 offset:2048
	ds_read_b64_tr_b16 v[28:29], v12 offset:0
	ds_read_b64_tr_b16 v[30:31], v12 offset:2048
	s_add_u32 m0, s40, 98304
	s_add_u32 s22, s22, s24
	buffer_load_dwordx4 v2, s[12:15], s22 offen lds
	s_add_u32 m0, s40, 102400
	s_add_u32 s22, s22, s24
	buffer_load_dwordx4 v2, s[12:15], s22 offen lds
	v_mfma_f32_32x32x16_bf16 a[48:63], v[52:55], v[48:51], a[48:63]
	s_add_u32 m0, s40, 106496
	s_add_u32 s22, s22, s24
	buffer_load_dwordx4 v2, s[12:15], s22 offen lds
	s_add_u32 m0, s40, 110592
	s_add_u32 s22, s22, s24
	buffer_load_dwordx4 v2, s[12:15], s22 offen lds
	s_add_u32 m0, s40, 114688
	s_add_u32 s22, s22, s24
	buffer_load_dwordx4 v2, s[12:15], s22 offen lds
	s_add_u32 m0, s40, 118784
	s_add_u32 s22, s22, s24
	buffer_load_dwordx4 v2, s[12:15], s22 offen lds
	s_add_u32 s19, s19, 128
	s_add_u32 s20, s20, s42
	s_waitcnt lgkmcnt(6)
	v_mfma_f32_32x32x16_bf16 a[0:15], v[32:35], v[16:19], a[0:15]
	ds_read_b64_tr_b16 v[36:37], v9 offset:8192
	ds_read_b64_tr_b16 v[38:39], v9 offset:10240
	ds_read_b128 v[52:55], v6 offset:0
	s_waitcnt lgkmcnt(7)
	v_mfma_f32_32x32x16_bf16 a[16:31], v[32:35], v[20:23], a[16:31]
	ds_read_b64_tr_b16 v[40:41], v10 offset:8192
	ds_read_b64_tr_b16 v[42:43], v10 offset:10240
	s_waitcnt lgkmcnt(7)
	v_mfma_f32_32x32x16_bf16 a[32:47], v[32:35], v[24:27], a[32:47]
	ds_read_b64_tr_b16 v[44:45], v11 offset:8192
	ds_read_b64_tr_b16 v[46:47], v11 offset:10240
	s_waitcnt lgkmcnt(7)
	v_mfma_f32_32x32x16_bf16 a[48:63], v[32:35], v[28:31], a[48:63]
	ds_read_b64_tr_b16 v[48:49], v12 offset:8192
	ds_read_b64_tr_b16 v[50:51], v12 offset:10240
	s_waitcnt lgkmcnt(6)
	v_mfma_f32_32x32x16_bf16 a[0:15], v[52:55], v[36:39], a[0:15]
	ds_read_b64_tr_b16 v[16:17], v9 offset:16384
	ds_read_b64_tr_b16 v[18:19], v9 offset:18432
	ds_read_b128 v[32:35], v7 offset:0
	s_waitcnt lgkmcnt(7)
	v_mfma_f32_32x32x16_bf16 a[16:31], v[52:55], v[40:43], a[16:31]
	ds_read_b64_tr_b16 v[20:21], v10 offset:16384
	ds_read_b64_tr_b16 v[22:23], v10 offset:18432
	s_waitcnt lgkmcnt(7)
	v_mfma_f32_32x32x16_bf16 a[32:47], v[52:55], v[44:47], a[32:47]
	ds_read_b64_tr_b16 v[24:25], v11 offset:16384
	ds_read_b64_tr_b16 v[26:27], v11 offset:18432
	s_waitcnt lgkmcnt(7)
	v_mfma_f32_32x32x16_bf16 a[48:63], v[52:55], v[48:51], a[48:63]
	ds_read_b64_tr_b16 v[28:29], v12 offset:16384
	ds_read_b64_tr_b16 v[30:31], v12 offset:18432
	s_waitcnt lgkmcnt(6)
	v_mfma_f32_32x32x16_bf16 a[0:15], v[32:35], v[16:19], a[0:15]
	ds_read_b64_tr_b16 v[36:37], v9 offset:24576
	ds_read_b64_tr_b16 v[38:39], v9 offset:26624
	ds_read_b128 v[52:55], v8 offset:0
	s_waitcnt lgkmcnt(7)
	v_mfma_f32_32x32x16_bf16 a[16:31], v[32:35], v[20:23], a[16:31]
	ds_read_b64_tr_b16 v[40:41], v10 offset:24576
	ds_read_b64_tr_b16 v[42:43], v10 offset:26624
	s_waitcnt lgkmcnt(7)
	v_mfma_f32_32x32x16_bf16 a[32:47], v[32:35], v[24:27], a[32:47]
	ds_read_b64_tr_b16 v[44:45], v11 offset:24576
	ds_read_b64_tr_b16 v[46:47], v11 offset:26624
	s_waitcnt lgkmcnt(7)
	v_mfma_f32_32x32x16_bf16 a[48:63], v[32:35], v[28:31], a[48:63]
	ds_read_b64_tr_b16 v[48:49], v12 offset:24576
	ds_read_b64_tr_b16 v[50:51], v12 offset:26624
	s_waitcnt vmcnt(10) lgkmcnt(0)
	s_barrier
	v_add_u32 v5, 0xa000, v5
	v_add_u32 v6, 0xa000, v6
	v_add_u32 v7, 0xa000, v7
	v_add_u32 v8, 0xa000, v8
	v_add_u32 v9, 0xa000, v9
	v_add_u32 v10, 0xa000, v10
	v_add_u32 v11, 0xa000, v11
	v_add_u32 v12, 0xa000, v12
	v_mfma_f32_32x32x16_bf16 a[0:15], v[52:55], v[36:39], a[0:15]
	ds_read_b64_tr_b16 v[16:17], v9 offset:0
	ds_read_b64_tr_b16 v[18:19], v9 offset:2048
	ds_read_b128 v[32:35], v5 offset:0
	v_mfma_f32_32x32x16_bf16 a[16:31], v[52:55], v[40:43], a[16:31]
	ds_read_b64_tr_b16 v[20:21], v10 offset:0
	ds_read_b64_tr_b16 v[22:23], v10 offset:2048
	v_mfma_f32_32x32x16_bf16 a[32:47], v[52:55], v[44:47], a[32:47]
	ds_read_b64_tr_b16 v[24:25], v11 offset:0
	ds_read_b64_tr_b16 v[26:27], v11 offset:2048
	v_mfma_f32_32x32x16_bf16 a[48:63], v[52:55], v[48:51], a[48:63]
	ds_read_b64_tr_b16 v[28:29], v12 offset:0
	ds_read_b64_tr_b16 v[30:31], v12 offset:2048
	s_waitcnt lgkmcnt(6)
	v_mfma_f32_32x32x16_bf16 a[0:15], v[32:35], v[16:19], a[0:15]
	ds_read_b64_tr_b16 v[36:37], v9 offset:8192
	ds_read_b64_tr_b16 v[38:39], v9 offset:10240
	ds_read_b128 v[52:55], v6 offset:0
	s_waitcnt lgkmcnt(7)
	v_mfma_f32_32x32x16_bf16 a[16:31], v[32:35], v[20:23], a[16:31]
	ds_read_b64_tr_b16 v[40:41], v10 offset:8192
	ds_read_b64_tr_b16 v[42:43], v10 offset:10240
	s_waitcnt lgkmcnt(7)
	v_mfma_f32_32x32x16_bf16 a[32:47], v[32:35], v[24:27], a[32:47]
	ds_read_b64_tr_b16 v[44:45], v11 offset:8192
	ds_read_b64_tr_b16 v[46:47], v11 offset:10240
	s_waitcnt lgkmcnt(7)
	v_mfma_f32_32x32x16_bf16 a[48:63], v[32:35], v[28:31], a[48:63]
	ds_read_b64_tr_b16 v[48:49], v12 offset:8192
	ds_read_b64_tr_b16 v[50:51], v12 offset:10240
	s_waitcnt lgkmcnt(6)
	v_mfma_f32_32x32x16_bf16 a[0:15], v[52:55], v[36:39], a[0:15]
	ds_read_b64_tr_b16 v[16:17], v9 offset:16384
	ds_read_b64_tr_b16 v[18:19], v9 offset:18432
	ds_read_b128 v[32:35], v7 offset:0
	s_waitcnt lgkmcnt(7)
	v_mfma_f32_32x32x16_bf16 a[16:31], v[52:55], v[40:43], a[16:31]
	ds_read_b64_tr_b16 v[20:21], v10 offset:16384
	ds_read_b64_tr_b16 v[22:23], v10 offset:18432
	s_waitcnt lgkmcnt(7)
	v_mfma_f32_32x32x16_bf16 a[32:47], v[52:55], v[44:47], a[32:47]
	ds_read_b64_tr_b16 v[24:25], v11 offset:16384
	ds_read_b64_tr_b16 v[26:27], v11 offset:18432
	s_waitcnt lgkmcnt(7)
	v_mfma_f32_32x32x16_bf16 a[48:63], v[52:55], v[48:51], a[48:63]
	ds_read_b64_tr_b16 v[28:29], v12 offset:16384
	ds_read_b64_tr_b16 v[30:31], v12 offset:18432
	s_waitcnt lgkmcnt(6)
	v_mfma_f32_32x32x16_bf16 a[0:15], v[32:35], v[16:19], a[0:15]
	ds_read_b64_tr_b16 v[36:37], v9 offset:24576
	ds_read_b64_tr_b16 v[38:39], v9 offset:26624
	ds_read_b128 v[52:55], v8 offset:0
	s_waitcnt lgkmcnt(7)
	v_mfma_f32_32x32x16_bf16 a[16:31], v[32:35], v[20:23], a[16:31]
	ds_read_b64_tr_b16 v[40:41], v10 offset:24576
	ds_read_b64_tr_b16 v[42:43], v10 offset:26624
	s_waitcnt lgkmcnt(7)
	v_mfma_f32_32x32x16_bf16 a[32:47], v[32:35], v[24:27], a[32:47]
	ds_read_b64_tr_b16 v[44:45], v11 offset:24576
	ds_read_b64_tr_b16 v[46:47], v11 offset:26624
	s_waitcnt lgkmcnt(7)
	v_mfma_f32_32x32x16_bf16 a[48:63], v[32:35], v[28:31], a[48:63]
	ds_read_b64_tr_b16 v[48:49], v12 offset:24576
	ds_read_b64_tr_b16 v[50:51], v12 offset:26624
	s_waitcnt vmcnt(0) lgkmcnt(0)
	s_barrier
	v_add_u32 v5, 0xa000, v5
	v_add_u32 v6, 0xa000, v6
	v_add_u32 v7, 0xa000, v7
	v_add_u32 v8, 0xa000, v8
	v_add_u32 v9, 0xa000, v9
	v_add_u32 v10, 0xa000, v10
	v_add_u32 v11, 0xa000, v11
	v_add_u32 v12, 0xa000, v12
	v_mfma_f32_32x32x16_bf16 a[0:15], v[52:55], v[36:39], a[0:15]
	ds_read_b64_tr_b16 v[16:17], v9 offset:0
	ds_read_b64_tr_b16 v[18:19], v9 offset:2048
	ds_read_b128 v[32:35], v5 offset:0
	v_mfma_f32_32x32x16_bf16 a[16:31], v[52:55], v[40:43], a[16:31]
	ds_read_b64_tr_b16 v[20:21], v10 offset:0
	ds_read_b64_tr_b16 v[22:23], v10 offset:2048
	v_mfma_f32_32x32x16_bf16 a[32:47], v[52:55], v[44:47], a[32:47]
	ds_read_b64_tr_b16 v[24:25], v11 offset:0
	ds_read_b64_tr_b16 v[26:27], v11 offset:2048
	v_mfma_f32_32x32x16_bf16 a[48:63], v[52:55], v[48:51], a[48:63]
	ds_read_b64_tr_b16 v[28:29], v12 offset:0
	ds_read_b64_tr_b16 v[30:31], v12 offset:2048
	s_waitcnt lgkmcnt(6)
	v_mfma_f32_32x32x16_bf16 a[0:15], v[32:35], v[16:19], a[0:15]
	ds_read_b64_tr_b16 v[36:37], v9 offset:8192
	ds_read_b64_tr_b16 v[38:39], v9 offset:10240
	ds_read_b128 v[52:55], v6 offset:0
	s_waitcnt lgkmcnt(7)
	v_mfma_f32_32x32x16_bf16 a[16:31], v[32:35], v[20:23], a[16:31]
	ds_read_b64_tr_b16 v[40:41], v10 offset:8192
	ds_read_b64_tr_b16 v[42:43], v10 offset:10240
	s_waitcnt lgkmcnt(7)
	v_mfma_f32_32x32x16_bf16 a[32:47], v[32:35], v[24:27], a[32:47]
	ds_read_b64_tr_b16 v[44:45], v11 offset:8192
	ds_read_b64_tr_b16 v[46:47], v11 offset:10240
	s_waitcnt lgkmcnt(7)
	v_mfma_f32_32x32x16_bf16 a[48:63], v[32:35], v[28:31], a[48:63]
	ds_read_b64_tr_b16 v[48:49], v12 offset:8192
	ds_read_b64_tr_b16 v[50:51], v12 offset:10240
	s_waitcnt lgkmcnt(6)
	v_mfma_f32_32x32x16_bf16 a[0:15], v[52:55], v[36:39], a[0:15]
	ds_read_b64_tr_b16 v[16:17], v9 offset:16384
	ds_read_b64_tr_b16 v[18:19], v9 offset:18432
	ds_read_b128 v[32:35], v7 offset:0
	s_waitcnt lgkmcnt(7)
	v_mfma_f32_32x32x16_bf16 a[16:31], v[52:55], v[40:43], a[16:31]
	ds_read_b64_tr_b16 v[20:21], v10 offset:16384
	ds_read_b64_tr_b16 v[22:23], v10 offset:18432
	s_waitcnt lgkmcnt(7)
	v_mfma_f32_32x32x16_bf16 a[32:47], v[52:55], v[44:47], a[32:47]
	ds_read_b64_tr_b16 v[24:25], v11 offset:16384
	ds_read_b64_tr_b16 v[26:27], v11 offset:18432
	s_waitcnt lgkmcnt(7)
	v_mfma_f32_32x32x16_bf16 a[48:63], v[52:55], v[48:51], a[48:63]
	ds_read_b64_tr_b16 v[28:29], v12 offset:16384
	ds_read_b64_tr_b16 v[30:31], v12 offset:18432
	s_waitcnt lgkmcnt(6)
	v_mfma_f32_32x32x16_bf16 a[0:15], v[32:35], v[16:19], a[0:15]
	ds_read_b64_tr_b16 v[36:37], v9 offset:24576
	ds_read_b64_tr_b16 v[38:39], v9 offset:26624
	ds_read_b128 v[52:55], v8 offset:0
	s_waitcnt lgkmcnt(7)
	v_mfma_f32_32x32x16_bf16 a[16:31], v[32:35], v[20:23], a[16:31]
	ds_read_b64_tr_b16 v[40:41], v10 offset:24576
	ds_read_b64_tr_b16 v[42:43], v10 offset:26624
	s_waitcnt lgkmcnt(7)
	v_mfma_f32_32x32x16_bf16 a[32:47], v[32:35], v[24:27], a[32:47]
	ds_read_b64_tr_b16 v[44:45], v11 offset:24576
	ds_read_b64_tr_b16 v[46:47], v11 offset:26624
	s_waitcnt lgkmcnt(7)
	v_mfma_f32_32x32x16_bf16 a[48:63], v[32:35], v[28:31], a[48:63]
	ds_read_b64_tr_b16 v[48:49], v12 offset:24576
	ds_read_b64_tr_b16 v[50:51], v12 offset:26624
	s_waitcnt lgkmcnt(6)
	v_mfma_f32_32x32x16_bf16 a[0:15], v[52:55], v[36:39], a[0:15]
	s_waitcnt lgkmcnt(4)
	v_mfma_f32_32x32x16_bf16 a[16:31], v[52:55], v[40:43], a[16:31]
	s_waitcnt lgkmcnt(2)
	v_mfma_f32_32x32x16_bf16 a[32:47], v[52:55], v[44:47], a[32:47]
	s_waitcnt lgkmcnt(0)
	v_mfma_f32_32x32x16_bf16 a[48:63], v[52:55], v[48:51], a[48:63]
	v_add_u32 v5, 0xfffec000, v5
	v_add_u32 v6, 0xfffec000, v6
	v_add_u32 v7, 0xfffec000, v7
	v_add_u32 v8, 0xfffec000, v8
	v_add_u32 v9, 0xfffec000, v9
	v_add_u32 v10, 0xfffec000, v10
	v_add_u32 v11, 0xfffec000, v11
	v_add_u32 v12, 0xfffec000, v12
	s_barrier
	s_mov_b32 s26, 64
	s_lshl_b32 s25, s27, 6
	s_lshl_b32 s21, s28, 13
	s_add_u32 s25, s25, s21
	s_add_u32 s25, s25, 37748736
	s_and_b32 s21, s4, 1
	s_lshr_b32 s22, s4, 1
	s_mul_i32 s21, s21, 128
	s_mul_i32 s22, s22, 262144
	v_and_b32 v13, 15, v0
	v_add_u32 v13, s21, v13
	v_mul_lo_u32 v13, v13, s26
	v_bfe_u32 v14, v0, 4, 1
	v_lshl_add_u32 v13, v14, 5, v13
	v_lshrrev_b32 v14, 5, v0
	v_lshl_add_u32 v13, v14, 4, v13
	v_add_u32 v15, s22, v13
	s_lshl_b32 s22, s26, 4
	v_add_u32 v157, s22, v15
	s_lshl_b32 s22, s26, 5
	v_accvgpr_read_b32 v80, a0
	v_accvgpr_read_b32 v81, a1
	v_accvgpr_read_b32 v82, a2
	v_accvgpr_read_b32 v83, a3
	v_accvgpr_read_b32 v84, a4
	v_accvgpr_read_b32 v85, a5
	v_accvgpr_read_b32 v86, a6
	v_accvgpr_read_b32 v87, a7
	v_accvgpr_read_b32 v88, a8
	v_accvgpr_read_b32 v89, a9
	v_accvgpr_read_b32 v90, a10
	v_accvgpr_read_b32 v91, a11
	v_accvgpr_read_b32 v92, a12
	v_accvgpr_read_b32 v93, a13
	v_accvgpr_read_b32 v94, a14
	v_accvgpr_read_b32 v95, a15
	v_cvt_pk_bf16_f32 v80, v80, v81
	v_cvt_pk_bf16_f32 v81, v82, v83
	v_cvt_pk_bf16_f32 v82, v84, v85
	v_cvt_pk_bf16_f32 v83, v86, v87
	s_nop 0
	v_permlane32_swap_b32 v80, v82
	v_permlane32_swap_b32 v81, v83
	v_cvt_pk_bf16_f32 v88, v88, v89
	v_cvt_pk_bf16_f32 v89, v90, v91
	v_cvt_pk_bf16_f32 v90, v92, v93
	v_cvt_pk_bf16_f32 v91, v94, v95
	s_nop 0
	v_permlane32_swap_b32 v88, v90
	v_permlane32_swap_b32 v89, v91
	s_nop 0
	v_permlane16_swap_b32 v80, v88
	v_permlane16_swap_b32 v81, v89
	v_permlane16_swap_b32 v82, v90
	v_permlane16_swap_b32 v83, v91
	s_mov_b32 s23, s25
	buffer_store_dwordx4 v[80:83], v15, s[8:11], s23 offen offset:0 sc1
	buffer_store_dwordx4 v[88:91], v157, s[8:11], s23 offen offset:0 sc1
	s_nop 0
	v_accvgpr_read_b32 v80, a16
	v_accvgpr_read_b32 v81, a17
	v_accvgpr_read_b32 v82, a18
	v_accvgpr_read_b32 v83, a19
	v_accvgpr_read_b32 v84, a20
	v_accvgpr_read_b32 v85, a21
	v_accvgpr_read_b32 v86, a22
	v_accvgpr_read_b32 v87, a23
	v_accvgpr_read_b32 v88, a24
	v_accvgpr_read_b32 v89, a25
	v_accvgpr_read_b32 v90, a26
	v_accvgpr_read_b32 v91, a27
	v_accvgpr_read_b32 v92, a28
	v_accvgpr_read_b32 v93, a29
	v_accvgpr_read_b32 v94, a30
	v_accvgpr_read_b32 v95, a31
	v_cvt_pk_bf16_f32 v80, v80, v81
	v_cvt_pk_bf16_f32 v81, v82, v83
	v_cvt_pk_bf16_f32 v82, v84, v85
	v_cvt_pk_bf16_f32 v83, v86, v87
	s_nop 0
	v_permlane32_swap_b32 v80, v82
	v_permlane32_swap_b32 v81, v83
	v_cvt_pk_bf16_f32 v88, v88, v89
	v_cvt_pk_bf16_f32 v89, v90, v91
	v_cvt_pk_bf16_f32 v90, v92, v93
	v_cvt_pk_bf16_f32 v91, v94, v95
	s_nop 0
	v_permlane32_swap_b32 v88, v90
	v_permlane32_swap_b32 v89, v91
	s_nop 0
	v_permlane16_swap_b32 v80, v88
	v_permlane16_swap_b32 v81, v89
	v_permlane16_swap_b32 v82, v90
	v_permlane16_swap_b32 v83, v91
	s_mul_i32 s23, s22, 1
	s_add_u32 s23, s23, s25
	buffer_store_dwordx4 v[80:83], v15, s[8:11], s23 offen offset:0 sc1
	buffer_store_dwordx4 v[88:91], v157, s[8:11], s23 offen offset:0 sc1
	s_nop 0
	v_accvgpr_read_b32 v80, a32
	v_accvgpr_read_b32 v81, a33
	v_accvgpr_read_b32 v82, a34
	v_accvgpr_read_b32 v83, a35
	v_accvgpr_read_b32 v84, a36
	v_accvgpr_read_b32 v85, a37
	v_accvgpr_read_b32 v86, a38
	v_accvgpr_read_b32 v87, a39
	v_accvgpr_read_b32 v88, a40
	v_accvgpr_read_b32 v89, a41
	v_accvgpr_read_b32 v90, a42
	v_accvgpr_read_b32 v91, a43
	v_accvgpr_read_b32 v92, a44
	v_accvgpr_read_b32 v93, a45
	v_accvgpr_read_b32 v94, a46
	v_accvgpr_read_b32 v95, a47
	v_cvt_pk_bf16_f32 v80, v80, v81
	v_cvt_pk_bf16_f32 v81, v82, v83
	v_cvt_pk_bf16_f32 v82, v84, v85
	v_cvt_pk_bf16_f32 v83, v86, v87
	s_nop 0
	v_permlane32_swap_b32 v80, v82
	v_permlane32_swap_b32 v81, v83
	v_cvt_pk_bf16_f32 v88, v88, v89
	v_cvt_pk_bf16_f32 v89, v90, v91
	v_cvt_pk_bf16_f32 v90, v92, v93
	v_cvt_pk_bf16_f32 v91, v94, v95
	s_nop 0
	v_permlane32_swap_b32 v88, v90
	v_permlane32_swap_b32 v89, v91
	s_nop 0
	v_permlane16_swap_b32 v80, v88
	v_permlane16_swap_b32 v81, v89
	v_permlane16_swap_b32 v82, v90
	v_permlane16_swap_b32 v83, v91
	s_mul_i32 s23, s22, 2
	s_add_u32 s23, s23, s25
	buffer_store_dwordx4 v[80:83], v15, s[8:11], s23 offen offset:0 sc1
	buffer_store_dwordx4 v[88:91], v157, s[8:11], s23 offen offset:0 sc1
	s_nop 0
	v_accvgpr_read_b32 v80, a48
	v_accvgpr_read_b32 v81, a49
	v_accvgpr_read_b32 v82, a50
	v_accvgpr_read_b32 v83, a51
	v_accvgpr_read_b32 v84, a52
	v_accvgpr_read_b32 v85, a53
	v_accvgpr_read_b32 v86, a54
	v_accvgpr_read_b32 v87, a55
	v_accvgpr_read_b32 v88, a56
	v_accvgpr_read_b32 v89, a57
	v_accvgpr_read_b32 v90, a58
	v_accvgpr_read_b32 v91, a59
	v_accvgpr_read_b32 v92, a60
	v_accvgpr_read_b32 v93, a61
	v_accvgpr_read_b32 v94, a62
	v_accvgpr_read_b32 v95, a63
	v_cvt_pk_bf16_f32 v80, v80, v81
	v_cvt_pk_bf16_f32 v81, v82, v83
	v_cvt_pk_bf16_f32 v82, v84, v85
	v_cvt_pk_bf16_f32 v83, v86, v87
	s_nop 0
	v_permlane32_swap_b32 v80, v82
	v_permlane32_swap_b32 v81, v83
	v_cvt_pk_bf16_f32 v88, v88, v89
	v_cvt_pk_bf16_f32 v89, v90, v91
	v_cvt_pk_bf16_f32 v90, v92, v93
	v_cvt_pk_bf16_f32 v91, v94, v95
	s_nop 0
	v_permlane32_swap_b32 v88, v90
	v_permlane32_swap_b32 v89, v91
	s_nop 0
	v_permlane16_swap_b32 v80, v88
	v_permlane16_swap_b32 v81, v89
	v_permlane16_swap_b32 v82, v90
	v_permlane16_swap_b32 v83, v91
	s_mul_i32 s23, s22, 3
	s_add_u32 s23, s23, s25
	buffer_store_dwordx4 v[80:83], v15, s[8:11], s23 offen offset:0 sc1
	buffer_store_dwordx4 v[88:91], v157, s[8:11], s23 offen offset:0 sc1
main_kernel_g1x_done:
	s_mov_b32 s93, 16
	s_mov_b32 s100, 1
	s_waitcnt vmcnt(0)
	s_barrier
	s_cmp_lg_u32 s4, 0
	s_cbranch_scc1 main_kernel_sig0
	s_mov_b64 exec, 1
	v_mov_b32 v13, s100
	v_mov_b32 v14, s93
	buffer_atomic_add v13, v14, s[96:99], 0 offen sc1
	s_mov_b64 exec, -1
main_kernel_sig0:
main_kernel_lnbig:
	s_add_u32 s92, s92, 4
	s_cmp_lg_u32 s101, 0
	s_cbranch_scc1 main_kernel_r0map
	s_lshl_b32 s16, s88, 5
	s_add_u32 s17, s16, 35
	s_mul_i32 s17, s17, 9363
	s_lshr_b32 s17, s17, 16
	s_lshl_b32 s17, s17, 2
	s_add_u32 s16, s16, s89
	s_sub_u32 s16, s16, s17
	s_mul_i32 s17, s16, 21846
	s_lshr_b32 s17, s17, 16
	s_add_u32 s91, s17, 16
	s_mul_i32 s17, s17, 3
	s_sub_u32 s92, s16, s17
	s_add_u32 s92, s92, 1
main_kernel_r0map:
	s_lshl_b32 s93, s92, 2
	s_add_u32 s93, s93, 112
	s_cmp_lg_u32 s4, 0
	s_cbranch_scc1 main_kernel_lnacq_go
	v_mov_b32 v14, s93
main_kernel_lnacq_poll:
	buffer_load_dword v13, v14, s[96:99], 0 offen sc1
	s_waitcnt vmcnt(0)
	v_readfirstlane_b32 s95, v13
	s_sub_u32 s94, s94, 1
	s_cbranch_scc1 main_kernel_lnacq_got
	s_cmp_ge_u32 s95, 32
	s_cbranch_scc1 main_kernel_lnacq_got
	s_sleep 4
	s_branch main_kernel_lnacq_poll
main_kernel_lnacq_got:
	buffer_inv sc1
	s_waitcnt vmcnt(0)
main_kernel_lnacq_go:
	s_barrier
main_kernel_task:
	s_mov_b32 s93, 16
	s_cmp_ge_u32 s91, 48
	s_cselect_b32 s93, 48, s93
	s_cmp_lt_u32 s91, 16
	s_cselect_b32 s93, 80, s93
	s_cmp_eq_u32 s93, 16
	s_cselect_b32 s100, 4, 1
	s_lshl_b32 s95, s92, 2
	s_add_u32 s93, s93, s95
	s_lshr_b32 s21, s91, 4
	s_min_u32 s21, s21, 3
	s_lshl_b32 s22, s21, 3
	s_add_u32 s22, s22, 16
	s_cmp_eq_u32 s21, 3
	s_cselect_b32 s22, 64, s22
	s_load_dwordx2 s[12:13], s[0:1], s22
	s_load_dwordx2 s[32:33], s[0:1], 72
	s_mov_b32 s34, 9216
	s_mov_b32 s18, 8192
	s_cselect_b32 s18, 9216, s18
	s_mul_i32 s14, s18, 576
	s_lshl_b32 s40, s21, 4
	s_sub_u32 s27, s91, s40
	s_lshl_b32 s27, s27, 8
	s_lshl_b32 s17, s27, 1
	s_mul_i32 s28, s92, 256
	s_mul_i32 s16, s28, 1152
	s_add_u32 s16, s16, 0
	s_mov_b32 s43, s21
	s_waitcnt lgkmcnt(0)
	v_lshrrev_b32 v13, 4, v0
	s_and_b32 s21, s4, 1
	s_lshl_b32 s21, s21, 2
	v_add_u32 v13, s21, v13
	v_and_b32 v14, 7, v0
	v_xor_b32 v13, v13, v14
	v_lshlrev_b32 v13, 4, v13
	v_lshrrev_b32 v14, 3, v0
	s_lshl_b32 s21, s4, 3
	v_add_u32 v14, s21, v14
	s_mov_b32 s21, 1152
	v_mul_lo_u32 v14, v14, s21
	v_add_u32 v1, v13, v14
	v_lshrrev_b32 v13, 5, v0
	s_and_b32 s21, s4, 1
	s_lshl_b32 s21, s21, 1
	v_add_u32 v14, s21, v13
	v_lshlrev_b32 v14, 2, v14
	v_and_b32 v15, 31, v0
	v_xor_b32 v14, v14, v15
	v_lshlrev_b32 v14, 4, v14
	s_lshl_b32 s21, s4, 1
	v_add_u32 v13, s21, v13
	v_mul_lo_u32 v13, v13, s18
	v_add_u32 v2, v13, v14
	s_lshl_b32 s24, s18, 3
	v_and_b32 v13, 31, v0
	v_bfe_u32 v14, v0, 1, 3
	v_lshrrev_b32 v15, 5, v0
	v_xor_b32 v14, v14, v15
	v_lshlrev_b32 v14, 4, v14
	s_lshr_b32 s21, s4, 1
	s_mul_i32 s21, s21, 128
	v_add_u32 v13, s21, v13
	v_lshl_add_u32 v5, v13, 7, v14
	v_xor_b32 v6, 32, v5
	v_xor_b32 v7, 64, v5
	v_xor_b32 v8, 96, v5
	v_bfe_u32 v15, v0, 2, 2
	v_lshrrev_b32 v13, 5, v0
	v_lshl_add_u32 v13, v13, 3, v15
	v_mul_u32_u24 v13, 512, v13
	v_and_b32 v14, 1, v0
	v_lshl_add_u32 v13, v14, 3, v13
	v_add_u32 v13, 32768, v13
	v_lshlrev_b32 v15, 2, v15
	v_bfe_u32 v14, v0, 4, 1
	v_lshlrev_b32 v14, 1, v14
	v_bfe_u32 v9, v0, 1, 1
	v_add_u32 v14, v14, v9
	s_and_b32 s21, s4, 1
	s_mul_i32 s21, s21, 16
	s_add_u32 s21, s21, 0
	v_add_u32 v14, s21, v14
	v_xor_b32 v14, v14, v15
	v_lshl_add_u32 v9, v14, 4, v13
	v_bfe_u32 v14, v0, 4, 1
	v_lshlrev_b32 v14, 1, v14
	v_bfe_u32 v10, v0, 1, 1
	v_add_u32 v14, v14, v10
	s_and_b32 s21, s4, 1
	s_mul_i32 s21, s21, 16
	s_add_u32 s21, s21, 4
	v_add_u32 v14, s21, v14
	v_xor_b32 v14, v14, v15
	v_lshl_add_u32 v10, v14, 4, v13
	v_bfe_u32 v14, v0, 4, 1
	v_lshlrev_b32 v14, 1, v14
	v_bfe_u32 v11, v0, 1, 1
	v_add_u32 v14, v14, v11
	s_and_b32 s21, s4, 1
	s_mul_i32 s21, s21, 16
	s_add_u32 s21, s21, 8
	v_add_u32 v14, s21, v14
	v_xor_b32 v14, v14, v15
	v_lshl_add_u32 v11, v14, 4, v13
	v_bfe_u32 v14, v0, 4, 1
	v_lshlrev_b32 v14, 1, v14
	v_bfe_u32 v12, v0, 1, 1
	v_add_u32 v14, v14, v12
	s_and_b32 s21, s4, 1
	s_mul_i32 s21, s21, 16
	s_add_u32 s21, s21, 12
	v_add_u32 v14, s21, v14
	v_xor_b32 v14, v14, v15
	v_lshl_add_u32 v12, v14, 4, v13
	s_cmp_eq_u32 s43, 2
	s_cbranch_scc1 main_kernel_g1_vt
	s_lshl_b32 s40, s4, 10
	s_mul_i32 s41, s4, 6144
	s_lshl_b32 s42, s18, 6
	s_mov_b32 s19, s16
	s_mov_b32 s20, s17
	s_add_u32 m0, s40, 0
	s_add_u32 s21, s19, 0
	buffer_load_dwordx4 v1, s[8:11], s21 offen lds
	s_add_u32 m0, s40, 4096
	s_add_u32 s21, s19, 36864
	buffer_load_dwordx4 v1, s[8:11], s21 offen lds
	s_add_u32 m0, s40, 8192
	s_add_u32 s21, s19, 73728
	buffer_load_dwordx4 v1, s[8:11], s21 offen lds
	s_add_u32 m0, s40, 12288
	s_add_u32 s21, s19, 110592
	buffer_load_dwordx4 v1, s[8:11], s21 offen lds
	s_add_u32 m0, s40, 16384
	s_add_u32 s21, s19, 147456
	buffer_load_dwordx4 v1, s[8:11], s21 offen lds
	s_add_u32 m0, s40, 20480
	s_add_u32 s21, s19, 184320
	buffer_load_dwordx4 v1, s[8:11], s21 offen lds
	s_add_u32 m0, s40, 24576
	s_add_u32 s21, s19, 221184
	buffer_load_dwordx4 v1, s[8:11], s21 offen lds
	s_add_u32 m0, s40, 28672
	s_add_u32 s21, s19, 258048
	buffer_load_dwordx4 v1, s[8:11], s21 offen lds
	s_add_u32 m0, s40, 32768
	s_mov_b32 s22, s20
	buffer_load_dwordx4 v2, s[12:15], s22 offen lds
	s_add_u32 m0, s40, 36864
	s_add_u32 s22, s22, s24
	buffer_load_dwordx4 v2, s[12:15], s22 offen lds
	s_add_u32 m0, s40, 40960
	s_add_u32 s22, s22, s24
	buffer_load_dwordx4 v2, s[12:15], s22 offen lds
	s_add_u32 m0, s40, 45056
	s_add_u32 s22, s22, s24
	buffer_load_dwordx4 v2, s[12:15], s22 offen lds
	s_add_u32 m0, s40, 49152
	s_add_u32 s22, s22, s24
	buffer_load_dwordx4 v2, s[12:15], s22 offen lds
	s_add_u32 m0, s40, 53248
	s_add_u32 s22, s22, s24
	buffer_load_dwordx4 v2, s[12:15], s22 offen lds
	s_add_u32 m0, s40, 57344
	s_add_u32 s22, s22, s24
	buffer_load_dwordx4 v2, s[12:15], s22 offen lds
	s_add_u32 m0, s40, 61440
	s_add_u32 s22, s22, s24
	buffer_load_dwordx4 v2, s[12:15], s22 offen lds
	s_add_u32 s19, s19, 128
	s_add_u32 s20, s20, s42
	s_add_u32 m0, s40, 65536
	s_add_u32 s21, s19, 0
	buffer_load_dwordx4 v1, s[8:11], s21 offen lds
	s_add_u32 m0, s40, 69632
	s_add_u32 s21, s19, 36864
	buffer_load_dwordx4 v1, s[8:11], s21 offen lds
	s_add_u32 m0, s40, 73728
	s_add_u32 s21, s19, 73728
	buffer_load_dwordx4 v1, s[8:11], s21 offen lds
	s_add_u32 m0, s40, 77824
	s_add_u32 s21, s19, 110592
	buffer_load_dwordx4 v1, s[8:11], s21 offen lds
	s_add_u32 m0, s40, 81920
	s_add_u32 s21, s19, 147456
	buffer_load_dwordx4 v1, s[8:11], s21 offen lds
	s_add_u32 m0, s40, 86016
	s_add_u32 s21, s19, 184320
	buffer_load_dwordx4 v1, s[8:11], s21 offen lds
	s_add_u32 m0, s40, 90112
	s_add_u32 s21, s19, 221184
	buffer_load_dwordx4 v1, s[8:11], s21 offen lds
	s_add_u32 m0, s40, 94208
	s_add_u32 s21, s19, 258048
	buffer_load_dwordx4 v1, s[8:11], s21 offen lds
	s_add_u32 m0, s40, 98304
	s_mov_b32 s22, s20
	buffer_load_dwordx4 v2, s[12:15], s22 offen lds
	s_add_u32 m0, s40, 102400
	s_add_u32 s22, s22, s24
	buffer_load_dwordx4 v2, s[12:15], s22 offen lds
	s_add_u32 m0, s40, 106496
	s_add_u32 s22, s22, s24
	buffer_load_dwordx4 v2, s[12:15], s22 offen lds
	s_add_u32 m0, s40, 110592
	s_add_u32 s22, s22, s24
	buffer_load_dwordx4 v2, s[12:15], s22 offen lds
	s_add_u32 m0, s40, 114688
	s_add_u32 s22, s22, s24
	buffer_load_dwordx4 v2, s[12:15], s22 offen lds
	s_add_u32 m0, s40, 118784
	s_add_u32 s22, s22, s24
	buffer_load_dwordx4 v2, s[12:15], s22 offen lds
	s_add_u32 m0, s40, 122880
	s_add_u32 s22, s22, s24
	buffer_load_dwordx4 v2, s[12:15], s22 offen lds
	s_add_u32 m0, s40, 126976
	s_add_u32 s22, s22, s24
	buffer_load_dwordx4 v2, s[12:15], s22 offen lds
	s_add_u32 s19, s19, 128
	s_add_u32 s20, s20, s42
	s_waitcnt vmcnt(16)
	s_barrier
	ds_read_b64_tr_b16 v[16:17], v9 offset:0
	ds_read_b64_tr_b16 v[18:19], v9 offset:2048
	ds_read_b128 v[32:35], v5 offset:0
	ds_read_b64_tr_b16 v[20:21], v10 offset:0
	ds_read_b64_tr_b16 v[22:23], v10 offset:2048
	ds_read_b128 v[36:39], v5 offset:4096
	ds_read_b128 v[40:43], v5 offset:8192
	ds_read_b128 v[44:47], v5 offset:12288
	ds_read_b64_tr_b16 v[24:25], v11 offset:0
	ds_read_b64_tr_b16 v[26:27], v11 offset:2048
	ds_read_b64_tr_b16 v[28:29], v12 offset:0
	ds_read_b64_tr_b16 v[30:31], v12 offset:2048
	s_waitcnt lgkmcnt(9)
	v_mfma_f32_32x32x16_bf16 a[0:15], v[16:19], v[32:35], 0
	ds_read_b64_tr_b16 v[48:49], v9 offset:8192
	s_waitcnt lgkmcnt(7)
	v_mfma_f32_32x32x16_bf16 a[16:31], v[16:19], v[36:39], 0
	ds_read_b64_tr_b16 v[50:51], v9 offset:10240
	s_waitcnt lgkmcnt(7)
	v_mfma_f32_32x32x16_bf16 a[32:47], v[16:19], v[40:43], 0
	ds_read_b128 v[64:67], v6 offset:0
	s_waitcnt lgkmcnt(7)
	v_mfma_f32_32x32x16_bf16 a[48:63], v[16:19], v[44:47], 0
	v_mfma_f32_32x32x16_bf16 a[64:79], v[20:23], v[32:35], 0
	ds_read_b64_tr_b16 v[52:53], v10 offset:8192
	v_mfma_f32_32x32x16_bf16 a[80:95], v[20:23], v[36:39], 0
	ds_read_b64_tr_b16 v[54:55], v10 offset:10240
	v_mfma_f32_32x32x16_bf16 a[96:111], v[20:23], v[40:43], 0
	ds_read_b128 v[68:71], v6 offset:4096
	v_mfma_f32_32x32x16_bf16 a[112:127], v[20:23], v[44:47], 0
	s_waitcnt lgkmcnt(8)
	v_mfma_f32_32x32x16_bf16 a[128:143], v[24:27], v[32:35], 0
	ds_read_b128 v[72:75], v6 offset:8192
	v_mfma_f32_32x32x16_bf16 a[144:159], v[24:27], v[36:39], 0
	ds_read_b128 v[76:79], v6 offset:12288
	v_mfma_f32_32x32x16_bf16 a[160:175], v[24:27], v[40:43], 0
	ds_read_b64_tr_b16 v[56:57], v11 offset:8192
	v_mfma_f32_32x32x16_bf16 a[176:191], v[24:27], v[44:47], 0
	s_waitcnt lgkmcnt(9)
	v_mfma_f32_32x32x16_bf16 a[192:207], v[28:31], v[32:35], 0
	ds_read_b64_tr_b16 v[58:59], v11 offset:10240
	v_mfma_f32_32x32x16_bf16 a[208:223], v[28:31], v[36:39], 0
	ds_read_b64_tr_b16 v[60:61], v12 offset:8192
	v_mfma_f32_32x32x16_bf16 a[224:239], v[28:31], v[40:43], 0
	ds_read_b64_tr_b16 v[62:63], v12 offset:10240
	v_mfma_f32_32x32x16_bf16 a[240:255], v[28:31], v[44:47], 0
	s_waitcnt lgkmcnt(9)
	v_mfma_f32_32x32x16_bf16 a[0:15], v[48:51], v[64:67], a[0:15]
	ds_read_b64_tr_b16 v[16:17], v9 offset:16384
	s_waitcnt lgkmcnt(7)
	v_mfma_f32_32x32x16_bf16 a[16:31], v[48:51], v[68:71], a[16:31]
	ds_read_b64_tr_b16 v[18:19], v9 offset:18432
	s_waitcnt lgkmcnt(7)
	v_mfma_f32_32x32x16_bf16 a[32:47], v[48:51], v[72:75], a[32:47]
	ds_read_b128 v[32:35], v7 offset:0
	s_waitcnt lgkmcnt(7)
	v_mfma_f32_32x32x16_bf16 a[48:63], v[48:51], v[76:79], a[48:63]
	v_mfma_f32_32x32x16_bf16 a[64:79], v[52:55], v[64:67], a[64:79]
	ds_read_b64_tr_b16 v[20:21], v10 offset:16384
	v_mfma_f32_32x32x16_bf16 a[80:95], v[52:55], v[68:71], a[80:95]
	ds_read_b64_tr_b16 v[22:23], v10 offset:18432
	v_mfma_f32_32x32x16_bf16 a[96:111], v[52:55], v[72:75], a[96:111]
	ds_read_b128 v[36:39], v7 offset:4096
	v_mfma_f32_32x32x16_bf16 a[112:127], v[52:55], v[76:79], a[112:127]
	s_waitcnt lgkmcnt(8)
	v_mfma_f32_32x32x16_bf16 a[128:143], v[56:59], v[64:67], a[128:143]
	ds_read_b128 v[40:43], v7 offset:8192
	v_mfma_f32_32x32x16_bf16 a[144:159], v[56:59], v[68:71], a[144:159]
	ds_read_b128 v[44:47], v7 offset:12288
	v_mfma_f32_32x32x16_bf16 a[160:175], v[56:59], v[72:75], a[160:175]
	ds_read_b64_tr_b16 v[24:25], v11 offset:16384
	v_mfma_f32_32x32x16_bf16 a[176:191], v[56:59], v[76:79], a[176:191]
	s_waitcnt lgkmcnt(9)
	v_mfma_f32_32x32x16_bf16 a[192:207], v[60:63], v[64:67], a[192:207]
	ds_read_b64_tr_b16 v[26:27], v11 offset:18432
	v_mfma_f32_32x32x16_bf16 a[208:223], v[60:63], v[68:71], a[208:223]
	ds_read_b64_tr_b16 v[28:29], v12 offset:16384
	v_mfma_f32_32x32x16_bf16 a[224:239], v[60:63], v[72:75], a[224:239]
	ds_read_b64_tr_b16 v[30:31], v12 offset:18432
	v_mfma_f32_32x32x16_bf16 a[240:255], v[60:63], v[76:79], a[240:255]
	s_waitcnt lgkmcnt(9)
	v_mfma_f32_32x32x16_bf16 a[0:15], v[16:19], v[32:35], a[0:15]
	ds_read_b64_tr_b16 v[48:49], v9 offset:24576
	s_waitcnt lgkmcnt(7)
	v_mfma_f32_32x32x16_bf16 a[16:31], v[16:19], v[36:39], a[16:31]
	ds_read_b64_tr_b16 v[50:51], v9 offset:26624
	s_waitcnt lgkmcnt(7)
	v_mfma_f32_32x32x16_bf16 a[32:47], v[16:19], v[40:43], a[32:47]
	ds_read_b128 v[64:67], v8 offset:0
	s_waitcnt lgkmcnt(7)
	v_mfma_f32_32x32x16_bf16 a[48:63], v[16:19], v[44:47], a[48:63]
	v_mfma_f32_32x32x16_bf16 a[64:79], v[20:23], v[32:35], a[64:79]
	ds_read_b64_tr_b16 v[52:53], v10 offset:24576
	v_mfma_f32_32x32x16_bf16 a[80:95], v[20:23], v[36:39], a[80:95]
	ds_read_b64_tr_b16 v[54:55], v10 offset:26624
	v_mfma_f32_32x32x16_bf16 a[96:111], v[20:23], v[40:43], a[96:111]
	ds_read_b128 v[68:71], v8 offset:4096
	v_mfma_f32_32x32x16_bf16 a[112:127], v[20:23], v[44:47], a[112:127]
	s_waitcnt lgkmcnt(8)
	v_mfma_f32_32x32x16_bf16 a[128:143], v[24:27], v[32:35], a[128:143]
	ds_read_b128 v[72:75], v8 offset:8192
	v_mfma_f32_32x32x16_bf16 a[144:159], v[24:27], v[36:39], a[144:159]
	ds_read_b128 v[76:79], v8 offset:12288
	v_mfma_f32_32x32x16_bf16 a[160:175], v[24:27], v[40:43], a[160:175]
	ds_read_b64_tr_b16 v[56:57], v11 offset:24576
	v_mfma_f32_32x32x16_bf16 a[176:191], v[24:27], v[44:47], a[176:191]
	s_waitcnt lgkmcnt(9)
	v_mfma_f32_32x32x16_bf16 a[192:207], v[28:31], v[32:35], a[192:207]
	ds_read_b64_tr_b16 v[58:59], v11 offset:26624
	v_mfma_f32_32x32x16_bf16 a[208:223], v[28:31], v[36:39], a[208:223]
	ds_read_b64_tr_b16 v[60:61], v12 offset:24576
	v_mfma_f32_32x32x16_bf16 a[224:239], v[28:31], v[40:43], a[224:239]
	ds_read_b64_tr_b16 v[62:63], v12 offset:26624
	v_mfma_f32_32x32x16_bf16 a[240:255], v[28:31], v[44:47], a[240:255]
	s_waitcnt vmcnt(0) lgkmcnt(0)
	s_barrier
	v_add_u32 v5, 0x10000, v5
	v_add_u32 v6, 0x10000, v6
	v_add_u32 v7, 0x10000, v7
	v_add_u32 v8, 0x10000, v8
	v_add_u32 v9, 0x10000, v9
	v_add_u32 v10, 0x10000, v10
	v_add_u32 v11, 0x10000, v11
	v_add_u32 v12, 0x10000, v12
	v_mfma_f32_32x32x16_bf16 a[0:15], v[48:51], v[64:67], a[0:15]
	ds_read_b64_tr_b16 v[16:17], v9 offset:0
	ds_read_b64_tr_b16 v[18:19], v9 offset:2048
	v_mfma_f32_32x32x16_bf16 a[16:31], v[48:51], v[68:71], a[16:31]
	ds_read_b128 v[32:35], v5 offset:0
	s_add_u32 m0, s40, 0
	s_add_u32 s21, s19, 0
	buffer_load_dwordx4 v1, s[8:11], s21 offen lds
	v_mfma_f32_32x32x16_bf16 a[32:47], v[48:51], v[72:75], a[32:47]
	s_add_u32 m0, s40, 4096
	s_add_u32 s21, s19, 36864
	buffer_load_dwordx4 v1, s[8:11], s21 offen lds
	s_add_u32 m0, s40, 8192
	s_add_u32 s21, s19, 73728
	buffer_load_dwordx4 v1, s[8:11], s21 offen lds
	v_mfma_f32_32x32x16_bf16 a[48:63], v[48:51], v[76:79], a[48:63]
	s_add_u32 m0, s40, 12288
	s_add_u32 s21, s19, 110592
	buffer_load_dwordx4 v1, s[8:11], s21 offen lds
	ds_read_b64_tr_b16 v[20:21], v10 offset:0
	v_mfma_f32_32x32x16_bf16 a[64:79], v[52:55], v[64:67], a[64:79]
	ds_read_b64_tr_b16 v[22:23], v10 offset:2048
	ds_read_b128 v[36:39], v5 offset:4096
	v_mfma_f32_32x32x16_bf16 a[80:95], v[52:55], v[68:71], a[80:95]
	ds_read_b128 v[40:43], v5 offset:8192
	v_mfma_f32_32x32x16_bf16 a[96:111], v[52:55], v[72:75], a[96:111]
	ds_read_b128 v[44:47], v5 offset:12288
	ds_read_b64_tr_b16 v[24:25], v11 offset:0
	v_mfma_f32_32x32x16_bf16 a[112:127], v[52:55], v[76:79], a[112:127]
	ds_read_b64_tr_b16 v[26:27], v11 offset:2048
	ds_read_b64_tr_b16 v[28:29], v12 offset:0
	v_mfma_f32_32x32x16_bf16 a[128:143], v[56:59], v[64:67], a[128:143]
	ds_read_b64_tr_b16 v[30:31], v12 offset:2048
	s_add_u32 m0, s40, 16384
	s_add_u32 s21, s19, 147456
	buffer_load_dwordx4 v1, s[8:11], s21 offen lds
	v_mfma_f32_32x32x16_bf16 a[144:159], v[56:59], v[68:71], a[144:159]
	s_add_u32 m0, s40, 20480
	s_add_u32 s21, s19, 184320
	buffer_load_dwordx4 v1, s[8:11], s21 offen lds
	s_add_u32 m0, s40, 24576
	s_add_u32 s21, s19, 221184
	buffer_load_dwordx4 v1, s[8:11], s21 offen lds
	v_mfma_f32_32x32x16_bf16 a[160:175], v[56:59], v[72:75], a[160:175]
	s_add_u32 m0, s40, 28672
	s_add_u32 s21, s19, 258048
	buffer_load_dwordx4 v1, s[8:11], s21 offen lds
	v_mfma_f32_32x32x16_bf16 a[176:191], v[56:59], v[76:79], a[176:191]
	s_add_u32 m0, s40, 32768
	s_mov_b32 s22, s20
	buffer_load_dwordx4 v2, s[12:15], s22 offen lds
	s_add_u32 m0, s40, 36864
	s_add_u32 s22, s22, s24
	buffer_load_dwordx4 v2, s[12:15], s22 offen lds
	v_mfma_f32_32x32x16_bf16 a[192:207], v[60:63], v[64:67], a[192:207]
	s_add_u32 m0, s40, 40960
	s_add_u32 s22, s22, s24
	buffer_load_dwordx4 v2, s[12:15], s22 offen lds
	s_add_u32 m0, s40, 45056
	s_add_u32 s22, s22, s24
	buffer_load_dwordx4 v2, s[12:15], s22 offen lds
	v_mfma_f32_32x32x16_bf16 a[208:223], v[60:63], v[68:71], a[208:223]
	s_add_u32 m0, s40, 49152
	s_add_u32 s22, s22, s24
	buffer_load_dwordx4 v2, s[12:15], s22 offen lds
	s_add_u32 m0, s40, 53248
	s_add_u32 s22, s22, s24
	buffer_load_dwordx4 v2, s[12:15], s22 offen lds
	v_mfma_f32_32x32x16_bf16 a[224:239], v[60:63], v[72:75], a[224:239]
	s_add_u32 m0, s40, 57344
	s_add_u32 s22, s22, s24
	buffer_load_dwordx4 v2, s[12:15], s22 offen lds
	s_add_u32 m0, s40, 61440
	s_add_u32 s22, s22, s24
	buffer_load_dwordx4 v2, s[12:15], s22 offen lds
	v_mfma_f32_32x32x16_bf16 a[240:255], v[60:63], v[76:79], a[240:255]
	s_add_u32 s19, s19, 128
	s_add_u32 s20, s20, s42
	s_waitcnt lgkmcnt(9)
	v_mfma_f32_32x32x16_bf16 a[0:15], v[16:19], v[32:35], a[0:15]
	ds_read_b64_tr_b16 v[48:49], v9 offset:8192
	s_waitcnt lgkmcnt(7)
	v_mfma_f32_32x32x16_bf16 a[16:31], v[16:19], v[36:39], a[16:31]
	ds_read_b64_tr_b16 v[50:51], v9 offset:10240
	s_waitcnt lgkmcnt(7)
	v_mfma_f32_32x32x16_bf16 a[32:47], v[16:19], v[40:43], a[32:47]
	ds_read_b128 v[64:67], v6 offset:0
	s_waitcnt lgkmcnt(7)
	v_mfma_f32_32x32x16_bf16 a[48:63], v[16:19], v[44:47], a[48:63]
	v_mfma_f32_32x32x16_bf16 a[64:79], v[20:23], v[32:35], a[64:79]
	ds_read_b64_tr_b16 v[52:53], v10 offset:8192
	v_mfma_f32_32x32x16_bf16 a[80:95], v[20:23], v[36:39], a[80:95]
	ds_read_b64_tr_b16 v[54:55], v10 offset:10240
	v_mfma_f32_32x32x16_bf16 a[96:111], v[20:23], v[40:43], a[96:111]
	ds_read_b128 v[68:71], v6 offset:4096
	v_mfma_f32_32x32x16_bf16 a[112:127], v[20:23], v[44:47], a[112:127]
	s_waitcnt lgkmcnt(8)
	v_mfma_f32_32x32x16_bf16 a[128:143], v[24:27], v[32:35], a[128:143]
	ds_read_b128 v[72:75], v6 offset:8192
	v_mfma_f32_32x32x16_bf16 a[144:159], v[24:27], v[36:39], a[144:159]
	ds_read_b128 v[76:79], v6 offset:12288
	v_mfma_f32_32x32x16_bf16 a[160:175], v[24:27], v[40:43], a[160:175]
	ds_read_b64_tr_b16 v[56:57], v11 offset:8192
	v_mfma_f32_32x32x16_bf16 a[176:191], v[24:27], v[44:47], a[176:191]
	s_waitcnt lgkmcnt(9)
	v_mfma_f32_32x32x16_bf16 a[192:207], v[28:31], v[32:35], a[192:207]
	ds_read_b64_tr_b16 v[58:59], v11 offset:10240
	v_mfma_f32_32x32x16_bf16 a[208:223], v[28:31], v[36:39], a[208:223]
	ds_read_b64_tr_b16 v[60:61], v12 offset:8192
	v_mfma_f32_32x32x16_bf16 a[224:239], v[28:31], v[40:43], a[224:239]
	ds_read_b64_tr_b16 v[62:63], v12 offset:10240
	v_mfma_f32_32x32x16_bf16 a[240:255], v[28:31], v[44:47], a[240:255]
	s_waitcnt lgkmcnt(9)
	v_mfma_f32_32x32x16_bf16 a[0:15], v[48:51], v[64:67], a[0:15]
	ds_read_b64_tr_b16 v[16:17], v9 offset:16384
	s_waitcnt lgkmcnt(7)
	v_mfma_f32_32x32x16_bf16 a[16:31], v[48:51], v[68:71], a[16:31]
	ds_read_b64_tr_b16 v[18:19], v9 offset:18432
	s_waitcnt lgkmcnt(7)
	v_mfma_f32_32x32x16_bf16 a[32:47], v[48:51], v[72:75], a[32:47]
	ds_read_b128 v[32:35], v7 offset:0
	s_waitcnt lgkmcnt(7)
	v_mfma_f32_32x32x16_bf16 a[48:63], v[48:51], v[76:79], a[48:63]
	v_mfma_f32_32x32x16_bf16 a[64:79], v[52:55], v[64:67], a[64:79]
	ds_read_b64_tr_b16 v[20:21], v10 offset:16384
	v_mfma_f32_32x32x16_bf16 a[80:95], v[52:55], v[68:71], a[80:95]
	ds_read_b64_tr_b16 v[22:23], v10 offset:18432
	v_mfma_f32_32x32x16_bf16 a[96:111], v[52:55], v[72:75], a[96:111]
	ds_read_b128 v[36:39], v7 offset:4096
	v_mfma_f32_32x32x16_bf16 a[112:127], v[52:55], v[76:79], a[112:127]
	s_waitcnt lgkmcnt(8)
	v_mfma_f32_32x32x16_bf16 a[128:143], v[56:59], v[64:67], a[128:143]
	ds_read_b128 v[40:43], v7 offset:8192
	v_mfma_f32_32x32x16_bf16 a[144:159], v[56:59], v[68:71], a[144:159]
	ds_read_b128 v[44:47], v7 offset:12288
	v_mfma_f32_32x32x16_bf16 a[160:175], v[56:59], v[72:75], a[160:175]
	ds_read_b64_tr_b16 v[24:25], v11 offset:16384
	v_mfma_f32_32x32x16_bf16 a[176:191], v[56:59], v[76:79], a[176:191]
	s_waitcnt lgkmcnt(9)
	v_mfma_f32_32x32x16_bf16 a[192:207], v[60:63], v[64:67], a[192:207]
	ds_read_b64_tr_b16 v[26:27], v11 offset:18432
	v_mfma_f32_32x32x16_bf16 a[208:223], v[60:63], v[68:71], a[208:223]
	ds_read_b64_tr_b16 v[28:29], v12 offset:16384
	v_mfma_f32_32x32x16_bf16 a[224:239], v[60:63], v[72:75], a[224:239]
	ds_read_b64_tr_b16 v[30:31], v12 offset:18432
	v_mfma_f32_32x32x16_bf16 a[240:255], v[60:63], v[76:79], a[240:255]
	s_waitcnt lgkmcnt(9)
	v_mfma_f32_32x32x16_bf16 a[0:15], v[16:19], v[32:35], a[0:15]
	ds_read_b64_tr_b16 v[48:49], v9 offset:24576
	s_waitcnt lgkmcnt(7)
	v_mfma_f32_32x32x16_bf16 a[16:31], v[16:19], v[36:39], a[16:31]
	ds_read_b64_tr_b16 v[50:51], v9 offset:26624
	s_waitcnt lgkmcnt(7)
	v_mfma_f32_32x32x16_bf16 a[32:47], v[16:19], v[40:43], a[32:47]
	ds_read_b128 v[64:67], v8 offset:0
	s_waitcnt lgkmcnt(7)
	v_mfma_f32_32x32x16_bf16 a[48:63], v[16:19], v[44:47], a[48:63]
	v_mfma_f32_32x32x16_bf16 a[64:79], v[20:23], v[32:35], a[64:79]
	ds_read_b64_tr_b16 v[52:53], v10 offset:24576
	v_mfma_f32_32x32x16_bf16 a[80:95], v[20:23], v[36:39], a[80:95]
	ds_read_b64_tr_b16 v[54:55], v10 offset:26624
	v_mfma_f32_32x32x16_bf16 a[96:111], v[20:23], v[40:43], a[96:111]
	ds_read_b128 v[68:71], v8 offset:4096
	v_mfma_f32_32x32x16_bf16 a[112:127], v[20:23], v[44:47], a[112:127]
	s_waitcnt lgkmcnt(8)
	v_mfma_f32_32x32x16_bf16 a[128:143], v[24:27], v[32:35], a[128:143]
	ds_read_b128 v[72:75], v8 offset:8192
	v_mfma_f32_32x32x16_bf16 a[144:159], v[24:27], v[36:39], a[144:159]
	ds_read_b128 v[76:79], v8 offset:12288
	v_mfma_f32_32x32x16_bf16 a[160:175], v[24:27], v[40:43], a[160:175]
	ds_read_b64_tr_b16 v[56:57], v11 offset:24576
	v_mfma_f32_32x32x16_bf16 a[176:191], v[24:27], v[44:47], a[176:191]
	s_waitcnt lgkmcnt(9)
	v_mfma_f32_32x32x16_bf16 a[192:207], v[28:31], v[32:35], a[192:207]
	ds_read_b64_tr_b16 v[58:59], v11 offset:26624
	v_mfma_f32_32x32x16_bf16 a[208:223], v[28:31], v[36:39], a[208:223]
	ds_read_b64_tr_b16 v[60:61], v12 offset:24576
	v_mfma_f32_32x32x16_bf16 a[224:239], v[28:31], v[40:43], a[224:239]
	ds_read_b64_tr_b16 v[62:63], v12 offset:26624
	v_mfma_f32_32x32x16_bf16 a[240:255], v[28:31], v[44:47], a[240:255]
	s_waitcnt vmcnt(0) lgkmcnt(0)
	s_barrier
	v_add_u32 v5, 0xffff0000, v5
	v_add_u32 v6, 0xffff0000, v6
	v_add_u32 v7, 0xffff0000, v7
	v_add_u32 v8, 0xffff0000, v8
	v_add_u32 v9, 0xffff0000, v9
	v_add_u32 v10, 0xffff0000, v10
	v_add_u32 v11, 0xffff0000, v11
	v_add_u32 v12, 0xffff0000, v12
	v_mfma_f32_32x32x16_bf16 a[0:15], v[48:51], v[64:67], a[0:15]
	ds_read_b64_tr_b16 v[16:17], v9 offset:0
	ds_read_b64_tr_b16 v[18:19], v9 offset:2048
	v_mfma_f32_32x32x16_bf16 a[16:31], v[48:51], v[68:71], a[16:31]
	ds_read_b128 v[32:35], v5 offset:0
	s_add_u32 m0, s40, 65536
	s_add_u32 s21, s19, 0
	buffer_load_dwordx4 v1, s[8:11], s21 offen lds
	v_mfma_f32_32x32x16_bf16 a[32:47], v[48:51], v[72:75], a[32:47]
	s_add_u32 m0, s40, 69632
	s_add_u32 s21, s19, 36864
	buffer_load_dwordx4 v1, s[8:11], s21 offen lds
	s_add_u32 m0, s40, 73728
	s_add_u32 s21, s19, 73728
	buffer_load_dwordx4 v1, s[8:11], s21 offen lds
	v_mfma_f32_32x32x16_bf16 a[48:63], v[48:51], v[76:79], a[48:63]
	s_add_u32 m0, s40, 77824
	s_add_u32 s21, s19, 110592
	buffer_load_dwordx4 v1, s[8:11], s21 offen lds
	ds_read_b64_tr_b16 v[20:21], v10 offset:0
	v_mfma_f32_32x32x16_bf16 a[64:79], v[52:55], v[64:67], a[64:79]
	ds_read_b64_tr_b16 v[22:23], v10 offset:2048
	ds_read_b128 v[36:39], v5 offset:4096
	v_mfma_f32_32x32x16_bf16 a[80:95], v[52:55], v[68:71], a[80:95]
	ds_read_b128 v[40:43], v5 offset:8192
	v_mfma_f32_32x32x16_bf16 a[96:111], v[52:55], v[72:75], a[96:111]
	ds_read_b128 v[44:47], v5 offset:12288
	ds_read_b64_tr_b16 v[24:25], v11 offset:0
	v_mfma_f32_32x32x16_bf16 a[112:127], v[52:55], v[76:79], a[112:127]
	ds_read_b64_tr_b16 v[26:27], v11 offset:2048
	ds_read_b64_tr_b16 v[28:29], v12 offset:0
	v_mfma_f32_32x32x16_bf16 a[128:143], v[56:59], v[64:67], a[128:143]
	ds_read_b64_tr_b16 v[30:31], v12 offset:2048
	s_add_u32 m0, s40, 81920
	s_add_u32 s21, s19, 147456
	buffer_load_dwordx4 v1, s[8:11], s21 offen lds
	v_mfma_f32_32x32x16_bf16 a[144:159], v[56:59], v[68:71], a[144:159]
	s_add_u32 m0, s40, 86016
	s_add_u32 s21, s19, 184320
	buffer_load_dwordx4 v1, s[8:11], s21 offen lds
	s_add_u32 m0, s40, 90112
	s_add_u32 s21, s19, 221184
	buffer_load_dwordx4 v1, s[8:11], s21 offen lds
	v_mfma_f32_32x32x16_bf16 a[160:175], v[56:59], v[72:75], a[160:175]
	s_add_u32 m0, s40, 94208
	s_add_u32 s21, s19, 258048
	buffer_load_dwordx4 v1, s[8:11], s21 offen lds
	v_mfma_f32_32x32x16_bf16 a[176:191], v[56:59], v[76:79], a[176:191]
	s_add_u32 m0, s40, 98304
	s_mov_b32 s22, s20
	buffer_load_dwordx4 v2, s[12:15], s22 offen lds
	s_add_u32 m0, s40, 102400
	s_add_u32 s22, s22, s24
	buffer_load_dwordx4 v2, s[12:15], s22 offen lds
	v_mfma_f32_32x32x16_bf16 a[192:207], v[60:63], v[64:67], a[192:207]
	s_add_u32 m0, s40, 106496
	s_add_u32 s22, s22, s24
	buffer_load_dwordx4 v2, s[12:15], s22 offen lds
	s_add_u32 m0, s40, 110592
	s_add_u32 s22, s22, s24
	buffer_load_dwordx4 v2, s[12:15], s22 offen lds
	v_mfma_f32_32x32x16_bf16 a[208:223], v[60:63], v[68:71], a[208:223]
	s_add_u32 m0, s40, 114688
	s_add_u32 s22, s22, s24
	buffer_load_dwordx4 v2, s[12:15], s22 offen lds
	s_add_u32 m0, s40, 118784
	s_add_u32 s22, s22, s24
	buffer_load_dwordx4 v2, s[12:15], s22 offen lds
	v_mfma_f32_32x32x16_bf16 a[224:239], v[60:63], v[72:75], a[224:239]
	s_add_u32 m0, s40, 122880
	s_add_u32 s22, s22, s24
	buffer_load_dwordx4 v2, s[12:15], s22 offen lds
	s_add_u32 m0, s40, 126976
	s_add_u32 s22, s22, s24
	buffer_load_dwordx4 v2, s[12:15], s22 offen lds
	v_mfma_f32_32x32x16_bf16 a[240:255], v[60:63], v[76:79], a[240:255]
	s_add_u32 s19, s19, 128
	s_add_u32 s20, s20, s42
	s_waitcnt lgkmcnt(9)
	v_mfma_f32_32x32x16_bf16 a[0:15], v[16:19], v[32:35], a[0:15]
	ds_read_b64_tr_b16 v[48:49], v9 offset:8192
	s_waitcnt lgkmcnt(7)
	v_mfma_f32_32x32x16_bf16 a[16:31], v[16:19], v[36:39], a[16:31]
	ds_read_b64_tr_b16 v[50:51], v9 offset:10240
	s_waitcnt lgkmcnt(7)
	v_mfma_f32_32x32x16_bf16 a[32:47], v[16:19], v[40:43], a[32:47]
	ds_read_b128 v[64:67], v6 offset:0
	s_waitcnt lgkmcnt(7)
	v_mfma_f32_32x32x16_bf16 a[48:63], v[16:19], v[44:47], a[48:63]
	v_mfma_f32_32x32x16_bf16 a[64:79], v[20:23], v[32:35], a[64:79]
	ds_read_b64_tr_b16 v[52:53], v10 offset:8192
	v_mfma_f32_32x32x16_bf16 a[80:95], v[20:23], v[36:39], a[80:95]
	ds_read_b64_tr_b16 v[54:55], v10 offset:10240
	v_mfma_f32_32x32x16_bf16 a[96:111], v[20:23], v[40:43], a[96:111]
	ds_read_b128 v[68:71], v6 offset:4096
	v_mfma_f32_32x32x16_bf16 a[112:127], v[20:23], v[44:47], a[112:127]
	s_waitcnt lgkmcnt(8)
	v_mfma_f32_32x32x16_bf16 a[128:143], v[24:27], v[32:35], a[128:143]
	ds_read_b128 v[72:75], v6 offset:8192
	v_mfma_f32_32x32x16_bf16 a[144:159], v[24:27], v[36:39], a[144:159]
	ds_read_b128 v[76:79], v6 offset:12288
	v_mfma_f32_32x32x16_bf16 a[160:175], v[24:27], v[40:43], a[160:175]
	ds_read_b64_tr_b16 v[56:57], v11 offset:8192
	v_mfma_f32_32x32x16_bf16 a[176:191], v[24:27], v[44:47], a[176:191]
	s_waitcnt lgkmcnt(9)
	v_mfma_f32_32x32x16_bf16 a[192:207], v[28:31], v[32:35], a[192:207]
	ds_read_b64_tr_b16 v[58:59], v11 offset:10240
	v_mfma_f32_32x32x16_bf16 a[208:223], v[28:31], v[36:39], a[208:223]
	ds_read_b64_tr_b16 v[60:61], v12 offset:8192
	v_mfma_f32_32x32x16_bf16 a[224:239], v[28:31], v[40:43], a[224:239]
	ds_read_b64_tr_b16 v[62:63], v12 offset:10240
	v_mfma_f32_32x32x16_bf16 a[240:255], v[28:31], v[44:47], a[240:255]
	s_waitcnt lgkmcnt(9)
	v_mfma_f32_32x32x16_bf16 a[0:15], v[48:51], v[64:67], a[0:15]
	ds_read_b64_tr_b16 v[16:17], v9 offset:16384
	s_waitcnt lgkmcnt(7)
	v_mfma_f32_32x32x16_bf16 a[16:31], v[48:51], v[68:71], a[16:31]
	ds_read_b64_tr_b16 v[18:19], v9 offset:18432
	s_waitcnt lgkmcnt(7)
	v_mfma_f32_32x32x16_bf16 a[32:47], v[48:51], v[72:75], a[32:47]
	ds_read_b128 v[32:35], v7 offset:0
	s_waitcnt lgkmcnt(7)
	v_mfma_f32_32x32x16_bf16 a[48:63], v[48:51], v[76:79], a[48:63]
	v_mfma_f32_32x32x16_bf16 a[64:79], v[52:55], v[64:67], a[64:79]
	ds_read_b64_tr_b16 v[20:21], v10 offset:16384
	v_mfma_f32_32x32x16_bf16 a[80:95], v[52:55], v[68:71], a[80:95]
	ds_read_b64_tr_b16 v[22:23], v10 offset:18432
	v_mfma_f32_32x32x16_bf16 a[96:111], v[52:55], v[72:75], a[96:111]
	ds_read_b128 v[36:39], v7 offset:4096
	v_mfma_f32_32x32x16_bf16 a[112:127], v[52:55], v[76:79], a[112:127]
	s_waitcnt lgkmcnt(8)
	v_mfma_f32_32x32x16_bf16 a[128:143], v[56:59], v[64:67], a[128:143]
	ds_read_b128 v[40:43], v7 offset:8192
	v_mfma_f32_32x32x16_bf16 a[144:159], v[56:59], v[68:71], a[144:159]
	ds_read_b128 v[44:47], v7 offset:12288
	v_mfma_f32_32x32x16_bf16 a[160:175], v[56:59], v[72:75], a[160:175]
	ds_read_b64_tr_b16 v[24:25], v11 offset:16384
	v_mfma_f32_32x32x16_bf16 a[176:191], v[56:59], v[76:79], a[176:191]
	s_waitcnt lgkmcnt(9)
	v_mfma_f32_32x32x16_bf16 a[192:207], v[60:63], v[64:67], a[192:207]
	ds_read_b64_tr_b16 v[26:27], v11 offset:18432
	v_mfma_f32_32x32x16_bf16 a[208:223], v[60:63], v[68:71], a[208:223]
	ds_read_b64_tr_b16 v[28:29], v12 offset:16384
	v_mfma_f32_32x32x16_bf16 a[224:239], v[60:63], v[72:75], a[224:239]
	ds_read_b64_tr_b16 v[30:31], v12 offset:18432
	v_mfma_f32_32x32x16_bf16 a[240:255], v[60:63], v[76:79], a[240:255]
	s_waitcnt lgkmcnt(9)
	v_mfma_f32_32x32x16_bf16 a[0:15], v[16:19], v[32:35], a[0:15]
	ds_read_b64_tr_b16 v[48:49], v9 offset:24576
	s_waitcnt lgkmcnt(7)
	v_mfma_f32_32x32x16_bf16 a[16:31], v[16:19], v[36:39], a[16:31]
	ds_read_b64_tr_b16 v[50:51], v9 offset:26624
	s_waitcnt lgkmcnt(7)
	v_mfma_f32_32x32x16_bf16 a[32:47], v[16:19], v[40:43], a[32:47]
	ds_read_b128 v[64:67], v8 offset:0
	s_waitcnt lgkmcnt(7)
	v_mfma_f32_32x32x16_bf16 a[48:63], v[16:19], v[44:47], a[48:63]
	v_mfma_f32_32x32x16_bf16 a[64:79], v[20:23], v[32:35], a[64:79]
	ds_read_b64_tr_b16 v[52:53], v10 offset:24576
	v_mfma_f32_32x32x16_bf16 a[80:95], v[20:23], v[36:39], a[80:95]
	ds_read_b64_tr_b16 v[54:55], v10 offset:26624
	v_mfma_f32_32x32x16_bf16 a[96:111], v[20:23], v[40:43], a[96:111]
	ds_read_b128 v[68:71], v8 offset:4096
	v_mfma_f32_32x32x16_bf16 a[112:127], v[20:23], v[44:47], a[112:127]
	s_waitcnt lgkmcnt(8)
	v_mfma_f32_32x32x16_bf16 a[128:143], v[24:27], v[32:35], a[128:143]
	ds_read_b128 v[72:75], v8 offset:8192
	v_mfma_f32_32x32x16_bf16 a[144:159], v[24:27], v[36:39], a[144:159]
	ds_read_b128 v[76:79], v8 offset:12288
	v_mfma_f32_32x32x16_bf16 a[160:175], v[24:27], v[40:43], a[160:175]
	ds_read_b64_tr_b16 v[56:57], v11 offset:24576
	v_mfma_f32_32x32x16_bf16 a[176:191], v[24:27], v[44:47], a[176:191]
	s_waitcnt lgkmcnt(9)
	v_mfma_f32_32x32x16_bf16 a[192:207], v[28:31], v[32:35], a[192:207]
	ds_read_b64_tr_b16 v[58:59], v11 offset:26624
	v_mfma_f32_32x32x16_bf16 a[208:223], v[28:31], v[36:39], a[208:223]
	ds_read_b64_tr_b16 v[60:61], v12 offset:24576
	v_mfma_f32_32x32x16_bf16 a[224:239], v[28:31], v[40:43], a[224:239]
	ds_read_b64_tr_b16 v[62:63], v12 offset:26624
	v_mfma_f32_32x32x16_bf16 a[240:255], v[28:31], v[44:47], a[240:255]
	s_waitcnt vmcnt(0) lgkmcnt(0)
	s_barrier
	v_add_u32 v5, 0x10000, v5
	v_add_u32 v6, 0x10000, v6
	v_add_u32 v7, 0x10000, v7
	v_add_u32 v8, 0x10000, v8
	v_add_u32 v9, 0x10000, v9
	v_add_u32 v10, 0x10000, v10
	v_add_u32 v11, 0x10000, v11
	v_add_u32 v12, 0x10000, v12
	v_mfma_f32_32x32x16_bf16 a[0:15], v[48:51], v[64:67], a[0:15]
	ds_read_b64_tr_b16 v[16:17], v9 offset:0
	ds_read_b64_tr_b16 v[18:19], v9 offset:2048
	v_mfma_f32_32x32x16_bf16 a[16:31], v[48:51], v[68:71], a[16:31]
	ds_read_b128 v[32:35], v5 offset:0
	s_add_u32 m0, s40, 0
	s_add_u32 s21, s19, 0
	buffer_load_dwordx4 v1, s[8:11], s21 offen lds
	v_mfma_f32_32x32x16_bf16 a[32:47], v[48:51], v[72:75], a[32:47]
	s_add_u32 m0, s40, 4096
	s_add_u32 s21, s19, 36864
	buffer_load_dwordx4 v1, s[8:11], s21 offen lds
	s_add_u32 m0, s40, 8192
	s_add_u32 s21, s19, 73728
	buffer_load_dwordx4 v1, s[8:11], s21 offen lds
	v_mfma_f32_32x32x16_bf16 a[48:63], v[48:51], v[76:79], a[48:63]
	s_add_u32 m0, s40, 12288
	s_add_u32 s21, s19, 110592
	buffer_load_dwordx4 v1, s[8:11], s21 offen lds
	ds_read_b64_tr_b16 v[20:21], v10 offset:0
	v_mfma_f32_32x32x16_bf16 a[64:79], v[52:55], v[64:67], a[64:79]
	ds_read_b64_tr_b16 v[22:23], v10 offset:2048
	ds_read_b128 v[36:39], v5 offset:4096
	v_mfma_f32_32x32x16_bf16 a[80:95], v[52:55], v[68:71], a[80:95]
	ds_read_b128 v[40:43], v5 offset:8192
	v_mfma_f32_32x32x16_bf16 a[96:111], v[52:55], v[72:75], a[96:111]
	ds_read_b128 v[44:47], v5 offset:12288
	ds_read_b64_tr_b16 v[24:25], v11 offset:0
	v_mfma_f32_32x32x16_bf16 a[112:127], v[52:55], v[76:79], a[112:127]
	ds_read_b64_tr_b16 v[26:27], v11 offset:2048
	ds_read_b64_tr_b16 v[28:29], v12 offset:0
	v_mfma_f32_32x32x16_bf16 a[128:143], v[56:59], v[64:67], a[128:143]
	ds_read_b64_tr_b16 v[30:31], v12 offset:2048
	s_add_u32 m0, s40, 16384
	s_add_u32 s21, s19, 147456
	buffer_load_dwordx4 v1, s[8:11], s21 offen lds
	v_mfma_f32_32x32x16_bf16 a[144:159], v[56:59], v[68:71], a[144:159]
	s_add_u32 m0, s40, 20480
	s_add_u32 s21, s19, 184320
	buffer_load_dwordx4 v1, s[8:11], s21 offen lds
	s_add_u32 m0, s40, 24576
	s_add_u32 s21, s19, 221184
	buffer_load_dwordx4 v1, s[8:11], s21 offen lds
	v_mfma_f32_32x32x16_bf16 a[160:175], v[56:59], v[72:75], a[160:175]
	s_add_u32 m0, s40, 28672
	s_add_u32 s21, s19, 258048
	buffer_load_dwordx4 v1, s[8:11], s21 offen lds
	v_mfma_f32_32x32x16_bf16 a[176:191], v[56:59], v[76:79], a[176:191]
	s_add_u32 m0, s40, 32768
	s_mov_b32 s22, s20
	buffer_load_dwordx4 v2, s[12:15], s22 offen lds
	s_add_u32 m0, s40, 36864
	s_add_u32 s22, s22, s24
	buffer_load_dwordx4 v2, s[12:15], s22 offen lds
	v_mfma_f32_32x32x16_bf16 a[192:207], v[60:63], v[64:67], a[192:207]
	s_add_u32 m0, s40, 40960
	s_add_u32 s22, s22, s24
	buffer_load_dwordx4 v2, s[12:15], s22 offen lds
	s_add_u32 m0, s40, 45056
	s_add_u32 s22, s22, s24
	buffer_load_dwordx4 v2, s[12:15], s22 offen lds
	v_mfma_f32_32x32x16_bf16 a[208:223], v[60:63], v[68:71], a[208:223]
	s_add_u32 m0, s40, 49152
	s_add_u32 s22, s22, s24
	buffer_load_dwordx4 v2, s[12:15], s22 offen lds
	s_add_u32 m0, s40, 53248
	s_add_u32 s22, s22, s24
	buffer_load_dwordx4 v2, s[12:15], s22 offen lds
	v_mfma_f32_32x32x16_bf16 a[224:239], v[60:63], v[72:75], a[224:239]
	s_add_u32 m0, s40, 57344
	s_add_u32 s22, s22, s24
	buffer_load_dwordx4 v2, s[12:15], s22 offen lds
	s_add_u32 m0, s40, 61440
	s_add_u32 s22, s22, s24
	buffer_load_dwordx4 v2, s[12:15], s22 offen lds
	v_mfma_f32_32x32x16_bf16 a[240:255], v[60:63], v[76:79], a[240:255]
	s_add_u32 s19, s19, 128
	s_add_u32 s20, s20, s42
	s_waitcnt lgkmcnt(9)
	v_mfma_f32_32x32x16_bf16 a[0:15], v[16:19], v[32:35], a[0:15]
	ds_read_b64_tr_b16 v[48:49], v9 offset:8192
	s_waitcnt lgkmcnt(7)
	v_mfma_f32_32x32x16_bf16 a[16:31], v[16:19], v[36:39], a[16:31]
	ds_read_b64_tr_b16 v[50:51], v9 offset:10240
	s_waitcnt lgkmcnt(7)
	v_mfma_f32_32x32x16_bf16 a[32:47], v[16:19], v[40:43], a[32:47]
	ds_read_b128 v[64:67], v6 offset:0
	s_waitcnt lgkmcnt(7)
	v_mfma_f32_32x32x16_bf16 a[48:63], v[16:19], v[44:47], a[48:63]
	v_mfma_f32_32x32x16_bf16 a[64:79], v[20:23], v[32:35], a[64:79]
	ds_read_b64_tr_b16 v[52:53], v10 offset:8192
	v_mfma_f32_32x32x16_bf16 a[80:95], v[20:23], v[36:39], a[80:95]
	ds_read_b64_tr_b16 v[54:55], v10 offset:10240
	v_mfma_f32_32x32x16_bf16 a[96:111], v[20:23], v[40:43], a[96:111]
	ds_read_b128 v[68:71], v6 offset:4096
	v_mfma_f32_32x32x16_bf16 a[112:127], v[20:23], v[44:47], a[112:127]
	s_waitcnt lgkmcnt(8)
	v_mfma_f32_32x32x16_bf16 a[128:143], v[24:27], v[32:35], a[128:143]
	ds_read_b128 v[72:75], v6 offset:8192
	v_mfma_f32_32x32x16_bf16 a[144:159], v[24:27], v[36:39], a[144:159]
	ds_read_b128 v[76:79], v6 offset:12288
	v_mfma_f32_32x32x16_bf16 a[160:175], v[24:27], v[40:43], a[160:175]
	ds_read_b64_tr_b16 v[56:57], v11 offset:8192
	v_mfma_f32_32x32x16_bf16 a[176:191], v[24:27], v[44:47], a[176:191]
	s_waitcnt lgkmcnt(9)
	v_mfma_f32_32x32x16_bf16 a[192:207], v[28:31], v[32:35], a[192:207]
	ds_read_b64_tr_b16 v[58:59], v11 offset:10240
	v_mfma_f32_32x32x16_bf16 a[208:223], v[28:31], v[36:39], a[208:223]
	ds_read_b64_tr_b16 v[60:61], v12 offset:8192
	v_mfma_f32_32x32x16_bf16 a[224:239], v[28:31], v[40:43], a[224:239]
	ds_read_b64_tr_b16 v[62:63], v12 offset:10240
	v_mfma_f32_32x32x16_bf16 a[240:255], v[28:31], v[44:47], a[240:255]
	s_waitcnt lgkmcnt(9)
	v_mfma_f32_32x32x16_bf16 a[0:15], v[48:51], v[64:67], a[0:15]
	ds_read_b64_tr_b16 v[16:17], v9 offset:16384
	s_waitcnt lgkmcnt(7)
	v_mfma_f32_32x32x16_bf16 a[16:31], v[48:51], v[68:71], a[16:31]
	ds_read_b64_tr_b16 v[18:19], v9 offset:18432
	s_waitcnt lgkmcnt(7)
	v_mfma_f32_32x32x16_bf16 a[32:47], v[48:51], v[72:75], a[32:47]
	ds_read_b128 v[32:35], v7 offset:0
	s_waitcnt lgkmcnt(7)
	v_mfma_f32_32x32x16_bf16 a[48:63], v[48:51], v[76:79], a[48:63]
	v_mfma_f32_32x32x16_bf16 a[64:79], v[52:55], v[64:67], a[64:79]
	ds_read_b64_tr_b16 v[20:21], v10 offset:16384
	v_mfma_f32_32x32x16_bf16 a[80:95], v[52:55], v[68:71], a[80:95]
	ds_read_b64_tr_b16 v[22:23], v10 offset:18432
	v_mfma_f32_32x32x16_bf16 a[96:111], v[52:55], v[72:75], a[96:111]
	ds_read_b128 v[36:39], v7 offset:4096
	v_mfma_f32_32x32x16_bf16 a[112:127], v[52:55], v[76:79], a[112:127]
	s_waitcnt lgkmcnt(8)
	v_mfma_f32_32x32x16_bf16 a[128:143], v[56:59], v[64:67], a[128:143]
	ds_read_b128 v[40:43], v7 offset:8192
	v_mfma_f32_32x32x16_bf16 a[144:159], v[56:59], v[68:71], a[144:159]
	ds_read_b128 v[44:47], v7 offset:12288
	v_mfma_f32_32x32x16_bf16 a[160:175], v[56:59], v[72:75], a[160:175]
	ds_read_b64_tr_b16 v[24:25], v11 offset:16384
	v_mfma_f32_32x32x16_bf16 a[176:191], v[56:59], v[76:79], a[176:191]
	s_waitcnt lgkmcnt(9)
	v_mfma_f32_32x32x16_bf16 a[192:207], v[60:63], v[64:67], a[192:207]
	ds_read_b64_tr_b16 v[26:27], v11 offset:18432
	v_mfma_f32_32x32x16_bf16 a[208:223], v[60:63], v[68:71], a[208:223]
	ds_read_b64_tr_b16 v[28:29], v12 offset:16384
	v_mfma_f32_32x32x16_bf16 a[224:239], v[60:63], v[72:75], a[224:239]
	ds_read_b64_tr_b16 v[30:31], v12 offset:18432
	v_mfma_f32_32x32x16_bf16 a[240:255], v[60:63], v[76:79], a[240:255]
	s_waitcnt lgkmcnt(9)
	v_mfma_f32_32x32x16_bf16 a[0:15], v[16:19], v[32:35], a[0:15]
	ds_read_b64_tr_b16 v[48:49], v9 offset:24576
	s_waitcnt lgkmcnt(7)
	v_mfma_f32_32x32x16_bf16 a[16:31], v[16:19], v[36:39], a[16:31]
	ds_read_b64_tr_b16 v[50:51], v9 offset:26624
	s_waitcnt lgkmcnt(7)
	v_mfma_f32_32x32x16_bf16 a[32:47], v[16:19], v[40:43], a[32:47]
	ds_read_b128 v[64:67], v8 offset:0
	s_waitcnt lgkmcnt(7)
	v_mfma_f32_32x32x16_bf16 a[48:63], v[16:19], v[44:47], a[48:63]
	v_mfma_f32_32x32x16_bf16 a[64:79], v[20:23], v[32:35], a[64:79]
	ds_read_b64_tr_b16 v[52:53], v10 offset:24576
	v_mfma_f32_32x32x16_bf16 a[80:95], v[20:23], v[36:39], a[80:95]
	ds_read_b64_tr_b16 v[54:55], v10 offset:26624
	v_mfma_f32_32x32x16_bf16 a[96:111], v[20:23], v[40:43], a[96:111]
	ds_read_b128 v[68:71], v8 offset:4096
	v_mfma_f32_32x32x16_bf16 a[112:127], v[20:23], v[44:47], a[112:127]
	s_waitcnt lgkmcnt(8)
	v_mfma_f32_32x32x16_bf16 a[128:143], v[24:27], v[32:35], a[128:143]
	ds_read_b128 v[72:75], v8 offset:8192
	v_mfma_f32_32x32x16_bf16 a[144:159], v[24:27], v[36:39], a[144:159]
	ds_read_b128 v[76:79], v8 offset:12288
	v_mfma_f32_32x32x16_bf16 a[160:175], v[24:27], v[40:43], a[160:175]
	ds_read_b64_tr_b16 v[56:57], v11 offset:24576
	v_mfma_f32_32x32x16_bf16 a[176:191], v[24:27], v[44:47], a[176:191]
	s_waitcnt lgkmcnt(9)
	v_mfma_f32_32x32x16_bf16 a[192:207], v[28:31], v[32:35], a[192:207]
	ds_read_b64_tr_b16 v[58:59], v11 offset:26624
	v_mfma_f32_32x32x16_bf16 a[208:223], v[28:31], v[36:39], a[208:223]
	ds_read_b64_tr_b16 v[60:61], v12 offset:24576
	v_mfma_f32_32x32x16_bf16 a[224:239], v[28:31], v[40:43], a[224:239]
	ds_read_b64_tr_b16 v[62:63], v12 offset:26624
	v_mfma_f32_32x32x16_bf16 a[240:255], v[28:31], v[44:47], a[240:255]
	s_waitcnt vmcnt(0) lgkmcnt(0)
	s_barrier
	v_add_u32 v5, 0xffff0000, v5
	v_add_u32 v6, 0xffff0000, v6
	v_add_u32 v7, 0xffff0000, v7
	v_add_u32 v8, 0xffff0000, v8
	v_add_u32 v9, 0xffff0000, v9
	v_add_u32 v10, 0xffff0000, v10
	v_add_u32 v11, 0xffff0000, v11
	v_add_u32 v12, 0xffff0000, v12
	v_mfma_f32_32x32x16_bf16 a[0:15], v[48:51], v[64:67], a[0:15]
	ds_read_b64_tr_b16 v[16:17], v9 offset:0
	ds_read_b64_tr_b16 v[18:19], v9 offset:2048
	v_mfma_f32_32x32x16_bf16 a[16:31], v[48:51], v[68:71], a[16:31]
	ds_read_b128 v[32:35], v5 offset:0
	s_add_u32 m0, s40, 65536
	s_add_u32 s21, s19, 0
	buffer_load_dwordx4 v1, s[8:11], s21 offen lds
	v_mfma_f32_32x32x16_bf16 a[32:47], v[48:51], v[72:75], a[32:47]
	s_add_u32 m0, s40, 69632
	s_add_u32 s21, s19, 36864
	buffer_load_dwordx4 v1, s[8:11], s21 offen lds
	s_add_u32 m0, s40, 73728
	s_add_u32 s21, s19, 73728
	buffer_load_dwordx4 v1, s[8:11], s21 offen lds
	v_mfma_f32_32x32x16_bf16 a[48:63], v[48:51], v[76:79], a[48:63]
	s_add_u32 m0, s40, 77824
	s_add_u32 s21, s19, 110592
	buffer_load_dwordx4 v1, s[8:11], s21 offen lds
	ds_read_b64_tr_b16 v[20:21], v10 offset:0
	v_mfma_f32_32x32x16_bf16 a[64:79], v[52:55], v[64:67], a[64:79]
	ds_read_b64_tr_b16 v[22:23], v10 offset:2048
	ds_read_b128 v[36:39], v5 offset:4096
	v_mfma_f32_32x32x16_bf16 a[80:95], v[52:55], v[68:71], a[80:95]
	ds_read_b128 v[40:43], v5 offset:8192
	v_mfma_f32_32x32x16_bf16 a[96:111], v[52:55], v[72:75], a[96:111]
	ds_read_b128 v[44:47], v5 offset:12288
	ds_read_b64_tr_b16 v[24:25], v11 offset:0
	v_mfma_f32_32x32x16_bf16 a[112:127], v[52:55], v[76:79], a[112:127]
	ds_read_b64_tr_b16 v[26:27], v11 offset:2048
	ds_read_b64_tr_b16 v[28:29], v12 offset:0
	v_mfma_f32_32x32x16_bf16 a[128:143], v[56:59], v[64:67], a[128:143]
	ds_read_b64_tr_b16 v[30:31], v12 offset:2048
	s_add_u32 m0, s40, 81920
	s_add_u32 s21, s19, 147456
	buffer_load_dwordx4 v1, s[8:11], s21 offen lds
	v_mfma_f32_32x32x16_bf16 a[144:159], v[56:59], v[68:71], a[144:159]
	s_add_u32 m0, s40, 86016
	s_add_u32 s21, s19, 184320
	buffer_load_dwordx4 v1, s[8:11], s21 offen lds
	s_add_u32 m0, s40, 90112
	s_add_u32 s21, s19, 221184
	buffer_load_dwordx4 v1, s[8:11], s21 offen lds
	v_mfma_f32_32x32x16_bf16 a[160:175], v[56:59], v[72:75], a[160:175]
	s_add_u32 m0, s40, 94208
	s_add_u32 s21, s19, 258048
	buffer_load_dwordx4 v1, s[8:11], s21 offen lds
	v_mfma_f32_32x32x16_bf16 a[176:191], v[56:59], v[76:79], a[176:191]
	s_add_u32 m0, s40, 98304
	s_mov_b32 s22, s20
	buffer_load_dwordx4 v2, s[12:15], s22 offen lds
	s_add_u32 m0, s40, 102400
	s_add_u32 s22, s22, s24
	buffer_load_dwordx4 v2, s[12:15], s22 offen lds
	v_mfma_f32_32x32x16_bf16 a[192:207], v[60:63], v[64:67], a[192:207]
	s_add_u32 m0, s40, 106496
	s_add_u32 s22, s22, s24
	buffer_load_dwordx4 v2, s[12:15], s22 offen lds
	s_add_u32 m0, s40, 110592
	s_add_u32 s22, s22, s24
	buffer_load_dwordx4 v2, s[12:15], s22 offen lds
	v_mfma_f32_32x32x16_bf16 a[208:223], v[60:63], v[68:71], a[208:223]
	s_add_u32 m0, s40, 114688
	s_add_u32 s22, s22, s24
	buffer_load_dwordx4 v2, s[12:15], s22 offen lds
	s_add_u32 m0, s40, 118784
	s_add_u32 s22, s22, s24
	buffer_load_dwordx4 v2, s[12:15], s22 offen lds
	v_mfma_f32_32x32x16_bf16 a[224:239], v[60:63], v[72:75], a[224:239]
	s_add_u32 m0, s40, 122880
	s_add_u32 s22, s22, s24
	buffer_load_dwordx4 v2, s[12:15], s22 offen lds
	s_add_u32 m0, s40, 126976
	s_add_u32 s22, s22, s24
	buffer_load_dwordx4 v2, s[12:15], s22 offen lds
	v_mfma_f32_32x32x16_bf16 a[240:255], v[60:63], v[76:79], a[240:255]
	s_add_u32 s19, s19, 128
	s_add_u32 s20, s20, s42
	s_waitcnt lgkmcnt(9)
	v_mfma_f32_32x32x16_bf16 a[0:15], v[16:19], v[32:35], a[0:15]
	ds_read_b64_tr_b16 v[48:49], v9 offset:8192
	s_waitcnt lgkmcnt(7)
	v_mfma_f32_32x32x16_bf16 a[16:31], v[16:19], v[36:39], a[16:31]
	ds_read_b64_tr_b16 v[50:51], v9 offset:10240
	s_waitcnt lgkmcnt(7)
	v_mfma_f32_32x32x16_bf16 a[32:47], v[16:19], v[40:43], a[32:47]
	ds_read_b128 v[64:67], v6 offset:0
	s_waitcnt lgkmcnt(7)
	v_mfma_f32_32x32x16_bf16 a[48:63], v[16:19], v[44:47], a[48:63]
	v_mfma_f32_32x32x16_bf16 a[64:79], v[20:23], v[32:35], a[64:79]
	ds_read_b64_tr_b16 v[52:53], v10 offset:8192
	v_mfma_f32_32x32x16_bf16 a[80:95], v[20:23], v[36:39], a[80:95]
	ds_read_b64_tr_b16 v[54:55], v10 offset:10240
	v_mfma_f32_32x32x16_bf16 a[96:111], v[20:23], v[40:43], a[96:111]
	ds_read_b128 v[68:71], v6 offset:4096
	v_mfma_f32_32x32x16_bf16 a[112:127], v[20:23], v[44:47], a[112:127]
	s_waitcnt lgkmcnt(8)
	v_mfma_f32_32x32x16_bf16 a[128:143], v[24:27], v[32:35], a[128:143]
	ds_read_b128 v[72:75], v6 offset:8192
	v_mfma_f32_32x32x16_bf16 a[144:159], v[24:27], v[36:39], a[144:159]
	ds_read_b128 v[76:79], v6 offset:12288
	v_mfma_f32_32x32x16_bf16 a[160:175], v[24:27], v[40:43], a[160:175]
	ds_read_b64_tr_b16 v[56:57], v11 offset:8192
	v_mfma_f32_32x32x16_bf16 a[176:191], v[24:27], v[44:47], a[176:191]
	s_waitcnt lgkmcnt(9)
	v_mfma_f32_32x32x16_bf16 a[192:207], v[28:31], v[32:35], a[192:207]
	ds_read_b64_tr_b16 v[58:59], v11 offset:10240
	v_mfma_f32_32x32x16_bf16 a[208:223], v[28:31], v[36:39], a[208:223]
	ds_read_b64_tr_b16 v[60:61], v12 offset:8192
	v_mfma_f32_32x32x16_bf16 a[224:239], v[28:31], v[40:43], a[224:239]
	ds_read_b64_tr_b16 v[62:63], v12 offset:10240
	v_mfma_f32_32x32x16_bf16 a[240:255], v[28:31], v[44:47], a[240:255]
	s_waitcnt lgkmcnt(9)
	v_mfma_f32_32x32x16_bf16 a[0:15], v[48:51], v[64:67], a[0:15]
	ds_read_b64_tr_b16 v[16:17], v9 offset:16384
	s_waitcnt lgkmcnt(7)
	v_mfma_f32_32x32x16_bf16 a[16:31], v[48:51], v[68:71], a[16:31]
	ds_read_b64_tr_b16 v[18:19], v9 offset:18432
	s_waitcnt lgkmcnt(7)
	v_mfma_f32_32x32x16_bf16 a[32:47], v[48:51], v[72:75], a[32:47]
	ds_read_b128 v[32:35], v7 offset:0
	s_waitcnt lgkmcnt(7)
	v_mfma_f32_32x32x16_bf16 a[48:63], v[48:51], v[76:79], a[48:63]
	v_mfma_f32_32x32x16_bf16 a[64:79], v[52:55], v[64:67], a[64:79]
	ds_read_b64_tr_b16 v[20:21], v10 offset:16384
	v_mfma_f32_32x32x16_bf16 a[80:95], v[52:55], v[68:71], a[80:95]
	ds_read_b64_tr_b16 v[22:23], v10 offset:18432
	v_mfma_f32_32x32x16_bf16 a[96:111], v[52:55], v[72:75], a[96:111]
	ds_read_b128 v[36:39], v7 offset:4096
	v_mfma_f32_32x32x16_bf16 a[112:127], v[52:55], v[76:79], a[112:127]
	s_waitcnt lgkmcnt(8)
	v_mfma_f32_32x32x16_bf16 a[128:143], v[56:59], v[64:67], a[128:143]
	ds_read_b128 v[40:43], v7 offset:8192
	v_mfma_f32_32x32x16_bf16 a[144:159], v[56:59], v[68:71], a[144:159]
	ds_read_b128 v[44:47], v7 offset:12288
	v_mfma_f32_32x32x16_bf16 a[160:175], v[56:59], v[72:75], a[160:175]
	ds_read_b64_tr_b16 v[24:25], v11 offset:16384
	v_mfma_f32_32x32x16_bf16 a[176:191], v[56:59], v[76:79], a[176:191]
	s_waitcnt lgkmcnt(9)
	v_mfma_f32_32x32x16_bf16 a[192:207], v[60:63], v[64:67], a[192:207]
	ds_read_b64_tr_b16 v[26:27], v11 offset:18432
	v_mfma_f32_32x32x16_bf16 a[208:223], v[60:63], v[68:71], a[208:223]
	ds_read_b64_tr_b16 v[28:29], v12 offset:16384
	v_mfma_f32_32x32x16_bf16 a[224:239], v[60:63], v[72:75], a[224:239]
	ds_read_b64_tr_b16 v[30:31], v12 offset:18432
	v_mfma_f32_32x32x16_bf16 a[240:255], v[60:63], v[76:79], a[240:255]
	s_waitcnt lgkmcnt(9)
	v_mfma_f32_32x32x16_bf16 a[0:15], v[16:19], v[32:35], a[0:15]
	ds_read_b64_tr_b16 v[48:49], v9 offset:24576
	s_waitcnt lgkmcnt(7)
	v_mfma_f32_32x32x16_bf16 a[16:31], v[16:19], v[36:39], a[16:31]
	ds_read_b64_tr_b16 v[50:51], v9 offset:26624
	s_waitcnt lgkmcnt(7)
	v_mfma_f32_32x32x16_bf16 a[32:47], v[16:19], v[40:43], a[32:47]
	ds_read_b128 v[64:67], v8 offset:0
	s_waitcnt lgkmcnt(7)
	v_mfma_f32_32x32x16_bf16 a[48:63], v[16:19], v[44:47], a[48:63]
	v_mfma_f32_32x32x16_bf16 a[64:79], v[20:23], v[32:35], a[64:79]
	ds_read_b64_tr_b16 v[52:53], v10 offset:24576
	v_mfma_f32_32x32x16_bf16 a[80:95], v[20:23], v[36:39], a[80:95]
	ds_read_b64_tr_b16 v[54:55], v10 offset:26624
	v_mfma_f32_32x32x16_bf16 a[96:111], v[20:23], v[40:43], a[96:111]
	ds_read_b128 v[68:71], v8 offset:4096
	v_mfma_f32_32x32x16_bf16 a[112:127], v[20:23], v[44:47], a[112:127]
	s_waitcnt lgkmcnt(8)
	v_mfma_f32_32x32x16_bf16 a[128:143], v[24:27], v[32:35], a[128:143]
	ds_read_b128 v[72:75], v8 offset:8192
	v_mfma_f32_32x32x16_bf16 a[144:159], v[24:27], v[36:39], a[144:159]
	ds_read_b128 v[76:79], v8 offset:12288
	v_mfma_f32_32x32x16_bf16 a[160:175], v[24:27], v[40:43], a[160:175]
	ds_read_b64_tr_b16 v[56:57], v11 offset:24576
	v_mfma_f32_32x32x16_bf16 a[176:191], v[24:27], v[44:47], a[176:191]
	s_waitcnt lgkmcnt(9)
	v_mfma_f32_32x32x16_bf16 a[192:207], v[28:31], v[32:35], a[192:207]
	ds_read_b64_tr_b16 v[58:59], v11 offset:26624
	v_mfma_f32_32x32x16_bf16 a[208:223], v[28:31], v[36:39], a[208:223]
	ds_read_b64_tr_b16 v[60:61], v12 offset:24576
	v_mfma_f32_32x32x16_bf16 a[224:239], v[28:31], v[40:43], a[224:239]
	ds_read_b64_tr_b16 v[62:63], v12 offset:26624
	v_mfma_f32_32x32x16_bf16 a[240:255], v[28:31], v[44:47], a[240:255]
	s_waitcnt vmcnt(0) lgkmcnt(0)
	s_barrier
	v_add_u32 v5, 0x10000, v5
	v_add_u32 v6, 0x10000, v6
	v_add_u32 v7, 0x10000, v7
	v_add_u32 v8, 0x10000, v8
	v_add_u32 v9, 0x10000, v9
	v_add_u32 v10, 0x10000, v10
	v_add_u32 v11, 0x10000, v11
	v_add_u32 v12, 0x10000, v12
	v_mfma_f32_32x32x16_bf16 a[0:15], v[48:51], v[64:67], a[0:15]
	ds_read_b64_tr_b16 v[16:17], v9 offset:0
	ds_read_b64_tr_b16 v[18:19], v9 offset:2048
	v_mfma_f32_32x32x16_bf16 a[16:31], v[48:51], v[68:71], a[16:31]
	ds_read_b128 v[32:35], v5 offset:0
	s_add_u32 m0, s40, 0
	s_add_u32 s21, s19, 0
	buffer_load_dwordx4 v1, s[8:11], s21 offen lds
	v_mfma_f32_32x32x16_bf16 a[32:47], v[48:51], v[72:75], a[32:47]
	s_add_u32 m0, s40, 4096
	s_add_u32 s21, s19, 36864
	buffer_load_dwordx4 v1, s[8:11], s21 offen lds
	s_add_u32 m0, s40, 8192
	s_add_u32 s21, s19, 73728
	buffer_load_dwordx4 v1, s[8:11], s21 offen lds
	v_mfma_f32_32x32x16_bf16 a[48:63], v[48:51], v[76:79], a[48:63]
	s_add_u32 m0, s40, 12288
	s_add_u32 s21, s19, 110592
	buffer_load_dwordx4 v1, s[8:11], s21 offen lds
	ds_read_b64_tr_b16 v[20:21], v10 offset:0
	v_mfma_f32_32x32x16_bf16 a[64:79], v[52:55], v[64:67], a[64:79]
	ds_read_b64_tr_b16 v[22:23], v10 offset:2048
	ds_read_b128 v[36:39], v5 offset:4096
	v_mfma_f32_32x32x16_bf16 a[80:95], v[52:55], v[68:71], a[80:95]
	ds_read_b128 v[40:43], v5 offset:8192
	v_mfma_f32_32x32x16_bf16 a[96:111], v[52:55], v[72:75], a[96:111]
	ds_read_b128 v[44:47], v5 offset:12288
	ds_read_b64_tr_b16 v[24:25], v11 offset:0
	v_mfma_f32_32x32x16_bf16 a[112:127], v[52:55], v[76:79], a[112:127]
	ds_read_b64_tr_b16 v[26:27], v11 offset:2048
	ds_read_b64_tr_b16 v[28:29], v12 offset:0
	v_mfma_f32_32x32x16_bf16 a[128:143], v[56:59], v[64:67], a[128:143]
	ds_read_b64_tr_b16 v[30:31], v12 offset:2048
	s_add_u32 m0, s40, 16384
	s_add_u32 s21, s19, 147456
	buffer_load_dwordx4 v1, s[8:11], s21 offen lds
	v_mfma_f32_32x32x16_bf16 a[144:159], v[56:59], v[68:71], a[144:159]
	s_add_u32 m0, s40, 20480
	s_add_u32 s21, s19, 184320
	buffer_load_dwordx4 v1, s[8:11], s21 offen lds
	s_add_u32 m0, s40, 24576
	s_add_u32 s21, s19, 221184
	buffer_load_dwordx4 v1, s[8:11], s21 offen lds
	v_mfma_f32_32x32x16_bf16 a[160:175], v[56:59], v[72:75], a[160:175]
	s_add_u32 m0, s40, 28672
	s_add_u32 s21, s19, 258048
	buffer_load_dwordx4 v1, s[8:11], s21 offen lds
	v_mfma_f32_32x32x16_bf16 a[176:191], v[56:59], v[76:79], a[176:191]
	s_add_u32 m0, s40, 32768
	s_mov_b32 s22, s20
	buffer_load_dwordx4 v2, s[12:15], s22 offen lds
	s_add_u32 m0, s40, 36864
	s_add_u32 s22, s22, s24
	buffer_load_dwordx4 v2, s[12:15], s22 offen lds
	v_mfma_f32_32x32x16_bf16 a[192:207], v[60:63], v[64:67], a[192:207]
	s_add_u32 m0, s40, 40960
	s_add_u32 s22, s22, s24
	buffer_load_dwordx4 v2, s[12:15], s22 offen lds
	s_add_u32 m0, s40, 45056
	s_add_u32 s22, s22, s24
	buffer_load_dwordx4 v2, s[12:15], s22 offen lds
	v_mfma_f32_32x32x16_bf16 a[208:223], v[60:63], v[68:71], a[208:223]
	s_add_u32 m0, s40, 49152
	s_add_u32 s22, s22, s24
	buffer_load_dwordx4 v2, s[12:15], s22 offen lds
	s_add_u32 m0, s40, 53248
	s_add_u32 s22, s22, s24
	buffer_load_dwordx4 v2, s[12:15], s22 offen lds
	v_mfma_f32_32x32x16_bf16 a[224:239], v[60:63], v[72:75], a[224:239]
	s_add_u32 m0, s40, 57344
	s_add_u32 s22, s22, s24
	buffer_load_dwordx4 v2, s[12:15], s22 offen lds
	s_add_u32 m0, s40, 61440
	s_add_u32 s22, s22, s24
	buffer_load_dwordx4 v2, s[12:15], s22 offen lds
	v_mfma_f32_32x32x16_bf16 a[240:255], v[60:63], v[76:79], a[240:255]
	s_add_u32 s19, s19, 128
	s_add_u32 s20, s20, s42
	s_waitcnt lgkmcnt(9)
	v_mfma_f32_32x32x16_bf16 a[0:15], v[16:19], v[32:35], a[0:15]
	ds_read_b64_tr_b16 v[48:49], v9 offset:8192
	s_waitcnt lgkmcnt(7)
	v_mfma_f32_32x32x16_bf16 a[16:31], v[16:19], v[36:39], a[16:31]
	ds_read_b64_tr_b16 v[50:51], v9 offset:10240
	s_waitcnt lgkmcnt(7)
	v_mfma_f32_32x32x16_bf16 a[32:47], v[16:19], v[40:43], a[32:47]
	ds_read_b128 v[64:67], v6 offset:0
	s_waitcnt lgkmcnt(7)
	v_mfma_f32_32x32x16_bf16 a[48:63], v[16:19], v[44:47], a[48:63]
	v_mfma_f32_32x32x16_bf16 a[64:79], v[20:23], v[32:35], a[64:79]
	ds_read_b64_tr_b16 v[52:53], v10 offset:8192
	v_mfma_f32_32x32x16_bf16 a[80:95], v[20:23], v[36:39], a[80:95]
	ds_read_b64_tr_b16 v[54:55], v10 offset:10240
	v_mfma_f32_32x32x16_bf16 a[96:111], v[20:23], v[40:43], a[96:111]
	ds_read_b128 v[68:71], v6 offset:4096
	v_mfma_f32_32x32x16_bf16 a[112:127], v[20:23], v[44:47], a[112:127]
	s_waitcnt lgkmcnt(8)
	v_mfma_f32_32x32x16_bf16 a[128:143], v[24:27], v[32:35], a[128:143]
	ds_read_b128 v[72:75], v6 offset:8192
	v_mfma_f32_32x32x16_bf16 a[144:159], v[24:27], v[36:39], a[144:159]
	ds_read_b128 v[76:79], v6 offset:12288
	v_mfma_f32_32x32x16_bf16 a[160:175], v[24:27], v[40:43], a[160:175]
	ds_read_b64_tr_b16 v[56:57], v11 offset:8192
	v_mfma_f32_32x32x16_bf16 a[176:191], v[24:27], v[44:47], a[176:191]
	s_waitcnt lgkmcnt(9)
	v_mfma_f32_32x32x16_bf16 a[192:207], v[28:31], v[32:35], a[192:207]
	ds_read_b64_tr_b16 v[58:59], v11 offset:10240
	v_mfma_f32_32x32x16_bf16 a[208:223], v[28:31], v[36:39], a[208:223]
	ds_read_b64_tr_b16 v[60:61], v12 offset:8192
	v_mfma_f32_32x32x16_bf16 a[224:239], v[28:31], v[40:43], a[224:239]
	ds_read_b64_tr_b16 v[62:63], v12 offset:10240
	v_mfma_f32_32x32x16_bf16 a[240:255], v[28:31], v[44:47], a[240:255]
	s_waitcnt lgkmcnt(9)
	v_mfma_f32_32x32x16_bf16 a[0:15], v[48:51], v[64:67], a[0:15]
	ds_read_b64_tr_b16 v[16:17], v9 offset:16384
	s_waitcnt lgkmcnt(7)
	v_mfma_f32_32x32x16_bf16 a[16:31], v[48:51], v[68:71], a[16:31]
	ds_read_b64_tr_b16 v[18:19], v9 offset:18432
	s_waitcnt lgkmcnt(7)
	v_mfma_f32_32x32x16_bf16 a[32:47], v[48:51], v[72:75], a[32:47]
	ds_read_b128 v[32:35], v7 offset:0
	s_waitcnt lgkmcnt(7)
	v_mfma_f32_32x32x16_bf16 a[48:63], v[48:51], v[76:79], a[48:63]
	v_mfma_f32_32x32x16_bf16 a[64:79], v[52:55], v[64:67], a[64:79]
	ds_read_b64_tr_b16 v[20:21], v10 offset:16384
	v_mfma_f32_32x32x16_bf16 a[80:95], v[52:55], v[68:71], a[80:95]
	ds_read_b64_tr_b16 v[22:23], v10 offset:18432
	v_mfma_f32_32x32x16_bf16 a[96:111], v[52:55], v[72:75], a[96:111]
	ds_read_b128 v[36:39], v7 offset:4096
	v_mfma_f32_32x32x16_bf16 a[112:127], v[52:55], v[76:79], a[112:127]
	s_waitcnt lgkmcnt(8)
	v_mfma_f32_32x32x16_bf16 a[128:143], v[56:59], v[64:67], a[128:143]
	ds_read_b128 v[40:43], v7 offset:8192
	v_mfma_f32_32x32x16_bf16 a[144:159], v[56:59], v[68:71], a[144:159]
	ds_read_b128 v[44:47], v7 offset:12288
	v_mfma_f32_32x32x16_bf16 a[160:175], v[56:59], v[72:75], a[160:175]
	ds_read_b64_tr_b16 v[24:25], v11 offset:16384
	v_mfma_f32_32x32x16_bf16 a[176:191], v[56:59], v[76:79], a[176:191]
	s_waitcnt lgkmcnt(9)
	v_mfma_f32_32x32x16_bf16 a[192:207], v[60:63], v[64:67], a[192:207]
	ds_read_b64_tr_b16 v[26:27], v11 offset:18432
	v_mfma_f32_32x32x16_bf16 a[208:223], v[60:63], v[68:71], a[208:223]
	ds_read_b64_tr_b16 v[28:29], v12 offset:16384
	v_mfma_f32_32x32x16_bf16 a[224:239], v[60:63], v[72:75], a[224:239]
	ds_read_b64_tr_b16 v[30:31], v12 offset:18432
	v_mfma_f32_32x32x16_bf16 a[240:255], v[60:63], v[76:79], a[240:255]
	s_waitcnt lgkmcnt(9)
	v_mfma_f32_32x32x16_bf16 a[0:15], v[16:19], v[32:35], a[0:15]
	ds_read_b64_tr_b16 v[48:49], v9 offset:24576
	s_waitcnt lgkmcnt(7)
	v_mfma_f32_32x32x16_bf16 a[16:31], v[16:19], v[36:39], a[16:31]
	ds_read_b64_tr_b16 v[50:51], v9 offset:26624
	s_waitcnt lgkmcnt(7)
	v_mfma_f32_32x32x16_bf16 a[32:47], v[16:19], v[40:43], a[32:47]
	ds_read_b128 v[64:67], v8 offset:0
	s_waitcnt lgkmcnt(7)
	v_mfma_f32_32x32x16_bf16 a[48:63], v[16:19], v[44:47], a[48:63]
	v_mfma_f32_32x32x16_bf16 a[64:79], v[20:23], v[32:35], a[64:79]
	ds_read_b64_tr_b16 v[52:53], v10 offset:24576
	v_mfma_f32_32x32x16_bf16 a[80:95], v[20:23], v[36:39], a[80:95]
	ds_read_b64_tr_b16 v[54:55], v10 offset:26624
	v_mfma_f32_32x32x16_bf16 a[96:111], v[20:23], v[40:43], a[96:111]
	ds_read_b128 v[68:71], v8 offset:4096
	v_mfma_f32_32x32x16_bf16 a[112:127], v[20:23], v[44:47], a[112:127]
	s_waitcnt lgkmcnt(8)
	v_mfma_f32_32x32x16_bf16 a[128:143], v[24:27], v[32:35], a[128:143]
	ds_read_b128 v[72:75], v8 offset:8192
	v_mfma_f32_32x32x16_bf16 a[144:159], v[24:27], v[36:39], a[144:159]
	ds_read_b128 v[76:79], v8 offset:12288
	v_mfma_f32_32x32x16_bf16 a[160:175], v[24:27], v[40:43], a[160:175]
	ds_read_b64_tr_b16 v[56:57], v11 offset:24576
	v_mfma_f32_32x32x16_bf16 a[176:191], v[24:27], v[44:47], a[176:191]
	s_waitcnt lgkmcnt(9)
	v_mfma_f32_32x32x16_bf16 a[192:207], v[28:31], v[32:35], a[192:207]
	ds_read_b64_tr_b16 v[58:59], v11 offset:26624
	v_mfma_f32_32x32x16_bf16 a[208:223], v[28:31], v[36:39], a[208:223]
	ds_read_b64_tr_b16 v[60:61], v12 offset:24576
	v_mfma_f32_32x32x16_bf16 a[224:239], v[28:31], v[40:43], a[224:239]
	ds_read_b64_tr_b16 v[62:63], v12 offset:26624
	v_mfma_f32_32x32x16_bf16 a[240:255], v[28:31], v[44:47], a[240:255]
	s_waitcnt vmcnt(0) lgkmcnt(0)
	s_barrier
	v_add_u32 v5, 0xffff0000, v5
	v_add_u32 v6, 0xffff0000, v6
	v_add_u32 v7, 0xffff0000, v7
	v_add_u32 v8, 0xffff0000, v8
	v_add_u32 v9, 0xffff0000, v9
	v_add_u32 v10, 0xffff0000, v10
	v_add_u32 v11, 0xffff0000, v11
	v_add_u32 v12, 0xffff0000, v12
	v_mfma_f32_32x32x16_bf16 a[0:15], v[48:51], v[64:67], a[0:15]
	ds_read_b64_tr_b16 v[16:17], v9 offset:0
	ds_read_b64_tr_b16 v[18:19], v9 offset:2048
	v_mfma_f32_32x32x16_bf16 a[16:31], v[48:51], v[68:71], a[16:31]
	ds_read_b128 v[32:35], v5 offset:0
	s_add_u32 m0, s40, 65536
	s_add_u32 s21, s19, 0
	buffer_load_dwordx4 v1, s[8:11], s21 offen lds
	v_mfma_f32_32x32x16_bf16 a[32:47], v[48:51], v[72:75], a[32:47]
	s_add_u32 m0, s40, 69632
	s_add_u32 s21, s19, 36864
	buffer_load_dwordx4 v1, s[8:11], s21 offen lds
	s_add_u32 m0, s40, 73728
	s_add_u32 s21, s19, 73728
	buffer_load_dwordx4 v1, s[8:11], s21 offen lds
	v_mfma_f32_32x32x16_bf16 a[48:63], v[48:51], v[76:79], a[48:63]
	s_add_u32 m0, s40, 77824
	s_add_u32 s21, s19, 110592
	buffer_load_dwordx4 v1, s[8:11], s21 offen lds
	ds_read_b64_tr_b16 v[20:21], v10 offset:0
	v_mfma_f32_32x32x16_bf16 a[64:79], v[52:55], v[64:67], a[64:79]
	ds_read_b64_tr_b16 v[22:23], v10 offset:2048
	ds_read_b128 v[36:39], v5 offset:4096
	v_mfma_f32_32x32x16_bf16 a[80:95], v[52:55], v[68:71], a[80:95]
	ds_read_b128 v[40:43], v5 offset:8192
	v_mfma_f32_32x32x16_bf16 a[96:111], v[52:55], v[72:75], a[96:111]
	ds_read_b128 v[44:47], v5 offset:12288
	ds_read_b64_tr_b16 v[24:25], v11 offset:0
	v_mfma_f32_32x32x16_bf16 a[112:127], v[52:55], v[76:79], a[112:127]
	ds_read_b64_tr_b16 v[26:27], v11 offset:2048
	ds_read_b64_tr_b16 v[28:29], v12 offset:0
	v_mfma_f32_32x32x16_bf16 a[128:143], v[56:59], v[64:67], a[128:143]
	ds_read_b64_tr_b16 v[30:31], v12 offset:2048
	s_add_u32 m0, s40, 81920
	s_add_u32 s21, s19, 147456
	buffer_load_dwordx4 v1, s[8:11], s21 offen lds
	v_mfma_f32_32x32x16_bf16 a[144:159], v[56:59], v[68:71], a[144:159]
	s_add_u32 m0, s40, 86016
	s_add_u32 s21, s19, 184320
	buffer_load_dwordx4 v1, s[8:11], s21 offen lds
	s_add_u32 m0, s40, 90112
	s_add_u32 s21, s19, 221184
	buffer_load_dwordx4 v1, s[8:11], s21 offen lds
	v_mfma_f32_32x32x16_bf16 a[160:175], v[56:59], v[72:75], a[160:175]
	s_add_u32 m0, s40, 94208
	s_add_u32 s21, s19, 258048
	buffer_load_dwordx4 v1, s[8:11], s21 offen lds
	v_mfma_f32_32x32x16_bf16 a[176:191], v[56:59], v[76:79], a[176:191]
	s_add_u32 m0, s40, 98304
	s_mov_b32 s22, s20
	buffer_load_dwordx4 v2, s[12:15], s22 offen lds
	s_add_u32 m0, s40, 102400
	s_add_u32 s22, s22, s24
	buffer_load_dwordx4 v2, s[12:15], s22 offen lds
	v_mfma_f32_32x32x16_bf16 a[192:207], v[60:63], v[64:67], a[192:207]
	s_add_u32 m0, s40, 106496
	s_add_u32 s22, s22, s24
	buffer_load_dwordx4 v2, s[12:15], s22 offen lds
	s_add_u32 m0, s40, 110592
	s_add_u32 s22, s22, s24
	buffer_load_dwordx4 v2, s[12:15], s22 offen lds
	v_mfma_f32_32x32x16_bf16 a[208:223], v[60:63], v[68:71], a[208:223]
	s_add_u32 m0, s40, 114688
	s_add_u32 s22, s22, s24
	buffer_load_dwordx4 v2, s[12:15], s22 offen lds
	s_add_u32 m0, s40, 118784
	s_add_u32 s22, s22, s24
	buffer_load_dwordx4 v2, s[12:15], s22 offen lds
	v_mfma_f32_32x32x16_bf16 a[224:239], v[60:63], v[72:75], a[224:239]
	s_add_u32 m0, s40, 122880
	s_add_u32 s22, s22, s24
	buffer_load_dwordx4 v2, s[12:15], s22 offen lds
	s_add_u32 m0, s40, 126976
	s_add_u32 s22, s22, s24
	buffer_load_dwordx4 v2, s[12:15], s22 offen lds
	v_mfma_f32_32x32x16_bf16 a[240:255], v[60:63], v[76:79], a[240:255]
	s_add_u32 s19, s19, 128
	s_add_u32 s20, s20, s42
	s_waitcnt lgkmcnt(9)
	v_mfma_f32_32x32x16_bf16 a[0:15], v[16:19], v[32:35], a[0:15]
	ds_read_b64_tr_b16 v[48:49], v9 offset:8192
	s_waitcnt lgkmcnt(7)
	v_mfma_f32_32x32x16_bf16 a[16:31], v[16:19], v[36:39], a[16:31]
	ds_read_b64_tr_b16 v[50:51], v9 offset:10240
	s_waitcnt lgkmcnt(7)
	v_mfma_f32_32x32x16_bf16 a[32:47], v[16:19], v[40:43], a[32:47]
	ds_read_b128 v[64:67], v6 offset:0
	s_waitcnt lgkmcnt(7)
	v_mfma_f32_32x32x16_bf16 a[48:63], v[16:19], v[44:47], a[48:63]
	v_mfma_f32_32x32x16_bf16 a[64:79], v[20:23], v[32:35], a[64:79]
	ds_read_b64_tr_b16 v[52:53], v10 offset:8192
	v_mfma_f32_32x32x16_bf16 a[80:95], v[20:23], v[36:39], a[80:95]
	ds_read_b64_tr_b16 v[54:55], v10 offset:10240
	v_mfma_f32_32x32x16_bf16 a[96:111], v[20:23], v[40:43], a[96:111]
	ds_read_b128 v[68:71], v6 offset:4096
	v_mfma_f32_32x32x16_bf16 a[112:127], v[20:23], v[44:47], a[112:127]
	s_waitcnt lgkmcnt(8)
	v_mfma_f32_32x32x16_bf16 a[128:143], v[24:27], v[32:35], a[128:143]
	ds_read_b128 v[72:75], v6 offset:8192
	v_mfma_f32_32x32x16_bf16 a[144:159], v[24:27], v[36:39], a[144:159]
	ds_read_b128 v[76:79], v6 offset:12288
	v_mfma_f32_32x32x16_bf16 a[160:175], v[24:27], v[40:43], a[160:175]
	ds_read_b64_tr_b16 v[56:57], v11 offset:8192
	v_mfma_f32_32x32x16_bf16 a[176:191], v[24:27], v[44:47], a[176:191]
	s_waitcnt lgkmcnt(9)
	v_mfma_f32_32x32x16_bf16 a[192:207], v[28:31], v[32:35], a[192:207]
	ds_read_b64_tr_b16 v[58:59], v11 offset:10240
	v_mfma_f32_32x32x16_bf16 a[208:223], v[28:31], v[36:39], a[208:223]
	ds_read_b64_tr_b16 v[60:61], v12 offset:8192
	v_mfma_f32_32x32x16_bf16 a[224:239], v[28:31], v[40:43], a[224:239]
	ds_read_b64_tr_b16 v[62:63], v12 offset:10240
	v_mfma_f32_32x32x16_bf16 a[240:255], v[28:31], v[44:47], a[240:255]
	s_waitcnt lgkmcnt(9)
	v_mfma_f32_32x32x16_bf16 a[0:15], v[48:51], v[64:67], a[0:15]
	ds_read_b64_tr_b16 v[16:17], v9 offset:16384
	s_waitcnt lgkmcnt(7)
	v_mfma_f32_32x32x16_bf16 a[16:31], v[48:51], v[68:71], a[16:31]
	ds_read_b64_tr_b16 v[18:19], v9 offset:18432
	s_waitcnt lgkmcnt(7)
	v_mfma_f32_32x32x16_bf16 a[32:47], v[48:51], v[72:75], a[32:47]
	ds_read_b128 v[32:35], v7 offset:0
	s_waitcnt lgkmcnt(7)
	v_mfma_f32_32x32x16_bf16 a[48:63], v[48:51], v[76:79], a[48:63]
	v_mfma_f32_32x32x16_bf16 a[64:79], v[52:55], v[64:67], a[64:79]
	ds_read_b64_tr_b16 v[20:21], v10 offset:16384
	v_mfma_f32_32x32x16_bf16 a[80:95], v[52:55], v[68:71], a[80:95]
	ds_read_b64_tr_b16 v[22:23], v10 offset:18432
	v_mfma_f32_32x32x16_bf16 a[96:111], v[52:55], v[72:75], a[96:111]
	ds_read_b128 v[36:39], v7 offset:4096
	v_mfma_f32_32x32x16_bf16 a[112:127], v[52:55], v[76:79], a[112:127]
	s_waitcnt lgkmcnt(8)
	v_mfma_f32_32x32x16_bf16 a[128:143], v[56:59], v[64:67], a[128:143]
	ds_read_b128 v[40:43], v7 offset:8192
	v_mfma_f32_32x32x16_bf16 a[144:159], v[56:59], v[68:71], a[144:159]
	ds_read_b128 v[44:47], v7 offset:12288
	v_mfma_f32_32x32x16_bf16 a[160:175], v[56:59], v[72:75], a[160:175]
	ds_read_b64_tr_b16 v[24:25], v11 offset:16384
	v_mfma_f32_32x32x16_bf16 a[176:191], v[56:59], v[76:79], a[176:191]
	s_waitcnt lgkmcnt(9)
	v_mfma_f32_32x32x16_bf16 a[192:207], v[60:63], v[64:67], a[192:207]
	ds_read_b64_tr_b16 v[26:27], v11 offset:18432
	v_mfma_f32_32x32x16_bf16 a[208:223], v[60:63], v[68:71], a[208:223]
	ds_read_b64_tr_b16 v[28:29], v12 offset:16384
	v_mfma_f32_32x32x16_bf16 a[224:239], v[60:63], v[72:75], a[224:239]
	ds_read_b64_tr_b16 v[30:31], v12 offset:18432
	v_mfma_f32_32x32x16_bf16 a[240:255], v[60:63], v[76:79], a[240:255]
	s_waitcnt lgkmcnt(9)
	v_mfma_f32_32x32x16_bf16 a[0:15], v[16:19], v[32:35], a[0:15]
	ds_read_b64_tr_b16 v[48:49], v9 offset:24576
	s_waitcnt lgkmcnt(7)
	v_mfma_f32_32x32x16_bf16 a[16:31], v[16:19], v[36:39], a[16:31]
	ds_read_b64_tr_b16 v[50:51], v9 offset:26624
	s_waitcnt lgkmcnt(7)
	v_mfma_f32_32x32x16_bf16 a[32:47], v[16:19], v[40:43], a[32:47]
	ds_read_b128 v[64:67], v8 offset:0
	s_waitcnt lgkmcnt(7)
	v_mfma_f32_32x32x16_bf16 a[48:63], v[16:19], v[44:47], a[48:63]
	v_mfma_f32_32x32x16_bf16 a[64:79], v[20:23], v[32:35], a[64:79]
	ds_read_b64_tr_b16 v[52:53], v10 offset:24576
	v_mfma_f32_32x32x16_bf16 a[80:95], v[20:23], v[36:39], a[80:95]
	ds_read_b64_tr_b16 v[54:55], v10 offset:26624
	v_mfma_f32_32x32x16_bf16 a[96:111], v[20:23], v[40:43], a[96:111]
	ds_read_b128 v[68:71], v8 offset:4096
	v_mfma_f32_32x32x16_bf16 a[112:127], v[20:23], v[44:47], a[112:127]
	s_waitcnt lgkmcnt(8)
	v_mfma_f32_32x32x16_bf16 a[128:143], v[24:27], v[32:35], a[128:143]
	ds_read_b128 v[72:75], v8 offset:8192
	v_mfma_f32_32x32x16_bf16 a[144:159], v[24:27], v[36:39], a[144:159]
	ds_read_b128 v[76:79], v8 offset:12288
	v_mfma_f32_32x32x16_bf16 a[160:175], v[24:27], v[40:43], a[160:175]
	ds_read_b64_tr_b16 v[56:57], v11 offset:24576
	v_mfma_f32_32x32x16_bf16 a[176:191], v[24:27], v[44:47], a[176:191]
	s_waitcnt lgkmcnt(9)
	v_mfma_f32_32x32x16_bf16 a[192:207], v[28:31], v[32:35], a[192:207]
	ds_read_b64_tr_b16 v[58:59], v11 offset:26624
	v_mfma_f32_32x32x16_bf16 a[208:223], v[28:31], v[36:39], a[208:223]
	ds_read_b64_tr_b16 v[60:61], v12 offset:24576
	v_mfma_f32_32x32x16_bf16 a[224:239], v[28:31], v[40:43], a[224:239]
	ds_read_b64_tr_b16 v[62:63], v12 offset:26624
	v_mfma_f32_32x32x16_bf16 a[240:255], v[28:31], v[44:47], a[240:255]
	s_waitcnt vmcnt(0) lgkmcnt(0)
	s_barrier
	v_add_u32 v5, 0x10000, v5
	v_add_u32 v6, 0x10000, v6
	v_add_u32 v7, 0x10000, v7
	v_add_u32 v8, 0x10000, v8
	v_add_u32 v9, 0x10000, v9
	v_add_u32 v10, 0x10000, v10
	v_add_u32 v11, 0x10000, v11
	v_add_u32 v12, 0x10000, v12
	v_mfma_f32_32x32x16_bf16 a[0:15], v[48:51], v[64:67], a[0:15]
	ds_read_b64_tr_b16 v[16:17], v9 offset:0
	ds_read_b64_tr_b16 v[18:19], v9 offset:2048
	v_mfma_f32_32x32x16_bf16 a[16:31], v[48:51], v[68:71], a[16:31]
	ds_read_b128 v[32:35], v5 offset:0
	s_add_u32 m0, s40, 0
	s_add_u32 s21, s19, 0
	buffer_load_dwordx4 v1, s[8:11], s21 offen lds
	v_mfma_f32_32x32x16_bf16 a[32:47], v[48:51], v[72:75], a[32:47]
	s_add_u32 m0, s40, 4096
	s_add_u32 s21, s19, 36864
	buffer_load_dwordx4 v1, s[8:11], s21 offen lds
	s_add_u32 m0, s40, 8192
	s_add_u32 s21, s19, 73728
	buffer_load_dwordx4 v1, s[8:11], s21 offen lds
	v_mfma_f32_32x32x16_bf16 a[48:63], v[48:51], v[76:79], a[48:63]
	s_add_u32 m0, s40, 12288
	s_add_u32 s21, s19, 110592
	buffer_load_dwordx4 v1, s[8:11], s21 offen lds
	ds_read_b64_tr_b16 v[20:21], v10 offset:0
	v_mfma_f32_32x32x16_bf16 a[64:79], v[52:55], v[64:67], a[64:79]
	ds_read_b64_tr_b16 v[22:23], v10 offset:2048
	ds_read_b128 v[36:39], v5 offset:4096
	v_mfma_f32_32x32x16_bf16 a[80:95], v[52:55], v[68:71], a[80:95]
	ds_read_b128 v[40:43], v5 offset:8192
	v_mfma_f32_32x32x16_bf16 a[96:111], v[52:55], v[72:75], a[96:111]
	ds_read_b128 v[44:47], v5 offset:12288
	ds_read_b64_tr_b16 v[24:25], v11 offset:0
	v_mfma_f32_32x32x16_bf16 a[112:127], v[52:55], v[76:79], a[112:127]
	ds_read_b64_tr_b16 v[26:27], v11 offset:2048
	ds_read_b64_tr_b16 v[28:29], v12 offset:0
	v_mfma_f32_32x32x16_bf16 a[128:143], v[56:59], v[64:67], a[128:143]
	ds_read_b64_tr_b16 v[30:31], v12 offset:2048
	s_add_u32 m0, s40, 16384
	s_add_u32 s21, s19, 147456
	buffer_load_dwordx4 v1, s[8:11], s21 offen lds
	v_mfma_f32_32x32x16_bf16 a[144:159], v[56:59], v[68:71], a[144:159]
	s_add_u32 m0, s40, 20480
	s_add_u32 s21, s19, 184320
	buffer_load_dwordx4 v1, s[8:11], s21 offen lds
	s_add_u32 m0, s40, 24576
	s_add_u32 s21, s19, 221184
	buffer_load_dwordx4 v1, s[8:11], s21 offen lds
	v_mfma_f32_32x32x16_bf16 a[160:175], v[56:59], v[72:75], a[160:175]
	s_add_u32 m0, s40, 28672
	s_add_u32 s21, s19, 258048
	buffer_load_dwordx4 v1, s[8:11], s21 offen lds
	v_mfma_f32_32x32x16_bf16 a[176:191], v[56:59], v[76:79], a[176:191]
	s_add_u32 m0, s40, 32768
	s_mov_b32 s22, s20
	buffer_load_dwordx4 v2, s[12:15], s22 offen lds
	s_add_u32 m0, s40, 36864
	s_add_u32 s22, s22, s24
	buffer_load_dwordx4 v2, s[12:15], s22 offen lds
	v_mfma_f32_32x32x16_bf16 a[192:207], v[60:63], v[64:67], a[192:207]
	s_add_u32 m0, s40, 40960
	s_add_u32 s22, s22, s24
	buffer_load_dwordx4 v2, s[12:15], s22 offen lds
	s_add_u32 m0, s40, 45056
	s_add_u32 s22, s22, s24
	buffer_load_dwordx4 v2, s[12:15], s22 offen lds
	v_mfma_f32_32x32x16_bf16 a[208:223], v[60:63], v[68:71], a[208:223]
	s_add_u32 m0, s40, 49152
	s_add_u32 s22, s22, s24
	buffer_load_dwordx4 v2, s[12:15], s22 offen lds
	s_add_u32 m0, s40, 53248
	s_add_u32 s22, s22, s24
	buffer_load_dwordx4 v2, s[12:15], s22 offen lds
	v_mfma_f32_32x32x16_bf16 a[224:239], v[60:63], v[72:75], a[224:239]
	s_add_u32 m0, s40, 57344
	s_add_u32 s22, s22, s24
	buffer_load_dwordx4 v2, s[12:15], s22 offen lds
	s_add_u32 m0, s40, 61440
	s_add_u32 s22, s22, s24
	buffer_load_dwordx4 v2, s[12:15], s22 offen lds
	v_mfma_f32_32x32x16_bf16 a[240:255], v[60:63], v[76:79], a[240:255]
	s_add_u32 s19, s19, 128
	s_add_u32 s20, s20, s42
	s_waitcnt lgkmcnt(9)
	v_mfma_f32_32x32x16_bf16 a[0:15], v[16:19], v[32:35], a[0:15]
	ds_read_b64_tr_b16 v[48:49], v9 offset:8192
	s_waitcnt lgkmcnt(7)
	v_mfma_f32_32x32x16_bf16 a[16:31], v[16:19], v[36:39], a[16:31]
	ds_read_b64_tr_b16 v[50:51], v9 offset:10240
	s_waitcnt lgkmcnt(7)
	v_mfma_f32_32x32x16_bf16 a[32:47], v[16:19], v[40:43], a[32:47]
	ds_read_b128 v[64:67], v6 offset:0
	s_waitcnt lgkmcnt(7)
	v_mfma_f32_32x32x16_bf16 a[48:63], v[16:19], v[44:47], a[48:63]
	v_mfma_f32_32x32x16_bf16 a[64:79], v[20:23], v[32:35], a[64:79]
	ds_read_b64_tr_b16 v[52:53], v10 offset:8192
	v_mfma_f32_32x32x16_bf16 a[80:95], v[20:23], v[36:39], a[80:95]
	ds_read_b64_tr_b16 v[54:55], v10 offset:10240
	v_mfma_f32_32x32x16_bf16 a[96:111], v[20:23], v[40:43], a[96:111]
	ds_read_b128 v[68:71], v6 offset:4096
	v_mfma_f32_32x32x16_bf16 a[112:127], v[20:23], v[44:47], a[112:127]
	s_waitcnt lgkmcnt(8)
	v_mfma_f32_32x32x16_bf16 a[128:143], v[24:27], v[32:35], a[128:143]
	ds_read_b128 v[72:75], v6 offset:8192
	v_mfma_f32_32x32x16_bf16 a[144:159], v[24:27], v[36:39], a[144:159]
	ds_read_b128 v[76:79], v6 offset:12288
	v_mfma_f32_32x32x16_bf16 a[160:175], v[24:27], v[40:43], a[160:175]
	ds_read_b64_tr_b16 v[56:57], v11 offset:8192
	v_mfma_f32_32x32x16_bf16 a[176:191], v[24:27], v[44:47], a[176:191]
	s_waitcnt lgkmcnt(9)
	v_mfma_f32_32x32x16_bf16 a[192:207], v[28:31], v[32:35], a[192:207]
	ds_read_b64_tr_b16 v[58:59], v11 offset:10240
	v_mfma_f32_32x32x16_bf16 a[208:223], v[28:31], v[36:39], a[208:223]
	ds_read_b64_tr_b16 v[60:61], v12 offset:8192
	v_mfma_f32_32x32x16_bf16 a[224:239], v[28:31], v[40:43], a[224:239]
	ds_read_b64_tr_b16 v[62:63], v12 offset:10240
	v_mfma_f32_32x32x16_bf16 a[240:255], v[28:31], v[44:47], a[240:255]
	s_waitcnt lgkmcnt(9)
	v_mfma_f32_32x32x16_bf16 a[0:15], v[48:51], v[64:67], a[0:15]
	ds_read_b64_tr_b16 v[16:17], v9 offset:16384
	s_waitcnt lgkmcnt(7)
	v_mfma_f32_32x32x16_bf16 a[16:31], v[48:51], v[68:71], a[16:31]
	ds_read_b64_tr_b16 v[18:19], v9 offset:18432
	s_waitcnt lgkmcnt(7)
	v_mfma_f32_32x32x16_bf16 a[32:47], v[48:51], v[72:75], a[32:47]
	ds_read_b128 v[32:35], v7 offset:0
	s_waitcnt lgkmcnt(7)
	v_mfma_f32_32x32x16_bf16 a[48:63], v[48:51], v[76:79], a[48:63]
	v_mfma_f32_32x32x16_bf16 a[64:79], v[52:55], v[64:67], a[64:79]
	ds_read_b64_tr_b16 v[20:21], v10 offset:16384
	v_mfma_f32_32x32x16_bf16 a[80:95], v[52:55], v[68:71], a[80:95]
	ds_read_b64_tr_b16 v[22:23], v10 offset:18432
	v_mfma_f32_32x32x16_bf16 a[96:111], v[52:55], v[72:75], a[96:111]
	ds_read_b128 v[36:39], v7 offset:4096
	v_mfma_f32_32x32x16_bf16 a[112:127], v[52:55], v[76:79], a[112:127]
	s_waitcnt lgkmcnt(8)
	v_mfma_f32_32x32x16_bf16 a[128:143], v[56:59], v[64:67], a[128:143]
	ds_read_b128 v[40:43], v7 offset:8192
	v_mfma_f32_32x32x16_bf16 a[144:159], v[56:59], v[68:71], a[144:159]
	ds_read_b128 v[44:47], v7 offset:12288
	v_mfma_f32_32x32x16_bf16 a[160:175], v[56:59], v[72:75], a[160:175]
	ds_read_b64_tr_b16 v[24:25], v11 offset:16384
	v_mfma_f32_32x32x16_bf16 a[176:191], v[56:59], v[76:79], a[176:191]
	s_waitcnt lgkmcnt(9)
	v_mfma_f32_32x32x16_bf16 a[192:207], v[60:63], v[64:67], a[192:207]
	ds_read_b64_tr_b16 v[26:27], v11 offset:18432
	v_mfma_f32_32x32x16_bf16 a[208:223], v[60:63], v[68:71], a[208:223]
	ds_read_b64_tr_b16 v[28:29], v12 offset:16384
	v_mfma_f32_32x32x16_bf16 a[224:239], v[60:63], v[72:75], a[224:239]
	ds_read_b64_tr_b16 v[30:31], v12 offset:18432
	v_mfma_f32_32x32x16_bf16 a[240:255], v[60:63], v[76:79], a[240:255]
	s_waitcnt lgkmcnt(9)
	v_mfma_f32_32x32x16_bf16 a[0:15], v[16:19], v[32:35], a[0:15]
	ds_read_b64_tr_b16 v[48:49], v9 offset:24576
	s_waitcnt lgkmcnt(7)
	v_mfma_f32_32x32x16_bf16 a[16:31], v[16:19], v[36:39], a[16:31]
	ds_read_b64_tr_b16 v[50:51], v9 offset:26624
	s_waitcnt lgkmcnt(7)
	v_mfma_f32_32x32x16_bf16 a[32:47], v[16:19], v[40:43], a[32:47]
	ds_read_b128 v[64:67], v8 offset:0
	s_waitcnt lgkmcnt(7)
	v_mfma_f32_32x32x16_bf16 a[48:63], v[16:19], v[44:47], a[48:63]
	v_mfma_f32_32x32x16_bf16 a[64:79], v[20:23], v[32:35], a[64:79]
	ds_read_b64_tr_b16 v[52:53], v10 offset:24576
	v_mfma_f32_32x32x16_bf16 a[80:95], v[20:23], v[36:39], a[80:95]
	ds_read_b64_tr_b16 v[54:55], v10 offset:26624
	v_mfma_f32_32x32x16_bf16 a[96:111], v[20:23], v[40:43], a[96:111]
	ds_read_b128 v[68:71], v8 offset:4096
	v_mfma_f32_32x32x16_bf16 a[112:127], v[20:23], v[44:47], a[112:127]
	s_waitcnt lgkmcnt(8)
	v_mfma_f32_32x32x16_bf16 a[128:143], v[24:27], v[32:35], a[128:143]
	ds_read_b128 v[72:75], v8 offset:8192
	v_mfma_f32_32x32x16_bf16 a[144:159], v[24:27], v[36:39], a[144:159]
	ds_read_b128 v[76:79], v8 offset:12288
	v_mfma_f32_32x32x16_bf16 a[160:175], v[24:27], v[40:43], a[160:175]
	ds_read_b64_tr_b16 v[56:57], v11 offset:24576
	v_mfma_f32_32x32x16_bf16 a[176:191], v[24:27], v[44:47], a[176:191]
	s_waitcnt lgkmcnt(9)
	v_mfma_f32_32x32x16_bf16 a[192:207], v[28:31], v[32:35], a[192:207]
	ds_read_b64_tr_b16 v[58:59], v11 offset:26624
	v_mfma_f32_32x32x16_bf16 a[208:223], v[28:31], v[36:39], a[208:223]
	ds_read_b64_tr_b16 v[60:61], v12 offset:24576
	v_mfma_f32_32x32x16_bf16 a[224:239], v[28:31], v[40:43], a[224:239]
	ds_read_b64_tr_b16 v[62:63], v12 offset:26624
	v_mfma_f32_32x32x16_bf16 a[240:255], v[28:31], v[44:47], a[240:255]
	s_waitcnt vmcnt(0) lgkmcnt(0)
	s_barrier
	v_add_u32 v5, 0xffff0000, v5
	v_add_u32 v6, 0xffff0000, v6
	v_add_u32 v7, 0xffff0000, v7
	v_add_u32 v8, 0xffff0000, v8
	v_add_u32 v9, 0xffff0000, v9
	v_add_u32 v10, 0xffff0000, v10
	v_add_u32 v11, 0xffff0000, v11
	v_add_u32 v12, 0xffff0000, v12
	v_mfma_f32_32x32x16_bf16 a[0:15], v[48:51], v[64:67], a[0:15]
	ds_read_b64_tr_b16 v[16:17], v9 offset:0
	v_mfma_f32_32x32x16_bf16 a[16:31], v[48:51], v[68:71], a[16:31]
	ds_read_b64_tr_b16 v[18:19], v9 offset:2048
	v_mfma_f32_32x32x16_bf16 a[32:47], v[48:51], v[72:75], a[32:47]
	ds_read_b128 v[32:35], v5 offset:0
	v_mfma_f32_32x32x16_bf16 a[48:63], v[48:51], v[76:79], a[48:63]
	v_mfma_f32_32x32x16_bf16 a[64:79], v[52:55], v[64:67], a[64:79]
	ds_read_b64_tr_b16 v[20:21], v10 offset:0
	v_mfma_f32_32x32x16_bf16 a[80:95], v[52:55], v[68:71], a[80:95]
	ds_read_b64_tr_b16 v[22:23], v10 offset:2048
	v_mfma_f32_32x32x16_bf16 a[96:111], v[52:55], v[72:75], a[96:111]
	ds_read_b128 v[36:39], v5 offset:4096
	v_mfma_f32_32x32x16_bf16 a[112:127], v[52:55], v[76:79], a[112:127]
	v_mfma_f32_32x32x16_bf16 a[128:143], v[56:59], v[64:67], a[128:143]
	ds_read_b128 v[40:43], v5 offset:8192
	v_mfma_f32_32x32x16_bf16 a[144:159], v[56:59], v[68:71], a[144:159]
	ds_read_b128 v[44:47], v5 offset:12288
	v_mfma_f32_32x32x16_bf16 a[160:175], v[56:59], v[72:75], a[160:175]
	ds_read_b64_tr_b16 v[24:25], v11 offset:0
	v_mfma_f32_32x32x16_bf16 a[176:191], v[56:59], v[76:79], a[176:191]
	v_mfma_f32_32x32x16_bf16 a[192:207], v[60:63], v[64:67], a[192:207]
	ds_read_b64_tr_b16 v[26:27], v11 offset:2048
	v_mfma_f32_32x32x16_bf16 a[208:223], v[60:63], v[68:71], a[208:223]
	ds_read_b64_tr_b16 v[28:29], v12 offset:0
	v_mfma_f32_32x32x16_bf16 a[224:239], v[60:63], v[72:75], a[224:239]
	ds_read_b64_tr_b16 v[30:31], v12 offset:2048
	v_mfma_f32_32x32x16_bf16 a[240:255], v[60:63], v[76:79], a[240:255]
	s_waitcnt lgkmcnt(9)
	v_mfma_f32_32x32x16_bf16 a[0:15], v[16:19], v[32:35], a[0:15]
	ds_read_b64_tr_b16 v[48:49], v9 offset:8192
	s_waitcnt lgkmcnt(7)
	v_mfma_f32_32x32x16_bf16 a[16:31], v[16:19], v[36:39], a[16:31]
	ds_read_b64_tr_b16 v[50:51], v9 offset:10240
	s_waitcnt lgkmcnt(7)
	v_mfma_f32_32x32x16_bf16 a[32:47], v[16:19], v[40:43], a[32:47]
	ds_read_b128 v[64:67], v6 offset:0
	s_waitcnt lgkmcnt(7)
	v_mfma_f32_32x32x16_bf16 a[48:63], v[16:19], v[44:47], a[48:63]
	v_mfma_f32_32x32x16_bf16 a[64:79], v[20:23], v[32:35], a[64:79]
	ds_read_b64_tr_b16 v[52:53], v10 offset:8192
	v_mfma_f32_32x32x16_bf16 a[80:95], v[20:23], v[36:39], a[80:95]
	ds_read_b64_tr_b16 v[54:55], v10 offset:10240
	v_mfma_f32_32x32x16_bf16 a[96:111], v[20:23], v[40:43], a[96:111]
	ds_read_b128 v[68:71], v6 offset:4096
	v_mfma_f32_32x32x16_bf16 a[112:127], v[20:23], v[44:47], a[112:127]
	s_waitcnt lgkmcnt(8)
	v_mfma_f32_32x32x16_bf16 a[128:143], v[24:27], v[32:35], a[128:143]
	ds_read_b128 v[72:75], v6 offset:8192
	v_mfma_f32_32x32x16_bf16 a[144:159], v[24:27], v[36:39], a[144:159]
	ds_read_b128 v[76:79], v6 offset:12288
	v_mfma_f32_32x32x16_bf16 a[160:175], v[24:27], v[40:43], a[160:175]
	ds_read_b64_tr_b16 v[56:57], v11 offset:8192
	v_mfma_f32_32x32x16_bf16 a[176:191], v[24:27], v[44:47], a[176:191]
	s_waitcnt lgkmcnt(9)
	v_mfma_f32_32x32x16_bf16 a[192:207], v[28:31], v[32:35], a[192:207]
	ds_read_b64_tr_b16 v[58:59], v11 offset:10240
	v_mfma_f32_32x32x16_bf16 a[208:223], v[28:31], v[36:39], a[208:223]
	ds_read_b64_tr_b16 v[60:61], v12 offset:8192
	v_mfma_f32_32x32x16_bf16 a[224:239], v[28:31], v[40:43], a[224:239]
	ds_read_b64_tr_b16 v[62:63], v12 offset:10240
	v_mfma_f32_32x32x16_bf16 a[240:255], v[28:31], v[44:47], a[240:255]
	s_waitcnt lgkmcnt(9)
	v_mfma_f32_32x32x16_bf16 a[0:15], v[48:51], v[64:67], a[0:15]
	ds_read_b64_tr_b16 v[16:17], v9 offset:16384
	s_waitcnt lgkmcnt(7)
	v_mfma_f32_32x32x16_bf16 a[16:31], v[48:51], v[68:71], a[16:31]
	ds_read_b64_tr_b16 v[18:19], v9 offset:18432
	s_waitcnt lgkmcnt(7)
	v_mfma_f32_32x32x16_bf16 a[32:47], v[48:51], v[72:75], a[32:47]
	ds_read_b128 v[32:35], v7 offset:0
	s_waitcnt lgkmcnt(7)
	v_mfma_f32_32x32x16_bf16 a[48:63], v[48:51], v[76:79], a[48:63]
	v_mfma_f32_32x32x16_bf16 a[64:79], v[52:55], v[64:67], a[64:79]
	ds_read_b64_tr_b16 v[20:21], v10 offset:16384
	v_mfma_f32_32x32x16_bf16 a[80:95], v[52:55], v[68:71], a[80:95]
	ds_read_b64_tr_b16 v[22:23], v10 offset:18432
	v_mfma_f32_32x32x16_bf16 a[96:111], v[52:55], v[72:75], a[96:111]
	ds_read_b128 v[36:39], v7 offset:4096
	v_mfma_f32_32x32x16_bf16 a[112:127], v[52:55], v[76:79], a[112:127]
	s_waitcnt lgkmcnt(8)
	v_mfma_f32_32x32x16_bf16 a[128:143], v[56:59], v[64:67], a[128:143]
	ds_read_b128 v[40:43], v7 offset:8192
	v_mfma_f32_32x32x16_bf16 a[144:159], v[56:59], v[68:71], a[144:159]
	ds_read_b128 v[44:47], v7 offset:12288
	v_mfma_f32_32x32x16_bf16 a[160:175], v[56:59], v[72:75], a[160:175]
	ds_read_b64_tr_b16 v[24:25], v11 offset:16384
	v_mfma_f32_32x32x16_bf16 a[176:191], v[56:59], v[76:79], a[176:191]
	s_waitcnt lgkmcnt(9)
	v_mfma_f32_32x32x16_bf16 a[192:207], v[60:63], v[64:67], a[192:207]
	ds_read_b64_tr_b16 v[26:27], v11 offset:18432
	v_mfma_f32_32x32x16_bf16 a[208:223], v[60:63], v[68:71], a[208:223]
	ds_read_b64_tr_b16 v[28:29], v12 offset:16384
	v_mfma_f32_32x32x16_bf16 a[224:239], v[60:63], v[72:75], a[224:239]
	ds_read_b64_tr_b16 v[30:31], v12 offset:18432
	v_mfma_f32_32x32x16_bf16 a[240:255], v[60:63], v[76:79], a[240:255]
	s_waitcnt lgkmcnt(9)
	v_mfma_f32_32x32x16_bf16 a[0:15], v[16:19], v[32:35], a[0:15]
	ds_read_b64_tr_b16 v[48:49], v9 offset:24576
	s_waitcnt lgkmcnt(7)
	v_mfma_f32_32x32x16_bf16 a[16:31], v[16:19], v[36:39], a[16:31]
	ds_read_b64_tr_b16 v[50:51], v9 offset:26624
	s_waitcnt lgkmcnt(7)
	v_mfma_f32_32x32x16_bf16 a[32:47], v[16:19], v[40:43], a[32:47]
	ds_read_b128 v[64:67], v8 offset:0
	s_waitcnt lgkmcnt(7)
	v_mfma_f32_32x32x16_bf16 a[48:63], v[16:19], v[44:47], a[48:63]
	v_mfma_f32_32x32x16_bf16 a[64:79], v[20:23], v[32:35], a[64:79]
	ds_read_b64_tr_b16 v[52:53], v10 offset:24576
	v_mfma_f32_32x32x16_bf16 a[80:95], v[20:23], v[36:39], a[80:95]
	ds_read_b64_tr_b16 v[54:55], v10 offset:26624
	v_mfma_f32_32x32x16_bf16 a[96:111], v[20:23], v[40:43], a[96:111]
	ds_read_b128 v[68:71], v8 offset:4096
	v_mfma_f32_32x32x16_bf16 a[112:127], v[20:23], v[44:47], a[112:127]
	s_waitcnt lgkmcnt(8)
	v_mfma_f32_32x32x16_bf16 a[128:143], v[24:27], v[32:35], a[128:143]
	ds_read_b128 v[72:75], v8 offset:8192
	v_mfma_f32_32x32x16_bf16 a[144:159], v[24:27], v[36:39], a[144:159]
	ds_read_b128 v[76:79], v8 offset:12288
	v_mfma_f32_32x32x16_bf16 a[160:175], v[24:27], v[40:43], a[160:175]
	ds_read_b64_tr_b16 v[56:57], v11 offset:24576
	v_mfma_f32_32x32x16_bf16 a[176:191], v[24:27], v[44:47], a[176:191]
	s_waitcnt lgkmcnt(9)
	v_mfma_f32_32x32x16_bf16 a[192:207], v[28:31], v[32:35], a[192:207]
	ds_read_b64_tr_b16 v[58:59], v11 offset:26624
	v_mfma_f32_32x32x16_bf16 a[208:223], v[28:31], v[36:39], a[208:223]
	ds_read_b64_tr_b16 v[60:61], v12 offset:24576
	v_mfma_f32_32x32x16_bf16 a[224:239], v[28:31], v[40:43], a[224:239]
	ds_read_b64_tr_b16 v[62:63], v12 offset:26624
	v_mfma_f32_32x32x16_bf16 a[240:255], v[28:31], v[44:47], a[240:255]
	s_waitcnt lgkmcnt(9)
	v_mfma_f32_32x32x16_bf16 a[0:15], v[48:51], v[64:67], a[0:15]
	s_waitcnt lgkmcnt(6)
	v_mfma_f32_32x32x16_bf16 a[16:31], v[48:51], v[68:71], a[16:31]
	s_waitcnt lgkmcnt(5)
	v_mfma_f32_32x32x16_bf16 a[32:47], v[48:51], v[72:75], a[32:47]
	s_waitcnt lgkmcnt(4)
	v_mfma_f32_32x32x16_bf16 a[48:63], v[48:51], v[76:79], a[48:63]
	v_mfma_f32_32x32x16_bf16 a[64:79], v[52:55], v[64:67], a[64:79]
	v_mfma_f32_32x32x16_bf16 a[80:95], v[52:55], v[68:71], a[80:95]
	v_mfma_f32_32x32x16_bf16 a[96:111], v[52:55], v[72:75], a[96:111]
	v_mfma_f32_32x32x16_bf16 a[112:127], v[52:55], v[76:79], a[112:127]
	s_waitcnt lgkmcnt(2)
	v_mfma_f32_32x32x16_bf16 a[128:143], v[56:59], v[64:67], a[128:143]
	v_mfma_f32_32x32x16_bf16 a[144:159], v[56:59], v[68:71], a[144:159]
	v_mfma_f32_32x32x16_bf16 a[160:175], v[56:59], v[72:75], a[160:175]
	v_mfma_f32_32x32x16_bf16 a[176:191], v[56:59], v[76:79], a[176:191]
	s_waitcnt lgkmcnt(0)
	v_mfma_f32_32x32x16_bf16 a[192:207], v[60:63], v[64:67], a[192:207]
	v_mfma_f32_32x32x16_bf16 a[208:223], v[60:63], v[68:71], a[208:223]
	v_mfma_f32_32x32x16_bf16 a[224:239], v[60:63], v[72:75], a[224:239]
	v_mfma_f32_32x32x16_bf16 a[240:255], v[60:63], v[76:79], a[240:255]
	s_barrier
	s_cmp_eq_u32 s43, 3
	s_cbranch_scc1 main_kernel_g1_h
	s_lshl_b32 s25, s43, 24
	s_add_u32 s25, s25, 4194304
	s_mov_b32 s26, 8192
	s_lshl_b32 s21, s28, 13
	s_add_u32 s25, s25, s21
	s_add_u32 s25, s25, s17
	s_lshr_b32 s21, s4, 1
	s_and_b32 s22, s4, 1
	s_mul_i32 s21, s21, 128
	s_mul_i32 s22, s22, 256
	v_and_b32 v13, 15, v0
	v_add_u32 v13, s21, v13
	v_mul_lo_u32 v13, v13, s26
	v_bfe_u32 v14, v0, 4, 1
	v_lshl_add_u32 v13, v14, 5, v13
	v_lshrrev_b32 v14, 5, v0
	v_lshl_add_u32 v13, v14, 4, v13
	v_add_u32 v15, s22, v13
	s_lshl_b32 s22, s26, 4
	v_add_u32 v157, s22, v15
	s_lshl_b32 s22, s26, 5
	s_lshr_b32 s23, s4, 1
	s_mul_i32 s23, s23, 128
	v_and_b32 v13, 7, v0
	v_add_u32 v13, s23, v13
	v_mul_lo_u32 v13, v13, s26
	v_bfe_u32 v189, v0, 3, 1
	v_lshl_add_u32 v13, v189, 6, v13
	v_bfe_u32 v189, v0, 4, 1
	v_lshl_add_u32 v13, v189, 5, v13
	v_lshrrev_b32 v189, 5, v0
	v_lshl_add_u32 v13, v189, 4, v13
	s_and_b32 s23, s4, 1
	s_mul_i32 s23, s23, 256
	v_add_u32 v188, s23, v13
	s_lshl_b32 s23, s26, 3
	v_add_u32 v189, s23, v188
	v_add_u32 v190, s23, v189
	v_add_u32 v191, s23, v190
	v_accvgpr_read_b32 v80, a0
	v_accvgpr_read_b32 v81, a1
	v_accvgpr_read_b32 v82, a2
	v_accvgpr_read_b32 v83, a3
	v_accvgpr_read_b32 v84, a4
	v_accvgpr_read_b32 v85, a5
	v_accvgpr_read_b32 v86, a6
	v_accvgpr_read_b32 v87, a7
	v_accvgpr_read_b32 v88, a8
	v_accvgpr_read_b32 v89, a9
	v_accvgpr_read_b32 v90, a10
	v_accvgpr_read_b32 v91, a11
	v_accvgpr_read_b32 v92, a12
	v_accvgpr_read_b32 v93, a13
	v_accvgpr_read_b32 v94, a14
	v_accvgpr_read_b32 v95, a15
	v_cvt_pk_bf16_f32 v80, v80, v81
	v_cvt_pk_bf16_f32 v81, v82, v83
	v_cvt_pk_bf16_f32 v82, v84, v85
	v_cvt_pk_bf16_f32 v83, v86, v87
	s_nop 0
	v_permlane32_swap_b32 v80, v82
	v_permlane32_swap_b32 v81, v83
	v_cvt_pk_bf16_f32 v88, v88, v89
	v_cvt_pk_bf16_f32 v89, v90, v91
	v_cvt_pk_bf16_f32 v90, v92, v93
	v_cvt_pk_bf16_f32 v91, v94, v95
	s_nop 0
	v_permlane32_swap_b32 v88, v90
	v_permlane32_swap_b32 v89, v91
	s_nop 0
	v_permlane16_swap_b32 v80, v88
	v_permlane16_swap_b32 v81, v89
	v_permlane16_swap_b32 v82, v90
	v_permlane16_swap_b32 v83, v91
	v_accvgpr_read_b32 v100, a64
	v_accvgpr_read_b32 v101, a65
	v_accvgpr_read_b32 v102, a66
	v_accvgpr_read_b32 v103, a67
	v_accvgpr_read_b32 v104, a68
	v_accvgpr_read_b32 v105, a69
	v_accvgpr_read_b32 v106, a70
	v_accvgpr_read_b32 v107, a71
	v_accvgpr_read_b32 v108, a72
	v_accvgpr_read_b32 v109, a73
	v_accvgpr_read_b32 v110, a74
	v_accvgpr_read_b32 v111, a75
	v_accvgpr_read_b32 v112, a76
	v_accvgpr_read_b32 v113, a77
	v_accvgpr_read_b32 v114, a78
	v_accvgpr_read_b32 v115, a79
	v_cvt_pk_bf16_f32 v100, v100, v101
	v_cvt_pk_bf16_f32 v101, v102, v103
	v_cvt_pk_bf16_f32 v102, v104, v105
	v_cvt_pk_bf16_f32 v103, v106, v107
	s_nop 0
	v_permlane32_swap_b32 v100, v102
	v_permlane32_swap_b32 v101, v103
	v_cvt_pk_bf16_f32 v108, v108, v109
	v_cvt_pk_bf16_f32 v109, v110, v111
	v_cvt_pk_bf16_f32 v110, v112, v113
	v_cvt_pk_bf16_f32 v111, v114, v115
	s_nop 0
	v_permlane32_swap_b32 v108, v110
	v_permlane32_swap_b32 v109, v111
	s_nop 0
	v_permlane16_swap_b32 v100, v108
	v_permlane16_swap_b32 v101, v109
	v_permlane16_swap_b32 v102, v110
	v_permlane16_swap_b32 v103, v111
	v_mov_b32 v232, v80
	v_mov_b32 v233, v81
	v_mov_b32 v234, v82
	v_mov_b32 v235, v83
	v_mov_b32_dpp v80, v100 row_ror:8 row_mask:0xf bank_mask:0xc
	v_mov_b32_dpp v81, v101 row_ror:8 row_mask:0xf bank_mask:0xc
	v_mov_b32_dpp v82, v102 row_ror:8 row_mask:0xf bank_mask:0xc
	v_mov_b32_dpp v83, v103 row_ror:8 row_mask:0xf bank_mask:0xc
	v_mov_b32_dpp v100, v232 row_ror:8 row_mask:0xf bank_mask:0x3
	v_mov_b32_dpp v101, v233 row_ror:8 row_mask:0xf bank_mask:0x3
	v_mov_b32_dpp v102, v234 row_ror:8 row_mask:0xf bank_mask:0x3
	v_mov_b32_dpp v103, v235 row_ror:8 row_mask:0xf bank_mask:0x3
	v_mov_b32 v232, v88
	v_mov_b32 v233, v89
	v_mov_b32 v234, v90
	v_mov_b32 v235, v91
	v_mov_b32_dpp v88, v108 row_ror:8 row_mask:0xf bank_mask:0xc
	v_mov_b32_dpp v89, v109 row_ror:8 row_mask:0xf bank_mask:0xc
	v_mov_b32_dpp v90, v110 row_ror:8 row_mask:0xf bank_mask:0xc
	v_mov_b32_dpp v91, v111 row_ror:8 row_mask:0xf bank_mask:0xc
	v_mov_b32_dpp v108, v232 row_ror:8 row_mask:0xf bank_mask:0x3
	v_mov_b32_dpp v109, v233 row_ror:8 row_mask:0xf bank_mask:0x3
	v_mov_b32_dpp v110, v234 row_ror:8 row_mask:0xf bank_mask:0x3
	v_mov_b32_dpp v111, v235 row_ror:8 row_mask:0xf bank_mask:0x3
	s_mov_b32 s23, s25
	buffer_store_dwordx4 v[80:83], v188, s[8:11], s23 offen offset:0 sc1
	buffer_store_dwordx4 v[100:103], v189, s[8:11], s23 offen offset:0 sc1
	buffer_store_dwordx4 v[88:91], v190, s[8:11], s23 offen offset:0 sc1
	buffer_store_dwordx4 v[108:111], v191, s[8:11], s23 offen offset:0 sc1
	v_accvgpr_read_b32 v192, a16
	v_accvgpr_read_b32 v193, a17
	v_accvgpr_read_b32 v194, a18
	v_accvgpr_read_b32 v195, a19
	v_accvgpr_read_b32 v196, a20
	v_accvgpr_read_b32 v197, a21
	v_accvgpr_read_b32 v198, a22
	v_accvgpr_read_b32 v199, a23
	v_accvgpr_read_b32 v200, a24
	v_accvgpr_read_b32 v201, a25
	v_accvgpr_read_b32 v202, a26
	v_accvgpr_read_b32 v203, a27
	v_accvgpr_read_b32 v204, a28
	v_accvgpr_read_b32 v205, a29
	v_accvgpr_read_b32 v206, a30
	v_accvgpr_read_b32 v207, a31
	v_cvt_pk_bf16_f32 v192, v192, v193
	v_cvt_pk_bf16_f32 v193, v194, v195
	v_cvt_pk_bf16_f32 v194, v196, v197
	v_cvt_pk_bf16_f32 v195, v198, v199
	s_nop 0
	v_permlane32_swap_b32 v192, v194
	v_permlane32_swap_b32 v193, v195
	v_cvt_pk_bf16_f32 v200, v200, v201
	v_cvt_pk_bf16_f32 v201, v202, v203
	v_cvt_pk_bf16_f32 v202, v204, v205
	v_cvt_pk_bf16_f32 v203, v206, v207
	s_nop 0
	v_permlane32_swap_b32 v200, v202
	v_permlane32_swap_b32 v201, v203
	s_nop 0
	v_permlane16_swap_b32 v192, v200
	v_permlane16_swap_b32 v193, v201
	v_permlane16_swap_b32 v194, v202
	v_permlane16_swap_b32 v195, v203
	v_accvgpr_read_b32 v212, a80
	v_accvgpr_read_b32 v213, a81
	v_accvgpr_read_b32 v214, a82
	v_accvgpr_read_b32 v215, a83
	v_accvgpr_read_b32 v216, a84
	v_accvgpr_read_b32 v217, a85
	v_accvgpr_read_b32 v218, a86
	v_accvgpr_read_b32 v219, a87
	v_accvgpr_read_b32 v220, a88
	v_accvgpr_read_b32 v221, a89
	v_accvgpr_read_b32 v222, a90
	v_accvgpr_read_b32 v223, a91
	v_accvgpr_read_b32 v224, a92
	v_accvgpr_read_b32 v225, a93
	v_accvgpr_read_b32 v226, a94
	v_accvgpr_read_b32 v227, a95
	v_cvt_pk_bf16_f32 v212, v212, v213
	v_cvt_pk_bf16_f32 v213, v214, v215
	v_cvt_pk_bf16_f32 v214, v216, v217
	v_cvt_pk_bf16_f32 v215, v218, v219
	s_nop 0
	v_permlane32_swap_b32 v212, v214
	v_permlane32_swap_b32 v213, v215
	v_cvt_pk_bf16_f32 v220, v220, v221
	v_cvt_pk_bf16_f32 v221, v222, v223
	v_cvt_pk_bf16_f32 v222, v224, v225
	v_cvt_pk_bf16_f32 v223, v226, v227
	s_nop 0
	v_permlane32_swap_b32 v220, v222
	v_permlane32_swap_b32 v221, v223
	s_nop 0
	v_permlane16_swap_b32 v212, v220
	v_permlane16_swap_b32 v213, v221
	v_permlane16_swap_b32 v214, v222
	v_permlane16_swap_b32 v215, v223
	v_mov_b32 v232, v192
	v_mov_b32 v233, v193
	v_mov_b32 v234, v194
	v_mov_b32 v235, v195
	v_mov_b32_dpp v192, v212 row_ror:8 row_mask:0xf bank_mask:0xc
	v_mov_b32_dpp v193, v213 row_ror:8 row_mask:0xf bank_mask:0xc
	v_mov_b32_dpp v194, v214 row_ror:8 row_mask:0xf bank_mask:0xc
	v_mov_b32_dpp v195, v215 row_ror:8 row_mask:0xf bank_mask:0xc
	v_mov_b32_dpp v212, v232 row_ror:8 row_mask:0xf bank_mask:0x3
	v_mov_b32_dpp v213, v233 row_ror:8 row_mask:0xf bank_mask:0x3
	v_mov_b32_dpp v214, v234 row_ror:8 row_mask:0xf bank_mask:0x3
	v_mov_b32_dpp v215, v235 row_ror:8 row_mask:0xf bank_mask:0x3
	v_mov_b32 v232, v200
	v_mov_b32 v233, v201
	v_mov_b32 v234, v202
	v_mov_b32 v235, v203
	v_mov_b32_dpp v200, v220 row_ror:8 row_mask:0xf bank_mask:0xc
	v_mov_b32_dpp v201, v221 row_ror:8 row_mask:0xf bank_mask:0xc
	v_mov_b32_dpp v202, v222 row_ror:8 row_mask:0xf bank_mask:0xc
	v_mov_b32_dpp v203, v223 row_ror:8 row_mask:0xf bank_mask:0xc
	v_mov_b32_dpp v220, v232 row_ror:8 row_mask:0xf bank_mask:0x3
	v_mov_b32_dpp v221, v233 row_ror:8 row_mask:0xf bank_mask:0x3
	v_mov_b32_dpp v222, v234 row_ror:8 row_mask:0xf bank_mask:0x3
	v_mov_b32_dpp v223, v235 row_ror:8 row_mask:0xf bank_mask:0x3
	s_mul_i32 s23, s22, 1
	s_add_u32 s23, s23, s25
	buffer_store_dwordx4 v[192:195], v188, s[8:11], s23 offen offset:0 sc1
	buffer_store_dwordx4 v[212:215], v189, s[8:11], s23 offen offset:0 sc1
	buffer_store_dwordx4 v[200:203], v190, s[8:11], s23 offen offset:0 sc1
	buffer_store_dwordx4 v[220:223], v191, s[8:11], s23 offen offset:0 sc1
	v_accvgpr_read_b32 v80, a32
	v_accvgpr_read_b32 v81, a33
	v_accvgpr_read_b32 v82, a34
	v_accvgpr_read_b32 v83, a35
	v_accvgpr_read_b32 v84, a36
	v_accvgpr_read_b32 v85, a37
	v_accvgpr_read_b32 v86, a38
	v_accvgpr_read_b32 v87, a39
	v_accvgpr_read_b32 v88, a40
	v_accvgpr_read_b32 v89, a41
	v_accvgpr_read_b32 v90, a42
	v_accvgpr_read_b32 v91, a43
	v_accvgpr_read_b32 v92, a44
	v_accvgpr_read_b32 v93, a45
	v_accvgpr_read_b32 v94, a46
	v_accvgpr_read_b32 v95, a47
	v_cvt_pk_bf16_f32 v80, v80, v81
	v_cvt_pk_bf16_f32 v81, v82, v83
	v_cvt_pk_bf16_f32 v82, v84, v85
	v_cvt_pk_bf16_f32 v83, v86, v87
	s_nop 0
	v_permlane32_swap_b32 v80, v82
	v_permlane32_swap_b32 v81, v83
	v_cvt_pk_bf16_f32 v88, v88, v89
	v_cvt_pk_bf16_f32 v89, v90, v91
	v_cvt_pk_bf16_f32 v90, v92, v93
	v_cvt_pk_bf16_f32 v91, v94, v95
	s_nop 0
	v_permlane32_swap_b32 v88, v90
	v_permlane32_swap_b32 v89, v91
	s_nop 0
	v_permlane16_swap_b32 v80, v88
	v_permlane16_swap_b32 v81, v89
	v_permlane16_swap_b32 v82, v90
	v_permlane16_swap_b32 v83, v91
	v_accvgpr_read_b32 v100, a96
	v_accvgpr_read_b32 v101, a97
	v_accvgpr_read_b32 v102, a98
	v_accvgpr_read_b32 v103, a99
	v_accvgpr_read_b32 v104, a100
	v_accvgpr_read_b32 v105, a101
	v_accvgpr_read_b32 v106, a102
	v_accvgpr_read_b32 v107, a103
	v_accvgpr_read_b32 v108, a104
	v_accvgpr_read_b32 v109, a105
	v_accvgpr_read_b32 v110, a106
	v_accvgpr_read_b32 v111, a107
	v_accvgpr_read_b32 v112, a108
	v_accvgpr_read_b32 v113, a109
	v_accvgpr_read_b32 v114, a110
	v_accvgpr_read_b32 v115, a111
	v_cvt_pk_bf16_f32 v100, v100, v101
	v_cvt_pk_bf16_f32 v101, v102, v103
	v_cvt_pk_bf16_f32 v102, v104, v105
	v_cvt_pk_bf16_f32 v103, v106, v107
	s_nop 0
	v_permlane32_swap_b32 v100, v102
	v_permlane32_swap_b32 v101, v103
	v_cvt_pk_bf16_f32 v108, v108, v109
	v_cvt_pk_bf16_f32 v109, v110, v111
	v_cvt_pk_bf16_f32 v110, v112, v113
	v_cvt_pk_bf16_f32 v111, v114, v115
	s_nop 0
	v_permlane32_swap_b32 v108, v110
	v_permlane32_swap_b32 v109, v111
	s_nop 0
	v_permlane16_swap_b32 v100, v108
	v_permlane16_swap_b32 v101, v109
	v_permlane16_swap_b32 v102, v110
	v_permlane16_swap_b32 v103, v111
	v_mov_b32 v232, v80
	v_mov_b32 v233, v81
	v_mov_b32 v234, v82
	v_mov_b32 v235, v83
	v_mov_b32_dpp v80, v100 row_ror:8 row_mask:0xf bank_mask:0xc
	v_mov_b32_dpp v81, v101 row_ror:8 row_mask:0xf bank_mask:0xc
	v_mov_b32_dpp v82, v102 row_ror:8 row_mask:0xf bank_mask:0xc
	v_mov_b32_dpp v83, v103 row_ror:8 row_mask:0xf bank_mask:0xc
	v_mov_b32_dpp v100, v232 row_ror:8 row_mask:0xf bank_mask:0x3
	v_mov_b32_dpp v101, v233 row_ror:8 row_mask:0xf bank_mask:0x3
	v_mov_b32_dpp v102, v234 row_ror:8 row_mask:0xf bank_mask:0x3
	v_mov_b32_dpp v103, v235 row_ror:8 row_mask:0xf bank_mask:0x3
	v_mov_b32 v232, v88
	v_mov_b32 v233, v89
	v_mov_b32 v234, v90
	v_mov_b32 v235, v91
	v_mov_b32_dpp v88, v108 row_ror:8 row_mask:0xf bank_mask:0xc
	v_mov_b32_dpp v89, v109 row_ror:8 row_mask:0xf bank_mask:0xc
	v_mov_b32_dpp v90, v110 row_ror:8 row_mask:0xf bank_mask:0xc
	v_mov_b32_dpp v91, v111 row_ror:8 row_mask:0xf bank_mask:0xc
	v_mov_b32_dpp v108, v232 row_ror:8 row_mask:0xf bank_mask:0x3
	v_mov_b32_dpp v109, v233 row_ror:8 row_mask:0xf bank_mask:0x3
	v_mov_b32_dpp v110, v234 row_ror:8 row_mask:0xf bank_mask:0x3
	v_mov_b32_dpp v111, v235 row_ror:8 row_mask:0xf bank_mask:0x3
	s_mul_i32 s23, s22, 2
	s_add_u32 s23, s23, s25
	buffer_store_dwordx4 v[80:83], v188, s[8:11], s23 offen offset:0 sc1
	buffer_store_dwordx4 v[100:103], v189, s[8:11], s23 offen offset:0 sc1
	buffer_store_dwordx4 v[88:91], v190, s[8:11], s23 offen offset:0 sc1
	buffer_store_dwordx4 v[108:111], v191, s[8:11], s23 offen offset:0 sc1
	v_accvgpr_read_b32 v192, a48
	v_accvgpr_read_b32 v193, a49
	v_accvgpr_read_b32 v194, a50
	v_accvgpr_read_b32 v195, a51
	v_accvgpr_read_b32 v196, a52
	v_accvgpr_read_b32 v197, a53
	v_accvgpr_read_b32 v198, a54
	v_accvgpr_read_b32 v199, a55
	v_accvgpr_read_b32 v200, a56
	v_accvgpr_read_b32 v201, a57
	v_accvgpr_read_b32 v202, a58
	v_accvgpr_read_b32 v203, a59
	v_accvgpr_read_b32 v204, a60
	v_accvgpr_read_b32 v205, a61
	v_accvgpr_read_b32 v206, a62
	v_accvgpr_read_b32 v207, a63
	v_cvt_pk_bf16_f32 v192, v192, v193
	v_cvt_pk_bf16_f32 v193, v194, v195
	v_cvt_pk_bf16_f32 v194, v196, v197
	v_cvt_pk_bf16_f32 v195, v198, v199
	s_nop 0
	v_permlane32_swap_b32 v192, v194
	v_permlane32_swap_b32 v193, v195
	v_cvt_pk_bf16_f32 v200, v200, v201
	v_cvt_pk_bf16_f32 v201, v202, v203
	v_cvt_pk_bf16_f32 v202, v204, v205
	v_cvt_pk_bf16_f32 v203, v206, v207
	s_nop 0
	v_permlane32_swap_b32 v200, v202
	v_permlane32_swap_b32 v201, v203
	s_nop 0
	v_permlane16_swap_b32 v192, v200
	v_permlane16_swap_b32 v193, v201
	v_permlane16_swap_b32 v194, v202
	v_permlane16_swap_b32 v195, v203
	v_accvgpr_read_b32 v212, a112
	v_accvgpr_read_b32 v213, a113
	v_accvgpr_read_b32 v214, a114
	v_accvgpr_read_b32 v215, a115
	v_accvgpr_read_b32 v216, a116
	v_accvgpr_read_b32 v217, a117
	v_accvgpr_read_b32 v218, a118
	v_accvgpr_read_b32 v219, a119
	v_accvgpr_read_b32 v220, a120
	v_accvgpr_read_b32 v221, a121
	v_accvgpr_read_b32 v222, a122
	v_accvgpr_read_b32 v223, a123
	v_accvgpr_read_b32 v224, a124
	v_accvgpr_read_b32 v225, a125
	v_accvgpr_read_b32 v226, a126
	v_accvgpr_read_b32 v227, a127
	v_cvt_pk_bf16_f32 v212, v212, v213
	v_cvt_pk_bf16_f32 v213, v214, v215
	v_cvt_pk_bf16_f32 v214, v216, v217
	v_cvt_pk_bf16_f32 v215, v218, v219
	s_nop 0
	v_permlane32_swap_b32 v212, v214
	v_permlane32_swap_b32 v213, v215
	v_cvt_pk_bf16_f32 v220, v220, v221
	v_cvt_pk_bf16_f32 v221, v222, v223
	v_cvt_pk_bf16_f32 v222, v224, v225
	v_cvt_pk_bf16_f32 v223, v226, v227
	s_nop 0
	v_permlane32_swap_b32 v220, v222
	v_permlane32_swap_b32 v221, v223
	s_nop 0
	v_permlane16_swap_b32 v212, v220
	v_permlane16_swap_b32 v213, v221
	v_permlane16_swap_b32 v214, v222
	v_permlane16_swap_b32 v215, v223
	v_mov_b32 v232, v192
	v_mov_b32 v233, v193
	v_mov_b32 v234, v194
	v_mov_b32 v235, v195
	v_mov_b32_dpp v192, v212 row_ror:8 row_mask:0xf bank_mask:0xc
	v_mov_b32_dpp v193, v213 row_ror:8 row_mask:0xf bank_mask:0xc
	v_mov_b32_dpp v194, v214 row_ror:8 row_mask:0xf bank_mask:0xc
	v_mov_b32_dpp v195, v215 row_ror:8 row_mask:0xf bank_mask:0xc
	v_mov_b32_dpp v212, v232 row_ror:8 row_mask:0xf bank_mask:0x3
	v_mov_b32_dpp v213, v233 row_ror:8 row_mask:0xf bank_mask:0x3
	v_mov_b32_dpp v214, v234 row_ror:8 row_mask:0xf bank_mask:0x3
	v_mov_b32_dpp v215, v235 row_ror:8 row_mask:0xf bank_mask:0x3
	v_mov_b32 v232, v200
	v_mov_b32 v233, v201
	v_mov_b32 v234, v202
	v_mov_b32 v235, v203
	v_mov_b32_dpp v200, v220 row_ror:8 row_mask:0xf bank_mask:0xc
	v_mov_b32_dpp v201, v221 row_ror:8 row_mask:0xf bank_mask:0xc
	v_mov_b32_dpp v202, v222 row_ror:8 row_mask:0xf bank_mask:0xc
	v_mov_b32_dpp v203, v223 row_ror:8 row_mask:0xf bank_mask:0xc
	v_mov_b32_dpp v220, v232 row_ror:8 row_mask:0xf bank_mask:0x3
	v_mov_b32_dpp v221, v233 row_ror:8 row_mask:0xf bank_mask:0x3
	v_mov_b32_dpp v222, v234 row_ror:8 row_mask:0xf bank_mask:0x3
	v_mov_b32_dpp v223, v235 row_ror:8 row_mask:0xf bank_mask:0x3
	s_mul_i32 s23, s22, 3
	s_add_u32 s23, s23, s25
	buffer_store_dwordx4 v[192:195], v188, s[8:11], s23 offen offset:0 sc1
	buffer_store_dwordx4 v[212:215], v189, s[8:11], s23 offen offset:0 sc1
	buffer_store_dwordx4 v[200:203], v190, s[8:11], s23 offen offset:0 sc1
	buffer_store_dwordx4 v[220:223], v191, s[8:11], s23 offen offset:0 sc1
	v_accvgpr_read_b32 v80, a128
	v_accvgpr_read_b32 v81, a129
	v_accvgpr_read_b32 v82, a130
	v_accvgpr_read_b32 v83, a131
	v_accvgpr_read_b32 v84, a132
	v_accvgpr_read_b32 v85, a133
	v_accvgpr_read_b32 v86, a134
	v_accvgpr_read_b32 v87, a135
	v_accvgpr_read_b32 v88, a136
	v_accvgpr_read_b32 v89, a137
	v_accvgpr_read_b32 v90, a138
	v_accvgpr_read_b32 v91, a139
	v_accvgpr_read_b32 v92, a140
	v_accvgpr_read_b32 v93, a141
	v_accvgpr_read_b32 v94, a142
	v_accvgpr_read_b32 v95, a143
	v_cvt_pk_bf16_f32 v80, v80, v81
	v_cvt_pk_bf16_f32 v81, v82, v83
	v_cvt_pk_bf16_f32 v82, v84, v85
	v_cvt_pk_bf16_f32 v83, v86, v87
	s_nop 0
	v_permlane32_swap_b32 v80, v82
	v_permlane32_swap_b32 v81, v83
	v_cvt_pk_bf16_f32 v88, v88, v89
	v_cvt_pk_bf16_f32 v89, v90, v91
	v_cvt_pk_bf16_f32 v90, v92, v93
	v_cvt_pk_bf16_f32 v91, v94, v95
	s_nop 0
	v_permlane32_swap_b32 v88, v90
	v_permlane32_swap_b32 v89, v91
	s_nop 0
	v_permlane16_swap_b32 v80, v88
	v_permlane16_swap_b32 v81, v89
	v_permlane16_swap_b32 v82, v90
	v_permlane16_swap_b32 v83, v91
	v_accvgpr_read_b32 v100, a192
	v_accvgpr_read_b32 v101, a193
	v_accvgpr_read_b32 v102, a194
	v_accvgpr_read_b32 v103, a195
	v_accvgpr_read_b32 v104, a196
	v_accvgpr_read_b32 v105, a197
	v_accvgpr_read_b32 v106, a198
	v_accvgpr_read_b32 v107, a199
	v_accvgpr_read_b32 v108, a200
	v_accvgpr_read_b32 v109, a201
	v_accvgpr_read_b32 v110, a202
	v_accvgpr_read_b32 v111, a203
	v_accvgpr_read_b32 v112, a204
	v_accvgpr_read_b32 v113, a205
	v_accvgpr_read_b32 v114, a206
	v_accvgpr_read_b32 v115, a207
	v_cvt_pk_bf16_f32 v100, v100, v101
	v_cvt_pk_bf16_f32 v101, v102, v103
	v_cvt_pk_bf16_f32 v102, v104, v105
	v_cvt_pk_bf16_f32 v103, v106, v107
	s_nop 0
	v_permlane32_swap_b32 v100, v102
	v_permlane32_swap_b32 v101, v103
	v_cvt_pk_bf16_f32 v108, v108, v109
	v_cvt_pk_bf16_f32 v109, v110, v111
	v_cvt_pk_bf16_f32 v110, v112, v113
	v_cvt_pk_bf16_f32 v111, v114, v115
	s_nop 0
	v_permlane32_swap_b32 v108, v110
	v_permlane32_swap_b32 v109, v111
	s_nop 0
	v_permlane16_swap_b32 v100, v108
	v_permlane16_swap_b32 v101, v109
	v_permlane16_swap_b32 v102, v110
	v_permlane16_swap_b32 v103, v111
	v_mov_b32 v232, v80
	v_mov_b32 v233, v81
	v_mov_b32 v234, v82
	v_mov_b32 v235, v83
	v_mov_b32_dpp v80, v100 row_ror:8 row_mask:0xf bank_mask:0xc
	v_mov_b32_dpp v81, v101 row_ror:8 row_mask:0xf bank_mask:0xc
	v_mov_b32_dpp v82, v102 row_ror:8 row_mask:0xf bank_mask:0xc
	v_mov_b32_dpp v83, v103 row_ror:8 row_mask:0xf bank_mask:0xc
	v_mov_b32_dpp v100, v232 row_ror:8 row_mask:0xf bank_mask:0x3
	v_mov_b32_dpp v101, v233 row_ror:8 row_mask:0xf bank_mask:0x3
	v_mov_b32_dpp v102, v234 row_ror:8 row_mask:0xf bank_mask:0x3
	v_mov_b32_dpp v103, v235 row_ror:8 row_mask:0xf bank_mask:0x3
	v_mov_b32 v232, v88
	v_mov_b32 v233, v89
	v_mov_b32 v234, v90
	v_mov_b32 v235, v91
	v_mov_b32_dpp v88, v108 row_ror:8 row_mask:0xf bank_mask:0xc
	v_mov_b32_dpp v89, v109 row_ror:8 row_mask:0xf bank_mask:0xc
	v_mov_b32_dpp v90, v110 row_ror:8 row_mask:0xf bank_mask:0xc
	v_mov_b32_dpp v91, v111 row_ror:8 row_mask:0xf bank_mask:0xc
	v_mov_b32_dpp v108, v232 row_ror:8 row_mask:0xf bank_mask:0x3
	v_mov_b32_dpp v109, v233 row_ror:8 row_mask:0xf bank_mask:0x3
	v_mov_b32_dpp v110, v234 row_ror:8 row_mask:0xf bank_mask:0x3
	v_mov_b32_dpp v111, v235 row_ror:8 row_mask:0xf bank_mask:0x3
	s_mov_b32 s23, s25
	buffer_store_dwordx4 v[80:83], v188, s[8:11], s23 offen offset:128 sc1
	buffer_store_dwordx4 v[100:103], v189, s[8:11], s23 offen offset:128 sc1
	buffer_store_dwordx4 v[88:91], v190, s[8:11], s23 offen offset:128 sc1
	buffer_store_dwordx4 v[108:111], v191, s[8:11], s23 offen offset:128 sc1
	v_accvgpr_read_b32 v192, a144
	v_accvgpr_read_b32 v193, a145
	v_accvgpr_read_b32 v194, a146
	v_accvgpr_read_b32 v195, a147
	v_accvgpr_read_b32 v196, a148
	v_accvgpr_read_b32 v197, a149
	v_accvgpr_read_b32 v198, a150
	v_accvgpr_read_b32 v199, a151
	v_accvgpr_read_b32 v200, a152
	v_accvgpr_read_b32 v201, a153
	v_accvgpr_read_b32 v202, a154
	v_accvgpr_read_b32 v203, a155
	v_accvgpr_read_b32 v204, a156
	v_accvgpr_read_b32 v205, a157
	v_accvgpr_read_b32 v206, a158
	v_accvgpr_read_b32 v207, a159
	v_cvt_pk_bf16_f32 v192, v192, v193
	v_cvt_pk_bf16_f32 v193, v194, v195
	v_cvt_pk_bf16_f32 v194, v196, v197
	v_cvt_pk_bf16_f32 v195, v198, v199
	s_nop 0
	v_permlane32_swap_b32 v192, v194
	v_permlane32_swap_b32 v193, v195
	v_cvt_pk_bf16_f32 v200, v200, v201
	v_cvt_pk_bf16_f32 v201, v202, v203
	v_cvt_pk_bf16_f32 v202, v204, v205
	v_cvt_pk_bf16_f32 v203, v206, v207
	s_nop 0
	v_permlane32_swap_b32 v200, v202
	v_permlane32_swap_b32 v201, v203
	s_nop 0
	v_permlane16_swap_b32 v192, v200
	v_permlane16_swap_b32 v193, v201
	v_permlane16_swap_b32 v194, v202
	v_permlane16_swap_b32 v195, v203
	v_accvgpr_read_b32 v212, a208
	v_accvgpr_read_b32 v213, a209
	v_accvgpr_read_b32 v214, a210
	v_accvgpr_read_b32 v215, a211
	v_accvgpr_read_b32 v216, a212
	v_accvgpr_read_b32 v217, a213
	v_accvgpr_read_b32 v218, a214
	v_accvgpr_read_b32 v219, a215
	v_accvgpr_read_b32 v220, a216
	v_accvgpr_read_b32 v221, a217
	v_accvgpr_read_b32 v222, a218
	v_accvgpr_read_b32 v223, a219
	v_accvgpr_read_b32 v224, a220
	v_accvgpr_read_b32 v225, a221
	v_accvgpr_read_b32 v226, a222
	v_accvgpr_read_b32 v227, a223
	v_cvt_pk_bf16_f32 v212, v212, v213
	v_cvt_pk_bf16_f32 v213, v214, v215
	v_cvt_pk_bf16_f32 v214, v216, v217
	v_cvt_pk_bf16_f32 v215, v218, v219
	s_nop 0
	v_permlane32_swap_b32 v212, v214
	v_permlane32_swap_b32 v213, v215
	v_cvt_pk_bf16_f32 v220, v220, v221
	v_cvt_pk_bf16_f32 v221, v222, v223
	v_cvt_pk_bf16_f32 v222, v224, v225
	v_cvt_pk_bf16_f32 v223, v226, v227
	s_nop 0
	v_permlane32_swap_b32 v220, v222
	v_permlane32_swap_b32 v221, v223
	s_nop 0
	v_permlane16_swap_b32 v212, v220
	v_permlane16_swap_b32 v213, v221
	v_permlane16_swap_b32 v214, v222
	v_permlane16_swap_b32 v215, v223
	v_mov_b32 v232, v192
	v_mov_b32 v233, v193
	v_mov_b32 v234, v194
	v_mov_b32 v235, v195
	v_mov_b32_dpp v192, v212 row_ror:8 row_mask:0xf bank_mask:0xc
	v_mov_b32_dpp v193, v213 row_ror:8 row_mask:0xf bank_mask:0xc
	v_mov_b32_dpp v194, v214 row_ror:8 row_mask:0xf bank_mask:0xc
	v_mov_b32_dpp v195, v215 row_ror:8 row_mask:0xf bank_mask:0xc
	v_mov_b32_dpp v212, v232 row_ror:8 row_mask:0xf bank_mask:0x3
	v_mov_b32_dpp v213, v233 row_ror:8 row_mask:0xf bank_mask:0x3
	v_mov_b32_dpp v214, v234 row_ror:8 row_mask:0xf bank_mask:0x3
	v_mov_b32_dpp v215, v235 row_ror:8 row_mask:0xf bank_mask:0x3
	v_mov_b32 v232, v200
	v_mov_b32 v233, v201
	v_mov_b32 v234, v202
	v_mov_b32 v235, v203
	v_mov_b32_dpp v200, v220 row_ror:8 row_mask:0xf bank_mask:0xc
	v_mov_b32_dpp v201, v221 row_ror:8 row_mask:0xf bank_mask:0xc
	v_mov_b32_dpp v202, v222 row_ror:8 row_mask:0xf bank_mask:0xc
	v_mov_b32_dpp v203, v223 row_ror:8 row_mask:0xf bank_mask:0xc
	v_mov_b32_dpp v220, v232 row_ror:8 row_mask:0xf bank_mask:0x3
	v_mov_b32_dpp v221, v233 row_ror:8 row_mask:0xf bank_mask:0x3
	v_mov_b32_dpp v222, v234 row_ror:8 row_mask:0xf bank_mask:0x3
	v_mov_b32_dpp v223, v235 row_ror:8 row_mask:0xf bank_mask:0x3
	s_mul_i32 s23, s22, 1
	s_add_u32 s23, s23, s25
	buffer_store_dwordx4 v[192:195], v188, s[8:11], s23 offen offset:128 sc1
	buffer_store_dwordx4 v[212:215], v189, s[8:11], s23 offen offset:128 sc1
	buffer_store_dwordx4 v[200:203], v190, s[8:11], s23 offen offset:128 sc1
	buffer_store_dwordx4 v[220:223], v191, s[8:11], s23 offen offset:128 sc1
	v_accvgpr_read_b32 v80, a160
	v_accvgpr_read_b32 v81, a161
	v_accvgpr_read_b32 v82, a162
	v_accvgpr_read_b32 v83, a163
	v_accvgpr_read_b32 v84, a164
	v_accvgpr_read_b32 v85, a165
	v_accvgpr_read_b32 v86, a166
	v_accvgpr_read_b32 v87, a167
	v_accvgpr_read_b32 v88, a168
	v_accvgpr_read_b32 v89, a169
	v_accvgpr_read_b32 v90, a170
	v_accvgpr_read_b32 v91, a171
	v_accvgpr_read_b32 v92, a172
	v_accvgpr_read_b32 v93, a173
	v_accvgpr_read_b32 v94, a174
	v_accvgpr_read_b32 v95, a175
	v_cvt_pk_bf16_f32 v80, v80, v81
	v_cvt_pk_bf16_f32 v81, v82, v83
	v_cvt_pk_bf16_f32 v82, v84, v85
	v_cvt_pk_bf16_f32 v83, v86, v87
	s_nop 0
	v_permlane32_swap_b32 v80, v82
	v_permlane32_swap_b32 v81, v83
	v_cvt_pk_bf16_f32 v88, v88, v89
	v_cvt_pk_bf16_f32 v89, v90, v91
	v_cvt_pk_bf16_f32 v90, v92, v93
	v_cvt_pk_bf16_f32 v91, v94, v95
	s_nop 0
	v_permlane32_swap_b32 v88, v90
	v_permlane32_swap_b32 v89, v91
	s_nop 0
	v_permlane16_swap_b32 v80, v88
	v_permlane16_swap_b32 v81, v89
	v_permlane16_swap_b32 v82, v90
	v_permlane16_swap_b32 v83, v91
	v_accvgpr_read_b32 v100, a224
	v_accvgpr_read_b32 v101, a225
	v_accvgpr_read_b32 v102, a226
	v_accvgpr_read_b32 v103, a227
	v_accvgpr_read_b32 v104, a228
	v_accvgpr_read_b32 v105, a229
	v_accvgpr_read_b32 v106, a230
	v_accvgpr_read_b32 v107, a231
	v_accvgpr_read_b32 v108, a232
	v_accvgpr_read_b32 v109, a233
	v_accvgpr_read_b32 v110, a234
	v_accvgpr_read_b32 v111, a235
	v_accvgpr_read_b32 v112, a236
	v_accvgpr_read_b32 v113, a237
	v_accvgpr_read_b32 v114, a238
	v_accvgpr_read_b32 v115, a239
	v_cvt_pk_bf16_f32 v100, v100, v101
	v_cvt_pk_bf16_f32 v101, v102, v103
	v_cvt_pk_bf16_f32 v102, v104, v105
	v_cvt_pk_bf16_f32 v103, v106, v107
	s_nop 0
	v_permlane32_swap_b32 v100, v102
	v_permlane32_swap_b32 v101, v103
	v_cvt_pk_bf16_f32 v108, v108, v109
	v_cvt_pk_bf16_f32 v109, v110, v111
	v_cvt_pk_bf16_f32 v110, v112, v113
	v_cvt_pk_bf16_f32 v111, v114, v115
	s_nop 0
	v_permlane32_swap_b32 v108, v110
	v_permlane32_swap_b32 v109, v111
	s_nop 0
	v_permlane16_swap_b32 v100, v108
	v_permlane16_swap_b32 v101, v109
	v_permlane16_swap_b32 v102, v110
	v_permlane16_swap_b32 v103, v111
	v_mov_b32 v232, v80
	v_mov_b32 v233, v81
	v_mov_b32 v234, v82
	v_mov_b32 v235, v83
	v_mov_b32_dpp v80, v100 row_ror:8 row_mask:0xf bank_mask:0xc
	v_mov_b32_dpp v81, v101 row_ror:8 row_mask:0xf bank_mask:0xc
	v_mov_b32_dpp v82, v102 row_ror:8 row_mask:0xf bank_mask:0xc
	v_mov_b32_dpp v83, v103 row_ror:8 row_mask:0xf bank_mask:0xc
	v_mov_b32_dpp v100, v232 row_ror:8 row_mask:0xf bank_mask:0x3
	v_mov_b32_dpp v101, v233 row_ror:8 row_mask:0xf bank_mask:0x3
	v_mov_b32_dpp v102, v234 row_ror:8 row_mask:0xf bank_mask:0x3
	v_mov_b32_dpp v103, v235 row_ror:8 row_mask:0xf bank_mask:0x3
	v_mov_b32 v232, v88
	v_mov_b32 v233, v89
	v_mov_b32 v234, v90
	v_mov_b32 v235, v91
	v_mov_b32_dpp v88, v108 row_ror:8 row_mask:0xf bank_mask:0xc
	v_mov_b32_dpp v89, v109 row_ror:8 row_mask:0xf bank_mask:0xc
	v_mov_b32_dpp v90, v110 row_ror:8 row_mask:0xf bank_mask:0xc
	v_mov_b32_dpp v91, v111 row_ror:8 row_mask:0xf bank_mask:0xc
	v_mov_b32_dpp v108, v232 row_ror:8 row_mask:0xf bank_mask:0x3
	v_mov_b32_dpp v109, v233 row_ror:8 row_mask:0xf bank_mask:0x3
	v_mov_b32_dpp v110, v234 row_ror:8 row_mask:0xf bank_mask:0x3
	v_mov_b32_dpp v111, v235 row_ror:8 row_mask:0xf bank_mask:0x3
	s_mul_i32 s23, s22, 2
	s_add_u32 s23, s23, s25
	buffer_store_dwordx4 v[80:83], v188, s[8:11], s23 offen offset:128 sc1
	buffer_store_dwordx4 v[100:103], v189, s[8:11], s23 offen offset:128 sc1
	buffer_store_dwordx4 v[88:91], v190, s[8:11], s23 offen offset:128 sc1
	buffer_store_dwordx4 v[108:111], v191, s[8:11], s23 offen offset:128 sc1
	v_accvgpr_read_b32 v192, a176
	v_accvgpr_read_b32 v193, a177
	v_accvgpr_read_b32 v194, a178
	v_accvgpr_read_b32 v195, a179
	v_accvgpr_read_b32 v196, a180
	v_accvgpr_read_b32 v197, a181
	v_accvgpr_read_b32 v198, a182
	v_accvgpr_read_b32 v199, a183
	v_accvgpr_read_b32 v200, a184
	v_accvgpr_read_b32 v201, a185
	v_accvgpr_read_b32 v202, a186
	v_accvgpr_read_b32 v203, a187
	v_accvgpr_read_b32 v204, a188
	v_accvgpr_read_b32 v205, a189
	v_accvgpr_read_b32 v206, a190
	v_accvgpr_read_b32 v207, a191
	v_cvt_pk_bf16_f32 v192, v192, v193
	v_cvt_pk_bf16_f32 v193, v194, v195
	v_cvt_pk_bf16_f32 v194, v196, v197
	v_cvt_pk_bf16_f32 v195, v198, v199
	s_nop 0
	v_permlane32_swap_b32 v192, v194
	v_permlane32_swap_b32 v193, v195
	v_cvt_pk_bf16_f32 v200, v200, v201
	v_cvt_pk_bf16_f32 v201, v202, v203
	v_cvt_pk_bf16_f32 v202, v204, v205
	v_cvt_pk_bf16_f32 v203, v206, v207
	s_nop 0
	v_permlane32_swap_b32 v200, v202
	v_permlane32_swap_b32 v201, v203
	s_nop 0
	v_permlane16_swap_b32 v192, v200
	v_permlane16_swap_b32 v193, v201
	v_permlane16_swap_b32 v194, v202
	v_permlane16_swap_b32 v195, v203
	v_accvgpr_read_b32 v212, a240
	v_accvgpr_read_b32 v213, a241
	v_accvgpr_read_b32 v214, a242
	v_accvgpr_read_b32 v215, a243
	v_accvgpr_read_b32 v216, a244
	v_accvgpr_read_b32 v217, a245
	v_accvgpr_read_b32 v218, a246
	v_accvgpr_read_b32 v219, a247
	v_accvgpr_read_b32 v220, a248
	v_accvgpr_read_b32 v221, a249
	v_accvgpr_read_b32 v222, a250
	v_accvgpr_read_b32 v223, a251
	v_accvgpr_read_b32 v224, a252
	v_accvgpr_read_b32 v225, a253
	v_accvgpr_read_b32 v226, a254
	v_accvgpr_read_b32 v227, a255
	v_cvt_pk_bf16_f32 v212, v212, v213
	v_cvt_pk_bf16_f32 v213, v214, v215
	v_cvt_pk_bf16_f32 v214, v216, v217
	v_cvt_pk_bf16_f32 v215, v218, v219
	s_nop 0
	v_permlane32_swap_b32 v212, v214
	v_permlane32_swap_b32 v213, v215
	v_cvt_pk_bf16_f32 v220, v220, v221
	v_cvt_pk_bf16_f32 v221, v222, v223
	v_cvt_pk_bf16_f32 v222, v224, v225
	v_cvt_pk_bf16_f32 v223, v226, v227
	s_nop 0
	v_permlane32_swap_b32 v220, v222
	v_permlane32_swap_b32 v221, v223
	s_nop 0
	v_permlane16_swap_b32 v212, v220
	v_permlane16_swap_b32 v213, v221
	v_permlane16_swap_b32 v214, v222
	v_permlane16_swap_b32 v215, v223
	v_mov_b32 v232, v192
	v_mov_b32 v233, v193
	v_mov_b32 v234, v194
	v_mov_b32 v235, v195
	v_mov_b32_dpp v192, v212 row_ror:8 row_mask:0xf bank_mask:0xc
	v_mov_b32_dpp v193, v213 row_ror:8 row_mask:0xf bank_mask:0xc
	v_mov_b32_dpp v194, v214 row_ror:8 row_mask:0xf bank_mask:0xc
	v_mov_b32_dpp v195, v215 row_ror:8 row_mask:0xf bank_mask:0xc
	v_mov_b32_dpp v212, v232 row_ror:8 row_mask:0xf bank_mask:0x3
	v_mov_b32_dpp v213, v233 row_ror:8 row_mask:0xf bank_mask:0x3
	v_mov_b32_dpp v214, v234 row_ror:8 row_mask:0xf bank_mask:0x3
	v_mov_b32_dpp v215, v235 row_ror:8 row_mask:0xf bank_mask:0x3
	v_mov_b32 v232, v200
	v_mov_b32 v233, v201
	v_mov_b32 v234, v202
	v_mov_b32 v235, v203
	v_mov_b32_dpp v200, v220 row_ror:8 row_mask:0xf bank_mask:0xc
	v_mov_b32_dpp v201, v221 row_ror:8 row_mask:0xf bank_mask:0xc
	v_mov_b32_dpp v202, v222 row_ror:8 row_mask:0xf bank_mask:0xc
	v_mov_b32_dpp v203, v223 row_ror:8 row_mask:0xf bank_mask:0xc
	v_mov_b32_dpp v220, v232 row_ror:8 row_mask:0xf bank_mask:0x3
	v_mov_b32_dpp v221, v233 row_ror:8 row_mask:0xf bank_mask:0x3
	v_mov_b32_dpp v222, v234 row_ror:8 row_mask:0xf bank_mask:0x3
	v_mov_b32_dpp v223, v235 row_ror:8 row_mask:0xf bank_mask:0x3
	s_mul_i32 s23, s22, 3
	s_add_u32 s23, s23, s25
	buffer_store_dwordx4 v[192:195], v188, s[8:11], s23 offen offset:128 sc1
	buffer_store_dwordx4 v[212:215], v189, s[8:11], s23 offen offset:128 sc1
	buffer_store_dwordx4 v[200:203], v190, s[8:11], s23 offen offset:128 sc1
	buffer_store_dwordx4 v[220:223], v191, s[8:11], s23 offen offset:128 sc1
	s_branch main_kernel_g1_done
main_kernel_g1_h:
	s_mov_b32 s26, 9216
	s_mul_i32 s25, s28, 9216
	s_add_u32 s25, s25, 54525952
	s_add_u32 s25, s25, s17
	s_lshr_b32 s21, s4, 1
	s_and_b32 s22, s4, 1
	s_mul_i32 s21, s21, 128
	s_mul_i32 s22, s22, 256
	v_and_b32 v13, 15, v0
	v_add_u32 v13, s21, v13
	v_mul_lo_u32 v13, v13, s26
	v_bfe_u32 v14, v0, 4, 1
	v_lshl_add_u32 v13, v14, 5, v13
	v_lshrrev_b32 v14, 5, v0
	v_lshl_add_u32 v13, v14, 4, v13
	v_add_u32 v15, s22, v13
	s_lshl_b32 s22, s26, 4
	v_add_u32 v157, s22, v15
	s_lshl_b32 s22, s26, 5
	s_and_b32 s21, s4, 1
	s_mul_i32 s21, s21, 128
	s_add_u32 s21, s21, s27
	s_lshl_b32 s21, s21, 1
	v_lshrrev_b32 v14, 5, v0
	v_lshlrev_b32 v14, 3, v14
	v_mov_b32 v156, 0xc0135761
	s_mov_b32 s41, 0xbdd2d3e8
	s_lshr_b32 s23, s4, 1
	s_mul_i32 s23, s23, 128
	v_and_b32 v13, 7, v0
	v_add_u32 v13, s23, v13
	v_mul_lo_u32 v13, v13, s26
	v_bfe_u32 v189, v0, 3, 1
	v_lshl_add_u32 v13, v189, 6, v13
	v_bfe_u32 v189, v0, 4, 1
	v_lshl_add_u32 v13, v189, 5, v13
	v_lshrrev_b32 v189, 5, v0
	v_lshl_add_u32 v13, v189, 4, v13
	s_and_b32 s23, s4, 1
	s_mul_i32 s23, s23, 256
	v_add_u32 v188, s23, v13
	s_lshl_b32 s23, s26, 3
	v_add_u32 v189, s23, v188
	v_add_u32 v190, s23, v189
	v_add_u32 v191, s23, v190
	buffer_load_dwordx2 v[136:137], v14, s[32:35], s21 offen offset:0
	buffer_load_dwordx2 v[138:139], v14, s[32:35], s21 offen offset:16
	buffer_load_dwordx2 v[140:141], v14, s[32:35], s21 offen offset:32
	buffer_load_dwordx2 v[142:143], v14, s[32:35], s21 offen offset:48
	s_waitcnt vmcnt(3)
	v_lshlrev_b32 v120, 16, v136
	v_and_b32 v121, 0xffff0000, v136
	v_lshlrev_b32 v122, 16, v137
	v_and_b32 v123, 0xffff0000, v137
	s_waitcnt vmcnt(2)
	v_lshlrev_b32 v124, 16, v138
	v_and_b32 v125, 0xffff0000, v138
	v_lshlrev_b32 v126, 16, v139
	v_and_b32 v127, 0xffff0000, v139
	s_waitcnt vmcnt(1)
	v_lshlrev_b32 v128, 16, v140
	v_and_b32 v129, 0xffff0000, v140
	v_lshlrev_b32 v130, 16, v141
	v_and_b32 v131, 0xffff0000, v141
	s_waitcnt vmcnt(0)
	v_lshlrev_b32 v132, 16, v142
	v_and_b32 v133, 0xffff0000, v142
	v_lshlrev_b32 v134, 16, v143
	v_and_b32 v135, 0xffff0000, v143
	buffer_load_dwordx2 v[180:181], v14, s[32:35], s21 offen offset:64
	buffer_load_dwordx2 v[182:183], v14, s[32:35], s21 offen offset:80
	buffer_load_dwordx2 v[184:185], v14, s[32:35], s21 offen offset:96
	buffer_load_dwordx2 v[186:187], v14, s[32:35], s21 offen offset:112
	s_waitcnt vmcnt(3)
	v_lshlrev_b32 v164, 16, v180
	v_and_b32 v165, 0xffff0000, v180
	v_lshlrev_b32 v166, 16, v181
	v_and_b32 v167, 0xffff0000, v181
	s_waitcnt vmcnt(2)
	v_lshlrev_b32 v168, 16, v182
	v_and_b32 v169, 0xffff0000, v182
	v_lshlrev_b32 v170, 16, v183
	v_and_b32 v171, 0xffff0000, v183
	s_waitcnt vmcnt(1)
	v_lshlrev_b32 v172, 16, v184
	v_and_b32 v173, 0xffff0000, v184
	v_lshlrev_b32 v174, 16, v185
	v_and_b32 v175, 0xffff0000, v185
	s_waitcnt vmcnt(0)
	v_lshlrev_b32 v176, 16, v186
	v_and_b32 v177, 0xffff0000, v186
	v_lshlrev_b32 v178, 16, v187
	v_and_b32 v179, 0xffff0000, v187
	v_accvgpr_read_b32 v80, a0
	v_accvgpr_read_b32 v81, a1
	v_accvgpr_read_b32 v82, a2
	v_accvgpr_read_b32 v83, a3
	v_accvgpr_read_b32 v84, a4
	v_accvgpr_read_b32 v85, a5
	v_accvgpr_read_b32 v86, a6
	v_accvgpr_read_b32 v87, a7
	v_accvgpr_read_b32 v88, a8
	v_accvgpr_read_b32 v89, a9
	v_accvgpr_read_b32 v90, a10
	v_accvgpr_read_b32 v91, a11
	v_accvgpr_read_b32 v92, a12
	v_accvgpr_read_b32 v93, a13
	v_accvgpr_read_b32 v94, a14
	v_accvgpr_read_b32 v95, a15
	v_add_f32 v80, v80, v120
	v_add_f32 v81, v81, v121
	v_add_f32 v82, v82, v122
	v_add_f32 v83, v83, v123
	v_mul_f32 v152, v80, v80
	v_mul_f32 v153, v81, v81
	v_mul_f32 v154, v82, v82
	v_mul_f32 v155, v83, v83
	v_fma_f32 v152, v152, s41, v156
	v_fma_f32 v153, v153, s41, v156
	v_fma_f32 v154, v154, s41, v156
	v_fma_f32 v155, v155, s41, v156
	v_mul_f32 v152, v152, v80
	v_mul_f32 v153, v153, v81
	v_mul_f32 v154, v154, v82
	v_mul_f32 v155, v155, v83
	v_exp_f32 v152, v152
	v_exp_f32 v153, v153
	v_exp_f32 v154, v154
	v_exp_f32 v155, v155
	v_add_f32 v152, 1.0, v152
	v_add_f32 v153, 1.0, v153
	v_add_f32 v154, 1.0, v154
	v_add_f32 v155, 1.0, v155
	v_rcp_f32 v152, v152
	v_rcp_f32 v153, v153
	v_rcp_f32 v154, v154
	v_rcp_f32 v155, v155
	v_mul_f32 v80, v80, v152
	v_mul_f32 v81, v81, v153
	v_mul_f32 v82, v82, v154
	v_mul_f32 v83, v83, v155
	v_add_f32 v84, v84, v124
	v_add_f32 v85, v85, v125
	v_add_f32 v86, v86, v126
	v_add_f32 v87, v87, v127
	v_mul_f32 v152, v84, v84
	v_mul_f32 v153, v85, v85
	v_mul_f32 v154, v86, v86
	v_mul_f32 v155, v87, v87
	v_fma_f32 v152, v152, s41, v156
	v_fma_f32 v153, v153, s41, v156
	v_fma_f32 v154, v154, s41, v156
	v_fma_f32 v155, v155, s41, v156
	v_mul_f32 v152, v152, v84
	v_mul_f32 v153, v153, v85
	v_mul_f32 v154, v154, v86
	v_mul_f32 v155, v155, v87
	v_exp_f32 v152, v152
	v_exp_f32 v153, v153
	v_exp_f32 v154, v154
	v_exp_f32 v155, v155
	v_add_f32 v152, 1.0, v152
	v_add_f32 v153, 1.0, v153
	v_add_f32 v154, 1.0, v154
	v_add_f32 v155, 1.0, v155
	v_rcp_f32 v152, v152
	v_rcp_f32 v153, v153
	v_rcp_f32 v154, v154
	v_rcp_f32 v155, v155
	v_mul_f32 v84, v84, v152
	v_mul_f32 v85, v85, v153
	v_mul_f32 v86, v86, v154
	v_mul_f32 v87, v87, v155
	v_add_f32 v88, v88, v128
	v_add_f32 v89, v89, v129
	v_add_f32 v90, v90, v130
	v_add_f32 v91, v91, v131
	v_mul_f32 v152, v88, v88
	v_mul_f32 v153, v89, v89
	v_mul_f32 v154, v90, v90
	v_mul_f32 v155, v91, v91
	v_fma_f32 v152, v152, s41, v156
	v_fma_f32 v153, v153, s41, v156
	v_fma_f32 v154, v154, s41, v156
	v_fma_f32 v155, v155, s41, v156
	v_mul_f32 v152, v152, v88
	v_mul_f32 v153, v153, v89
	v_mul_f32 v154, v154, v90
	v_mul_f32 v155, v155, v91
	v_exp_f32 v152, v152
	v_exp_f32 v153, v153
	v_exp_f32 v154, v154
	v_exp_f32 v155, v155
	v_add_f32 v152, 1.0, v152
	v_add_f32 v153, 1.0, v153
	v_add_f32 v154, 1.0, v154
	v_add_f32 v155, 1.0, v155
	v_rcp_f32 v152, v152
	v_rcp_f32 v153, v153
	v_rcp_f32 v154, v154
	v_rcp_f32 v155, v155
	v_mul_f32 v88, v88, v152
	v_mul_f32 v89, v89, v153
	v_mul_f32 v90, v90, v154
	v_mul_f32 v91, v91, v155
	v_add_f32 v92, v92, v132
	v_add_f32 v93, v93, v133
	v_add_f32 v94, v94, v134
	v_add_f32 v95, v95, v135
	v_mul_f32 v152, v92, v92
	v_mul_f32 v153, v93, v93
	v_mul_f32 v154, v94, v94
	v_mul_f32 v155, v95, v95
	v_fma_f32 v152, v152, s41, v156
	v_fma_f32 v153, v153, s41, v156
	v_fma_f32 v154, v154, s41, v156
	v_fma_f32 v155, v155, s41, v156
	v_mul_f32 v152, v152, v92
	v_mul_f32 v153, v153, v93
	v_mul_f32 v154, v154, v94
	v_mul_f32 v155, v155, v95
	v_exp_f32 v152, v152
	v_exp_f32 v153, v153
	v_exp_f32 v154, v154
	v_exp_f32 v155, v155
	v_add_f32 v152, 1.0, v152
	v_add_f32 v153, 1.0, v153
	v_add_f32 v154, 1.0, v154
	v_add_f32 v155, 1.0, v155
	v_rcp_f32 v152, v152
	v_rcp_f32 v153, v153
	v_rcp_f32 v154, v154
	v_rcp_f32 v155, v155
	v_mul_f32 v92, v92, v152
	v_mul_f32 v93, v93, v153
	v_mul_f32 v94, v94, v154
	v_mul_f32 v95, v95, v155
	v_cvt_pk_bf16_f32 v80, v80, v81
	v_cvt_pk_bf16_f32 v81, v82, v83
	v_cvt_pk_bf16_f32 v82, v84, v85
	v_cvt_pk_bf16_f32 v83, v86, v87
	s_nop 0
	v_permlane32_swap_b32 v80, v82
	v_permlane32_swap_b32 v81, v83
	v_cvt_pk_bf16_f32 v88, v88, v89
	v_cvt_pk_bf16_f32 v89, v90, v91
	v_cvt_pk_bf16_f32 v90, v92, v93
	v_cvt_pk_bf16_f32 v91, v94, v95
	s_nop 0
	v_permlane32_swap_b32 v88, v90
	v_permlane32_swap_b32 v89, v91
	s_nop 0
	v_permlane16_swap_b32 v80, v88
	v_permlane16_swap_b32 v81, v89
	v_permlane16_swap_b32 v82, v90
	v_permlane16_swap_b32 v83, v91
	v_accvgpr_read_b32 v100, a64
	v_accvgpr_read_b32 v101, a65
	v_accvgpr_read_b32 v102, a66
	v_accvgpr_read_b32 v103, a67
	v_accvgpr_read_b32 v104, a68
	v_accvgpr_read_b32 v105, a69
	v_accvgpr_read_b32 v106, a70
	v_accvgpr_read_b32 v107, a71
	v_accvgpr_read_b32 v108, a72
	v_accvgpr_read_b32 v109, a73
	v_accvgpr_read_b32 v110, a74
	v_accvgpr_read_b32 v111, a75
	v_accvgpr_read_b32 v112, a76
	v_accvgpr_read_b32 v113, a77
	v_accvgpr_read_b32 v114, a78
	v_accvgpr_read_b32 v115, a79
	v_add_f32 v100, v100, v164
	v_add_f32 v101, v101, v165
	v_add_f32 v102, v102, v166
	v_add_f32 v103, v103, v167
	v_mul_f32 v152, v100, v100
	v_mul_f32 v153, v101, v101
	v_mul_f32 v154, v102, v102
	v_mul_f32 v155, v103, v103
	v_fma_f32 v152, v152, s41, v156
	v_fma_f32 v153, v153, s41, v156
	v_fma_f32 v154, v154, s41, v156
	v_fma_f32 v155, v155, s41, v156
	v_mul_f32 v152, v152, v100
	v_mul_f32 v153, v153, v101
	v_mul_f32 v154, v154, v102
	v_mul_f32 v155, v155, v103
	v_exp_f32 v152, v152
	v_exp_f32 v153, v153
	v_exp_f32 v154, v154
	v_exp_f32 v155, v155
	v_add_f32 v152, 1.0, v152
	v_add_f32 v153, 1.0, v153
	v_add_f32 v154, 1.0, v154
	v_add_f32 v155, 1.0, v155
	v_rcp_f32 v152, v152
	v_rcp_f32 v153, v153
	v_rcp_f32 v154, v154
	v_rcp_f32 v155, v155
	v_mul_f32 v100, v100, v152
	v_mul_f32 v101, v101, v153
	v_mul_f32 v102, v102, v154
	v_mul_f32 v103, v103, v155
	v_add_f32 v104, v104, v168
	v_add_f32 v105, v105, v169
	v_add_f32 v106, v106, v170
	v_add_f32 v107, v107, v171
	v_mul_f32 v152, v104, v104
	v_mul_f32 v153, v105, v105
	v_mul_f32 v154, v106, v106
	v_mul_f32 v155, v107, v107
	v_fma_f32 v152, v152, s41, v156
	v_fma_f32 v153, v153, s41, v156
	v_fma_f32 v154, v154, s41, v156
	v_fma_f32 v155, v155, s41, v156
	v_mul_f32 v152, v152, v104
	v_mul_f32 v153, v153, v105
	v_mul_f32 v154, v154, v106
	v_mul_f32 v155, v155, v107
	v_exp_f32 v152, v152
	v_exp_f32 v153, v153
	v_exp_f32 v154, v154
	v_exp_f32 v155, v155
	v_add_f32 v152, 1.0, v152
	v_add_f32 v153, 1.0, v153
	v_add_f32 v154, 1.0, v154
	v_add_f32 v155, 1.0, v155
	v_rcp_f32 v152, v152
	v_rcp_f32 v153, v153
	v_rcp_f32 v154, v154
	v_rcp_f32 v155, v155
	v_mul_f32 v104, v104, v152
	v_mul_f32 v105, v105, v153
	v_mul_f32 v106, v106, v154
	v_mul_f32 v107, v107, v155
	v_add_f32 v108, v108, v172
	v_add_f32 v109, v109, v173
	v_add_f32 v110, v110, v174
	v_add_f32 v111, v111, v175
	v_mul_f32 v152, v108, v108
	v_mul_f32 v153, v109, v109
	v_mul_f32 v154, v110, v110
	v_mul_f32 v155, v111, v111
	v_fma_f32 v152, v152, s41, v156
	v_fma_f32 v153, v153, s41, v156
	v_fma_f32 v154, v154, s41, v156
	v_fma_f32 v155, v155, s41, v156
	v_mul_f32 v152, v152, v108
	v_mul_f32 v153, v153, v109
	v_mul_f32 v154, v154, v110
	v_mul_f32 v155, v155, v111
	v_exp_f32 v152, v152
	v_exp_f32 v153, v153
	v_exp_f32 v154, v154
	v_exp_f32 v155, v155
	v_add_f32 v152, 1.0, v152
	v_add_f32 v153, 1.0, v153
	v_add_f32 v154, 1.0, v154
	v_add_f32 v155, 1.0, v155
	v_rcp_f32 v152, v152
	v_rcp_f32 v153, v153
	v_rcp_f32 v154, v154
	v_rcp_f32 v155, v155
	v_mul_f32 v108, v108, v152
	v_mul_f32 v109, v109, v153
	v_mul_f32 v110, v110, v154
	v_mul_f32 v111, v111, v155
	v_add_f32 v112, v112, v176
	v_add_f32 v113, v113, v177
	v_add_f32 v114, v114, v178
	v_add_f32 v115, v115, v179
	v_mul_f32 v152, v112, v112
	v_mul_f32 v153, v113, v113
	v_mul_f32 v154, v114, v114
	v_mul_f32 v155, v115, v115
	v_fma_f32 v152, v152, s41, v156
	v_fma_f32 v153, v153, s41, v156
	v_fma_f32 v154, v154, s41, v156
	v_fma_f32 v155, v155, s41, v156
	v_mul_f32 v152, v152, v112
	v_mul_f32 v153, v153, v113
	v_mul_f32 v154, v154, v114
	v_mul_f32 v155, v155, v115
	v_exp_f32 v152, v152
	v_exp_f32 v153, v153
	v_exp_f32 v154, v154
	v_exp_f32 v155, v155
	v_add_f32 v152, 1.0, v152
	v_add_f32 v153, 1.0, v153
	v_add_f32 v154, 1.0, v154
	v_add_f32 v155, 1.0, v155
	v_rcp_f32 v152, v152
	v_rcp_f32 v153, v153
	v_rcp_f32 v154, v154
	v_rcp_f32 v155, v155
	v_mul_f32 v112, v112, v152
	v_mul_f32 v113, v113, v153
	v_mul_f32 v114, v114, v154
	v_mul_f32 v115, v115, v155
	v_cvt_pk_bf16_f32 v100, v100, v101
	v_cvt_pk_bf16_f32 v101, v102, v103
	v_cvt_pk_bf16_f32 v102, v104, v105
	v_cvt_pk_bf16_f32 v103, v106, v107
	s_nop 0
	v_permlane32_swap_b32 v100, v102
	v_permlane32_swap_b32 v101, v103
	v_cvt_pk_bf16_f32 v108, v108, v109
	v_cvt_pk_bf16_f32 v109, v110, v111
	v_cvt_pk_bf16_f32 v110, v112, v113
	v_cvt_pk_bf16_f32 v111, v114, v115
	s_nop 0
	v_permlane32_swap_b32 v108, v110
	v_permlane32_swap_b32 v109, v111
	s_nop 0
	v_permlane16_swap_b32 v100, v108
	v_permlane16_swap_b32 v101, v109
	v_permlane16_swap_b32 v102, v110
	v_permlane16_swap_b32 v103, v111
	v_mov_b32 v232, v80
	v_mov_b32 v233, v81
	v_mov_b32 v234, v82
	v_mov_b32 v235, v83
	v_mov_b32_dpp v80, v100 row_ror:8 row_mask:0xf bank_mask:0xc
	v_mov_b32_dpp v81, v101 row_ror:8 row_mask:0xf bank_mask:0xc
	v_mov_b32_dpp v82, v102 row_ror:8 row_mask:0xf bank_mask:0xc
	v_mov_b32_dpp v83, v103 row_ror:8 row_mask:0xf bank_mask:0xc
	v_mov_b32_dpp v100, v232 row_ror:8 row_mask:0xf bank_mask:0x3
	v_mov_b32_dpp v101, v233 row_ror:8 row_mask:0xf bank_mask:0x3
	v_mov_b32_dpp v102, v234 row_ror:8 row_mask:0xf bank_mask:0x3
	v_mov_b32_dpp v103, v235 row_ror:8 row_mask:0xf bank_mask:0x3
	v_mov_b32 v232, v88
	v_mov_b32 v233, v89
	v_mov_b32 v234, v90
	v_mov_b32 v235, v91
	v_mov_b32_dpp v88, v108 row_ror:8 row_mask:0xf bank_mask:0xc
	v_mov_b32_dpp v89, v109 row_ror:8 row_mask:0xf bank_mask:0xc
	v_mov_b32_dpp v90, v110 row_ror:8 row_mask:0xf bank_mask:0xc
	v_mov_b32_dpp v91, v111 row_ror:8 row_mask:0xf bank_mask:0xc
	v_mov_b32_dpp v108, v232 row_ror:8 row_mask:0xf bank_mask:0x3
	v_mov_b32_dpp v109, v233 row_ror:8 row_mask:0xf bank_mask:0x3
	v_mov_b32_dpp v110, v234 row_ror:8 row_mask:0xf bank_mask:0x3
	v_mov_b32_dpp v111, v235 row_ror:8 row_mask:0xf bank_mask:0x3
	s_mov_b32 s23, s25
	buffer_store_dwordx4 v[80:83], v188, s[8:11], s23 offen offset:0 sc1
	buffer_store_dwordx4 v[100:103], v189, s[8:11], s23 offen offset:0 sc1
	buffer_store_dwordx4 v[88:91], v190, s[8:11], s23 offen offset:0 sc1
	buffer_store_dwordx4 v[108:111], v191, s[8:11], s23 offen offset:0 sc1
	v_accvgpr_read_b32 v192, a16
	v_accvgpr_read_b32 v193, a17
	v_accvgpr_read_b32 v194, a18
	v_accvgpr_read_b32 v195, a19
	v_accvgpr_read_b32 v196, a20
	v_accvgpr_read_b32 v197, a21
	v_accvgpr_read_b32 v198, a22
	v_accvgpr_read_b32 v199, a23
	v_accvgpr_read_b32 v200, a24
	v_accvgpr_read_b32 v201, a25
	v_accvgpr_read_b32 v202, a26
	v_accvgpr_read_b32 v203, a27
	v_accvgpr_read_b32 v204, a28
	v_accvgpr_read_b32 v205, a29
	v_accvgpr_read_b32 v206, a30
	v_accvgpr_read_b32 v207, a31
	v_add_f32 v192, v192, v120
	v_add_f32 v193, v193, v121
	v_add_f32 v194, v194, v122
	v_add_f32 v195, v195, v123
	v_mul_f32 v152, v192, v192
	v_mul_f32 v153, v193, v193
	v_mul_f32 v154, v194, v194
	v_mul_f32 v155, v195, v195
	v_fma_f32 v152, v152, s41, v156
	v_fma_f32 v153, v153, s41, v156
	v_fma_f32 v154, v154, s41, v156
	v_fma_f32 v155, v155, s41, v156
	v_mul_f32 v152, v152, v192
	v_mul_f32 v153, v153, v193
	v_mul_f32 v154, v154, v194
	v_mul_f32 v155, v155, v195
	v_exp_f32 v152, v152
	v_exp_f32 v153, v153
	v_exp_f32 v154, v154
	v_exp_f32 v155, v155
	v_add_f32 v152, 1.0, v152
	v_add_f32 v153, 1.0, v153
	v_add_f32 v154, 1.0, v154
	v_add_f32 v155, 1.0, v155
	v_rcp_f32 v152, v152
	v_rcp_f32 v153, v153
	v_rcp_f32 v154, v154
	v_rcp_f32 v155, v155
	v_mul_f32 v192, v192, v152
	v_mul_f32 v193, v193, v153
	v_mul_f32 v194, v194, v154
	v_mul_f32 v195, v195, v155
	v_add_f32 v196, v196, v124
	v_add_f32 v197, v197, v125
	v_add_f32 v198, v198, v126
	v_add_f32 v199, v199, v127
	v_mul_f32 v152, v196, v196
	v_mul_f32 v153, v197, v197
	v_mul_f32 v154, v198, v198
	v_mul_f32 v155, v199, v199
	v_fma_f32 v152, v152, s41, v156
	v_fma_f32 v153, v153, s41, v156
	v_fma_f32 v154, v154, s41, v156
	v_fma_f32 v155, v155, s41, v156
	v_mul_f32 v152, v152, v196
	v_mul_f32 v153, v153, v197
	v_mul_f32 v154, v154, v198
	v_mul_f32 v155, v155, v199
	v_exp_f32 v152, v152
	v_exp_f32 v153, v153
	v_exp_f32 v154, v154
	v_exp_f32 v155, v155
	v_add_f32 v152, 1.0, v152
	v_add_f32 v153, 1.0, v153
	v_add_f32 v154, 1.0, v154
	v_add_f32 v155, 1.0, v155
	v_rcp_f32 v152, v152
	v_rcp_f32 v153, v153
	v_rcp_f32 v154, v154
	v_rcp_f32 v155, v155
	v_mul_f32 v196, v196, v152
	v_mul_f32 v197, v197, v153
	v_mul_f32 v198, v198, v154
	v_mul_f32 v199, v199, v155
	v_add_f32 v200, v200, v128
	v_add_f32 v201, v201, v129
	v_add_f32 v202, v202, v130
	v_add_f32 v203, v203, v131
	v_mul_f32 v152, v200, v200
	v_mul_f32 v153, v201, v201
	v_mul_f32 v154, v202, v202
	v_mul_f32 v155, v203, v203
	v_fma_f32 v152, v152, s41, v156
	v_fma_f32 v153, v153, s41, v156
	v_fma_f32 v154, v154, s41, v156
	v_fma_f32 v155, v155, s41, v156
	v_mul_f32 v152, v152, v200
	v_mul_f32 v153, v153, v201
	v_mul_f32 v154, v154, v202
	v_mul_f32 v155, v155, v203
	v_exp_f32 v152, v152
	v_exp_f32 v153, v153
	v_exp_f32 v154, v154
	v_exp_f32 v155, v155
	v_add_f32 v152, 1.0, v152
	v_add_f32 v153, 1.0, v153
	v_add_f32 v154, 1.0, v154
	v_add_f32 v155, 1.0, v155
	v_rcp_f32 v152, v152
	v_rcp_f32 v153, v153
	v_rcp_f32 v154, v154
	v_rcp_f32 v155, v155
	v_mul_f32 v200, v200, v152
	v_mul_f32 v201, v201, v153
	v_mul_f32 v202, v202, v154
	v_mul_f32 v203, v203, v155
	v_add_f32 v204, v204, v132
	v_add_f32 v205, v205, v133
	v_add_f32 v206, v206, v134
	v_add_f32 v207, v207, v135
	v_mul_f32 v152, v204, v204
	v_mul_f32 v153, v205, v205
	v_mul_f32 v154, v206, v206
	v_mul_f32 v155, v207, v207
	v_fma_f32 v152, v152, s41, v156
	v_fma_f32 v153, v153, s41, v156
	v_fma_f32 v154, v154, s41, v156
	v_fma_f32 v155, v155, s41, v156
	v_mul_f32 v152, v152, v204
	v_mul_f32 v153, v153, v205
	v_mul_f32 v154, v154, v206
	v_mul_f32 v155, v155, v207
	v_exp_f32 v152, v152
	v_exp_f32 v153, v153
	v_exp_f32 v154, v154
	v_exp_f32 v155, v155
	v_add_f32 v152, 1.0, v152
	v_add_f32 v153, 1.0, v153
	v_add_f32 v154, 1.0, v154
	v_add_f32 v155, 1.0, v155
	v_rcp_f32 v152, v152
	v_rcp_f32 v153, v153
	v_rcp_f32 v154, v154
	v_rcp_f32 v155, v155
	v_mul_f32 v204, v204, v152
	v_mul_f32 v205, v205, v153
	v_mul_f32 v206, v206, v154
	v_mul_f32 v207, v207, v155
	v_cvt_pk_bf16_f32 v192, v192, v193
	v_cvt_pk_bf16_f32 v193, v194, v195
	v_cvt_pk_bf16_f32 v194, v196, v197
	v_cvt_pk_bf16_f32 v195, v198, v199
	s_nop 0
	v_permlane32_swap_b32 v192, v194
	v_permlane32_swap_b32 v193, v195
	v_cvt_pk_bf16_f32 v200, v200, v201
	v_cvt_pk_bf16_f32 v201, v202, v203
	v_cvt_pk_bf16_f32 v202, v204, v205
	v_cvt_pk_bf16_f32 v203, v206, v207
	s_nop 0
	v_permlane32_swap_b32 v200, v202
	v_permlane32_swap_b32 v201, v203
	s_nop 0
	v_permlane16_swap_b32 v192, v200
	v_permlane16_swap_b32 v193, v201
	v_permlane16_swap_b32 v194, v202
	v_permlane16_swap_b32 v195, v203
	v_accvgpr_read_b32 v212, a80
	v_accvgpr_read_b32 v213, a81
	v_accvgpr_read_b32 v214, a82
	v_accvgpr_read_b32 v215, a83
	v_accvgpr_read_b32 v216, a84
	v_accvgpr_read_b32 v217, a85
	v_accvgpr_read_b32 v218, a86
	v_accvgpr_read_b32 v219, a87
	v_accvgpr_read_b32 v220, a88
	v_accvgpr_read_b32 v221, a89
	v_accvgpr_read_b32 v222, a90
	v_accvgpr_read_b32 v223, a91
	v_accvgpr_read_b32 v224, a92
	v_accvgpr_read_b32 v225, a93
	v_accvgpr_read_b32 v226, a94
	v_accvgpr_read_b32 v227, a95
	v_add_f32 v212, v212, v164
	v_add_f32 v213, v213, v165
	v_add_f32 v214, v214, v166
	v_add_f32 v215, v215, v167
	v_mul_f32 v152, v212, v212
	v_mul_f32 v153, v213, v213
	v_mul_f32 v154, v214, v214
	v_mul_f32 v155, v215, v215
	v_fma_f32 v152, v152, s41, v156
	v_fma_f32 v153, v153, s41, v156
	v_fma_f32 v154, v154, s41, v156
	v_fma_f32 v155, v155, s41, v156
	v_mul_f32 v152, v152, v212
	v_mul_f32 v153, v153, v213
	v_mul_f32 v154, v154, v214
	v_mul_f32 v155, v155, v215
	v_exp_f32 v152, v152
	v_exp_f32 v153, v153
	v_exp_f32 v154, v154
	v_exp_f32 v155, v155
	v_add_f32 v152, 1.0, v152
	v_add_f32 v153, 1.0, v153
	v_add_f32 v154, 1.0, v154
	v_add_f32 v155, 1.0, v155
	v_rcp_f32 v152, v152
	v_rcp_f32 v153, v153
	v_rcp_f32 v154, v154
	v_rcp_f32 v155, v155
	v_mul_f32 v212, v212, v152
	v_mul_f32 v213, v213, v153
	v_mul_f32 v214, v214, v154
	v_mul_f32 v215, v215, v155
	v_add_f32 v216, v216, v168
	v_add_f32 v217, v217, v169
	v_add_f32 v218, v218, v170
	v_add_f32 v219, v219, v171
	v_mul_f32 v152, v216, v216
	v_mul_f32 v153, v217, v217
	v_mul_f32 v154, v218, v218
	v_mul_f32 v155, v219, v219
	v_fma_f32 v152, v152, s41, v156
	v_fma_f32 v153, v153, s41, v156
	v_fma_f32 v154, v154, s41, v156
	v_fma_f32 v155, v155, s41, v156
	v_mul_f32 v152, v152, v216
	v_mul_f32 v153, v153, v217
	v_mul_f32 v154, v154, v218
	v_mul_f32 v155, v155, v219
	v_exp_f32 v152, v152
	v_exp_f32 v153, v153
	v_exp_f32 v154, v154
	v_exp_f32 v155, v155
	v_add_f32 v152, 1.0, v152
	v_add_f32 v153, 1.0, v153
	v_add_f32 v154, 1.0, v154
	v_add_f32 v155, 1.0, v155
	v_rcp_f32 v152, v152
	v_rcp_f32 v153, v153
	v_rcp_f32 v154, v154
	v_rcp_f32 v155, v155
	v_mul_f32 v216, v216, v152
	v_mul_f32 v217, v217, v153
	v_mul_f32 v218, v218, v154
	v_mul_f32 v219, v219, v155
	v_add_f32 v220, v220, v172
	v_add_f32 v221, v221, v173
	v_add_f32 v222, v222, v174
	v_add_f32 v223, v223, v175
	v_mul_f32 v152, v220, v220
	v_mul_f32 v153, v221, v221
	v_mul_f32 v154, v222, v222
	v_mul_f32 v155, v223, v223
	v_fma_f32 v152, v152, s41, v156
	v_fma_f32 v153, v153, s41, v156
	v_fma_f32 v154, v154, s41, v156
	v_fma_f32 v155, v155, s41, v156
	v_mul_f32 v152, v152, v220
	v_mul_f32 v153, v153, v221
	v_mul_f32 v154, v154, v222
	v_mul_f32 v155, v155, v223
	v_exp_f32 v152, v152
	v_exp_f32 v153, v153
	v_exp_f32 v154, v154
	v_exp_f32 v155, v155
	v_add_f32 v152, 1.0, v152
	v_add_f32 v153, 1.0, v153
	v_add_f32 v154, 1.0, v154
	v_add_f32 v155, 1.0, v155
	v_rcp_f32 v152, v152
	v_rcp_f32 v153, v153
	v_rcp_f32 v154, v154
	v_rcp_f32 v155, v155
	v_mul_f32 v220, v220, v152
	v_mul_f32 v221, v221, v153
	v_mul_f32 v222, v222, v154
	v_mul_f32 v223, v223, v155
	v_add_f32 v224, v224, v176
	v_add_f32 v225, v225, v177
	v_add_f32 v226, v226, v178
	v_add_f32 v227, v227, v179
	v_mul_f32 v152, v224, v224
	v_mul_f32 v153, v225, v225
	v_mul_f32 v154, v226, v226
	v_mul_f32 v155, v227, v227
	v_fma_f32 v152, v152, s41, v156
	v_fma_f32 v153, v153, s41, v156
	v_fma_f32 v154, v154, s41, v156
	v_fma_f32 v155, v155, s41, v156
	v_mul_f32 v152, v152, v224
	v_mul_f32 v153, v153, v225
	v_mul_f32 v154, v154, v226
	v_mul_f32 v155, v155, v227
	v_exp_f32 v152, v152
	v_exp_f32 v153, v153
	v_exp_f32 v154, v154
	v_exp_f32 v155, v155
	v_add_f32 v152, 1.0, v152
	v_add_f32 v153, 1.0, v153
	v_add_f32 v154, 1.0, v154
	v_add_f32 v155, 1.0, v155
	v_rcp_f32 v152, v152
	v_rcp_f32 v153, v153
	v_rcp_f32 v154, v154
	v_rcp_f32 v155, v155
	v_mul_f32 v224, v224, v152
	v_mul_f32 v225, v225, v153
	v_mul_f32 v226, v226, v154
	v_mul_f32 v227, v227, v155
	v_cvt_pk_bf16_f32 v212, v212, v213
	v_cvt_pk_bf16_f32 v213, v214, v215
	v_cvt_pk_bf16_f32 v214, v216, v217
	v_cvt_pk_bf16_f32 v215, v218, v219
	s_nop 0
	v_permlane32_swap_b32 v212, v214
	v_permlane32_swap_b32 v213, v215
	v_cvt_pk_bf16_f32 v220, v220, v221
	v_cvt_pk_bf16_f32 v221, v222, v223
	v_cvt_pk_bf16_f32 v222, v224, v225
	v_cvt_pk_bf16_f32 v223, v226, v227
	s_nop 0
	v_permlane32_swap_b32 v220, v222
	v_permlane32_swap_b32 v221, v223
	s_nop 0
	v_permlane16_swap_b32 v212, v220
	v_permlane16_swap_b32 v213, v221
	v_permlane16_swap_b32 v214, v222
	v_permlane16_swap_b32 v215, v223
	v_mov_b32 v232, v192
	v_mov_b32 v233, v193
	v_mov_b32 v234, v194
	v_mov_b32 v235, v195
	v_mov_b32_dpp v192, v212 row_ror:8 row_mask:0xf bank_mask:0xc
	v_mov_b32_dpp v193, v213 row_ror:8 row_mask:0xf bank_mask:0xc
	v_mov_b32_dpp v194, v214 row_ror:8 row_mask:0xf bank_mask:0xc
	v_mov_b32_dpp v195, v215 row_ror:8 row_mask:0xf bank_mask:0xc
	v_mov_b32_dpp v212, v232 row_ror:8 row_mask:0xf bank_mask:0x3
	v_mov_b32_dpp v213, v233 row_ror:8 row_mask:0xf bank_mask:0x3
	v_mov_b32_dpp v214, v234 row_ror:8 row_mask:0xf bank_mask:0x3
	v_mov_b32_dpp v215, v235 row_ror:8 row_mask:0xf bank_mask:0x3
	v_mov_b32 v232, v200
	v_mov_b32 v233, v201
	v_mov_b32 v234, v202
	v_mov_b32 v235, v203
	v_mov_b32_dpp v200, v220 row_ror:8 row_mask:0xf bank_mask:0xc
	v_mov_b32_dpp v201, v221 row_ror:8 row_mask:0xf bank_mask:0xc
	v_mov_b32_dpp v202, v222 row_ror:8 row_mask:0xf bank_mask:0xc
	v_mov_b32_dpp v203, v223 row_ror:8 row_mask:0xf bank_mask:0xc
	v_mov_b32_dpp v220, v232 row_ror:8 row_mask:0xf bank_mask:0x3
	v_mov_b32_dpp v221, v233 row_ror:8 row_mask:0xf bank_mask:0x3
	v_mov_b32_dpp v222, v234 row_ror:8 row_mask:0xf bank_mask:0x3
	v_mov_b32_dpp v223, v235 row_ror:8 row_mask:0xf bank_mask:0x3
	s_mul_i32 s23, s22, 1
	s_add_u32 s23, s23, s25
	buffer_store_dwordx4 v[192:195], v188, s[8:11], s23 offen offset:0 sc1
	buffer_store_dwordx4 v[212:215], v189, s[8:11], s23 offen offset:0 sc1
	buffer_store_dwordx4 v[200:203], v190, s[8:11], s23 offen offset:0 sc1
	buffer_store_dwordx4 v[220:223], v191, s[8:11], s23 offen offset:0 sc1
	v_accvgpr_read_b32 v80, a32
	v_accvgpr_read_b32 v81, a33
	v_accvgpr_read_b32 v82, a34
	v_accvgpr_read_b32 v83, a35
	v_accvgpr_read_b32 v84, a36
	v_accvgpr_read_b32 v85, a37
	v_accvgpr_read_b32 v86, a38
	v_accvgpr_read_b32 v87, a39
	v_accvgpr_read_b32 v88, a40
	v_accvgpr_read_b32 v89, a41
	v_accvgpr_read_b32 v90, a42
	v_accvgpr_read_b32 v91, a43
	v_accvgpr_read_b32 v92, a44
	v_accvgpr_read_b32 v93, a45
	v_accvgpr_read_b32 v94, a46
	v_accvgpr_read_b32 v95, a47
	v_add_f32 v80, v80, v120
	v_add_f32 v81, v81, v121
	v_add_f32 v82, v82, v122
	v_add_f32 v83, v83, v123
	v_mul_f32 v152, v80, v80
	v_mul_f32 v153, v81, v81
	v_mul_f32 v154, v82, v82
	v_mul_f32 v155, v83, v83
	v_fma_f32 v152, v152, s41, v156
	v_fma_f32 v153, v153, s41, v156
	v_fma_f32 v154, v154, s41, v156
	v_fma_f32 v155, v155, s41, v156
	v_mul_f32 v152, v152, v80
	v_mul_f32 v153, v153, v81
	v_mul_f32 v154, v154, v82
	v_mul_f32 v155, v155, v83
	v_exp_f32 v152, v152
	v_exp_f32 v153, v153
	v_exp_f32 v154, v154
	v_exp_f32 v155, v155
	v_add_f32 v152, 1.0, v152
	v_add_f32 v153, 1.0, v153
	v_add_f32 v154, 1.0, v154
	v_add_f32 v155, 1.0, v155
	v_rcp_f32 v152, v152
	v_rcp_f32 v153, v153
	v_rcp_f32 v154, v154
	v_rcp_f32 v155, v155
	v_mul_f32 v80, v80, v152
	v_mul_f32 v81, v81, v153
	v_mul_f32 v82, v82, v154
	v_mul_f32 v83, v83, v155
	v_add_f32 v84, v84, v124
	v_add_f32 v85, v85, v125
	v_add_f32 v86, v86, v126
	v_add_f32 v87, v87, v127
	v_mul_f32 v152, v84, v84
	v_mul_f32 v153, v85, v85
	v_mul_f32 v154, v86, v86
	v_mul_f32 v155, v87, v87
	v_fma_f32 v152, v152, s41, v156
	v_fma_f32 v153, v153, s41, v156
	v_fma_f32 v154, v154, s41, v156
	v_fma_f32 v155, v155, s41, v156
	v_mul_f32 v152, v152, v84
	v_mul_f32 v153, v153, v85
	v_mul_f32 v154, v154, v86
	v_mul_f32 v155, v155, v87
	v_exp_f32 v152, v152
	v_exp_f32 v153, v153
	v_exp_f32 v154, v154
	v_exp_f32 v155, v155
	v_add_f32 v152, 1.0, v152
	v_add_f32 v153, 1.0, v153
	v_add_f32 v154, 1.0, v154
	v_add_f32 v155, 1.0, v155
	v_rcp_f32 v152, v152
	v_rcp_f32 v153, v153
	v_rcp_f32 v154, v154
	v_rcp_f32 v155, v155
	v_mul_f32 v84, v84, v152
	v_mul_f32 v85, v85, v153
	v_mul_f32 v86, v86, v154
	v_mul_f32 v87, v87, v155
	v_add_f32 v88, v88, v128
	v_add_f32 v89, v89, v129
	v_add_f32 v90, v90, v130
	v_add_f32 v91, v91, v131
	v_mul_f32 v152, v88, v88
	v_mul_f32 v153, v89, v89
	v_mul_f32 v154, v90, v90
	v_mul_f32 v155, v91, v91
	v_fma_f32 v152, v152, s41, v156
	v_fma_f32 v153, v153, s41, v156
	v_fma_f32 v154, v154, s41, v156
	v_fma_f32 v155, v155, s41, v156
	v_mul_f32 v152, v152, v88
	v_mul_f32 v153, v153, v89
	v_mul_f32 v154, v154, v90
	v_mul_f32 v155, v155, v91
	v_exp_f32 v152, v152
	v_exp_f32 v153, v153
	v_exp_f32 v154, v154
	v_exp_f32 v155, v155
	v_add_f32 v152, 1.0, v152
	v_add_f32 v153, 1.0, v153
	v_add_f32 v154, 1.0, v154
	v_add_f32 v155, 1.0, v155
	v_rcp_f32 v152, v152
	v_rcp_f32 v153, v153
	v_rcp_f32 v154, v154
	v_rcp_f32 v155, v155
	v_mul_f32 v88, v88, v152
	v_mul_f32 v89, v89, v153
	v_mul_f32 v90, v90, v154
	v_mul_f32 v91, v91, v155
	v_add_f32 v92, v92, v132
	v_add_f32 v93, v93, v133
	v_add_f32 v94, v94, v134
	v_add_f32 v95, v95, v135
	v_mul_f32 v152, v92, v92
	v_mul_f32 v153, v93, v93
	v_mul_f32 v154, v94, v94
	v_mul_f32 v155, v95, v95
	v_fma_f32 v152, v152, s41, v156
	v_fma_f32 v153, v153, s41, v156
	v_fma_f32 v154, v154, s41, v156
	v_fma_f32 v155, v155, s41, v156
	v_mul_f32 v152, v152, v92
	v_mul_f32 v153, v153, v93
	v_mul_f32 v154, v154, v94
	v_mul_f32 v155, v155, v95
	v_exp_f32 v152, v152
	v_exp_f32 v153, v153
	v_exp_f32 v154, v154
	v_exp_f32 v155, v155
	v_add_f32 v152, 1.0, v152
	v_add_f32 v153, 1.0, v153
	v_add_f32 v154, 1.0, v154
	v_add_f32 v155, 1.0, v155
	v_rcp_f32 v152, v152
	v_rcp_f32 v153, v153
	v_rcp_f32 v154, v154
	v_rcp_f32 v155, v155
	v_mul_f32 v92, v92, v152
	v_mul_f32 v93, v93, v153
	v_mul_f32 v94, v94, v154
	v_mul_f32 v95, v95, v155
	v_cvt_pk_bf16_f32 v80, v80, v81
	v_cvt_pk_bf16_f32 v81, v82, v83
	v_cvt_pk_bf16_f32 v82, v84, v85
	v_cvt_pk_bf16_f32 v83, v86, v87
	s_nop 0
	v_permlane32_swap_b32 v80, v82
	v_permlane32_swap_b32 v81, v83
	v_cvt_pk_bf16_f32 v88, v88, v89
	v_cvt_pk_bf16_f32 v89, v90, v91
	v_cvt_pk_bf16_f32 v90, v92, v93
	v_cvt_pk_bf16_f32 v91, v94, v95
	s_nop 0
	v_permlane32_swap_b32 v88, v90
	v_permlane32_swap_b32 v89, v91
	s_nop 0
	v_permlane16_swap_b32 v80, v88
	v_permlane16_swap_b32 v81, v89
	v_permlane16_swap_b32 v82, v90
	v_permlane16_swap_b32 v83, v91
	v_accvgpr_read_b32 v100, a96
	v_accvgpr_read_b32 v101, a97
	v_accvgpr_read_b32 v102, a98
	v_accvgpr_read_b32 v103, a99
	v_accvgpr_read_b32 v104, a100
	v_accvgpr_read_b32 v105, a101
	v_accvgpr_read_b32 v106, a102
	v_accvgpr_read_b32 v107, a103
	v_accvgpr_read_b32 v108, a104
	v_accvgpr_read_b32 v109, a105
	v_accvgpr_read_b32 v110, a106
	v_accvgpr_read_b32 v111, a107
	v_accvgpr_read_b32 v112, a108
	v_accvgpr_read_b32 v113, a109
	v_accvgpr_read_b32 v114, a110
	v_accvgpr_read_b32 v115, a111
	v_add_f32 v100, v100, v164
	v_add_f32 v101, v101, v165
	v_add_f32 v102, v102, v166
	v_add_f32 v103, v103, v167
	v_mul_f32 v152, v100, v100
	v_mul_f32 v153, v101, v101
	v_mul_f32 v154, v102, v102
	v_mul_f32 v155, v103, v103
	v_fma_f32 v152, v152, s41, v156
	v_fma_f32 v153, v153, s41, v156
	v_fma_f32 v154, v154, s41, v156
	v_fma_f32 v155, v155, s41, v156
	v_mul_f32 v152, v152, v100
	v_mul_f32 v153, v153, v101
	v_mul_f32 v154, v154, v102
	v_mul_f32 v155, v155, v103
	v_exp_f32 v152, v152
	v_exp_f32 v153, v153
	v_exp_f32 v154, v154
	v_exp_f32 v155, v155
	v_add_f32 v152, 1.0, v152
	v_add_f32 v153, 1.0, v153
	v_add_f32 v154, 1.0, v154
	v_add_f32 v155, 1.0, v155
	v_rcp_f32 v152, v152
	v_rcp_f32 v153, v153
	v_rcp_f32 v154, v154
	v_rcp_f32 v155, v155
	v_mul_f32 v100, v100, v152
	v_mul_f32 v101, v101, v153
	v_mul_f32 v102, v102, v154
	v_mul_f32 v103, v103, v155
	v_add_f32 v104, v104, v168
	v_add_f32 v105, v105, v169
	v_add_f32 v106, v106, v170
	v_add_f32 v107, v107, v171
	v_mul_f32 v152, v104, v104
	v_mul_f32 v153, v105, v105
	v_mul_f32 v154, v106, v106
	v_mul_f32 v155, v107, v107
	v_fma_f32 v152, v152, s41, v156
	v_fma_f32 v153, v153, s41, v156
	v_fma_f32 v154, v154, s41, v156
	v_fma_f32 v155, v155, s41, v156
	v_mul_f32 v152, v152, v104
	v_mul_f32 v153, v153, v105
	v_mul_f32 v154, v154, v106
	v_mul_f32 v155, v155, v107
	v_exp_f32 v152, v152
	v_exp_f32 v153, v153
	v_exp_f32 v154, v154
	v_exp_f32 v155, v155
	v_add_f32 v152, 1.0, v152
	v_add_f32 v153, 1.0, v153
	v_add_f32 v154, 1.0, v154
	v_add_f32 v155, 1.0, v155
	v_rcp_f32 v152, v152
	v_rcp_f32 v153, v153
	v_rcp_f32 v154, v154
	v_rcp_f32 v155, v155
	v_mul_f32 v104, v104, v152
	v_mul_f32 v105, v105, v153
	v_mul_f32 v106, v106, v154
	v_mul_f32 v107, v107, v155
	v_add_f32 v108, v108, v172
	v_add_f32 v109, v109, v173
	v_add_f32 v110, v110, v174
	v_add_f32 v111, v111, v175
	v_mul_f32 v152, v108, v108
	v_mul_f32 v153, v109, v109
	v_mul_f32 v154, v110, v110
	v_mul_f32 v155, v111, v111
	v_fma_f32 v152, v152, s41, v156
	v_fma_f32 v153, v153, s41, v156
	v_fma_f32 v154, v154, s41, v156
	v_fma_f32 v155, v155, s41, v156
	v_mul_f32 v152, v152, v108
	v_mul_f32 v153, v153, v109
	v_mul_f32 v154, v154, v110
	v_mul_f32 v155, v155, v111
	v_exp_f32 v152, v152
	v_exp_f32 v153, v153
	v_exp_f32 v154, v154
	v_exp_f32 v155, v155
	v_add_f32 v152, 1.0, v152
	v_add_f32 v153, 1.0, v153
	v_add_f32 v154, 1.0, v154
	v_add_f32 v155, 1.0, v155
	v_rcp_f32 v152, v152
	v_rcp_f32 v153, v153
	v_rcp_f32 v154, v154
	v_rcp_f32 v155, v155
	v_mul_f32 v108, v108, v152
	v_mul_f32 v109, v109, v153
	v_mul_f32 v110, v110, v154
	v_mul_f32 v111, v111, v155
	v_add_f32 v112, v112, v176
	v_add_f32 v113, v113, v177
	v_add_f32 v114, v114, v178
	v_add_f32 v115, v115, v179
	v_mul_f32 v152, v112, v112
	v_mul_f32 v153, v113, v113
	v_mul_f32 v154, v114, v114
	v_mul_f32 v155, v115, v115
	v_fma_f32 v152, v152, s41, v156
	v_fma_f32 v153, v153, s41, v156
	v_fma_f32 v154, v154, s41, v156
	v_fma_f32 v155, v155, s41, v156
	v_mul_f32 v152, v152, v112
	v_mul_f32 v153, v153, v113
	v_mul_f32 v154, v154, v114
	v_mul_f32 v155, v155, v115
	v_exp_f32 v152, v152
	v_exp_f32 v153, v153
	v_exp_f32 v154, v154
	v_exp_f32 v155, v155
	v_add_f32 v152, 1.0, v152
	v_add_f32 v153, 1.0, v153
	v_add_f32 v154, 1.0, v154
	v_add_f32 v155, 1.0, v155
	v_rcp_f32 v152, v152
	v_rcp_f32 v153, v153
	v_rcp_f32 v154, v154
	v_rcp_f32 v155, v155
	v_mul_f32 v112, v112, v152
	v_mul_f32 v113, v113, v153
	v_mul_f32 v114, v114, v154
	v_mul_f32 v115, v115, v155
	v_cvt_pk_bf16_f32 v100, v100, v101
	v_cvt_pk_bf16_f32 v101, v102, v103
	v_cvt_pk_bf16_f32 v102, v104, v105
	v_cvt_pk_bf16_f32 v103, v106, v107
	s_nop 0
	v_permlane32_swap_b32 v100, v102
	v_permlane32_swap_b32 v101, v103
	v_cvt_pk_bf16_f32 v108, v108, v109
	v_cvt_pk_bf16_f32 v109, v110, v111
	v_cvt_pk_bf16_f32 v110, v112, v113
	v_cvt_pk_bf16_f32 v111, v114, v115
	s_nop 0
	v_permlane32_swap_b32 v108, v110
	v_permlane32_swap_b32 v109, v111
	s_nop 0
	v_permlane16_swap_b32 v100, v108
	v_permlane16_swap_b32 v101, v109
	v_permlane16_swap_b32 v102, v110
	v_permlane16_swap_b32 v103, v111
	v_mov_b32 v232, v80
	v_mov_b32 v233, v81
	v_mov_b32 v234, v82
	v_mov_b32 v235, v83
	v_mov_b32_dpp v80, v100 row_ror:8 row_mask:0xf bank_mask:0xc
	v_mov_b32_dpp v81, v101 row_ror:8 row_mask:0xf bank_mask:0xc
	v_mov_b32_dpp v82, v102 row_ror:8 row_mask:0xf bank_mask:0xc
	v_mov_b32_dpp v83, v103 row_ror:8 row_mask:0xf bank_mask:0xc
	v_mov_b32_dpp v100, v232 row_ror:8 row_mask:0xf bank_mask:0x3
	v_mov_b32_dpp v101, v233 row_ror:8 row_mask:0xf bank_mask:0x3
	v_mov_b32_dpp v102, v234 row_ror:8 row_mask:0xf bank_mask:0x3
	v_mov_b32_dpp v103, v235 row_ror:8 row_mask:0xf bank_mask:0x3
	v_mov_b32 v232, v88
	v_mov_b32 v233, v89
	v_mov_b32 v234, v90
	v_mov_b32 v235, v91
	v_mov_b32_dpp v88, v108 row_ror:8 row_mask:0xf bank_mask:0xc
	v_mov_b32_dpp v89, v109 row_ror:8 row_mask:0xf bank_mask:0xc
	v_mov_b32_dpp v90, v110 row_ror:8 row_mask:0xf bank_mask:0xc
	v_mov_b32_dpp v91, v111 row_ror:8 row_mask:0xf bank_mask:0xc
	v_mov_b32_dpp v108, v232 row_ror:8 row_mask:0xf bank_mask:0x3
	v_mov_b32_dpp v109, v233 row_ror:8 row_mask:0xf bank_mask:0x3
	v_mov_b32_dpp v110, v234 row_ror:8 row_mask:0xf bank_mask:0x3
	v_mov_b32_dpp v111, v235 row_ror:8 row_mask:0xf bank_mask:0x3
	s_mul_i32 s23, s22, 2
	s_add_u32 s23, s23, s25
	buffer_store_dwordx4 v[80:83], v188, s[8:11], s23 offen offset:0 sc1
	buffer_store_dwordx4 v[100:103], v189, s[8:11], s23 offen offset:0 sc1
	buffer_store_dwordx4 v[88:91], v190, s[8:11], s23 offen offset:0 sc1
	buffer_store_dwordx4 v[108:111], v191, s[8:11], s23 offen offset:0 sc1
	v_accvgpr_read_b32 v192, a48
	v_accvgpr_read_b32 v193, a49
	v_accvgpr_read_b32 v194, a50
	v_accvgpr_read_b32 v195, a51
	v_accvgpr_read_b32 v196, a52
	v_accvgpr_read_b32 v197, a53
	v_accvgpr_read_b32 v198, a54
	v_accvgpr_read_b32 v199, a55
	v_accvgpr_read_b32 v200, a56
	v_accvgpr_read_b32 v201, a57
	v_accvgpr_read_b32 v202, a58
	v_accvgpr_read_b32 v203, a59
	v_accvgpr_read_b32 v204, a60
	v_accvgpr_read_b32 v205, a61
	v_accvgpr_read_b32 v206, a62
	v_accvgpr_read_b32 v207, a63
	v_add_f32 v192, v192, v120
	v_add_f32 v193, v193, v121
	v_add_f32 v194, v194, v122
	v_add_f32 v195, v195, v123
	v_mul_f32 v152, v192, v192
	v_mul_f32 v153, v193, v193
	v_mul_f32 v154, v194, v194
	v_mul_f32 v155, v195, v195
	v_fma_f32 v152, v152, s41, v156
	v_fma_f32 v153, v153, s41, v156
	v_fma_f32 v154, v154, s41, v156
	v_fma_f32 v155, v155, s41, v156
	v_mul_f32 v152, v152, v192
	v_mul_f32 v153, v153, v193
	v_mul_f32 v154, v154, v194
	v_mul_f32 v155, v155, v195
	v_exp_f32 v152, v152
	v_exp_f32 v153, v153
	v_exp_f32 v154, v154
	v_exp_f32 v155, v155
	v_add_f32 v152, 1.0, v152
	v_add_f32 v153, 1.0, v153
	v_add_f32 v154, 1.0, v154
	v_add_f32 v155, 1.0, v155
	v_rcp_f32 v152, v152
	v_rcp_f32 v153, v153
	v_rcp_f32 v154, v154
	v_rcp_f32 v155, v155
	v_mul_f32 v192, v192, v152
	v_mul_f32 v193, v193, v153
	v_mul_f32 v194, v194, v154
	v_mul_f32 v195, v195, v155
	v_add_f32 v196, v196, v124
	v_add_f32 v197, v197, v125
	v_add_f32 v198, v198, v126
	v_add_f32 v199, v199, v127
	v_mul_f32 v152, v196, v196
	v_mul_f32 v153, v197, v197
	v_mul_f32 v154, v198, v198
	v_mul_f32 v155, v199, v199
	v_fma_f32 v152, v152, s41, v156
	v_fma_f32 v153, v153, s41, v156
	v_fma_f32 v154, v154, s41, v156
	v_fma_f32 v155, v155, s41, v156
	v_mul_f32 v152, v152, v196
	v_mul_f32 v153, v153, v197
	v_mul_f32 v154, v154, v198
	v_mul_f32 v155, v155, v199
	v_exp_f32 v152, v152
	v_exp_f32 v153, v153
	v_exp_f32 v154, v154
	v_exp_f32 v155, v155
	v_add_f32 v152, 1.0, v152
	v_add_f32 v153, 1.0, v153
	v_add_f32 v154, 1.0, v154
	v_add_f32 v155, 1.0, v155
	v_rcp_f32 v152, v152
	v_rcp_f32 v153, v153
	v_rcp_f32 v154, v154
	v_rcp_f32 v155, v155
	v_mul_f32 v196, v196, v152
	v_mul_f32 v197, v197, v153
	v_mul_f32 v198, v198, v154
	v_mul_f32 v199, v199, v155
	v_add_f32 v200, v200, v128
	v_add_f32 v201, v201, v129
	v_add_f32 v202, v202, v130
	v_add_f32 v203, v203, v131
	v_mul_f32 v152, v200, v200
	v_mul_f32 v153, v201, v201
	v_mul_f32 v154, v202, v202
	v_mul_f32 v155, v203, v203
	v_fma_f32 v152, v152, s41, v156
	v_fma_f32 v153, v153, s41, v156
	v_fma_f32 v154, v154, s41, v156
	v_fma_f32 v155, v155, s41, v156
	v_mul_f32 v152, v152, v200
	v_mul_f32 v153, v153, v201
	v_mul_f32 v154, v154, v202
	v_mul_f32 v155, v155, v203
	v_exp_f32 v152, v152
	v_exp_f32 v153, v153
	v_exp_f32 v154, v154
	v_exp_f32 v155, v155
	v_add_f32 v152, 1.0, v152
	v_add_f32 v153, 1.0, v153
	v_add_f32 v154, 1.0, v154
	v_add_f32 v155, 1.0, v155
	v_rcp_f32 v152, v152
	v_rcp_f32 v153, v153
	v_rcp_f32 v154, v154
	v_rcp_f32 v155, v155
	v_mul_f32 v200, v200, v152
	v_mul_f32 v201, v201, v153
	v_mul_f32 v202, v202, v154
	v_mul_f32 v203, v203, v155
	v_add_f32 v204, v204, v132
	v_add_f32 v205, v205, v133
	v_add_f32 v206, v206, v134
	v_add_f32 v207, v207, v135
	v_mul_f32 v152, v204, v204
	v_mul_f32 v153, v205, v205
	v_mul_f32 v154, v206, v206
	v_mul_f32 v155, v207, v207
	v_fma_f32 v152, v152, s41, v156
	v_fma_f32 v153, v153, s41, v156
	v_fma_f32 v154, v154, s41, v156
	v_fma_f32 v155, v155, s41, v156
	v_mul_f32 v152, v152, v204
	v_mul_f32 v153, v153, v205
	v_mul_f32 v154, v154, v206
	v_mul_f32 v155, v155, v207
	v_exp_f32 v152, v152
	v_exp_f32 v153, v153
	v_exp_f32 v154, v154
	v_exp_f32 v155, v155
	v_add_f32 v152, 1.0, v152
	v_add_f32 v153, 1.0, v153
	v_add_f32 v154, 1.0, v154
	v_add_f32 v155, 1.0, v155
	v_rcp_f32 v152, v152
	v_rcp_f32 v153, v153
	v_rcp_f32 v154, v154
	v_rcp_f32 v155, v155
	v_mul_f32 v204, v204, v152
	v_mul_f32 v205, v205, v153
	v_mul_f32 v206, v206, v154
	v_mul_f32 v207, v207, v155
	v_cvt_pk_bf16_f32 v192, v192, v193
	v_cvt_pk_bf16_f32 v193, v194, v195
	v_cvt_pk_bf16_f32 v194, v196, v197
	v_cvt_pk_bf16_f32 v195, v198, v199
	s_nop 0
	v_permlane32_swap_b32 v192, v194
	v_permlane32_swap_b32 v193, v195
	v_cvt_pk_bf16_f32 v200, v200, v201
	v_cvt_pk_bf16_f32 v201, v202, v203
	v_cvt_pk_bf16_f32 v202, v204, v205
	v_cvt_pk_bf16_f32 v203, v206, v207
	s_nop 0
	v_permlane32_swap_b32 v200, v202
	v_permlane32_swap_b32 v201, v203
	s_nop 0
	v_permlane16_swap_b32 v192, v200
	v_permlane16_swap_b32 v193, v201
	v_permlane16_swap_b32 v194, v202
	v_permlane16_swap_b32 v195, v203
	v_accvgpr_read_b32 v212, a112
	v_accvgpr_read_b32 v213, a113
	v_accvgpr_read_b32 v214, a114
	v_accvgpr_read_b32 v215, a115
	v_accvgpr_read_b32 v216, a116
	v_accvgpr_read_b32 v217, a117
	v_accvgpr_read_b32 v218, a118
	v_accvgpr_read_b32 v219, a119
	v_accvgpr_read_b32 v220, a120
	v_accvgpr_read_b32 v221, a121
	v_accvgpr_read_b32 v222, a122
	v_accvgpr_read_b32 v223, a123
	v_accvgpr_read_b32 v224, a124
	v_accvgpr_read_b32 v225, a125
	v_accvgpr_read_b32 v226, a126
	v_accvgpr_read_b32 v227, a127
	v_add_f32 v212, v212, v164
	v_add_f32 v213, v213, v165
	v_add_f32 v214, v214, v166
	v_add_f32 v215, v215, v167
	v_mul_f32 v152, v212, v212
	v_mul_f32 v153, v213, v213
	v_mul_f32 v154, v214, v214
	v_mul_f32 v155, v215, v215
	v_fma_f32 v152, v152, s41, v156
	v_fma_f32 v153, v153, s41, v156
	v_fma_f32 v154, v154, s41, v156
	v_fma_f32 v155, v155, s41, v156
	v_mul_f32 v152, v152, v212
	v_mul_f32 v153, v153, v213
	v_mul_f32 v154, v154, v214
	v_mul_f32 v155, v155, v215
	v_exp_f32 v152, v152
	v_exp_f32 v153, v153
	v_exp_f32 v154, v154
	v_exp_f32 v155, v155
	v_add_f32 v152, 1.0, v152
	v_add_f32 v153, 1.0, v153
	v_add_f32 v154, 1.0, v154
	v_add_f32 v155, 1.0, v155
	v_rcp_f32 v152, v152
	v_rcp_f32 v153, v153
	v_rcp_f32 v154, v154
	v_rcp_f32 v155, v155
	v_mul_f32 v212, v212, v152
	v_mul_f32 v213, v213, v153
	v_mul_f32 v214, v214, v154
	v_mul_f32 v215, v215, v155
	v_add_f32 v216, v216, v168
	v_add_f32 v217, v217, v169
	v_add_f32 v218, v218, v170
	v_add_f32 v219, v219, v171
	v_mul_f32 v152, v216, v216
	v_mul_f32 v153, v217, v217
	v_mul_f32 v154, v218, v218
	v_mul_f32 v155, v219, v219
	v_fma_f32 v152, v152, s41, v156
	v_fma_f32 v153, v153, s41, v156
	v_fma_f32 v154, v154, s41, v156
	v_fma_f32 v155, v155, s41, v156
	v_mul_f32 v152, v152, v216
	v_mul_f32 v153, v153, v217
	v_mul_f32 v154, v154, v218
	v_mul_f32 v155, v155, v219
	v_exp_f32 v152, v152
	v_exp_f32 v153, v153
	v_exp_f32 v154, v154
	v_exp_f32 v155, v155
	v_add_f32 v152, 1.0, v152
	v_add_f32 v153, 1.0, v153
	v_add_f32 v154, 1.0, v154
	v_add_f32 v155, 1.0, v155
	v_rcp_f32 v152, v152
	v_rcp_f32 v153, v153
	v_rcp_f32 v154, v154
	v_rcp_f32 v155, v155
	v_mul_f32 v216, v216, v152
	v_mul_f32 v217, v217, v153
	v_mul_f32 v218, v218, v154
	v_mul_f32 v219, v219, v155
	v_add_f32 v220, v220, v172
	v_add_f32 v221, v221, v173
	v_add_f32 v222, v222, v174
	v_add_f32 v223, v223, v175
	v_mul_f32 v152, v220, v220
	v_mul_f32 v153, v221, v221
	v_mul_f32 v154, v222, v222
	v_mul_f32 v155, v223, v223
	v_fma_f32 v152, v152, s41, v156
	v_fma_f32 v153, v153, s41, v156
	v_fma_f32 v154, v154, s41, v156
	v_fma_f32 v155, v155, s41, v156
	v_mul_f32 v152, v152, v220
	v_mul_f32 v153, v153, v221
	v_mul_f32 v154, v154, v222
	v_mul_f32 v155, v155, v223
	v_exp_f32 v152, v152
	v_exp_f32 v153, v153
	v_exp_f32 v154, v154
	v_exp_f32 v155, v155
	v_add_f32 v152, 1.0, v152
	v_add_f32 v153, 1.0, v153
	v_add_f32 v154, 1.0, v154
	v_add_f32 v155, 1.0, v155
	v_rcp_f32 v152, v152
	v_rcp_f32 v153, v153
	v_rcp_f32 v154, v154
	v_rcp_f32 v155, v155
	v_mul_f32 v220, v220, v152
	v_mul_f32 v221, v221, v153
	v_mul_f32 v222, v222, v154
	v_mul_f32 v223, v223, v155
	v_add_f32 v224, v224, v176
	v_add_f32 v225, v225, v177
	v_add_f32 v226, v226, v178
	v_add_f32 v227, v227, v179
	v_mul_f32 v152, v224, v224
	v_mul_f32 v153, v225, v225
	v_mul_f32 v154, v226, v226
	v_mul_f32 v155, v227, v227
	v_fma_f32 v152, v152, s41, v156
	v_fma_f32 v153, v153, s41, v156
	v_fma_f32 v154, v154, s41, v156
	v_fma_f32 v155, v155, s41, v156
	v_mul_f32 v152, v152, v224
	v_mul_f32 v153, v153, v225
	v_mul_f32 v154, v154, v226
	v_mul_f32 v155, v155, v227
	v_exp_f32 v152, v152
	v_exp_f32 v153, v153
	v_exp_f32 v154, v154
	v_exp_f32 v155, v155
	v_add_f32 v152, 1.0, v152
	v_add_f32 v153, 1.0, v153
	v_add_f32 v154, 1.0, v154
	v_add_f32 v155, 1.0, v155
	v_rcp_f32 v152, v152
	v_rcp_f32 v153, v153
	v_rcp_f32 v154, v154
	v_rcp_f32 v155, v155
	v_mul_f32 v224, v224, v152
	v_mul_f32 v225, v225, v153
	v_mul_f32 v226, v226, v154
	v_mul_f32 v227, v227, v155
	v_cvt_pk_bf16_f32 v212, v212, v213
	v_cvt_pk_bf16_f32 v213, v214, v215
	v_cvt_pk_bf16_f32 v214, v216, v217
	v_cvt_pk_bf16_f32 v215, v218, v219
	s_nop 0
	v_permlane32_swap_b32 v212, v214
	v_permlane32_swap_b32 v213, v215
	v_cvt_pk_bf16_f32 v220, v220, v221
	v_cvt_pk_bf16_f32 v221, v222, v223
	v_cvt_pk_bf16_f32 v222, v224, v225
	v_cvt_pk_bf16_f32 v223, v226, v227
	s_nop 0
	v_permlane32_swap_b32 v220, v222
	v_permlane32_swap_b32 v221, v223
	s_nop 0
	v_permlane16_swap_b32 v212, v220
	v_permlane16_swap_b32 v213, v221
	v_permlane16_swap_b32 v214, v222
	v_permlane16_swap_b32 v215, v223
	v_mov_b32 v232, v192
	v_mov_b32 v233, v193
	v_mov_b32 v234, v194
	v_mov_b32 v235, v195
	v_mov_b32_dpp v192, v212 row_ror:8 row_mask:0xf bank_mask:0xc
	v_mov_b32_dpp v193, v213 row_ror:8 row_mask:0xf bank_mask:0xc
	v_mov_b32_dpp v194, v214 row_ror:8 row_mask:0xf bank_mask:0xc
	v_mov_b32_dpp v195, v215 row_ror:8 row_mask:0xf bank_mask:0xc
	v_mov_b32_dpp v212, v232 row_ror:8 row_mask:0xf bank_mask:0x3
	v_mov_b32_dpp v213, v233 row_ror:8 row_mask:0xf bank_mask:0x3
	v_mov_b32_dpp v214, v234 row_ror:8 row_mask:0xf bank_mask:0x3
	v_mov_b32_dpp v215, v235 row_ror:8 row_mask:0xf bank_mask:0x3
	v_mov_b32 v232, v200
	v_mov_b32 v233, v201
	v_mov_b32 v234, v202
	v_mov_b32 v235, v203
	v_mov_b32_dpp v200, v220 row_ror:8 row_mask:0xf bank_mask:0xc
	v_mov_b32_dpp v201, v221 row_ror:8 row_mask:0xf bank_mask:0xc
	v_mov_b32_dpp v202, v222 row_ror:8 row_mask:0xf bank_mask:0xc
	v_mov_b32_dpp v203, v223 row_ror:8 row_mask:0xf bank_mask:0xc
	v_mov_b32_dpp v220, v232 row_ror:8 row_mask:0xf bank_mask:0x3
	v_mov_b32_dpp v221, v233 row_ror:8 row_mask:0xf bank_mask:0x3
	v_mov_b32_dpp v222, v234 row_ror:8 row_mask:0xf bank_mask:0x3
	v_mov_b32_dpp v223, v235 row_ror:8 row_mask:0xf bank_mask:0x3
	s_mul_i32 s23, s22, 3
	s_add_u32 s23, s23, s25
	buffer_store_dwordx4 v[192:195], v188, s[8:11], s23 offen offset:0 sc1
	buffer_store_dwordx4 v[212:215], v189, s[8:11], s23 offen offset:0 sc1
	buffer_store_dwordx4 v[200:203], v190, s[8:11], s23 offen offset:0 sc1
	buffer_store_dwordx4 v[220:223], v191, s[8:11], s23 offen offset:0 sc1
	buffer_load_dwordx2 v[136:137], v14, s[32:35], s21 offen offset:128
	buffer_load_dwordx2 v[138:139], v14, s[32:35], s21 offen offset:144
	buffer_load_dwordx2 v[140:141], v14, s[32:35], s21 offen offset:160
	buffer_load_dwordx2 v[142:143], v14, s[32:35], s21 offen offset:176
	s_waitcnt vmcnt(3)
	v_lshlrev_b32 v120, 16, v136
	v_and_b32 v121, 0xffff0000, v136
	v_lshlrev_b32 v122, 16, v137
	v_and_b32 v123, 0xffff0000, v137
	s_waitcnt vmcnt(2)
	v_lshlrev_b32 v124, 16, v138
	v_and_b32 v125, 0xffff0000, v138
	v_lshlrev_b32 v126, 16, v139
	v_and_b32 v127, 0xffff0000, v139
	s_waitcnt vmcnt(1)
	v_lshlrev_b32 v128, 16, v140
	v_and_b32 v129, 0xffff0000, v140
	v_lshlrev_b32 v130, 16, v141
	v_and_b32 v131, 0xffff0000, v141
	s_waitcnt vmcnt(0)
	v_lshlrev_b32 v132, 16, v142
	v_and_b32 v133, 0xffff0000, v142
	v_lshlrev_b32 v134, 16, v143
	v_and_b32 v135, 0xffff0000, v143
	buffer_load_dwordx2 v[180:181], v14, s[32:35], s21 offen offset:192
	buffer_load_dwordx2 v[182:183], v14, s[32:35], s21 offen offset:208
	buffer_load_dwordx2 v[184:185], v14, s[32:35], s21 offen offset:224
	buffer_load_dwordx2 v[186:187], v14, s[32:35], s21 offen offset:240
	s_waitcnt vmcnt(3)
	v_lshlrev_b32 v164, 16, v180
	v_and_b32 v165, 0xffff0000, v180
	v_lshlrev_b32 v166, 16, v181
	v_and_b32 v167, 0xffff0000, v181
	s_waitcnt vmcnt(2)
	v_lshlrev_b32 v168, 16, v182
	v_and_b32 v169, 0xffff0000, v182
	v_lshlrev_b32 v170, 16, v183
	v_and_b32 v171, 0xffff0000, v183
	s_waitcnt vmcnt(1)
	v_lshlrev_b32 v172, 16, v184
	v_and_b32 v173, 0xffff0000, v184
	v_lshlrev_b32 v174, 16, v185
	v_and_b32 v175, 0xffff0000, v185
	s_waitcnt vmcnt(0)
	v_lshlrev_b32 v176, 16, v186
	v_and_b32 v177, 0xffff0000, v186
	v_lshlrev_b32 v178, 16, v187
	v_and_b32 v179, 0xffff0000, v187
	v_accvgpr_read_b32 v80, a128
	v_accvgpr_read_b32 v81, a129
	v_accvgpr_read_b32 v82, a130
	v_accvgpr_read_b32 v83, a131
	v_accvgpr_read_b32 v84, a132
	v_accvgpr_read_b32 v85, a133
	v_accvgpr_read_b32 v86, a134
	v_accvgpr_read_b32 v87, a135
	v_accvgpr_read_b32 v88, a136
	v_accvgpr_read_b32 v89, a137
	v_accvgpr_read_b32 v90, a138
	v_accvgpr_read_b32 v91, a139
	v_accvgpr_read_b32 v92, a140
	v_accvgpr_read_b32 v93, a141
	v_accvgpr_read_b32 v94, a142
	v_accvgpr_read_b32 v95, a143
	v_add_f32 v80, v80, v120
	v_add_f32 v81, v81, v121
	v_add_f32 v82, v82, v122
	v_add_f32 v83, v83, v123
	v_mul_f32 v152, v80, v80
	v_mul_f32 v153, v81, v81
	v_mul_f32 v154, v82, v82
	v_mul_f32 v155, v83, v83
	v_fma_f32 v152, v152, s41, v156
	v_fma_f32 v153, v153, s41, v156
	v_fma_f32 v154, v154, s41, v156
	v_fma_f32 v155, v155, s41, v156
	v_mul_f32 v152, v152, v80
	v_mul_f32 v153, v153, v81
	v_mul_f32 v154, v154, v82
	v_mul_f32 v155, v155, v83
	v_exp_f32 v152, v152
	v_exp_f32 v153, v153
	v_exp_f32 v154, v154
	v_exp_f32 v155, v155
	v_add_f32 v152, 1.0, v152
	v_add_f32 v153, 1.0, v153
	v_add_f32 v154, 1.0, v154
	v_add_f32 v155, 1.0, v155
	v_rcp_f32 v152, v152
	v_rcp_f32 v153, v153
	v_rcp_f32 v154, v154
	v_rcp_f32 v155, v155
	v_mul_f32 v80, v80, v152
	v_mul_f32 v81, v81, v153
	v_mul_f32 v82, v82, v154
	v_mul_f32 v83, v83, v155
	v_add_f32 v84, v84, v124
	v_add_f32 v85, v85, v125
	v_add_f32 v86, v86, v126
	v_add_f32 v87, v87, v127
	v_mul_f32 v152, v84, v84
	v_mul_f32 v153, v85, v85
	v_mul_f32 v154, v86, v86
	v_mul_f32 v155, v87, v87
	v_fma_f32 v152, v152, s41, v156
	v_fma_f32 v153, v153, s41, v156
	v_fma_f32 v154, v154, s41, v156
	v_fma_f32 v155, v155, s41, v156
	v_mul_f32 v152, v152, v84
	v_mul_f32 v153, v153, v85
	v_mul_f32 v154, v154, v86
	v_mul_f32 v155, v155, v87
	v_exp_f32 v152, v152
	v_exp_f32 v153, v153
	v_exp_f32 v154, v154
	v_exp_f32 v155, v155
	v_add_f32 v152, 1.0, v152
	v_add_f32 v153, 1.0, v153
	v_add_f32 v154, 1.0, v154
	v_add_f32 v155, 1.0, v155
	v_rcp_f32 v152, v152
	v_rcp_f32 v153, v153
	v_rcp_f32 v154, v154
	v_rcp_f32 v155, v155
	v_mul_f32 v84, v84, v152
	v_mul_f32 v85, v85, v153
	v_mul_f32 v86, v86, v154
	v_mul_f32 v87, v87, v155
	v_add_f32 v88, v88, v128
	v_add_f32 v89, v89, v129
	v_add_f32 v90, v90, v130
	v_add_f32 v91, v91, v131
	v_mul_f32 v152, v88, v88
	v_mul_f32 v153, v89, v89
	v_mul_f32 v154, v90, v90
	v_mul_f32 v155, v91, v91
	v_fma_f32 v152, v152, s41, v156
	v_fma_f32 v153, v153, s41, v156
	v_fma_f32 v154, v154, s41, v156
	v_fma_f32 v155, v155, s41, v156
	v_mul_f32 v152, v152, v88
	v_mul_f32 v153, v153, v89
	v_mul_f32 v154, v154, v90
	v_mul_f32 v155, v155, v91
	v_exp_f32 v152, v152
	v_exp_f32 v153, v153
	v_exp_f32 v154, v154
	v_exp_f32 v155, v155
	v_add_f32 v152, 1.0, v152
	v_add_f32 v153, 1.0, v153
	v_add_f32 v154, 1.0, v154
	v_add_f32 v155, 1.0, v155
	v_rcp_f32 v152, v152
	v_rcp_f32 v153, v153
	v_rcp_f32 v154, v154
	v_rcp_f32 v155, v155
	v_mul_f32 v88, v88, v152
	v_mul_f32 v89, v89, v153
	v_mul_f32 v90, v90, v154
	v_mul_f32 v91, v91, v155
	v_add_f32 v92, v92, v132
	v_add_f32 v93, v93, v133
	v_add_f32 v94, v94, v134
	v_add_f32 v95, v95, v135
	v_mul_f32 v152, v92, v92
	v_mul_f32 v153, v93, v93
	v_mul_f32 v154, v94, v94
	v_mul_f32 v155, v95, v95
	v_fma_f32 v152, v152, s41, v156
	v_fma_f32 v153, v153, s41, v156
	v_fma_f32 v154, v154, s41, v156
	v_fma_f32 v155, v155, s41, v156
	v_mul_f32 v152, v152, v92
	v_mul_f32 v153, v153, v93
	v_mul_f32 v154, v154, v94
	v_mul_f32 v155, v155, v95
	v_exp_f32 v152, v152
	v_exp_f32 v153, v153
	v_exp_f32 v154, v154
	v_exp_f32 v155, v155
	v_add_f32 v152, 1.0, v152
	v_add_f32 v153, 1.0, v153
	v_add_f32 v154, 1.0, v154
	v_add_f32 v155, 1.0, v155
	v_rcp_f32 v152, v152
	v_rcp_f32 v153, v153
	v_rcp_f32 v154, v154
	v_rcp_f32 v155, v155
	v_mul_f32 v92, v92, v152
	v_mul_f32 v93, v93, v153
	v_mul_f32 v94, v94, v154
	v_mul_f32 v95, v95, v155
	v_cvt_pk_bf16_f32 v80, v80, v81
	v_cvt_pk_bf16_f32 v81, v82, v83
	v_cvt_pk_bf16_f32 v82, v84, v85
	v_cvt_pk_bf16_f32 v83, v86, v87
	s_nop 0
	v_permlane32_swap_b32 v80, v82
	v_permlane32_swap_b32 v81, v83
	v_cvt_pk_bf16_f32 v88, v88, v89
	v_cvt_pk_bf16_f32 v89, v90, v91
	v_cvt_pk_bf16_f32 v90, v92, v93
	v_cvt_pk_bf16_f32 v91, v94, v95
	s_nop 0
	v_permlane32_swap_b32 v88, v90
	v_permlane32_swap_b32 v89, v91
	s_nop 0
	v_permlane16_swap_b32 v80, v88
	v_permlane16_swap_b32 v81, v89
	v_permlane16_swap_b32 v82, v90
	v_permlane16_swap_b32 v83, v91
	v_accvgpr_read_b32 v100, a192
	v_accvgpr_read_b32 v101, a193
	v_accvgpr_read_b32 v102, a194
	v_accvgpr_read_b32 v103, a195
	v_accvgpr_read_b32 v104, a196
	v_accvgpr_read_b32 v105, a197
	v_accvgpr_read_b32 v106, a198
	v_accvgpr_read_b32 v107, a199
	v_accvgpr_read_b32 v108, a200
	v_accvgpr_read_b32 v109, a201
	v_accvgpr_read_b32 v110, a202
	v_accvgpr_read_b32 v111, a203
	v_accvgpr_read_b32 v112, a204
	v_accvgpr_read_b32 v113, a205
	v_accvgpr_read_b32 v114, a206
	v_accvgpr_read_b32 v115, a207
	v_add_f32 v100, v100, v164
	v_add_f32 v101, v101, v165
	v_add_f32 v102, v102, v166
	v_add_f32 v103, v103, v167
	v_mul_f32 v152, v100, v100
	v_mul_f32 v153, v101, v101
	v_mul_f32 v154, v102, v102
	v_mul_f32 v155, v103, v103
	v_fma_f32 v152, v152, s41, v156
	v_fma_f32 v153, v153, s41, v156
	v_fma_f32 v154, v154, s41, v156
	v_fma_f32 v155, v155, s41, v156
	v_mul_f32 v152, v152, v100
	v_mul_f32 v153, v153, v101
	v_mul_f32 v154, v154, v102
	v_mul_f32 v155, v155, v103
	v_exp_f32 v152, v152
	v_exp_f32 v153, v153
	v_exp_f32 v154, v154
	v_exp_f32 v155, v155
	v_add_f32 v152, 1.0, v152
	v_add_f32 v153, 1.0, v153
	v_add_f32 v154, 1.0, v154
	v_add_f32 v155, 1.0, v155
	v_rcp_f32 v152, v152
	v_rcp_f32 v153, v153
	v_rcp_f32 v154, v154
	v_rcp_f32 v155, v155
	v_mul_f32 v100, v100, v152
	v_mul_f32 v101, v101, v153
	v_mul_f32 v102, v102, v154
	v_mul_f32 v103, v103, v155
	v_add_f32 v104, v104, v168
	v_add_f32 v105, v105, v169
	v_add_f32 v106, v106, v170
	v_add_f32 v107, v107, v171
	v_mul_f32 v152, v104, v104
	v_mul_f32 v153, v105, v105
	v_mul_f32 v154, v106, v106
	v_mul_f32 v155, v107, v107
	v_fma_f32 v152, v152, s41, v156
	v_fma_f32 v153, v153, s41, v156
	v_fma_f32 v154, v154, s41, v156
	v_fma_f32 v155, v155, s41, v156
	v_mul_f32 v152, v152, v104
	v_mul_f32 v153, v153, v105
	v_mul_f32 v154, v154, v106
	v_mul_f32 v155, v155, v107
	v_exp_f32 v152, v152
	v_exp_f32 v153, v153
	v_exp_f32 v154, v154
	v_exp_f32 v155, v155
	v_add_f32 v152, 1.0, v152
	v_add_f32 v153, 1.0, v153
	v_add_f32 v154, 1.0, v154
	v_add_f32 v155, 1.0, v155
	v_rcp_f32 v152, v152
	v_rcp_f32 v153, v153
	v_rcp_f32 v154, v154
	v_rcp_f32 v155, v155
	v_mul_f32 v104, v104, v152
	v_mul_f32 v105, v105, v153
	v_mul_f32 v106, v106, v154
	v_mul_f32 v107, v107, v155
	v_add_f32 v108, v108, v172
	v_add_f32 v109, v109, v173
	v_add_f32 v110, v110, v174
	v_add_f32 v111, v111, v175
	v_mul_f32 v152, v108, v108
	v_mul_f32 v153, v109, v109
	v_mul_f32 v154, v110, v110
	v_mul_f32 v155, v111, v111
	v_fma_f32 v152, v152, s41, v156
	v_fma_f32 v153, v153, s41, v156
	v_fma_f32 v154, v154, s41, v156
	v_fma_f32 v155, v155, s41, v156
	v_mul_f32 v152, v152, v108
	v_mul_f32 v153, v153, v109
	v_mul_f32 v154, v154, v110
	v_mul_f32 v155, v155, v111
	v_exp_f32 v152, v152
	v_exp_f32 v153, v153
	v_exp_f32 v154, v154
	v_exp_f32 v155, v155
	v_add_f32 v152, 1.0, v152
	v_add_f32 v153, 1.0, v153
	v_add_f32 v154, 1.0, v154
	v_add_f32 v155, 1.0, v155
	v_rcp_f32 v152, v152
	v_rcp_f32 v153, v153
	v_rcp_f32 v154, v154
	v_rcp_f32 v155, v155
	v_mul_f32 v108, v108, v152
	v_mul_f32 v109, v109, v153
	v_mul_f32 v110, v110, v154
	v_mul_f32 v111, v111, v155
	v_add_f32 v112, v112, v176
	v_add_f32 v113, v113, v177
	v_add_f32 v114, v114, v178
	v_add_f32 v115, v115, v179
	v_mul_f32 v152, v112, v112
	v_mul_f32 v153, v113, v113
	v_mul_f32 v154, v114, v114
	v_mul_f32 v155, v115, v115
	v_fma_f32 v152, v152, s41, v156
	v_fma_f32 v153, v153, s41, v156
	v_fma_f32 v154, v154, s41, v156
	v_fma_f32 v155, v155, s41, v156
	v_mul_f32 v152, v152, v112
	v_mul_f32 v153, v153, v113
	v_mul_f32 v154, v154, v114
	v_mul_f32 v155, v155, v115
	v_exp_f32 v152, v152
	v_exp_f32 v153, v153
	v_exp_f32 v154, v154
	v_exp_f32 v155, v155
	v_add_f32 v152, 1.0, v152
	v_add_f32 v153, 1.0, v153
	v_add_f32 v154, 1.0, v154
	v_add_f32 v155, 1.0, v155
	v_rcp_f32 v152, v152
	v_rcp_f32 v153, v153
	v_rcp_f32 v154, v154
	v_rcp_f32 v155, v155
	v_mul_f32 v112, v112, v152
	v_mul_f32 v113, v113, v153
	v_mul_f32 v114, v114, v154
	v_mul_f32 v115, v115, v155
	v_cvt_pk_bf16_f32 v100, v100, v101
	v_cvt_pk_bf16_f32 v101, v102, v103
	v_cvt_pk_bf16_f32 v102, v104, v105
	v_cvt_pk_bf16_f32 v103, v106, v107
	s_nop 0
	v_permlane32_swap_b32 v100, v102
	v_permlane32_swap_b32 v101, v103
	v_cvt_pk_bf16_f32 v108, v108, v109
	v_cvt_pk_bf16_f32 v109, v110, v111
	v_cvt_pk_bf16_f32 v110, v112, v113
	v_cvt_pk_bf16_f32 v111, v114, v115
	s_nop 0
	v_permlane32_swap_b32 v108, v110
	v_permlane32_swap_b32 v109, v111
	s_nop 0
	v_permlane16_swap_b32 v100, v108
	v_permlane16_swap_b32 v101, v109
	v_permlane16_swap_b32 v102, v110
	v_permlane16_swap_b32 v103, v111
	v_mov_b32 v232, v80
	v_mov_b32 v233, v81
	v_mov_b32 v234, v82
	v_mov_b32 v235, v83
	v_mov_b32_dpp v80, v100 row_ror:8 row_mask:0xf bank_mask:0xc
	v_mov_b32_dpp v81, v101 row_ror:8 row_mask:0xf bank_mask:0xc
	v_mov_b32_dpp v82, v102 row_ror:8 row_mask:0xf bank_mask:0xc
	v_mov_b32_dpp v83, v103 row_ror:8 row_mask:0xf bank_mask:0xc
	v_mov_b32_dpp v100, v232 row_ror:8 row_mask:0xf bank_mask:0x3
	v_mov_b32_dpp v101, v233 row_ror:8 row_mask:0xf bank_mask:0x3
	v_mov_b32_dpp v102, v234 row_ror:8 row_mask:0xf bank_mask:0x3
	v_mov_b32_dpp v103, v235 row_ror:8 row_mask:0xf bank_mask:0x3
	v_mov_b32 v232, v88
	v_mov_b32 v233, v89
	v_mov_b32 v234, v90
	v_mov_b32 v235, v91
	v_mov_b32_dpp v88, v108 row_ror:8 row_mask:0xf bank_mask:0xc
	v_mov_b32_dpp v89, v109 row_ror:8 row_mask:0xf bank_mask:0xc
	v_mov_b32_dpp v90, v110 row_ror:8 row_mask:0xf bank_mask:0xc
	v_mov_b32_dpp v91, v111 row_ror:8 row_mask:0xf bank_mask:0xc
	v_mov_b32_dpp v108, v232 row_ror:8 row_mask:0xf bank_mask:0x3
	v_mov_b32_dpp v109, v233 row_ror:8 row_mask:0xf bank_mask:0x3
	v_mov_b32_dpp v110, v234 row_ror:8 row_mask:0xf bank_mask:0x3
	v_mov_b32_dpp v111, v235 row_ror:8 row_mask:0xf bank_mask:0x3
	s_mov_b32 s23, s25
	buffer_store_dwordx4 v[80:83], v188, s[8:11], s23 offen offset:128 sc1
	buffer_store_dwordx4 v[100:103], v189, s[8:11], s23 offen offset:128 sc1
	buffer_store_dwordx4 v[88:91], v190, s[8:11], s23 offen offset:128 sc1
	buffer_store_dwordx4 v[108:111], v191, s[8:11], s23 offen offset:128 sc1
	v_accvgpr_read_b32 v192, a144
	v_accvgpr_read_b32 v193, a145
	v_accvgpr_read_b32 v194, a146
	v_accvgpr_read_b32 v195, a147
	v_accvgpr_read_b32 v196, a148
	v_accvgpr_read_b32 v197, a149
	v_accvgpr_read_b32 v198, a150
	v_accvgpr_read_b32 v199, a151
	v_accvgpr_read_b32 v200, a152
	v_accvgpr_read_b32 v201, a153
	v_accvgpr_read_b32 v202, a154
	v_accvgpr_read_b32 v203, a155
	v_accvgpr_read_b32 v204, a156
	v_accvgpr_read_b32 v205, a157
	v_accvgpr_read_b32 v206, a158
	v_accvgpr_read_b32 v207, a159
	v_add_f32 v192, v192, v120
	v_add_f32 v193, v193, v121
	v_add_f32 v194, v194, v122
	v_add_f32 v195, v195, v123
	v_mul_f32 v152, v192, v192
	v_mul_f32 v153, v193, v193
	v_mul_f32 v154, v194, v194
	v_mul_f32 v155, v195, v195
	v_fma_f32 v152, v152, s41, v156
	v_fma_f32 v153, v153, s41, v156
	v_fma_f32 v154, v154, s41, v156
	v_fma_f32 v155, v155, s41, v156
	v_mul_f32 v152, v152, v192
	v_mul_f32 v153, v153, v193
	v_mul_f32 v154, v154, v194
	v_mul_f32 v155, v155, v195
	v_exp_f32 v152, v152
	v_exp_f32 v153, v153
	v_exp_f32 v154, v154
	v_exp_f32 v155, v155
	v_add_f32 v152, 1.0, v152
	v_add_f32 v153, 1.0, v153
	v_add_f32 v154, 1.0, v154
	v_add_f32 v155, 1.0, v155
	v_rcp_f32 v152, v152
	v_rcp_f32 v153, v153
	v_rcp_f32 v154, v154
	v_rcp_f32 v155, v155
	v_mul_f32 v192, v192, v152
	v_mul_f32 v193, v193, v153
	v_mul_f32 v194, v194, v154
	v_mul_f32 v195, v195, v155
	v_add_f32 v196, v196, v124
	v_add_f32 v197, v197, v125
	v_add_f32 v198, v198, v126
	v_add_f32 v199, v199, v127
	v_mul_f32 v152, v196, v196
	v_mul_f32 v153, v197, v197
	v_mul_f32 v154, v198, v198
	v_mul_f32 v155, v199, v199
	v_fma_f32 v152, v152, s41, v156
	v_fma_f32 v153, v153, s41, v156
	v_fma_f32 v154, v154, s41, v156
	v_fma_f32 v155, v155, s41, v156
	v_mul_f32 v152, v152, v196
	v_mul_f32 v153, v153, v197
	v_mul_f32 v154, v154, v198
	v_mul_f32 v155, v155, v199
	v_exp_f32 v152, v152
	v_exp_f32 v153, v153
	v_exp_f32 v154, v154
	v_exp_f32 v155, v155
	v_add_f32 v152, 1.0, v152
	v_add_f32 v153, 1.0, v153
	v_add_f32 v154, 1.0, v154
	v_add_f32 v155, 1.0, v155
	v_rcp_f32 v152, v152
	v_rcp_f32 v153, v153
	v_rcp_f32 v154, v154
	v_rcp_f32 v155, v155
	v_mul_f32 v196, v196, v152
	v_mul_f32 v197, v197, v153
	v_mul_f32 v198, v198, v154
	v_mul_f32 v199, v199, v155
	v_add_f32 v200, v200, v128
	v_add_f32 v201, v201, v129
	v_add_f32 v202, v202, v130
	v_add_f32 v203, v203, v131
	v_mul_f32 v152, v200, v200
	v_mul_f32 v153, v201, v201
	v_mul_f32 v154, v202, v202
	v_mul_f32 v155, v203, v203
	v_fma_f32 v152, v152, s41, v156
	v_fma_f32 v153, v153, s41, v156
	v_fma_f32 v154, v154, s41, v156
	v_fma_f32 v155, v155, s41, v156
	v_mul_f32 v152, v152, v200
	v_mul_f32 v153, v153, v201
	v_mul_f32 v154, v154, v202
	v_mul_f32 v155, v155, v203
	v_exp_f32 v152, v152
	v_exp_f32 v153, v153
	v_exp_f32 v154, v154
	v_exp_f32 v155, v155
	v_add_f32 v152, 1.0, v152
	v_add_f32 v153, 1.0, v153
	v_add_f32 v154, 1.0, v154
	v_add_f32 v155, 1.0, v155
	v_rcp_f32 v152, v152
	v_rcp_f32 v153, v153
	v_rcp_f32 v154, v154
	v_rcp_f32 v155, v155
	v_mul_f32 v200, v200, v152
	v_mul_f32 v201, v201, v153
	v_mul_f32 v202, v202, v154
	v_mul_f32 v203, v203, v155
	v_add_f32 v204, v204, v132
	v_add_f32 v205, v205, v133
	v_add_f32 v206, v206, v134
	v_add_f32 v207, v207, v135
	v_mul_f32 v152, v204, v204
	v_mul_f32 v153, v205, v205
	v_mul_f32 v154, v206, v206
	v_mul_f32 v155, v207, v207
	v_fma_f32 v152, v152, s41, v156
	v_fma_f32 v153, v153, s41, v156
	v_fma_f32 v154, v154, s41, v156
	v_fma_f32 v155, v155, s41, v156
	v_mul_f32 v152, v152, v204
	v_mul_f32 v153, v153, v205
	v_mul_f32 v154, v154, v206
	v_mul_f32 v155, v155, v207
	v_exp_f32 v152, v152
	v_exp_f32 v153, v153
	v_exp_f32 v154, v154
	v_exp_f32 v155, v155
	v_add_f32 v152, 1.0, v152
	v_add_f32 v153, 1.0, v153
	v_add_f32 v154, 1.0, v154
	v_add_f32 v155, 1.0, v155
	v_rcp_f32 v152, v152
	v_rcp_f32 v153, v153
	v_rcp_f32 v154, v154
	v_rcp_f32 v155, v155
	v_mul_f32 v204, v204, v152
	v_mul_f32 v205, v205, v153
	v_mul_f32 v206, v206, v154
	v_mul_f32 v207, v207, v155
	v_cvt_pk_bf16_f32 v192, v192, v193
	v_cvt_pk_bf16_f32 v193, v194, v195
	v_cvt_pk_bf16_f32 v194, v196, v197
	v_cvt_pk_bf16_f32 v195, v198, v199
	s_nop 0
	v_permlane32_swap_b32 v192, v194
	v_permlane32_swap_b32 v193, v195
	v_cvt_pk_bf16_f32 v200, v200, v201
	v_cvt_pk_bf16_f32 v201, v202, v203
	v_cvt_pk_bf16_f32 v202, v204, v205
	v_cvt_pk_bf16_f32 v203, v206, v207
	s_nop 0
	v_permlane32_swap_b32 v200, v202
	v_permlane32_swap_b32 v201, v203
	s_nop 0
	v_permlane16_swap_b32 v192, v200
	v_permlane16_swap_b32 v193, v201
	v_permlane16_swap_b32 v194, v202
	v_permlane16_swap_b32 v195, v203
	v_accvgpr_read_b32 v212, a208
	v_accvgpr_read_b32 v213, a209
	v_accvgpr_read_b32 v214, a210
	v_accvgpr_read_b32 v215, a211
	v_accvgpr_read_b32 v216, a212
	v_accvgpr_read_b32 v217, a213
	v_accvgpr_read_b32 v218, a214
	v_accvgpr_read_b32 v219, a215
	v_accvgpr_read_b32 v220, a216
	v_accvgpr_read_b32 v221, a217
	v_accvgpr_read_b32 v222, a218
	v_accvgpr_read_b32 v223, a219
	v_accvgpr_read_b32 v224, a220
	v_accvgpr_read_b32 v225, a221
	v_accvgpr_read_b32 v226, a222
	v_accvgpr_read_b32 v227, a223
	v_add_f32 v212, v212, v164
	v_add_f32 v213, v213, v165
	v_add_f32 v214, v214, v166
	v_add_f32 v215, v215, v167
	v_mul_f32 v152, v212, v212
	v_mul_f32 v153, v213, v213
	v_mul_f32 v154, v214, v214
	v_mul_f32 v155, v215, v215
	v_fma_f32 v152, v152, s41, v156
	v_fma_f32 v153, v153, s41, v156
	v_fma_f32 v154, v154, s41, v156
	v_fma_f32 v155, v155, s41, v156
	v_mul_f32 v152, v152, v212
	v_mul_f32 v153, v153, v213
	v_mul_f32 v154, v154, v214
	v_mul_f32 v155, v155, v215
	v_exp_f32 v152, v152
	v_exp_f32 v153, v153
	v_exp_f32 v154, v154
	v_exp_f32 v155, v155
	v_add_f32 v152, 1.0, v152
	v_add_f32 v153, 1.0, v153
	v_add_f32 v154, 1.0, v154
	v_add_f32 v155, 1.0, v155
	v_rcp_f32 v152, v152
	v_rcp_f32 v153, v153
	v_rcp_f32 v154, v154
	v_rcp_f32 v155, v155
	v_mul_f32 v212, v212, v152
	v_mul_f32 v213, v213, v153
	v_mul_f32 v214, v214, v154
	v_mul_f32 v215, v215, v155
	v_add_f32 v216, v216, v168
	v_add_f32 v217, v217, v169
	v_add_f32 v218, v218, v170
	v_add_f32 v219, v219, v171
	v_mul_f32 v152, v216, v216
	v_mul_f32 v153, v217, v217
	v_mul_f32 v154, v218, v218
	v_mul_f32 v155, v219, v219
	v_fma_f32 v152, v152, s41, v156
	v_fma_f32 v153, v153, s41, v156
	v_fma_f32 v154, v154, s41, v156
	v_fma_f32 v155, v155, s41, v156
	v_mul_f32 v152, v152, v216
	v_mul_f32 v153, v153, v217
	v_mul_f32 v154, v154, v218
	v_mul_f32 v155, v155, v219
	v_exp_f32 v152, v152
	v_exp_f32 v153, v153
	v_exp_f32 v154, v154
	v_exp_f32 v155, v155
	v_add_f32 v152, 1.0, v152
	v_add_f32 v153, 1.0, v153
	v_add_f32 v154, 1.0, v154
	v_add_f32 v155, 1.0, v155
	v_rcp_f32 v152, v152
	v_rcp_f32 v153, v153
	v_rcp_f32 v154, v154
	v_rcp_f32 v155, v155
	v_mul_f32 v216, v216, v152
	v_mul_f32 v217, v217, v153
	v_mul_f32 v218, v218, v154
	v_mul_f32 v219, v219, v155
	v_add_f32 v220, v220, v172
	v_add_f32 v221, v221, v173
	v_add_f32 v222, v222, v174
	v_add_f32 v223, v223, v175
	v_mul_f32 v152, v220, v220
	v_mul_f32 v153, v221, v221
	v_mul_f32 v154, v222, v222
	v_mul_f32 v155, v223, v223
	v_fma_f32 v152, v152, s41, v156
	v_fma_f32 v153, v153, s41, v156
	v_fma_f32 v154, v154, s41, v156
	v_fma_f32 v155, v155, s41, v156
	v_mul_f32 v152, v152, v220
	v_mul_f32 v153, v153, v221
	v_mul_f32 v154, v154, v222
	v_mul_f32 v155, v155, v223
	v_exp_f32 v152, v152
	v_exp_f32 v153, v153
	v_exp_f32 v154, v154
	v_exp_f32 v155, v155
	v_add_f32 v152, 1.0, v152
	v_add_f32 v153, 1.0, v153
	v_add_f32 v154, 1.0, v154
	v_add_f32 v155, 1.0, v155
	v_rcp_f32 v152, v152
	v_rcp_f32 v153, v153
	v_rcp_f32 v154, v154
	v_rcp_f32 v155, v155
	v_mul_f32 v220, v220, v152
	v_mul_f32 v221, v221, v153
	v_mul_f32 v222, v222, v154
	v_mul_f32 v223, v223, v155
	v_add_f32 v224, v224, v176
	v_add_f32 v225, v225, v177
	v_add_f32 v226, v226, v178
	v_add_f32 v227, v227, v179
	v_mul_f32 v152, v224, v224
	v_mul_f32 v153, v225, v225
	v_mul_f32 v154, v226, v226
	v_mul_f32 v155, v227, v227
	v_fma_f32 v152, v152, s41, v156
	v_fma_f32 v153, v153, s41, v156
	v_fma_f32 v154, v154, s41, v156
	v_fma_f32 v155, v155, s41, v156
	v_mul_f32 v152, v152, v224
	v_mul_f32 v153, v153, v225
	v_mul_f32 v154, v154, v226
	v_mul_f32 v155, v155, v227
	v_exp_f32 v152, v152
	v_exp_f32 v153, v153
	v_exp_f32 v154, v154
	v_exp_f32 v155, v155
	v_add_f32 v152, 1.0, v152
	v_add_f32 v153, 1.0, v153
	v_add_f32 v154, 1.0, v154
	v_add_f32 v155, 1.0, v155
	v_rcp_f32 v152, v152
	v_rcp_f32 v153, v153
	v_rcp_f32 v154, v154
	v_rcp_f32 v155, v155
	v_mul_f32 v224, v224, v152
	v_mul_f32 v225, v225, v153
	v_mul_f32 v226, v226, v154
	v_mul_f32 v227, v227, v155
	v_cvt_pk_bf16_f32 v212, v212, v213
	v_cvt_pk_bf16_f32 v213, v214, v215
	v_cvt_pk_bf16_f32 v214, v216, v217
	v_cvt_pk_bf16_f32 v215, v218, v219
	s_nop 0
	v_permlane32_swap_b32 v212, v214
	v_permlane32_swap_b32 v213, v215
	v_cvt_pk_bf16_f32 v220, v220, v221
	v_cvt_pk_bf16_f32 v221, v222, v223
	v_cvt_pk_bf16_f32 v222, v224, v225
	v_cvt_pk_bf16_f32 v223, v226, v227
	s_nop 0
	v_permlane32_swap_b32 v220, v222
	v_permlane32_swap_b32 v221, v223
	s_nop 0
	v_permlane16_swap_b32 v212, v220
	v_permlane16_swap_b32 v213, v221
	v_permlane16_swap_b32 v214, v222
	v_permlane16_swap_b32 v215, v223
	v_mov_b32 v232, v192
	v_mov_b32 v233, v193
	v_mov_b32 v234, v194
	v_mov_b32 v235, v195
	v_mov_b32_dpp v192, v212 row_ror:8 row_mask:0xf bank_mask:0xc
	v_mov_b32_dpp v193, v213 row_ror:8 row_mask:0xf bank_mask:0xc
	v_mov_b32_dpp v194, v214 row_ror:8 row_mask:0xf bank_mask:0xc
	v_mov_b32_dpp v195, v215 row_ror:8 row_mask:0xf bank_mask:0xc
	v_mov_b32_dpp v212, v232 row_ror:8 row_mask:0xf bank_mask:0x3
	v_mov_b32_dpp v213, v233 row_ror:8 row_mask:0xf bank_mask:0x3
	v_mov_b32_dpp v214, v234 row_ror:8 row_mask:0xf bank_mask:0x3
	v_mov_b32_dpp v215, v235 row_ror:8 row_mask:0xf bank_mask:0x3
	v_mov_b32 v232, v200
	v_mov_b32 v233, v201
	v_mov_b32 v234, v202
	v_mov_b32 v235, v203
	v_mov_b32_dpp v200, v220 row_ror:8 row_mask:0xf bank_mask:0xc
	v_mov_b32_dpp v201, v221 row_ror:8 row_mask:0xf bank_mask:0xc
	v_mov_b32_dpp v202, v222 row_ror:8 row_mask:0xf bank_mask:0xc
	v_mov_b32_dpp v203, v223 row_ror:8 row_mask:0xf bank_mask:0xc
	v_mov_b32_dpp v220, v232 row_ror:8 row_mask:0xf bank_mask:0x3
	v_mov_b32_dpp v221, v233 row_ror:8 row_mask:0xf bank_mask:0x3
	v_mov_b32_dpp v222, v234 row_ror:8 row_mask:0xf bank_mask:0x3
	v_mov_b32_dpp v223, v235 row_ror:8 row_mask:0xf bank_mask:0x3
	s_mul_i32 s23, s22, 1
	s_add_u32 s23, s23, s25
	buffer_store_dwordx4 v[192:195], v188, s[8:11], s23 offen offset:128 sc1
	buffer_store_dwordx4 v[212:215], v189, s[8:11], s23 offen offset:128 sc1
	buffer_store_dwordx4 v[200:203], v190, s[8:11], s23 offen offset:128 sc1
	buffer_store_dwordx4 v[220:223], v191, s[8:11], s23 offen offset:128 sc1
	v_accvgpr_read_b32 v80, a160
	v_accvgpr_read_b32 v81, a161
	v_accvgpr_read_b32 v82, a162
	v_accvgpr_read_b32 v83, a163
	v_accvgpr_read_b32 v84, a164
	v_accvgpr_read_b32 v85, a165
	v_accvgpr_read_b32 v86, a166
	v_accvgpr_read_b32 v87, a167
	v_accvgpr_read_b32 v88, a168
	v_accvgpr_read_b32 v89, a169
	v_accvgpr_read_b32 v90, a170
	v_accvgpr_read_b32 v91, a171
	v_accvgpr_read_b32 v92, a172
	v_accvgpr_read_b32 v93, a173
	v_accvgpr_read_b32 v94, a174
	v_accvgpr_read_b32 v95, a175
	v_add_f32 v80, v80, v120
	v_add_f32 v81, v81, v121
	v_add_f32 v82, v82, v122
	v_add_f32 v83, v83, v123
	v_mul_f32 v152, v80, v80
	v_mul_f32 v153, v81, v81
	v_mul_f32 v154, v82, v82
	v_mul_f32 v155, v83, v83
	v_fma_f32 v152, v152, s41, v156
	v_fma_f32 v153, v153, s41, v156
	v_fma_f32 v154, v154, s41, v156
	v_fma_f32 v155, v155, s41, v156
	v_mul_f32 v152, v152, v80
	v_mul_f32 v153, v153, v81
	v_mul_f32 v154, v154, v82
	v_mul_f32 v155, v155, v83
	v_exp_f32 v152, v152
	v_exp_f32 v153, v153
	v_exp_f32 v154, v154
	v_exp_f32 v155, v155
	v_add_f32 v152, 1.0, v152
	v_add_f32 v153, 1.0, v153
	v_add_f32 v154, 1.0, v154
	v_add_f32 v155, 1.0, v155
	v_rcp_f32 v152, v152
	v_rcp_f32 v153, v153
	v_rcp_f32 v154, v154
	v_rcp_f32 v155, v155
	v_mul_f32 v80, v80, v152
	v_mul_f32 v81, v81, v153
	v_mul_f32 v82, v82, v154
	v_mul_f32 v83, v83, v155
	v_add_f32 v84, v84, v124
	v_add_f32 v85, v85, v125
	v_add_f32 v86, v86, v126
	v_add_f32 v87, v87, v127
	v_mul_f32 v152, v84, v84
	v_mul_f32 v153, v85, v85
	v_mul_f32 v154, v86, v86
	v_mul_f32 v155, v87, v87
	v_fma_f32 v152, v152, s41, v156
	v_fma_f32 v153, v153, s41, v156
	v_fma_f32 v154, v154, s41, v156
	v_fma_f32 v155, v155, s41, v156
	v_mul_f32 v152, v152, v84
	v_mul_f32 v153, v153, v85
	v_mul_f32 v154, v154, v86
	v_mul_f32 v155, v155, v87
	v_exp_f32 v152, v152
	v_exp_f32 v153, v153
	v_exp_f32 v154, v154
	v_exp_f32 v155, v155
	v_add_f32 v152, 1.0, v152
	v_add_f32 v153, 1.0, v153
	v_add_f32 v154, 1.0, v154
	v_add_f32 v155, 1.0, v155
	v_rcp_f32 v152, v152
	v_rcp_f32 v153, v153
	v_rcp_f32 v154, v154
	v_rcp_f32 v155, v155
	v_mul_f32 v84, v84, v152
	v_mul_f32 v85, v85, v153
	v_mul_f32 v86, v86, v154
	v_mul_f32 v87, v87, v155
	v_add_f32 v88, v88, v128
	v_add_f32 v89, v89, v129
	v_add_f32 v90, v90, v130
	v_add_f32 v91, v91, v131
	v_mul_f32 v152, v88, v88
	v_mul_f32 v153, v89, v89
	v_mul_f32 v154, v90, v90
	v_mul_f32 v155, v91, v91
	v_fma_f32 v152, v152, s41, v156
	v_fma_f32 v153, v153, s41, v156
	v_fma_f32 v154, v154, s41, v156
	v_fma_f32 v155, v155, s41, v156
	v_mul_f32 v152, v152, v88
	v_mul_f32 v153, v153, v89
	v_mul_f32 v154, v154, v90
	v_mul_f32 v155, v155, v91
	v_exp_f32 v152, v152
	v_exp_f32 v153, v153
	v_exp_f32 v154, v154
	v_exp_f32 v155, v155
	v_add_f32 v152, 1.0, v152
	v_add_f32 v153, 1.0, v153
	v_add_f32 v154, 1.0, v154
	v_add_f32 v155, 1.0, v155
	v_rcp_f32 v152, v152
	v_rcp_f32 v153, v153
	v_rcp_f32 v154, v154
	v_rcp_f32 v155, v155
	v_mul_f32 v88, v88, v152
	v_mul_f32 v89, v89, v153
	v_mul_f32 v90, v90, v154
	v_mul_f32 v91, v91, v155
	v_add_f32 v92, v92, v132
	v_add_f32 v93, v93, v133
	v_add_f32 v94, v94, v134
	v_add_f32 v95, v95, v135
	v_mul_f32 v152, v92, v92
	v_mul_f32 v153, v93, v93
	v_mul_f32 v154, v94, v94
	v_mul_f32 v155, v95, v95
	v_fma_f32 v152, v152, s41, v156
	v_fma_f32 v153, v153, s41, v156
	v_fma_f32 v154, v154, s41, v156
	v_fma_f32 v155, v155, s41, v156
	v_mul_f32 v152, v152, v92
	v_mul_f32 v153, v153, v93
	v_mul_f32 v154, v154, v94
	v_mul_f32 v155, v155, v95
	v_exp_f32 v152, v152
	v_exp_f32 v153, v153
	v_exp_f32 v154, v154
	v_exp_f32 v155, v155
	v_add_f32 v152, 1.0, v152
	v_add_f32 v153, 1.0, v153
	v_add_f32 v154, 1.0, v154
	v_add_f32 v155, 1.0, v155
	v_rcp_f32 v152, v152
	v_rcp_f32 v153, v153
	v_rcp_f32 v154, v154
	v_rcp_f32 v155, v155
	v_mul_f32 v92, v92, v152
	v_mul_f32 v93, v93, v153
	v_mul_f32 v94, v94, v154
	v_mul_f32 v95, v95, v155
	v_cvt_pk_bf16_f32 v80, v80, v81
	v_cvt_pk_bf16_f32 v81, v82, v83
	v_cvt_pk_bf16_f32 v82, v84, v85
	v_cvt_pk_bf16_f32 v83, v86, v87
	s_nop 0
	v_permlane32_swap_b32 v80, v82
	v_permlane32_swap_b32 v81, v83
	v_cvt_pk_bf16_f32 v88, v88, v89
	v_cvt_pk_bf16_f32 v89, v90, v91
	v_cvt_pk_bf16_f32 v90, v92, v93
	v_cvt_pk_bf16_f32 v91, v94, v95
	s_nop 0
	v_permlane32_swap_b32 v88, v90
	v_permlane32_swap_b32 v89, v91
	s_nop 0
	v_permlane16_swap_b32 v80, v88
	v_permlane16_swap_b32 v81, v89
	v_permlane16_swap_b32 v82, v90
	v_permlane16_swap_b32 v83, v91
	v_accvgpr_read_b32 v100, a224
	v_accvgpr_read_b32 v101, a225
	v_accvgpr_read_b32 v102, a226
	v_accvgpr_read_b32 v103, a227
	v_accvgpr_read_b32 v104, a228
	v_accvgpr_read_b32 v105, a229
	v_accvgpr_read_b32 v106, a230
	v_accvgpr_read_b32 v107, a231
	v_accvgpr_read_b32 v108, a232
	v_accvgpr_read_b32 v109, a233
	v_accvgpr_read_b32 v110, a234
	v_accvgpr_read_b32 v111, a235
	v_accvgpr_read_b32 v112, a236
	v_accvgpr_read_b32 v113, a237
	v_accvgpr_read_b32 v114, a238
	v_accvgpr_read_b32 v115, a239
	v_add_f32 v100, v100, v164
	v_add_f32 v101, v101, v165
	v_add_f32 v102, v102, v166
	v_add_f32 v103, v103, v167
	v_mul_f32 v152, v100, v100
	v_mul_f32 v153, v101, v101
	v_mul_f32 v154, v102, v102
	v_mul_f32 v155, v103, v103
	v_fma_f32 v152, v152, s41, v156
	v_fma_f32 v153, v153, s41, v156
	v_fma_f32 v154, v154, s41, v156
	v_fma_f32 v155, v155, s41, v156
	v_mul_f32 v152, v152, v100
	v_mul_f32 v153, v153, v101
	v_mul_f32 v154, v154, v102
	v_mul_f32 v155, v155, v103
	v_exp_f32 v152, v152
	v_exp_f32 v153, v153
	v_exp_f32 v154, v154
	v_exp_f32 v155, v155
	v_add_f32 v152, 1.0, v152
	v_add_f32 v153, 1.0, v153
	v_add_f32 v154, 1.0, v154
	v_add_f32 v155, 1.0, v155
	v_rcp_f32 v152, v152
	v_rcp_f32 v153, v153
	v_rcp_f32 v154, v154
	v_rcp_f32 v155, v155
	v_mul_f32 v100, v100, v152
	v_mul_f32 v101, v101, v153
	v_mul_f32 v102, v102, v154
	v_mul_f32 v103, v103, v155
	v_add_f32 v104, v104, v168
	v_add_f32 v105, v105, v169
	v_add_f32 v106, v106, v170
	v_add_f32 v107, v107, v171
	v_mul_f32 v152, v104, v104
	v_mul_f32 v153, v105, v105
	v_mul_f32 v154, v106, v106
	v_mul_f32 v155, v107, v107
	v_fma_f32 v152, v152, s41, v156
	v_fma_f32 v153, v153, s41, v156
	v_fma_f32 v154, v154, s41, v156
	v_fma_f32 v155, v155, s41, v156
	v_mul_f32 v152, v152, v104
	v_mul_f32 v153, v153, v105
	v_mul_f32 v154, v154, v106
	v_mul_f32 v155, v155, v107
	v_exp_f32 v152, v152
	v_exp_f32 v153, v153
	v_exp_f32 v154, v154
	v_exp_f32 v155, v155
	v_add_f32 v152, 1.0, v152
	v_add_f32 v153, 1.0, v153
	v_add_f32 v154, 1.0, v154
	v_add_f32 v155, 1.0, v155
	v_rcp_f32 v152, v152
	v_rcp_f32 v153, v153
	v_rcp_f32 v154, v154
	v_rcp_f32 v155, v155
	v_mul_f32 v104, v104, v152
	v_mul_f32 v105, v105, v153
	v_mul_f32 v106, v106, v154
	v_mul_f32 v107, v107, v155
	v_add_f32 v108, v108, v172
	v_add_f32 v109, v109, v173
	v_add_f32 v110, v110, v174
	v_add_f32 v111, v111, v175
	v_mul_f32 v152, v108, v108
	v_mul_f32 v153, v109, v109
	v_mul_f32 v154, v110, v110
	v_mul_f32 v155, v111, v111
	v_fma_f32 v152, v152, s41, v156
	v_fma_f32 v153, v153, s41, v156
	v_fma_f32 v154, v154, s41, v156
	v_fma_f32 v155, v155, s41, v156
	v_mul_f32 v152, v152, v108
	v_mul_f32 v153, v153, v109
	v_mul_f32 v154, v154, v110
	v_mul_f32 v155, v155, v111
	v_exp_f32 v152, v152
	v_exp_f32 v153, v153
	v_exp_f32 v154, v154
	v_exp_f32 v155, v155
	v_add_f32 v152, 1.0, v152
	v_add_f32 v153, 1.0, v153
	v_add_f32 v154, 1.0, v154
	v_add_f32 v155, 1.0, v155
	v_rcp_f32 v152, v152
	v_rcp_f32 v153, v153
	v_rcp_f32 v154, v154
	v_rcp_f32 v155, v155
	v_mul_f32 v108, v108, v152
	v_mul_f32 v109, v109, v153
	v_mul_f32 v110, v110, v154
	v_mul_f32 v111, v111, v155
	v_add_f32 v112, v112, v176
	v_add_f32 v113, v113, v177
	v_add_f32 v114, v114, v178
	v_add_f32 v115, v115, v179
	v_mul_f32 v152, v112, v112
	v_mul_f32 v153, v113, v113
	v_mul_f32 v154, v114, v114
	v_mul_f32 v155, v115, v115
	v_fma_f32 v152, v152, s41, v156
	v_fma_f32 v153, v153, s41, v156
	v_fma_f32 v154, v154, s41, v156
	v_fma_f32 v155, v155, s41, v156
	v_mul_f32 v152, v152, v112
	v_mul_f32 v153, v153, v113
	v_mul_f32 v154, v154, v114
	v_mul_f32 v155, v155, v115
	v_exp_f32 v152, v152
	v_exp_f32 v153, v153
	v_exp_f32 v154, v154
	v_exp_f32 v155, v155
	v_add_f32 v152, 1.0, v152
	v_add_f32 v153, 1.0, v153
	v_add_f32 v154, 1.0, v154
	v_add_f32 v155, 1.0, v155
	v_rcp_f32 v152, v152
	v_rcp_f32 v153, v153
	v_rcp_f32 v154, v154
	v_rcp_f32 v155, v155
	v_mul_f32 v112, v112, v152
	v_mul_f32 v113, v113, v153
	v_mul_f32 v114, v114, v154
	v_mul_f32 v115, v115, v155
	v_cvt_pk_bf16_f32 v100, v100, v101
	v_cvt_pk_bf16_f32 v101, v102, v103
	v_cvt_pk_bf16_f32 v102, v104, v105
	v_cvt_pk_bf16_f32 v103, v106, v107
	s_nop 0
	v_permlane32_swap_b32 v100, v102
	v_permlane32_swap_b32 v101, v103
	v_cvt_pk_bf16_f32 v108, v108, v109
	v_cvt_pk_bf16_f32 v109, v110, v111
	v_cvt_pk_bf16_f32 v110, v112, v113
	v_cvt_pk_bf16_f32 v111, v114, v115
	s_nop 0
	v_permlane32_swap_b32 v108, v110
	v_permlane32_swap_b32 v109, v111
	s_nop 0
	v_permlane16_swap_b32 v100, v108
	v_permlane16_swap_b32 v101, v109
	v_permlane16_swap_b32 v102, v110
	v_permlane16_swap_b32 v103, v111
	v_mov_b32 v232, v80
	v_mov_b32 v233, v81
	v_mov_b32 v234, v82
	v_mov_b32 v235, v83
	v_mov_b32_dpp v80, v100 row_ror:8 row_mask:0xf bank_mask:0xc
	v_mov_b32_dpp v81, v101 row_ror:8 row_mask:0xf bank_mask:0xc
	v_mov_b32_dpp v82, v102 row_ror:8 row_mask:0xf bank_mask:0xc
	v_mov_b32_dpp v83, v103 row_ror:8 row_mask:0xf bank_mask:0xc
	v_mov_b32_dpp v100, v232 row_ror:8 row_mask:0xf bank_mask:0x3
	v_mov_b32_dpp v101, v233 row_ror:8 row_mask:0xf bank_mask:0x3
	v_mov_b32_dpp v102, v234 row_ror:8 row_mask:0xf bank_mask:0x3
	v_mov_b32_dpp v103, v235 row_ror:8 row_mask:0xf bank_mask:0x3
	v_mov_b32 v232, v88
	v_mov_b32 v233, v89
	v_mov_b32 v234, v90
	v_mov_b32 v235, v91
	v_mov_b32_dpp v88, v108 row_ror:8 row_mask:0xf bank_mask:0xc
	v_mov_b32_dpp v89, v109 row_ror:8 row_mask:0xf bank_mask:0xc
	v_mov_b32_dpp v90, v110 row_ror:8 row_mask:0xf bank_mask:0xc
	v_mov_b32_dpp v91, v111 row_ror:8 row_mask:0xf bank_mask:0xc
	v_mov_b32_dpp v108, v232 row_ror:8 row_mask:0xf bank_mask:0x3
	v_mov_b32_dpp v109, v233 row_ror:8 row_mask:0xf bank_mask:0x3
	v_mov_b32_dpp v110, v234 row_ror:8 row_mask:0xf bank_mask:0x3
	v_mov_b32_dpp v111, v235 row_ror:8 row_mask:0xf bank_mask:0x3
	s_mul_i32 s23, s22, 2
	s_add_u32 s23, s23, s25
	buffer_store_dwordx4 v[80:83], v188, s[8:11], s23 offen offset:128 sc1
	buffer_store_dwordx4 v[100:103], v189, s[8:11], s23 offen offset:128 sc1
	buffer_store_dwordx4 v[88:91], v190, s[8:11], s23 offen offset:128 sc1
	buffer_store_dwordx4 v[108:111], v191, s[8:11], s23 offen offset:128 sc1
	v_accvgpr_read_b32 v192, a176
	v_accvgpr_read_b32 v193, a177
	v_accvgpr_read_b32 v194, a178
	v_accvgpr_read_b32 v195, a179
	v_accvgpr_read_b32 v196, a180
	v_accvgpr_read_b32 v197, a181
	v_accvgpr_read_b32 v198, a182
	v_accvgpr_read_b32 v199, a183
	v_accvgpr_read_b32 v200, a184
	v_accvgpr_read_b32 v201, a185
	v_accvgpr_read_b32 v202, a186
	v_accvgpr_read_b32 v203, a187
	v_accvgpr_read_b32 v204, a188
	v_accvgpr_read_b32 v205, a189
	v_accvgpr_read_b32 v206, a190
	v_accvgpr_read_b32 v207, a191
	v_add_f32 v192, v192, v120
	v_add_f32 v193, v193, v121
	v_add_f32 v194, v194, v122
	v_add_f32 v195, v195, v123
	v_mul_f32 v152, v192, v192
	v_mul_f32 v153, v193, v193
	v_mul_f32 v154, v194, v194
	v_mul_f32 v155, v195, v195
	v_fma_f32 v152, v152, s41, v156
	v_fma_f32 v153, v153, s41, v156
	v_fma_f32 v154, v154, s41, v156
	v_fma_f32 v155, v155, s41, v156
	v_mul_f32 v152, v152, v192
	v_mul_f32 v153, v153, v193
	v_mul_f32 v154, v154, v194
	v_mul_f32 v155, v155, v195
	v_exp_f32 v152, v152
	v_exp_f32 v153, v153
	v_exp_f32 v154, v154
	v_exp_f32 v155, v155
	v_add_f32 v152, 1.0, v152
	v_add_f32 v153, 1.0, v153
	v_add_f32 v154, 1.0, v154
	v_add_f32 v155, 1.0, v155
	v_rcp_f32 v152, v152
	v_rcp_f32 v153, v153
	v_rcp_f32 v154, v154
	v_rcp_f32 v155, v155
	v_mul_f32 v192, v192, v152
	v_mul_f32 v193, v193, v153
	v_mul_f32 v194, v194, v154
	v_mul_f32 v195, v195, v155
	v_add_f32 v196, v196, v124
	v_add_f32 v197, v197, v125
	v_add_f32 v198, v198, v126
	v_add_f32 v199, v199, v127
	v_mul_f32 v152, v196, v196
	v_mul_f32 v153, v197, v197
	v_mul_f32 v154, v198, v198
	v_mul_f32 v155, v199, v199
	v_fma_f32 v152, v152, s41, v156
	v_fma_f32 v153, v153, s41, v156
	v_fma_f32 v154, v154, s41, v156
	v_fma_f32 v155, v155, s41, v156
	v_mul_f32 v152, v152, v196
	v_mul_f32 v153, v153, v197
	v_mul_f32 v154, v154, v198
	v_mul_f32 v155, v155, v199
	v_exp_f32 v152, v152
	v_exp_f32 v153, v153
	v_exp_f32 v154, v154
	v_exp_f32 v155, v155
	v_add_f32 v152, 1.0, v152
	v_add_f32 v153, 1.0, v153
	v_add_f32 v154, 1.0, v154
	v_add_f32 v155, 1.0, v155
	v_rcp_f32 v152, v152
	v_rcp_f32 v153, v153
	v_rcp_f32 v154, v154
	v_rcp_f32 v155, v155
	v_mul_f32 v196, v196, v152
	v_mul_f32 v197, v197, v153
	v_mul_f32 v198, v198, v154
	v_mul_f32 v199, v199, v155
	v_add_f32 v200, v200, v128
	v_add_f32 v201, v201, v129
	v_add_f32 v202, v202, v130
	v_add_f32 v203, v203, v131
	v_mul_f32 v152, v200, v200
	v_mul_f32 v153, v201, v201
	v_mul_f32 v154, v202, v202
	v_mul_f32 v155, v203, v203
	v_fma_f32 v152, v152, s41, v156
	v_fma_f32 v153, v153, s41, v156
	v_fma_f32 v154, v154, s41, v156
	v_fma_f32 v155, v155, s41, v156
	v_mul_f32 v152, v152, v200
	v_mul_f32 v153, v153, v201
	v_mul_f32 v154, v154, v202
	v_mul_f32 v155, v155, v203
	v_exp_f32 v152, v152
	v_exp_f32 v153, v153
	v_exp_f32 v154, v154
	v_exp_f32 v155, v155
	v_add_f32 v152, 1.0, v152
	v_add_f32 v153, 1.0, v153
	v_add_f32 v154, 1.0, v154
	v_add_f32 v155, 1.0, v155
	v_rcp_f32 v152, v152
	v_rcp_f32 v153, v153
	v_rcp_f32 v154, v154
	v_rcp_f32 v155, v155
	v_mul_f32 v200, v200, v152
	v_mul_f32 v201, v201, v153
	v_mul_f32 v202, v202, v154
	v_mul_f32 v203, v203, v155
	v_add_f32 v204, v204, v132
	v_add_f32 v205, v205, v133
	v_add_f32 v206, v206, v134
	v_add_f32 v207, v207, v135
	v_mul_f32 v152, v204, v204
	v_mul_f32 v153, v205, v205
	v_mul_f32 v154, v206, v206
	v_mul_f32 v155, v207, v207
	v_fma_f32 v152, v152, s41, v156
	v_fma_f32 v153, v153, s41, v156
	v_fma_f32 v154, v154, s41, v156
	v_fma_f32 v155, v155, s41, v156
	v_mul_f32 v152, v152, v204
	v_mul_f32 v153, v153, v205
	v_mul_f32 v154, v154, v206
	v_mul_f32 v155, v155, v207
	v_exp_f32 v152, v152
	v_exp_f32 v153, v153
	v_exp_f32 v154, v154
	v_exp_f32 v155, v155
	v_add_f32 v152, 1.0, v152
	v_add_f32 v153, 1.0, v153
	v_add_f32 v154, 1.0, v154
	v_add_f32 v155, 1.0, v155
	v_rcp_f32 v152, v152
	v_rcp_f32 v153, v153
	v_rcp_f32 v154, v154
	v_rcp_f32 v155, v155
	v_mul_f32 v204, v204, v152
	v_mul_f32 v205, v205, v153
	v_mul_f32 v206, v206, v154
	v_mul_f32 v207, v207, v155
	v_cvt_pk_bf16_f32 v192, v192, v193
	v_cvt_pk_bf16_f32 v193, v194, v195
	v_cvt_pk_bf16_f32 v194, v196, v197
	v_cvt_pk_bf16_f32 v195, v198, v199
	s_nop 0
	v_permlane32_swap_b32 v192, v194
	v_permlane32_swap_b32 v193, v195
	v_cvt_pk_bf16_f32 v200, v200, v201
	v_cvt_pk_bf16_f32 v201, v202, v203
	v_cvt_pk_bf16_f32 v202, v204, v205
	v_cvt_pk_bf16_f32 v203, v206, v207
	s_nop 0
	v_permlane32_swap_b32 v200, v202
	v_permlane32_swap_b32 v201, v203
	s_nop 0
	v_permlane16_swap_b32 v192, v200
	v_permlane16_swap_b32 v193, v201
	v_permlane16_swap_b32 v194, v202
	v_permlane16_swap_b32 v195, v203
	v_accvgpr_read_b32 v212, a240
	v_accvgpr_read_b32 v213, a241
	v_accvgpr_read_b32 v214, a242
	v_accvgpr_read_b32 v215, a243
	v_accvgpr_read_b32 v216, a244
	v_accvgpr_read_b32 v217, a245
	v_accvgpr_read_b32 v218, a246
	v_accvgpr_read_b32 v219, a247
	v_accvgpr_read_b32 v220, a248
	v_accvgpr_read_b32 v221, a249
	v_accvgpr_read_b32 v222, a250
	v_accvgpr_read_b32 v223, a251
	v_accvgpr_read_b32 v224, a252
	v_accvgpr_read_b32 v225, a253
	v_accvgpr_read_b32 v226, a254
	v_accvgpr_read_b32 v227, a255
	v_add_f32 v212, v212, v164
	v_add_f32 v213, v213, v165
	v_add_f32 v214, v214, v166
	v_add_f32 v215, v215, v167
	v_mul_f32 v152, v212, v212
	v_mul_f32 v153, v213, v213
	v_mul_f32 v154, v214, v214
	v_mul_f32 v155, v215, v215
	v_fma_f32 v152, v152, s41, v156
	v_fma_f32 v153, v153, s41, v156
	v_fma_f32 v154, v154, s41, v156
	v_fma_f32 v155, v155, s41, v156
	v_mul_f32 v152, v152, v212
	v_mul_f32 v153, v153, v213
	v_mul_f32 v154, v154, v214
	v_mul_f32 v155, v155, v215
	v_exp_f32 v152, v152
	v_exp_f32 v153, v153
	v_exp_f32 v154, v154
	v_exp_f32 v155, v155
	v_add_f32 v152, 1.0, v152
	v_add_f32 v153, 1.0, v153
	v_add_f32 v154, 1.0, v154
	v_add_f32 v155, 1.0, v155
	v_rcp_f32 v152, v152
	v_rcp_f32 v153, v153
	v_rcp_f32 v154, v154
	v_rcp_f32 v155, v155
	v_mul_f32 v212, v212, v152
	v_mul_f32 v213, v213, v153
	v_mul_f32 v214, v214, v154
	v_mul_f32 v215, v215, v155
	v_add_f32 v216, v216, v168
	v_add_f32 v217, v217, v169
	v_add_f32 v218, v218, v170
	v_add_f32 v219, v219, v171
	v_mul_f32 v152, v216, v216
	v_mul_f32 v153, v217, v217
	v_mul_f32 v154, v218, v218
	v_mul_f32 v155, v219, v219
	v_fma_f32 v152, v152, s41, v156
	v_fma_f32 v153, v153, s41, v156
	v_fma_f32 v154, v154, s41, v156
	v_fma_f32 v155, v155, s41, v156
	v_mul_f32 v152, v152, v216
	v_mul_f32 v153, v153, v217
	v_mul_f32 v154, v154, v218
	v_mul_f32 v155, v155, v219
	v_exp_f32 v152, v152
	v_exp_f32 v153, v153
	v_exp_f32 v154, v154
	v_exp_f32 v155, v155
	v_add_f32 v152, 1.0, v152
	v_add_f32 v153, 1.0, v153
	v_add_f32 v154, 1.0, v154
	v_add_f32 v155, 1.0, v155
	v_rcp_f32 v152, v152
	v_rcp_f32 v153, v153
	v_rcp_f32 v154, v154
	v_rcp_f32 v155, v155
	v_mul_f32 v216, v216, v152
	v_mul_f32 v217, v217, v153
	v_mul_f32 v218, v218, v154
	v_mul_f32 v219, v219, v155
	v_add_f32 v220, v220, v172
	v_add_f32 v221, v221, v173
	v_add_f32 v222, v222, v174
	v_add_f32 v223, v223, v175
	v_mul_f32 v152, v220, v220
	v_mul_f32 v153, v221, v221
	v_mul_f32 v154, v222, v222
	v_mul_f32 v155, v223, v223
	v_fma_f32 v152, v152, s41, v156
	v_fma_f32 v153, v153, s41, v156
	v_fma_f32 v154, v154, s41, v156
	v_fma_f32 v155, v155, s41, v156
	v_mul_f32 v152, v152, v220
	v_mul_f32 v153, v153, v221
	v_mul_f32 v154, v154, v222
	v_mul_f32 v155, v155, v223
	v_exp_f32 v152, v152
	v_exp_f32 v153, v153
	v_exp_f32 v154, v154
	v_exp_f32 v155, v155
	v_add_f32 v152, 1.0, v152
	v_add_f32 v153, 1.0, v153
	v_add_f32 v154, 1.0, v154
	v_add_f32 v155, 1.0, v155
	v_rcp_f32 v152, v152
	v_rcp_f32 v153, v153
	v_rcp_f32 v154, v154
	v_rcp_f32 v155, v155
	v_mul_f32 v220, v220, v152
	v_mul_f32 v221, v221, v153
	v_mul_f32 v222, v222, v154
	v_mul_f32 v223, v223, v155
	v_add_f32 v224, v224, v176
	v_add_f32 v225, v225, v177
	v_add_f32 v226, v226, v178
	v_add_f32 v227, v227, v179
	v_mul_f32 v152, v224, v224
	v_mul_f32 v153, v225, v225
	v_mul_f32 v154, v226, v226
	v_mul_f32 v155, v227, v227
	v_fma_f32 v152, v152, s41, v156
	v_fma_f32 v153, v153, s41, v156
	v_fma_f32 v154, v154, s41, v156
	v_fma_f32 v155, v155, s41, v156
	v_mul_f32 v152, v152, v224
	v_mul_f32 v153, v153, v225
	v_mul_f32 v154, v154, v226
	v_mul_f32 v155, v155, v227
	v_exp_f32 v152, v152
	v_exp_f32 v153, v153
	v_exp_f32 v154, v154
	v_exp_f32 v155, v155
	v_add_f32 v152, 1.0, v152
	v_add_f32 v153, 1.0, v153
	v_add_f32 v154, 1.0, v154
	v_add_f32 v155, 1.0, v155
	v_rcp_f32 v152, v152
	v_rcp_f32 v153, v153
	v_rcp_f32 v154, v154
	v_rcp_f32 v155, v155
	v_mul_f32 v224, v224, v152
	v_mul_f32 v225, v225, v153
	v_mul_f32 v226, v226, v154
	v_mul_f32 v227, v227, v155
	v_cvt_pk_bf16_f32 v212, v212, v213
	v_cvt_pk_bf16_f32 v213, v214, v215
	v_cvt_pk_bf16_f32 v214, v216, v217
	v_cvt_pk_bf16_f32 v215, v218, v219
	s_nop 0
	v_permlane32_swap_b32 v212, v214
	v_permlane32_swap_b32 v213, v215
	v_cvt_pk_bf16_f32 v220, v220, v221
	v_cvt_pk_bf16_f32 v221, v222, v223
	v_cvt_pk_bf16_f32 v222, v224, v225
	v_cvt_pk_bf16_f32 v223, v226, v227
	s_nop 0
	v_permlane32_swap_b32 v220, v222
	v_permlane32_swap_b32 v221, v223
	s_nop 0
	v_permlane16_swap_b32 v212, v220
	v_permlane16_swap_b32 v213, v221
	v_permlane16_swap_b32 v214, v222
	v_permlane16_swap_b32 v215, v223
	v_mov_b32 v232, v192
	v_mov_b32 v233, v193
	v_mov_b32 v234, v194
	v_mov_b32 v235, v195
	v_mov_b32_dpp v192, v212 row_ror:8 row_mask:0xf bank_mask:0xc
	v_mov_b32_dpp v193, v213 row_ror:8 row_mask:0xf bank_mask:0xc
	v_mov_b32_dpp v194, v214 row_ror:8 row_mask:0xf bank_mask:0xc
	v_mov_b32_dpp v195, v215 row_ror:8 row_mask:0xf bank_mask:0xc
	v_mov_b32_dpp v212, v232 row_ror:8 row_mask:0xf bank_mask:0x3
	v_mov_b32_dpp v213, v233 row_ror:8 row_mask:0xf bank_mask:0x3
	v_mov_b32_dpp v214, v234 row_ror:8 row_mask:0xf bank_mask:0x3
	v_mov_b32_dpp v215, v235 row_ror:8 row_mask:0xf bank_mask:0x3
	v_mov_b32 v232, v200
	v_mov_b32 v233, v201
	v_mov_b32 v234, v202
	v_mov_b32 v235, v203
	v_mov_b32_dpp v200, v220 row_ror:8 row_mask:0xf bank_mask:0xc
	v_mov_b32_dpp v201, v221 row_ror:8 row_mask:0xf bank_mask:0xc
	v_mov_b32_dpp v202, v222 row_ror:8 row_mask:0xf bank_mask:0xc
	v_mov_b32_dpp v203, v223 row_ror:8 row_mask:0xf bank_mask:0xc
	v_mov_b32_dpp v220, v232 row_ror:8 row_mask:0xf bank_mask:0x3
	v_mov_b32_dpp v221, v233 row_ror:8 row_mask:0xf bank_mask:0x3
	v_mov_b32_dpp v222, v234 row_ror:8 row_mask:0xf bank_mask:0x3
	v_mov_b32_dpp v223, v235 row_ror:8 row_mask:0xf bank_mask:0x3
	s_mul_i32 s23, s22, 3
	s_add_u32 s23, s23, s25
	buffer_store_dwordx4 v[192:195], v188, s[8:11], s23 offen offset:128 sc1
	buffer_store_dwordx4 v[212:215], v189, s[8:11], s23 offen offset:128 sc1
	buffer_store_dwordx4 v[200:203], v190, s[8:11], s23 offen offset:128 sc1
	buffer_store_dwordx4 v[220:223], v191, s[8:11], s23 offen offset:128 sc1
	s_branch main_kernel_g1_done
main_kernel_g1_vt:
	s_lshl_b32 s40, s4, 10
	s_mul_i32 s41, s4, 6144
	s_lshl_b32 s42, s18, 6
	s_mov_b32 s19, s16
	s_mov_b32 s20, s17
	s_add_u32 m0, s40, 0
	s_add_u32 s21, s19, 0
	buffer_load_dwordx4 v1, s[8:11], s21 offen lds
	s_add_u32 m0, s40, 4096
	s_add_u32 s21, s19, 36864
	buffer_load_dwordx4 v1, s[8:11], s21 offen lds
	s_add_u32 m0, s40, 8192
	s_add_u32 s21, s19, 73728
	buffer_load_dwordx4 v1, s[8:11], s21 offen lds
	s_add_u32 m0, s40, 12288
	s_add_u32 s21, s19, 110592
	buffer_load_dwordx4 v1, s[8:11], s21 offen lds
	s_add_u32 m0, s40, 16384
	s_add_u32 s21, s19, 147456
	buffer_load_dwordx4 v1, s[8:11], s21 offen lds
	s_add_u32 m0, s40, 20480
	s_add_u32 s21, s19, 184320
	buffer_load_dwordx4 v1, s[8:11], s21 offen lds
	s_add_u32 m0, s40, 24576
	s_add_u32 s21, s19, 221184
	buffer_load_dwordx4 v1, s[8:11], s21 offen lds
	s_add_u32 m0, s40, 28672
	s_add_u32 s21, s19, 258048
	buffer_load_dwordx4 v1, s[8:11], s21 offen lds
	s_add_u32 m0, s40, 32768
	s_mov_b32 s22, s20
	buffer_load_dwordx4 v2, s[12:15], s22 offen lds
	s_add_u32 m0, s40, 36864
	s_add_u32 s22, s22, s24
	buffer_load_dwordx4 v2, s[12:15], s22 offen lds
	s_add_u32 m0, s40, 40960
	s_add_u32 s22, s22, s24
	buffer_load_dwordx4 v2, s[12:15], s22 offen lds
	s_add_u32 m0, s40, 45056
	s_add_u32 s22, s22, s24
	buffer_load_dwordx4 v2, s[12:15], s22 offen lds
	s_add_u32 m0, s40, 49152
	s_add_u32 s22, s22, s24
	buffer_load_dwordx4 v2, s[12:15], s22 offen lds
	s_add_u32 m0, s40, 53248
	s_add_u32 s22, s22, s24
	buffer_load_dwordx4 v2, s[12:15], s22 offen lds
	s_add_u32 m0, s40, 57344
	s_add_u32 s22, s22, s24
	buffer_load_dwordx4 v2, s[12:15], s22 offen lds
	s_add_u32 m0, s40, 61440
	s_add_u32 s22, s22, s24
	buffer_load_dwordx4 v2, s[12:15], s22 offen lds
	s_add_u32 s19, s19, 128
	s_add_u32 s20, s20, s42
	s_add_u32 m0, s40, 65536
	s_add_u32 s21, s19, 0
	buffer_load_dwordx4 v1, s[8:11], s21 offen lds
	s_add_u32 m0, s40, 69632
	s_add_u32 s21, s19, 36864
	buffer_load_dwordx4 v1, s[8:11], s21 offen lds
	s_add_u32 m0, s40, 73728
	s_add_u32 s21, s19, 73728
	buffer_load_dwordx4 v1, s[8:11], s21 offen lds
	s_add_u32 m0, s40, 77824
	s_add_u32 s21, s19, 110592
	buffer_load_dwordx4 v1, s[8:11], s21 offen lds
	s_add_u32 m0, s40, 81920
	s_add_u32 s21, s19, 147456
	buffer_load_dwordx4 v1, s[8:11], s21 offen lds
	s_add_u32 m0, s40, 86016
	s_add_u32 s21, s19, 184320
	buffer_load_dwordx4 v1, s[8:11], s21 offen lds
	s_add_u32 m0, s40, 90112
	s_add_u32 s21, s19, 221184
	buffer_load_dwordx4 v1, s[8:11], s21 offen lds
	s_add_u32 m0, s40, 94208
	s_add_u32 s21, s19, 258048
	buffer_load_dwordx4 v1, s[8:11], s21 offen lds
	s_add_u32 m0, s40, 98304
	s_mov_b32 s22, s20
	buffer_load_dwordx4 v2, s[12:15], s22 offen lds
	s_add_u32 m0, s40, 102400
	s_add_u32 s22, s22, s24
	buffer_load_dwordx4 v2, s[12:15], s22 offen lds
	s_add_u32 m0, s40, 106496
	s_add_u32 s22, s22, s24
	buffer_load_dwordx4 v2, s[12:15], s22 offen lds
	s_add_u32 m0, s40, 110592
	s_add_u32 s22, s22, s24
	buffer_load_dwordx4 v2, s[12:15], s22 offen lds
	s_add_u32 m0, s40, 114688
	s_add_u32 s22, s22, s24
	buffer_load_dwordx4 v2, s[12:15], s22 offen lds
	s_add_u32 m0, s40, 118784
	s_add_u32 s22, s22, s24
	buffer_load_dwordx4 v2, s[12:15], s22 offen lds
	s_add_u32 m0, s40, 122880
	s_add_u32 s22, s22, s24
	buffer_load_dwordx4 v2, s[12:15], s22 offen lds
	s_add_u32 m0, s40, 126976
	s_add_u32 s22, s22, s24
	buffer_load_dwordx4 v2, s[12:15], s22 offen lds
	s_add_u32 s19, s19, 128
	s_add_u32 s20, s20, s42
	s_waitcnt vmcnt(16)
	s_barrier
	ds_read_b64_tr_b16 v[16:17], v9 offset:0
	ds_read_b64_tr_b16 v[18:19], v9 offset:2048
	ds_read_b128 v[32:35], v5 offset:0
	ds_read_b64_tr_b16 v[20:21], v10 offset:0
	ds_read_b64_tr_b16 v[22:23], v10 offset:2048
	ds_read_b128 v[36:39], v5 offset:4096
	ds_read_b128 v[40:43], v5 offset:8192
	ds_read_b128 v[44:47], v5 offset:12288
	ds_read_b64_tr_b16 v[24:25], v11 offset:0
	ds_read_b64_tr_b16 v[26:27], v11 offset:2048
	ds_read_b64_tr_b16 v[28:29], v12 offset:0
	ds_read_b64_tr_b16 v[30:31], v12 offset:2048
	s_waitcnt lgkmcnt(9)
	v_mfma_f32_32x32x16_bf16 a[0:15], v[32:35], v[16:19], 0
	ds_read_b64_tr_b16 v[48:49], v9 offset:8192
	s_waitcnt lgkmcnt(7)
	v_mfma_f32_32x32x16_bf16 a[16:31], v[36:39], v[16:19], 0
	ds_read_b64_tr_b16 v[50:51], v9 offset:10240
	s_waitcnt lgkmcnt(7)
	v_mfma_f32_32x32x16_bf16 a[32:47], v[40:43], v[16:19], 0
	ds_read_b128 v[64:67], v6 offset:0
	s_waitcnt lgkmcnt(7)
	v_mfma_f32_32x32x16_bf16 a[48:63], v[44:47], v[16:19], 0
	v_mfma_f32_32x32x16_bf16 a[64:79], v[32:35], v[20:23], 0
	ds_read_b64_tr_b16 v[52:53], v10 offset:8192
	v_mfma_f32_32x32x16_bf16 a[80:95], v[36:39], v[20:23], 0
	ds_read_b64_tr_b16 v[54:55], v10 offset:10240
	v_mfma_f32_32x32x16_bf16 a[96:111], v[40:43], v[20:23], 0
	ds_read_b128 v[68:71], v6 offset:4096
	v_mfma_f32_32x32x16_bf16 a[112:127], v[44:47], v[20:23], 0
	s_waitcnt lgkmcnt(8)
	v_mfma_f32_32x32x16_bf16 a[128:143], v[32:35], v[24:27], 0
	ds_read_b128 v[72:75], v6 offset:8192
	v_mfma_f32_32x32x16_bf16 a[144:159], v[36:39], v[24:27], 0
	ds_read_b128 v[76:79], v6 offset:12288
	v_mfma_f32_32x32x16_bf16 a[160:175], v[40:43], v[24:27], 0
	ds_read_b64_tr_b16 v[56:57], v11 offset:8192
	v_mfma_f32_32x32x16_bf16 a[176:191], v[44:47], v[24:27], 0
	s_waitcnt lgkmcnt(9)
	v_mfma_f32_32x32x16_bf16 a[192:207], v[32:35], v[28:31], 0
	ds_read_b64_tr_b16 v[58:59], v11 offset:10240
	v_mfma_f32_32x32x16_bf16 a[208:223], v[36:39], v[28:31], 0
	ds_read_b64_tr_b16 v[60:61], v12 offset:8192
	v_mfma_f32_32x32x16_bf16 a[224:239], v[40:43], v[28:31], 0
	ds_read_b64_tr_b16 v[62:63], v12 offset:10240
	v_mfma_f32_32x32x16_bf16 a[240:255], v[44:47], v[28:31], 0
	s_waitcnt lgkmcnt(9)
	v_mfma_f32_32x32x16_bf16 a[0:15], v[64:67], v[48:51], a[0:15]
	ds_read_b64_tr_b16 v[16:17], v9 offset:16384
	s_waitcnt lgkmcnt(7)
	v_mfma_f32_32x32x16_bf16 a[16:31], v[68:71], v[48:51], a[16:31]
	ds_read_b64_tr_b16 v[18:19], v9 offset:18432
	s_waitcnt lgkmcnt(7)
	v_mfma_f32_32x32x16_bf16 a[32:47], v[72:75], v[48:51], a[32:47]
	ds_read_b128 v[32:35], v7 offset:0
	s_waitcnt lgkmcnt(7)
	v_mfma_f32_32x32x16_bf16 a[48:63], v[76:79], v[48:51], a[48:63]
	v_mfma_f32_32x32x16_bf16 a[64:79], v[64:67], v[52:55], a[64:79]
	ds_read_b64_tr_b16 v[20:21], v10 offset:16384
	v_mfma_f32_32x32x16_bf16 a[80:95], v[68:71], v[52:55], a[80:95]
	ds_read_b64_tr_b16 v[22:23], v10 offset:18432
	v_mfma_f32_32x32x16_bf16 a[96:111], v[72:75], v[52:55], a[96:111]
	ds_read_b128 v[36:39], v7 offset:4096
	v_mfma_f32_32x32x16_bf16 a[112:127], v[76:79], v[52:55], a[112:127]
	s_waitcnt lgkmcnt(8)
	v_mfma_f32_32x32x16_bf16 a[128:143], v[64:67], v[56:59], a[128:143]
	ds_read_b128 v[40:43], v7 offset:8192
	v_mfma_f32_32x32x16_bf16 a[144:159], v[68:71], v[56:59], a[144:159]
	ds_read_b128 v[44:47], v7 offset:12288
	v_mfma_f32_32x32x16_bf16 a[160:175], v[72:75], v[56:59], a[160:175]
	ds_read_b64_tr_b16 v[24:25], v11 offset:16384
	v_mfma_f32_32x32x16_bf16 a[176:191], v[76:79], v[56:59], a[176:191]
	s_waitcnt lgkmcnt(9)
	v_mfma_f32_32x32x16_bf16 a[192:207], v[64:67], v[60:63], a[192:207]
	ds_read_b64_tr_b16 v[26:27], v11 offset:18432
	v_mfma_f32_32x32x16_bf16 a[208:223], v[68:71], v[60:63], a[208:223]
	ds_read_b64_tr_b16 v[28:29], v12 offset:16384
	v_mfma_f32_32x32x16_bf16 a[224:239], v[72:75], v[60:63], a[224:239]
	ds_read_b64_tr_b16 v[30:31], v12 offset:18432
	v_mfma_f32_32x32x16_bf16 a[240:255], v[76:79], v[60:63], a[240:255]
	s_waitcnt lgkmcnt(9)
	v_mfma_f32_32x32x16_bf16 a[0:15], v[32:35], v[16:19], a[0:15]
	ds_read_b64_tr_b16 v[48:49], v9 offset:24576
	s_waitcnt lgkmcnt(7)
	v_mfma_f32_32x32x16_bf16 a[16:31], v[36:39], v[16:19], a[16:31]
	ds_read_b64_tr_b16 v[50:51], v9 offset:26624
	s_waitcnt lgkmcnt(7)
	v_mfma_f32_32x32x16_bf16 a[32:47], v[40:43], v[16:19], a[32:47]
	ds_read_b128 v[64:67], v8 offset:0
	s_waitcnt lgkmcnt(7)
	v_mfma_f32_32x32x16_bf16 a[48:63], v[44:47], v[16:19], a[48:63]
	v_mfma_f32_32x32x16_bf16 a[64:79], v[32:35], v[20:23], a[64:79]
	ds_read_b64_tr_b16 v[52:53], v10 offset:24576
	v_mfma_f32_32x32x16_bf16 a[80:95], v[36:39], v[20:23], a[80:95]
	ds_read_b64_tr_b16 v[54:55], v10 offset:26624
	v_mfma_f32_32x32x16_bf16 a[96:111], v[40:43], v[20:23], a[96:111]
	ds_read_b128 v[68:71], v8 offset:4096
	v_mfma_f32_32x32x16_bf16 a[112:127], v[44:47], v[20:23], a[112:127]
	s_waitcnt lgkmcnt(8)
	v_mfma_f32_32x32x16_bf16 a[128:143], v[32:35], v[24:27], a[128:143]
	ds_read_b128 v[72:75], v8 offset:8192
	v_mfma_f32_32x32x16_bf16 a[144:159], v[36:39], v[24:27], a[144:159]
	ds_read_b128 v[76:79], v8 offset:12288
	v_mfma_f32_32x32x16_bf16 a[160:175], v[40:43], v[24:27], a[160:175]
	ds_read_b64_tr_b16 v[56:57], v11 offset:24576
	v_mfma_f32_32x32x16_bf16 a[176:191], v[44:47], v[24:27], a[176:191]
	s_waitcnt lgkmcnt(9)
	v_mfma_f32_32x32x16_bf16 a[192:207], v[32:35], v[28:31], a[192:207]
	ds_read_b64_tr_b16 v[58:59], v11 offset:26624
	v_mfma_f32_32x32x16_bf16 a[208:223], v[36:39], v[28:31], a[208:223]
	ds_read_b64_tr_b16 v[60:61], v12 offset:24576
	v_mfma_f32_32x32x16_bf16 a[224:239], v[40:43], v[28:31], a[224:239]
	ds_read_b64_tr_b16 v[62:63], v12 offset:26624
	v_mfma_f32_32x32x16_bf16 a[240:255], v[44:47], v[28:31], a[240:255]
	s_waitcnt vmcnt(0) lgkmcnt(0)
	s_barrier
	v_add_u32 v5, 0x10000, v5
	v_add_u32 v6, 0x10000, v6
	v_add_u32 v7, 0x10000, v7
	v_add_u32 v8, 0x10000, v8
	v_add_u32 v9, 0x10000, v9
	v_add_u32 v10, 0x10000, v10
	v_add_u32 v11, 0x10000, v11
	v_add_u32 v12, 0x10000, v12
	v_mfma_f32_32x32x16_bf16 a[0:15], v[64:67], v[48:51], a[0:15]
	ds_read_b64_tr_b16 v[16:17], v9 offset:0
	ds_read_b64_tr_b16 v[18:19], v9 offset:2048
	v_mfma_f32_32x32x16_bf16 a[16:31], v[68:71], v[48:51], a[16:31]
	ds_read_b128 v[32:35], v5 offset:0
	s_add_u32 m0, s40, 0
	s_add_u32 s21, s19, 0
	buffer_load_dwordx4 v1, s[8:11], s21 offen lds
	v_mfma_f32_32x32x16_bf16 a[32:47], v[72:75], v[48:51], a[32:47]
	s_add_u32 m0, s40, 4096
	s_add_u32 s21, s19, 36864
	buffer_load_dwordx4 v1, s[8:11], s21 offen lds
	s_add_u32 m0, s40, 8192
	s_add_u32 s21, s19, 73728
	buffer_load_dwordx4 v1, s[8:11], s21 offen lds
	v_mfma_f32_32x32x16_bf16 a[48:63], v[76:79], v[48:51], a[48:63]
	s_add_u32 m0, s40, 12288
	s_add_u32 s21, s19, 110592
	buffer_load_dwordx4 v1, s[8:11], s21 offen lds
	ds_read_b64_tr_b16 v[20:21], v10 offset:0
	v_mfma_f32_32x32x16_bf16 a[64:79], v[64:67], v[52:55], a[64:79]
	ds_read_b64_tr_b16 v[22:23], v10 offset:2048
	ds_read_b128 v[36:39], v5 offset:4096
	v_mfma_f32_32x32x16_bf16 a[80:95], v[68:71], v[52:55], a[80:95]
	ds_read_b128 v[40:43], v5 offset:8192
	v_mfma_f32_32x32x16_bf16 a[96:111], v[72:75], v[52:55], a[96:111]
	ds_read_b128 v[44:47], v5 offset:12288
	ds_read_b64_tr_b16 v[24:25], v11 offset:0
	v_mfma_f32_32x32x16_bf16 a[112:127], v[76:79], v[52:55], a[112:127]
	ds_read_b64_tr_b16 v[26:27], v11 offset:2048
	ds_read_b64_tr_b16 v[28:29], v12 offset:0
	v_mfma_f32_32x32x16_bf16 a[128:143], v[64:67], v[56:59], a[128:143]
	ds_read_b64_tr_b16 v[30:31], v12 offset:2048
	s_add_u32 m0, s40, 16384
	s_add_u32 s21, s19, 147456
	buffer_load_dwordx4 v1, s[8:11], s21 offen lds
	v_mfma_f32_32x32x16_bf16 a[144:159], v[68:71], v[56:59], a[144:159]
	s_add_u32 m0, s40, 20480
	s_add_u32 s21, s19, 184320
	buffer_load_dwordx4 v1, s[8:11], s21 offen lds
	s_add_u32 m0, s40, 24576
	s_add_u32 s21, s19, 221184
	buffer_load_dwordx4 v1, s[8:11], s21 offen lds
	v_mfma_f32_32x32x16_bf16 a[160:175], v[72:75], v[56:59], a[160:175]
	s_add_u32 m0, s40, 28672
	s_add_u32 s21, s19, 258048
	buffer_load_dwordx4 v1, s[8:11], s21 offen lds
	v_mfma_f32_32x32x16_bf16 a[176:191], v[76:79], v[56:59], a[176:191]
	s_add_u32 m0, s40, 32768
	s_mov_b32 s22, s20
	buffer_load_dwordx4 v2, s[12:15], s22 offen lds
	s_add_u32 m0, s40, 36864
	s_add_u32 s22, s22, s24
	buffer_load_dwordx4 v2, s[12:15], s22 offen lds
	v_mfma_f32_32x32x16_bf16 a[192:207], v[64:67], v[60:63], a[192:207]
	s_add_u32 m0, s40, 40960
	s_add_u32 s22, s22, s24
	buffer_load_dwordx4 v2, s[12:15], s22 offen lds
	s_add_u32 m0, s40, 45056
	s_add_u32 s22, s22, s24
	buffer_load_dwordx4 v2, s[12:15], s22 offen lds
	v_mfma_f32_32x32x16_bf16 a[208:223], v[68:71], v[60:63], a[208:223]
	s_add_u32 m0, s40, 49152
	s_add_u32 s22, s22, s24
	buffer_load_dwordx4 v2, s[12:15], s22 offen lds
	s_add_u32 m0, s40, 53248
	s_add_u32 s22, s22, s24
	buffer_load_dwordx4 v2, s[12:15], s22 offen lds
	v_mfma_f32_32x32x16_bf16 a[224:239], v[72:75], v[60:63], a[224:239]
	s_add_u32 m0, s40, 57344
	s_add_u32 s22, s22, s24
	buffer_load_dwordx4 v2, s[12:15], s22 offen lds
	s_add_u32 m0, s40, 61440
	s_add_u32 s22, s22, s24
	buffer_load_dwordx4 v2, s[12:15], s22 offen lds
	v_mfma_f32_32x32x16_bf16 a[240:255], v[76:79], v[60:63], a[240:255]
	s_add_u32 s19, s19, 128
	s_add_u32 s20, s20, s42
	s_waitcnt lgkmcnt(9)
	v_mfma_f32_32x32x16_bf16 a[0:15], v[32:35], v[16:19], a[0:15]
	ds_read_b64_tr_b16 v[48:49], v9 offset:8192
	s_waitcnt lgkmcnt(7)
	v_mfma_f32_32x32x16_bf16 a[16:31], v[36:39], v[16:19], a[16:31]
	ds_read_b64_tr_b16 v[50:51], v9 offset:10240
	s_waitcnt lgkmcnt(7)
	v_mfma_f32_32x32x16_bf16 a[32:47], v[40:43], v[16:19], a[32:47]
	ds_read_b128 v[64:67], v6 offset:0
	s_waitcnt lgkmcnt(7)
	v_mfma_f32_32x32x16_bf16 a[48:63], v[44:47], v[16:19], a[48:63]
	v_mfma_f32_32x32x16_bf16 a[64:79], v[32:35], v[20:23], a[64:79]
	ds_read_b64_tr_b16 v[52:53], v10 offset:8192
	v_mfma_f32_32x32x16_bf16 a[80:95], v[36:39], v[20:23], a[80:95]
	ds_read_b64_tr_b16 v[54:55], v10 offset:10240
	v_mfma_f32_32x32x16_bf16 a[96:111], v[40:43], v[20:23], a[96:111]
	ds_read_b128 v[68:71], v6 offset:4096
	v_mfma_f32_32x32x16_bf16 a[112:127], v[44:47], v[20:23], a[112:127]
	s_waitcnt lgkmcnt(8)
	v_mfma_f32_32x32x16_bf16 a[128:143], v[32:35], v[24:27], a[128:143]
	ds_read_b128 v[72:75], v6 offset:8192
	v_mfma_f32_32x32x16_bf16 a[144:159], v[36:39], v[24:27], a[144:159]
	ds_read_b128 v[76:79], v6 offset:12288
	v_mfma_f32_32x32x16_bf16 a[160:175], v[40:43], v[24:27], a[160:175]
	ds_read_b64_tr_b16 v[56:57], v11 offset:8192
	v_mfma_f32_32x32x16_bf16 a[176:191], v[44:47], v[24:27], a[176:191]
	s_waitcnt lgkmcnt(9)
	v_mfma_f32_32x32x16_bf16 a[192:207], v[32:35], v[28:31], a[192:207]
	ds_read_b64_tr_b16 v[58:59], v11 offset:10240
	v_mfma_f32_32x32x16_bf16 a[208:223], v[36:39], v[28:31], a[208:223]
	ds_read_b64_tr_b16 v[60:61], v12 offset:8192
	v_mfma_f32_32x32x16_bf16 a[224:239], v[40:43], v[28:31], a[224:239]
	ds_read_b64_tr_b16 v[62:63], v12 offset:10240
	v_mfma_f32_32x32x16_bf16 a[240:255], v[44:47], v[28:31], a[240:255]
	s_waitcnt lgkmcnt(9)
	v_mfma_f32_32x32x16_bf16 a[0:15], v[64:67], v[48:51], a[0:15]
	ds_read_b64_tr_b16 v[16:17], v9 offset:16384
	s_waitcnt lgkmcnt(7)
	v_mfma_f32_32x32x16_bf16 a[16:31], v[68:71], v[48:51], a[16:31]
	ds_read_b64_tr_b16 v[18:19], v9 offset:18432
	s_waitcnt lgkmcnt(7)
	v_mfma_f32_32x32x16_bf16 a[32:47], v[72:75], v[48:51], a[32:47]
	ds_read_b128 v[32:35], v7 offset:0
	s_waitcnt lgkmcnt(7)
	v_mfma_f32_32x32x16_bf16 a[48:63], v[76:79], v[48:51], a[48:63]
	v_mfma_f32_32x32x16_bf16 a[64:79], v[64:67], v[52:55], a[64:79]
	ds_read_b64_tr_b16 v[20:21], v10 offset:16384
	v_mfma_f32_32x32x16_bf16 a[80:95], v[68:71], v[52:55], a[80:95]
	ds_read_b64_tr_b16 v[22:23], v10 offset:18432
	v_mfma_f32_32x32x16_bf16 a[96:111], v[72:75], v[52:55], a[96:111]
	ds_read_b128 v[36:39], v7 offset:4096
	v_mfma_f32_32x32x16_bf16 a[112:127], v[76:79], v[52:55], a[112:127]
	s_waitcnt lgkmcnt(8)
	v_mfma_f32_32x32x16_bf16 a[128:143], v[64:67], v[56:59], a[128:143]
	ds_read_b128 v[40:43], v7 offset:8192
	v_mfma_f32_32x32x16_bf16 a[144:159], v[68:71], v[56:59], a[144:159]
	ds_read_b128 v[44:47], v7 offset:12288
	v_mfma_f32_32x32x16_bf16 a[160:175], v[72:75], v[56:59], a[160:175]
	ds_read_b64_tr_b16 v[24:25], v11 offset:16384
	v_mfma_f32_32x32x16_bf16 a[176:191], v[76:79], v[56:59], a[176:191]
	s_waitcnt lgkmcnt(9)
	v_mfma_f32_32x32x16_bf16 a[192:207], v[64:67], v[60:63], a[192:207]
	ds_read_b64_tr_b16 v[26:27], v11 offset:18432
	v_mfma_f32_32x32x16_bf16 a[208:223], v[68:71], v[60:63], a[208:223]
	ds_read_b64_tr_b16 v[28:29], v12 offset:16384
	v_mfma_f32_32x32x16_bf16 a[224:239], v[72:75], v[60:63], a[224:239]
	ds_read_b64_tr_b16 v[30:31], v12 offset:18432
	v_mfma_f32_32x32x16_bf16 a[240:255], v[76:79], v[60:63], a[240:255]
	s_waitcnt lgkmcnt(9)
	v_mfma_f32_32x32x16_bf16 a[0:15], v[32:35], v[16:19], a[0:15]
	ds_read_b64_tr_b16 v[48:49], v9 offset:24576
	s_waitcnt lgkmcnt(7)
	v_mfma_f32_32x32x16_bf16 a[16:31], v[36:39], v[16:19], a[16:31]
	ds_read_b64_tr_b16 v[50:51], v9 offset:26624
	s_waitcnt lgkmcnt(7)
	v_mfma_f32_32x32x16_bf16 a[32:47], v[40:43], v[16:19], a[32:47]
	ds_read_b128 v[64:67], v8 offset:0
	s_waitcnt lgkmcnt(7)
	v_mfma_f32_32x32x16_bf16 a[48:63], v[44:47], v[16:19], a[48:63]
	v_mfma_f32_32x32x16_bf16 a[64:79], v[32:35], v[20:23], a[64:79]
	ds_read_b64_tr_b16 v[52:53], v10 offset:24576
	v_mfma_f32_32x32x16_bf16 a[80:95], v[36:39], v[20:23], a[80:95]
	ds_read_b64_tr_b16 v[54:55], v10 offset:26624
	v_mfma_f32_32x32x16_bf16 a[96:111], v[40:43], v[20:23], a[96:111]
	ds_read_b128 v[68:71], v8 offset:4096
	v_mfma_f32_32x32x16_bf16 a[112:127], v[44:47], v[20:23], a[112:127]
	s_waitcnt lgkmcnt(8)
	v_mfma_f32_32x32x16_bf16 a[128:143], v[32:35], v[24:27], a[128:143]
	ds_read_b128 v[72:75], v8 offset:8192
	v_mfma_f32_32x32x16_bf16 a[144:159], v[36:39], v[24:27], a[144:159]
	ds_read_b128 v[76:79], v8 offset:12288
	v_mfma_f32_32x32x16_bf16 a[160:175], v[40:43], v[24:27], a[160:175]
	ds_read_b64_tr_b16 v[56:57], v11 offset:24576
	v_mfma_f32_32x32x16_bf16 a[176:191], v[44:47], v[24:27], a[176:191]
	s_waitcnt lgkmcnt(9)
	v_mfma_f32_32x32x16_bf16 a[192:207], v[32:35], v[28:31], a[192:207]
	ds_read_b64_tr_b16 v[58:59], v11 offset:26624
	v_mfma_f32_32x32x16_bf16 a[208:223], v[36:39], v[28:31], a[208:223]
	ds_read_b64_tr_b16 v[60:61], v12 offset:24576
	v_mfma_f32_32x32x16_bf16 a[224:239], v[40:43], v[28:31], a[224:239]
	ds_read_b64_tr_b16 v[62:63], v12 offset:26624
	v_mfma_f32_32x32x16_bf16 a[240:255], v[44:47], v[28:31], a[240:255]
	s_waitcnt vmcnt(0) lgkmcnt(0)
	s_barrier
	v_add_u32 v5, 0xffff0000, v5
	v_add_u32 v6, 0xffff0000, v6
	v_add_u32 v7, 0xffff0000, v7
	v_add_u32 v8, 0xffff0000, v8
	v_add_u32 v9, 0xffff0000, v9
	v_add_u32 v10, 0xffff0000, v10
	v_add_u32 v11, 0xffff0000, v11
	v_add_u32 v12, 0xffff0000, v12
	v_mfma_f32_32x32x16_bf16 a[0:15], v[64:67], v[48:51], a[0:15]
	ds_read_b64_tr_b16 v[16:17], v9 offset:0
	ds_read_b64_tr_b16 v[18:19], v9 offset:2048
	v_mfma_f32_32x32x16_bf16 a[16:31], v[68:71], v[48:51], a[16:31]
	ds_read_b128 v[32:35], v5 offset:0
	s_add_u32 m0, s40, 65536
	s_add_u32 s21, s19, 0
	buffer_load_dwordx4 v1, s[8:11], s21 offen lds
	v_mfma_f32_32x32x16_bf16 a[32:47], v[72:75], v[48:51], a[32:47]
	s_add_u32 m0, s40, 69632
	s_add_u32 s21, s19, 36864
	buffer_load_dwordx4 v1, s[8:11], s21 offen lds
	s_add_u32 m0, s40, 73728
	s_add_u32 s21, s19, 73728
	buffer_load_dwordx4 v1, s[8:11], s21 offen lds
	v_mfma_f32_32x32x16_bf16 a[48:63], v[76:79], v[48:51], a[48:63]
	s_add_u32 m0, s40, 77824
	s_add_u32 s21, s19, 110592
	buffer_load_dwordx4 v1, s[8:11], s21 offen lds
	ds_read_b64_tr_b16 v[20:21], v10 offset:0
	v_mfma_f32_32x32x16_bf16 a[64:79], v[64:67], v[52:55], a[64:79]
	ds_read_b64_tr_b16 v[22:23], v10 offset:2048
	ds_read_b128 v[36:39], v5 offset:4096
	v_mfma_f32_32x32x16_bf16 a[80:95], v[68:71], v[52:55], a[80:95]
	ds_read_b128 v[40:43], v5 offset:8192
	v_mfma_f32_32x32x16_bf16 a[96:111], v[72:75], v[52:55], a[96:111]
	ds_read_b128 v[44:47], v5 offset:12288
	ds_read_b64_tr_b16 v[24:25], v11 offset:0
	v_mfma_f32_32x32x16_bf16 a[112:127], v[76:79], v[52:55], a[112:127]
	ds_read_b64_tr_b16 v[26:27], v11 offset:2048
	ds_read_b64_tr_b16 v[28:29], v12 offset:0
	v_mfma_f32_32x32x16_bf16 a[128:143], v[64:67], v[56:59], a[128:143]
	ds_read_b64_tr_b16 v[30:31], v12 offset:2048
	s_add_u32 m0, s40, 81920
	s_add_u32 s21, s19, 147456
	buffer_load_dwordx4 v1, s[8:11], s21 offen lds
	v_mfma_f32_32x32x16_bf16 a[144:159], v[68:71], v[56:59], a[144:159]
	s_add_u32 m0, s40, 86016
	s_add_u32 s21, s19, 184320
	buffer_load_dwordx4 v1, s[8:11], s21 offen lds
	s_add_u32 m0, s40, 90112
	s_add_u32 s21, s19, 221184
	buffer_load_dwordx4 v1, s[8:11], s21 offen lds
	v_mfma_f32_32x32x16_bf16 a[160:175], v[72:75], v[56:59], a[160:175]
	s_add_u32 m0, s40, 94208
	s_add_u32 s21, s19, 258048
	buffer_load_dwordx4 v1, s[8:11], s21 offen lds
	v_mfma_f32_32x32x16_bf16 a[176:191], v[76:79], v[56:59], a[176:191]
	s_add_u32 m0, s40, 98304
	s_mov_b32 s22, s20
	buffer_load_dwordx4 v2, s[12:15], s22 offen lds
	s_add_u32 m0, s40, 102400
	s_add_u32 s22, s22, s24
	buffer_load_dwordx4 v2, s[12:15], s22 offen lds
	v_mfma_f32_32x32x16_bf16 a[192:207], v[64:67], v[60:63], a[192:207]
	s_add_u32 m0, s40, 106496
	s_add_u32 s22, s22, s24
	buffer_load_dwordx4 v2, s[12:15], s22 offen lds
	s_add_u32 m0, s40, 110592
	s_add_u32 s22, s22, s24
	buffer_load_dwordx4 v2, s[12:15], s22 offen lds
	v_mfma_f32_32x32x16_bf16 a[208:223], v[68:71], v[60:63], a[208:223]
	s_add_u32 m0, s40, 114688
	s_add_u32 s22, s22, s24
	buffer_load_dwordx4 v2, s[12:15], s22 offen lds
	s_add_u32 m0, s40, 118784
	s_add_u32 s22, s22, s24
	buffer_load_dwordx4 v2, s[12:15], s22 offen lds
	v_mfma_f32_32x32x16_bf16 a[224:239], v[72:75], v[60:63], a[224:239]
	s_add_u32 m0, s40, 122880
	s_add_u32 s22, s22, s24
	buffer_load_dwordx4 v2, s[12:15], s22 offen lds
	s_add_u32 m0, s40, 126976
	s_add_u32 s22, s22, s24
	buffer_load_dwordx4 v2, s[12:15], s22 offen lds
	v_mfma_f32_32x32x16_bf16 a[240:255], v[76:79], v[60:63], a[240:255]
	s_add_u32 s19, s19, 128
	s_add_u32 s20, s20, s42
	s_waitcnt lgkmcnt(9)
	v_mfma_f32_32x32x16_bf16 a[0:15], v[32:35], v[16:19], a[0:15]
	ds_read_b64_tr_b16 v[48:49], v9 offset:8192
	s_waitcnt lgkmcnt(7)
	v_mfma_f32_32x32x16_bf16 a[16:31], v[36:39], v[16:19], a[16:31]
	ds_read_b64_tr_b16 v[50:51], v9 offset:10240
	s_waitcnt lgkmcnt(7)
	v_mfma_f32_32x32x16_bf16 a[32:47], v[40:43], v[16:19], a[32:47]
	ds_read_b128 v[64:67], v6 offset:0
	s_waitcnt lgkmcnt(7)
	v_mfma_f32_32x32x16_bf16 a[48:63], v[44:47], v[16:19], a[48:63]
	v_mfma_f32_32x32x16_bf16 a[64:79], v[32:35], v[20:23], a[64:79]
	ds_read_b64_tr_b16 v[52:53], v10 offset:8192
	v_mfma_f32_32x32x16_bf16 a[80:95], v[36:39], v[20:23], a[80:95]
	ds_read_b64_tr_b16 v[54:55], v10 offset:10240
	v_mfma_f32_32x32x16_bf16 a[96:111], v[40:43], v[20:23], a[96:111]
	ds_read_b128 v[68:71], v6 offset:4096
	v_mfma_f32_32x32x16_bf16 a[112:127], v[44:47], v[20:23], a[112:127]
	s_waitcnt lgkmcnt(8)
	v_mfma_f32_32x32x16_bf16 a[128:143], v[32:35], v[24:27], a[128:143]
	ds_read_b128 v[72:75], v6 offset:8192
	v_mfma_f32_32x32x16_bf16 a[144:159], v[36:39], v[24:27], a[144:159]
	ds_read_b128 v[76:79], v6 offset:12288
	v_mfma_f32_32x32x16_bf16 a[160:175], v[40:43], v[24:27], a[160:175]
	ds_read_b64_tr_b16 v[56:57], v11 offset:8192
	v_mfma_f32_32x32x16_bf16 a[176:191], v[44:47], v[24:27], a[176:191]
	s_waitcnt lgkmcnt(9)
	v_mfma_f32_32x32x16_bf16 a[192:207], v[32:35], v[28:31], a[192:207]
	ds_read_b64_tr_b16 v[58:59], v11 offset:10240
	v_mfma_f32_32x32x16_bf16 a[208:223], v[36:39], v[28:31], a[208:223]
	ds_read_b64_tr_b16 v[60:61], v12 offset:8192
	v_mfma_f32_32x32x16_bf16 a[224:239], v[40:43], v[28:31], a[224:239]
	ds_read_b64_tr_b16 v[62:63], v12 offset:10240
	v_mfma_f32_32x32x16_bf16 a[240:255], v[44:47], v[28:31], a[240:255]
	s_waitcnt lgkmcnt(9)
	v_mfma_f32_32x32x16_bf16 a[0:15], v[64:67], v[48:51], a[0:15]
	ds_read_b64_tr_b16 v[16:17], v9 offset:16384
	s_waitcnt lgkmcnt(7)
	v_mfma_f32_32x32x16_bf16 a[16:31], v[68:71], v[48:51], a[16:31]
	ds_read_b64_tr_b16 v[18:19], v9 offset:18432
	s_waitcnt lgkmcnt(7)
	v_mfma_f32_32x32x16_bf16 a[32:47], v[72:75], v[48:51], a[32:47]
	ds_read_b128 v[32:35], v7 offset:0
	s_waitcnt lgkmcnt(7)
	v_mfma_f32_32x32x16_bf16 a[48:63], v[76:79], v[48:51], a[48:63]
	v_mfma_f32_32x32x16_bf16 a[64:79], v[64:67], v[52:55], a[64:79]
	ds_read_b64_tr_b16 v[20:21], v10 offset:16384
	v_mfma_f32_32x32x16_bf16 a[80:95], v[68:71], v[52:55], a[80:95]
	ds_read_b64_tr_b16 v[22:23], v10 offset:18432
	v_mfma_f32_32x32x16_bf16 a[96:111], v[72:75], v[52:55], a[96:111]
	ds_read_b128 v[36:39], v7 offset:4096
	v_mfma_f32_32x32x16_bf16 a[112:127], v[76:79], v[52:55], a[112:127]
	s_waitcnt lgkmcnt(8)
	v_mfma_f32_32x32x16_bf16 a[128:143], v[64:67], v[56:59], a[128:143]
	ds_read_b128 v[40:43], v7 offset:8192
	v_mfma_f32_32x32x16_bf16 a[144:159], v[68:71], v[56:59], a[144:159]
	ds_read_b128 v[44:47], v7 offset:12288
	v_mfma_f32_32x32x16_bf16 a[160:175], v[72:75], v[56:59], a[160:175]
	ds_read_b64_tr_b16 v[24:25], v11 offset:16384
	v_mfma_f32_32x32x16_bf16 a[176:191], v[76:79], v[56:59], a[176:191]
	s_waitcnt lgkmcnt(9)
	v_mfma_f32_32x32x16_bf16 a[192:207], v[64:67], v[60:63], a[192:207]
	ds_read_b64_tr_b16 v[26:27], v11 offset:18432
	v_mfma_f32_32x32x16_bf16 a[208:223], v[68:71], v[60:63], a[208:223]
	ds_read_b64_tr_b16 v[28:29], v12 offset:16384
	v_mfma_f32_32x32x16_bf16 a[224:239], v[72:75], v[60:63], a[224:239]
	ds_read_b64_tr_b16 v[30:31], v12 offset:18432
	v_mfma_f32_32x32x16_bf16 a[240:255], v[76:79], v[60:63], a[240:255]
	s_waitcnt lgkmcnt(9)
	v_mfma_f32_32x32x16_bf16 a[0:15], v[32:35], v[16:19], a[0:15]
	ds_read_b64_tr_b16 v[48:49], v9 offset:24576
	s_waitcnt lgkmcnt(7)
	v_mfma_f32_32x32x16_bf16 a[16:31], v[36:39], v[16:19], a[16:31]
	ds_read_b64_tr_b16 v[50:51], v9 offset:26624
	s_waitcnt lgkmcnt(7)
	v_mfma_f32_32x32x16_bf16 a[32:47], v[40:43], v[16:19], a[32:47]
	ds_read_b128 v[64:67], v8 offset:0
	s_waitcnt lgkmcnt(7)
	v_mfma_f32_32x32x16_bf16 a[48:63], v[44:47], v[16:19], a[48:63]
	v_mfma_f32_32x32x16_bf16 a[64:79], v[32:35], v[20:23], a[64:79]
	ds_read_b64_tr_b16 v[52:53], v10 offset:24576
	v_mfma_f32_32x32x16_bf16 a[80:95], v[36:39], v[20:23], a[80:95]
	ds_read_b64_tr_b16 v[54:55], v10 offset:26624
	v_mfma_f32_32x32x16_bf16 a[96:111], v[40:43], v[20:23], a[96:111]
	ds_read_b128 v[68:71], v8 offset:4096
	v_mfma_f32_32x32x16_bf16 a[112:127], v[44:47], v[20:23], a[112:127]
	s_waitcnt lgkmcnt(8)
	v_mfma_f32_32x32x16_bf16 a[128:143], v[32:35], v[24:27], a[128:143]
	ds_read_b128 v[72:75], v8 offset:8192
	v_mfma_f32_32x32x16_bf16 a[144:159], v[36:39], v[24:27], a[144:159]
	ds_read_b128 v[76:79], v8 offset:12288
	v_mfma_f32_32x32x16_bf16 a[160:175], v[40:43], v[24:27], a[160:175]
	ds_read_b64_tr_b16 v[56:57], v11 offset:24576
	v_mfma_f32_32x32x16_bf16 a[176:191], v[44:47], v[24:27], a[176:191]
	s_waitcnt lgkmcnt(9)
	v_mfma_f32_32x32x16_bf16 a[192:207], v[32:35], v[28:31], a[192:207]
	ds_read_b64_tr_b16 v[58:59], v11 offset:26624
	v_mfma_f32_32x32x16_bf16 a[208:223], v[36:39], v[28:31], a[208:223]
	ds_read_b64_tr_b16 v[60:61], v12 offset:24576
	v_mfma_f32_32x32x16_bf16 a[224:239], v[40:43], v[28:31], a[224:239]
	ds_read_b64_tr_b16 v[62:63], v12 offset:26624
	v_mfma_f32_32x32x16_bf16 a[240:255], v[44:47], v[28:31], a[240:255]
	s_waitcnt vmcnt(0) lgkmcnt(0)
	s_barrier
	v_add_u32 v5, 0x10000, v5
	v_add_u32 v6, 0x10000, v6
	v_add_u32 v7, 0x10000, v7
	v_add_u32 v8, 0x10000, v8
	v_add_u32 v9, 0x10000, v9
	v_add_u32 v10, 0x10000, v10
	v_add_u32 v11, 0x10000, v11
	v_add_u32 v12, 0x10000, v12
	v_mfma_f32_32x32x16_bf16 a[0:15], v[64:67], v[48:51], a[0:15]
	ds_read_b64_tr_b16 v[16:17], v9 offset:0
	ds_read_b64_tr_b16 v[18:19], v9 offset:2048
	v_mfma_f32_32x32x16_bf16 a[16:31], v[68:71], v[48:51], a[16:31]
	ds_read_b128 v[32:35], v5 offset:0
	s_add_u32 m0, s40, 0
	s_add_u32 s21, s19, 0
	buffer_load_dwordx4 v1, s[8:11], s21 offen lds
	v_mfma_f32_32x32x16_bf16 a[32:47], v[72:75], v[48:51], a[32:47]
	s_add_u32 m0, s40, 4096
	s_add_u32 s21, s19, 36864
	buffer_load_dwordx4 v1, s[8:11], s21 offen lds
	s_add_u32 m0, s40, 8192
	s_add_u32 s21, s19, 73728
	buffer_load_dwordx4 v1, s[8:11], s21 offen lds
	v_mfma_f32_32x32x16_bf16 a[48:63], v[76:79], v[48:51], a[48:63]
	s_add_u32 m0, s40, 12288
	s_add_u32 s21, s19, 110592
	buffer_load_dwordx4 v1, s[8:11], s21 offen lds
	ds_read_b64_tr_b16 v[20:21], v10 offset:0
	v_mfma_f32_32x32x16_bf16 a[64:79], v[64:67], v[52:55], a[64:79]
	ds_read_b64_tr_b16 v[22:23], v10 offset:2048
	ds_read_b128 v[36:39], v5 offset:4096
	v_mfma_f32_32x32x16_bf16 a[80:95], v[68:71], v[52:55], a[80:95]
	ds_read_b128 v[40:43], v5 offset:8192
	v_mfma_f32_32x32x16_bf16 a[96:111], v[72:75], v[52:55], a[96:111]
	ds_read_b128 v[44:47], v5 offset:12288
	ds_read_b64_tr_b16 v[24:25], v11 offset:0
	v_mfma_f32_32x32x16_bf16 a[112:127], v[76:79], v[52:55], a[112:127]
	ds_read_b64_tr_b16 v[26:27], v11 offset:2048
	ds_read_b64_tr_b16 v[28:29], v12 offset:0
	v_mfma_f32_32x32x16_bf16 a[128:143], v[64:67], v[56:59], a[128:143]
	ds_read_b64_tr_b16 v[30:31], v12 offset:2048
	s_add_u32 m0, s40, 16384
	s_add_u32 s21, s19, 147456
	buffer_load_dwordx4 v1, s[8:11], s21 offen lds
	v_mfma_f32_32x32x16_bf16 a[144:159], v[68:71], v[56:59], a[144:159]
	s_add_u32 m0, s40, 20480
	s_add_u32 s21, s19, 184320
	buffer_load_dwordx4 v1, s[8:11], s21 offen lds
	s_add_u32 m0, s40, 24576
	s_add_u32 s21, s19, 221184
	buffer_load_dwordx4 v1, s[8:11], s21 offen lds
	v_mfma_f32_32x32x16_bf16 a[160:175], v[72:75], v[56:59], a[160:175]
	s_add_u32 m0, s40, 28672
	s_add_u32 s21, s19, 258048
	buffer_load_dwordx4 v1, s[8:11], s21 offen lds
	v_mfma_f32_32x32x16_bf16 a[176:191], v[76:79], v[56:59], a[176:191]
	s_add_u32 m0, s40, 32768
	s_mov_b32 s22, s20
	buffer_load_dwordx4 v2, s[12:15], s22 offen lds
	s_add_u32 m0, s40, 36864
	s_add_u32 s22, s22, s24
	buffer_load_dwordx4 v2, s[12:15], s22 offen lds
	v_mfma_f32_32x32x16_bf16 a[192:207], v[64:67], v[60:63], a[192:207]
	s_add_u32 m0, s40, 40960
	s_add_u32 s22, s22, s24
	buffer_load_dwordx4 v2, s[12:15], s22 offen lds
	s_add_u32 m0, s40, 45056
	s_add_u32 s22, s22, s24
	buffer_load_dwordx4 v2, s[12:15], s22 offen lds
	v_mfma_f32_32x32x16_bf16 a[208:223], v[68:71], v[60:63], a[208:223]
	s_add_u32 m0, s40, 49152
	s_add_u32 s22, s22, s24
	buffer_load_dwordx4 v2, s[12:15], s22 offen lds
	s_add_u32 m0, s40, 53248
	s_add_u32 s22, s22, s24
	buffer_load_dwordx4 v2, s[12:15], s22 offen lds
	v_mfma_f32_32x32x16_bf16 a[224:239], v[72:75], v[60:63], a[224:239]
	s_add_u32 m0, s40, 57344
	s_add_u32 s22, s22, s24
	buffer_load_dwordx4 v2, s[12:15], s22 offen lds
	s_add_u32 m0, s40, 61440
	s_add_u32 s22, s22, s24
	buffer_load_dwordx4 v2, s[12:15], s22 offen lds
	v_mfma_f32_32x32x16_bf16 a[240:255], v[76:79], v[60:63], a[240:255]
	s_add_u32 s19, s19, 128
	s_add_u32 s20, s20, s42
	s_waitcnt lgkmcnt(9)
	v_mfma_f32_32x32x16_bf16 a[0:15], v[32:35], v[16:19], a[0:15]
	ds_read_b64_tr_b16 v[48:49], v9 offset:8192
	s_waitcnt lgkmcnt(7)
	v_mfma_f32_32x32x16_bf16 a[16:31], v[36:39], v[16:19], a[16:31]
	ds_read_b64_tr_b16 v[50:51], v9 offset:10240
	s_waitcnt lgkmcnt(7)
	v_mfma_f32_32x32x16_bf16 a[32:47], v[40:43], v[16:19], a[32:47]
	ds_read_b128 v[64:67], v6 offset:0
	s_waitcnt lgkmcnt(7)
	v_mfma_f32_32x32x16_bf16 a[48:63], v[44:47], v[16:19], a[48:63]
	v_mfma_f32_32x32x16_bf16 a[64:79], v[32:35], v[20:23], a[64:79]
	ds_read_b64_tr_b16 v[52:53], v10 offset:8192
	v_mfma_f32_32x32x16_bf16 a[80:95], v[36:39], v[20:23], a[80:95]
	ds_read_b64_tr_b16 v[54:55], v10 offset:10240
	v_mfma_f32_32x32x16_bf16 a[96:111], v[40:43], v[20:23], a[96:111]
	ds_read_b128 v[68:71], v6 offset:4096
	v_mfma_f32_32x32x16_bf16 a[112:127], v[44:47], v[20:23], a[112:127]
	s_waitcnt lgkmcnt(8)
	v_mfma_f32_32x32x16_bf16 a[128:143], v[32:35], v[24:27], a[128:143]
	ds_read_b128 v[72:75], v6 offset:8192
	v_mfma_f32_32x32x16_bf16 a[144:159], v[36:39], v[24:27], a[144:159]
	ds_read_b128 v[76:79], v6 offset:12288
	v_mfma_f32_32x32x16_bf16 a[160:175], v[40:43], v[24:27], a[160:175]
	ds_read_b64_tr_b16 v[56:57], v11 offset:8192
	v_mfma_f32_32x32x16_bf16 a[176:191], v[44:47], v[24:27], a[176:191]
	s_waitcnt lgkmcnt(9)
	v_mfma_f32_32x32x16_bf16 a[192:207], v[32:35], v[28:31], a[192:207]
	ds_read_b64_tr_b16 v[58:59], v11 offset:10240
	v_mfma_f32_32x32x16_bf16 a[208:223], v[36:39], v[28:31], a[208:223]
	ds_read_b64_tr_b16 v[60:61], v12 offset:8192
	v_mfma_f32_32x32x16_bf16 a[224:239], v[40:43], v[28:31], a[224:239]
	ds_read_b64_tr_b16 v[62:63], v12 offset:10240
	v_mfma_f32_32x32x16_bf16 a[240:255], v[44:47], v[28:31], a[240:255]
	s_waitcnt lgkmcnt(9)
	v_mfma_f32_32x32x16_bf16 a[0:15], v[64:67], v[48:51], a[0:15]
	ds_read_b64_tr_b16 v[16:17], v9 offset:16384
	s_waitcnt lgkmcnt(7)
	v_mfma_f32_32x32x16_bf16 a[16:31], v[68:71], v[48:51], a[16:31]
	ds_read_b64_tr_b16 v[18:19], v9 offset:18432
	s_waitcnt lgkmcnt(7)
	v_mfma_f32_32x32x16_bf16 a[32:47], v[72:75], v[48:51], a[32:47]
	ds_read_b128 v[32:35], v7 offset:0
	s_waitcnt lgkmcnt(7)
	v_mfma_f32_32x32x16_bf16 a[48:63], v[76:79], v[48:51], a[48:63]
	v_mfma_f32_32x32x16_bf16 a[64:79], v[64:67], v[52:55], a[64:79]
	ds_read_b64_tr_b16 v[20:21], v10 offset:16384
	v_mfma_f32_32x32x16_bf16 a[80:95], v[68:71], v[52:55], a[80:95]
	ds_read_b64_tr_b16 v[22:23], v10 offset:18432
	v_mfma_f32_32x32x16_bf16 a[96:111], v[72:75], v[52:55], a[96:111]
	ds_read_b128 v[36:39], v7 offset:4096
	v_mfma_f32_32x32x16_bf16 a[112:127], v[76:79], v[52:55], a[112:127]
	s_waitcnt lgkmcnt(8)
	v_mfma_f32_32x32x16_bf16 a[128:143], v[64:67], v[56:59], a[128:143]
	ds_read_b128 v[40:43], v7 offset:8192
	v_mfma_f32_32x32x16_bf16 a[144:159], v[68:71], v[56:59], a[144:159]
	ds_read_b128 v[44:47], v7 offset:12288
	v_mfma_f32_32x32x16_bf16 a[160:175], v[72:75], v[56:59], a[160:175]
	ds_read_b64_tr_b16 v[24:25], v11 offset:16384
	v_mfma_f32_32x32x16_bf16 a[176:191], v[76:79], v[56:59], a[176:191]
	s_waitcnt lgkmcnt(9)
	v_mfma_f32_32x32x16_bf16 a[192:207], v[64:67], v[60:63], a[192:207]
	ds_read_b64_tr_b16 v[26:27], v11 offset:18432
	v_mfma_f32_32x32x16_bf16 a[208:223], v[68:71], v[60:63], a[208:223]
	ds_read_b64_tr_b16 v[28:29], v12 offset:16384
	v_mfma_f32_32x32x16_bf16 a[224:239], v[72:75], v[60:63], a[224:239]
	ds_read_b64_tr_b16 v[30:31], v12 offset:18432
	v_mfma_f32_32x32x16_bf16 a[240:255], v[76:79], v[60:63], a[240:255]
	s_waitcnt lgkmcnt(9)
	v_mfma_f32_32x32x16_bf16 a[0:15], v[32:35], v[16:19], a[0:15]
	ds_read_b64_tr_b16 v[48:49], v9 offset:24576
	s_waitcnt lgkmcnt(7)
	v_mfma_f32_32x32x16_bf16 a[16:31], v[36:39], v[16:19], a[16:31]
	ds_read_b64_tr_b16 v[50:51], v9 offset:26624
	s_waitcnt lgkmcnt(7)
	v_mfma_f32_32x32x16_bf16 a[32:47], v[40:43], v[16:19], a[32:47]
	ds_read_b128 v[64:67], v8 offset:0
	s_waitcnt lgkmcnt(7)
	v_mfma_f32_32x32x16_bf16 a[48:63], v[44:47], v[16:19], a[48:63]
	v_mfma_f32_32x32x16_bf16 a[64:79], v[32:35], v[20:23], a[64:79]
	ds_read_b64_tr_b16 v[52:53], v10 offset:24576
	v_mfma_f32_32x32x16_bf16 a[80:95], v[36:39], v[20:23], a[80:95]
	ds_read_b64_tr_b16 v[54:55], v10 offset:26624
	v_mfma_f32_32x32x16_bf16 a[96:111], v[40:43], v[20:23], a[96:111]
	ds_read_b128 v[68:71], v8 offset:4096
	v_mfma_f32_32x32x16_bf16 a[112:127], v[44:47], v[20:23], a[112:127]
	s_waitcnt lgkmcnt(8)
	v_mfma_f32_32x32x16_bf16 a[128:143], v[32:35], v[24:27], a[128:143]
	ds_read_b128 v[72:75], v8 offset:8192
	v_mfma_f32_32x32x16_bf16 a[144:159], v[36:39], v[24:27], a[144:159]
	ds_read_b128 v[76:79], v8 offset:12288
	v_mfma_f32_32x32x16_bf16 a[160:175], v[40:43], v[24:27], a[160:175]
	ds_read_b64_tr_b16 v[56:57], v11 offset:24576
	v_mfma_f32_32x32x16_bf16 a[176:191], v[44:47], v[24:27], a[176:191]
	s_waitcnt lgkmcnt(9)
	v_mfma_f32_32x32x16_bf16 a[192:207], v[32:35], v[28:31], a[192:207]
	ds_read_b64_tr_b16 v[58:59], v11 offset:26624
	v_mfma_f32_32x32x16_bf16 a[208:223], v[36:39], v[28:31], a[208:223]
	ds_read_b64_tr_b16 v[60:61], v12 offset:24576
	v_mfma_f32_32x32x16_bf16 a[224:239], v[40:43], v[28:31], a[224:239]
	ds_read_b64_tr_b16 v[62:63], v12 offset:26624
	v_mfma_f32_32x32x16_bf16 a[240:255], v[44:47], v[28:31], a[240:255]
	s_waitcnt vmcnt(0) lgkmcnt(0)
	s_barrier
	v_add_u32 v5, 0xffff0000, v5
	v_add_u32 v6, 0xffff0000, v6
	v_add_u32 v7, 0xffff0000, v7
	v_add_u32 v8, 0xffff0000, v8
	v_add_u32 v9, 0xffff0000, v9
	v_add_u32 v10, 0xffff0000, v10
	v_add_u32 v11, 0xffff0000, v11
	v_add_u32 v12, 0xffff0000, v12
	v_mfma_f32_32x32x16_bf16 a[0:15], v[64:67], v[48:51], a[0:15]
	ds_read_b64_tr_b16 v[16:17], v9 offset:0
	ds_read_b64_tr_b16 v[18:19], v9 offset:2048
	v_mfma_f32_32x32x16_bf16 a[16:31], v[68:71], v[48:51], a[16:31]
	ds_read_b128 v[32:35], v5 offset:0
	s_add_u32 m0, s40, 65536
	s_add_u32 s21, s19, 0
	buffer_load_dwordx4 v1, s[8:11], s21 offen lds
	v_mfma_f32_32x32x16_bf16 a[32:47], v[72:75], v[48:51], a[32:47]
	s_add_u32 m0, s40, 69632
	s_add_u32 s21, s19, 36864
	buffer_load_dwordx4 v1, s[8:11], s21 offen lds
	s_add_u32 m0, s40, 73728
	s_add_u32 s21, s19, 73728
	buffer_load_dwordx4 v1, s[8:11], s21 offen lds
	v_mfma_f32_32x32x16_bf16 a[48:63], v[76:79], v[48:51], a[48:63]
	s_add_u32 m0, s40, 77824
	s_add_u32 s21, s19, 110592
	buffer_load_dwordx4 v1, s[8:11], s21 offen lds
	ds_read_b64_tr_b16 v[20:21], v10 offset:0
	v_mfma_f32_32x32x16_bf16 a[64:79], v[64:67], v[52:55], a[64:79]
	ds_read_b64_tr_b16 v[22:23], v10 offset:2048
	ds_read_b128 v[36:39], v5 offset:4096
	v_mfma_f32_32x32x16_bf16 a[80:95], v[68:71], v[52:55], a[80:95]
	ds_read_b128 v[40:43], v5 offset:8192
	v_mfma_f32_32x32x16_bf16 a[96:111], v[72:75], v[52:55], a[96:111]
	ds_read_b128 v[44:47], v5 offset:12288
	ds_read_b64_tr_b16 v[24:25], v11 offset:0
	v_mfma_f32_32x32x16_bf16 a[112:127], v[76:79], v[52:55], a[112:127]
	ds_read_b64_tr_b16 v[26:27], v11 offset:2048
	ds_read_b64_tr_b16 v[28:29], v12 offset:0
	v_mfma_f32_32x32x16_bf16 a[128:143], v[64:67], v[56:59], a[128:143]
	ds_read_b64_tr_b16 v[30:31], v12 offset:2048
	s_add_u32 m0, s40, 81920
	s_add_u32 s21, s19, 147456
	buffer_load_dwordx4 v1, s[8:11], s21 offen lds
	v_mfma_f32_32x32x16_bf16 a[144:159], v[68:71], v[56:59], a[144:159]
	s_add_u32 m0, s40, 86016
	s_add_u32 s21, s19, 184320
	buffer_load_dwordx4 v1, s[8:11], s21 offen lds
	s_add_u32 m0, s40, 90112
	s_add_u32 s21, s19, 221184
	buffer_load_dwordx4 v1, s[8:11], s21 offen lds
	v_mfma_f32_32x32x16_bf16 a[160:175], v[72:75], v[56:59], a[160:175]
	s_add_u32 m0, s40, 94208
	s_add_u32 s21, s19, 258048
	buffer_load_dwordx4 v1, s[8:11], s21 offen lds
	v_mfma_f32_32x32x16_bf16 a[176:191], v[76:79], v[56:59], a[176:191]
	s_add_u32 m0, s40, 98304
	s_mov_b32 s22, s20
	buffer_load_dwordx4 v2, s[12:15], s22 offen lds
	s_add_u32 m0, s40, 102400
	s_add_u32 s22, s22, s24
	buffer_load_dwordx4 v2, s[12:15], s22 offen lds
	v_mfma_f32_32x32x16_bf16 a[192:207], v[64:67], v[60:63], a[192:207]
	s_add_u32 m0, s40, 106496
	s_add_u32 s22, s22, s24
	buffer_load_dwordx4 v2, s[12:15], s22 offen lds
	s_add_u32 m0, s40, 110592
	s_add_u32 s22, s22, s24
	buffer_load_dwordx4 v2, s[12:15], s22 offen lds
	v_mfma_f32_32x32x16_bf16 a[208:223], v[68:71], v[60:63], a[208:223]
	s_add_u32 m0, s40, 114688
	s_add_u32 s22, s22, s24
	buffer_load_dwordx4 v2, s[12:15], s22 offen lds
	s_add_u32 m0, s40, 118784
	s_add_u32 s22, s22, s24
	buffer_load_dwordx4 v2, s[12:15], s22 offen lds
	v_mfma_f32_32x32x16_bf16 a[224:239], v[72:75], v[60:63], a[224:239]
	s_add_u32 m0, s40, 122880
	s_add_u32 s22, s22, s24
	buffer_load_dwordx4 v2, s[12:15], s22 offen lds
	s_add_u32 m0, s40, 126976
	s_add_u32 s22, s22, s24
	buffer_load_dwordx4 v2, s[12:15], s22 offen lds
	v_mfma_f32_32x32x16_bf16 a[240:255], v[76:79], v[60:63], a[240:255]
	s_add_u32 s19, s19, 128
	s_add_u32 s20, s20, s42
	s_waitcnt lgkmcnt(9)
	v_mfma_f32_32x32x16_bf16 a[0:15], v[32:35], v[16:19], a[0:15]
	ds_read_b64_tr_b16 v[48:49], v9 offset:8192
	s_waitcnt lgkmcnt(7)
	v_mfma_f32_32x32x16_bf16 a[16:31], v[36:39], v[16:19], a[16:31]
	ds_read_b64_tr_b16 v[50:51], v9 offset:10240
	s_waitcnt lgkmcnt(7)
	v_mfma_f32_32x32x16_bf16 a[32:47], v[40:43], v[16:19], a[32:47]
	ds_read_b128 v[64:67], v6 offset:0
	s_waitcnt lgkmcnt(7)
	v_mfma_f32_32x32x16_bf16 a[48:63], v[44:47], v[16:19], a[48:63]
	v_mfma_f32_32x32x16_bf16 a[64:79], v[32:35], v[20:23], a[64:79]
	ds_read_b64_tr_b16 v[52:53], v10 offset:8192
	v_mfma_f32_32x32x16_bf16 a[80:95], v[36:39], v[20:23], a[80:95]
	ds_read_b64_tr_b16 v[54:55], v10 offset:10240
	v_mfma_f32_32x32x16_bf16 a[96:111], v[40:43], v[20:23], a[96:111]
	ds_read_b128 v[68:71], v6 offset:4096
	v_mfma_f32_32x32x16_bf16 a[112:127], v[44:47], v[20:23], a[112:127]
	s_waitcnt lgkmcnt(8)
	v_mfma_f32_32x32x16_bf16 a[128:143], v[32:35], v[24:27], a[128:143]
	ds_read_b128 v[72:75], v6 offset:8192
	v_mfma_f32_32x32x16_bf16 a[144:159], v[36:39], v[24:27], a[144:159]
	ds_read_b128 v[76:79], v6 offset:12288
	v_mfma_f32_32x32x16_bf16 a[160:175], v[40:43], v[24:27], a[160:175]
	ds_read_b64_tr_b16 v[56:57], v11 offset:8192
	v_mfma_f32_32x32x16_bf16 a[176:191], v[44:47], v[24:27], a[176:191]
	s_waitcnt lgkmcnt(9)
	v_mfma_f32_32x32x16_bf16 a[192:207], v[32:35], v[28:31], a[192:207]
	ds_read_b64_tr_b16 v[58:59], v11 offset:10240
	v_mfma_f32_32x32x16_bf16 a[208:223], v[36:39], v[28:31], a[208:223]
	ds_read_b64_tr_b16 v[60:61], v12 offset:8192
	v_mfma_f32_32x32x16_bf16 a[224:239], v[40:43], v[28:31], a[224:239]
	ds_read_b64_tr_b16 v[62:63], v12 offset:10240
	v_mfma_f32_32x32x16_bf16 a[240:255], v[44:47], v[28:31], a[240:255]
	s_waitcnt lgkmcnt(9)
	v_mfma_f32_32x32x16_bf16 a[0:15], v[64:67], v[48:51], a[0:15]
	ds_read_b64_tr_b16 v[16:17], v9 offset:16384
	s_waitcnt lgkmcnt(7)
	v_mfma_f32_32x32x16_bf16 a[16:31], v[68:71], v[48:51], a[16:31]
	ds_read_b64_tr_b16 v[18:19], v9 offset:18432
	s_waitcnt lgkmcnt(7)
	v_mfma_f32_32x32x16_bf16 a[32:47], v[72:75], v[48:51], a[32:47]
	ds_read_b128 v[32:35], v7 offset:0
	s_waitcnt lgkmcnt(7)
	v_mfma_f32_32x32x16_bf16 a[48:63], v[76:79], v[48:51], a[48:63]
	v_mfma_f32_32x32x16_bf16 a[64:79], v[64:67], v[52:55], a[64:79]
	ds_read_b64_tr_b16 v[20:21], v10 offset:16384
	v_mfma_f32_32x32x16_bf16 a[80:95], v[68:71], v[52:55], a[80:95]
	ds_read_b64_tr_b16 v[22:23], v10 offset:18432
	v_mfma_f32_32x32x16_bf16 a[96:111], v[72:75], v[52:55], a[96:111]
	ds_read_b128 v[36:39], v7 offset:4096
	v_mfma_f32_32x32x16_bf16 a[112:127], v[76:79], v[52:55], a[112:127]
	s_waitcnt lgkmcnt(8)
	v_mfma_f32_32x32x16_bf16 a[128:143], v[64:67], v[56:59], a[128:143]
	ds_read_b128 v[40:43], v7 offset:8192
	v_mfma_f32_32x32x16_bf16 a[144:159], v[68:71], v[56:59], a[144:159]
	ds_read_b128 v[44:47], v7 offset:12288
	v_mfma_f32_32x32x16_bf16 a[160:175], v[72:75], v[56:59], a[160:175]
	ds_read_b64_tr_b16 v[24:25], v11 offset:16384
	v_mfma_f32_32x32x16_bf16 a[176:191], v[76:79], v[56:59], a[176:191]
	s_waitcnt lgkmcnt(9)
	v_mfma_f32_32x32x16_bf16 a[192:207], v[64:67], v[60:63], a[192:207]
	ds_read_b64_tr_b16 v[26:27], v11 offset:18432
	v_mfma_f32_32x32x16_bf16 a[208:223], v[68:71], v[60:63], a[208:223]
	ds_read_b64_tr_b16 v[28:29], v12 offset:16384
	v_mfma_f32_32x32x16_bf16 a[224:239], v[72:75], v[60:63], a[224:239]
	ds_read_b64_tr_b16 v[30:31], v12 offset:18432
	v_mfma_f32_32x32x16_bf16 a[240:255], v[76:79], v[60:63], a[240:255]
	s_waitcnt lgkmcnt(9)
	v_mfma_f32_32x32x16_bf16 a[0:15], v[32:35], v[16:19], a[0:15]
	ds_read_b64_tr_b16 v[48:49], v9 offset:24576
	s_waitcnt lgkmcnt(7)
	v_mfma_f32_32x32x16_bf16 a[16:31], v[36:39], v[16:19], a[16:31]
	ds_read_b64_tr_b16 v[50:51], v9 offset:26624
	s_waitcnt lgkmcnt(7)
	v_mfma_f32_32x32x16_bf16 a[32:47], v[40:43], v[16:19], a[32:47]
	ds_read_b128 v[64:67], v8 offset:0
	s_waitcnt lgkmcnt(7)
	v_mfma_f32_32x32x16_bf16 a[48:63], v[44:47], v[16:19], a[48:63]
	v_mfma_f32_32x32x16_bf16 a[64:79], v[32:35], v[20:23], a[64:79]
	ds_read_b64_tr_b16 v[52:53], v10 offset:24576
	v_mfma_f32_32x32x16_bf16 a[80:95], v[36:39], v[20:23], a[80:95]
	ds_read_b64_tr_b16 v[54:55], v10 offset:26624
	v_mfma_f32_32x32x16_bf16 a[96:111], v[40:43], v[20:23], a[96:111]
	ds_read_b128 v[68:71], v8 offset:4096
	v_mfma_f32_32x32x16_bf16 a[112:127], v[44:47], v[20:23], a[112:127]
	s_waitcnt lgkmcnt(8)
	v_mfma_f32_32x32x16_bf16 a[128:143], v[32:35], v[24:27], a[128:143]
	ds_read_b128 v[72:75], v8 offset:8192
	v_mfma_f32_32x32x16_bf16 a[144:159], v[36:39], v[24:27], a[144:159]
	ds_read_b128 v[76:79], v8 offset:12288
	v_mfma_f32_32x32x16_bf16 a[160:175], v[40:43], v[24:27], a[160:175]
	ds_read_b64_tr_b16 v[56:57], v11 offset:24576
	v_mfma_f32_32x32x16_bf16 a[176:191], v[44:47], v[24:27], a[176:191]
	s_waitcnt lgkmcnt(9)
	v_mfma_f32_32x32x16_bf16 a[192:207], v[32:35], v[28:31], a[192:207]
	ds_read_b64_tr_b16 v[58:59], v11 offset:26624
	v_mfma_f32_32x32x16_bf16 a[208:223], v[36:39], v[28:31], a[208:223]
	ds_read_b64_tr_b16 v[60:61], v12 offset:24576
	v_mfma_f32_32x32x16_bf16 a[224:239], v[40:43], v[28:31], a[224:239]
	ds_read_b64_tr_b16 v[62:63], v12 offset:26624
	v_mfma_f32_32x32x16_bf16 a[240:255], v[44:47], v[28:31], a[240:255]
	s_waitcnt vmcnt(0) lgkmcnt(0)
	s_barrier
	v_add_u32 v5, 0x10000, v5
	v_add_u32 v6, 0x10000, v6
	v_add_u32 v7, 0x10000, v7
	v_add_u32 v8, 0x10000, v8
	v_add_u32 v9, 0x10000, v9
	v_add_u32 v10, 0x10000, v10
	v_add_u32 v11, 0x10000, v11
	v_add_u32 v12, 0x10000, v12
	v_mfma_f32_32x32x16_bf16 a[0:15], v[64:67], v[48:51], a[0:15]
	ds_read_b64_tr_b16 v[16:17], v9 offset:0
	ds_read_b64_tr_b16 v[18:19], v9 offset:2048
	v_mfma_f32_32x32x16_bf16 a[16:31], v[68:71], v[48:51], a[16:31]
	ds_read_b128 v[32:35], v5 offset:0
	s_add_u32 m0, s40, 0
	s_add_u32 s21, s19, 0
	buffer_load_dwordx4 v1, s[8:11], s21 offen lds
	v_mfma_f32_32x32x16_bf16 a[32:47], v[72:75], v[48:51], a[32:47]
	s_add_u32 m0, s40, 4096
	s_add_u32 s21, s19, 36864
	buffer_load_dwordx4 v1, s[8:11], s21 offen lds
	s_add_u32 m0, s40, 8192
	s_add_u32 s21, s19, 73728
	buffer_load_dwordx4 v1, s[8:11], s21 offen lds
	v_mfma_f32_32x32x16_bf16 a[48:63], v[76:79], v[48:51], a[48:63]
	s_add_u32 m0, s40, 12288
	s_add_u32 s21, s19, 110592
	buffer_load_dwordx4 v1, s[8:11], s21 offen lds
	ds_read_b64_tr_b16 v[20:21], v10 offset:0
	v_mfma_f32_32x32x16_bf16 a[64:79], v[64:67], v[52:55], a[64:79]
	ds_read_b64_tr_b16 v[22:23], v10 offset:2048
	ds_read_b128 v[36:39], v5 offset:4096
	v_mfma_f32_32x32x16_bf16 a[80:95], v[68:71], v[52:55], a[80:95]
	ds_read_b128 v[40:43], v5 offset:8192
	v_mfma_f32_32x32x16_bf16 a[96:111], v[72:75], v[52:55], a[96:111]
	ds_read_b128 v[44:47], v5 offset:12288
	ds_read_b64_tr_b16 v[24:25], v11 offset:0
	v_mfma_f32_32x32x16_bf16 a[112:127], v[76:79], v[52:55], a[112:127]
	ds_read_b64_tr_b16 v[26:27], v11 offset:2048
	ds_read_b64_tr_b16 v[28:29], v12 offset:0
	v_mfma_f32_32x32x16_bf16 a[128:143], v[64:67], v[56:59], a[128:143]
	ds_read_b64_tr_b16 v[30:31], v12 offset:2048
	s_add_u32 m0, s40, 16384
	s_add_u32 s21, s19, 147456
	buffer_load_dwordx4 v1, s[8:11], s21 offen lds
	v_mfma_f32_32x32x16_bf16 a[144:159], v[68:71], v[56:59], a[144:159]
	s_add_u32 m0, s40, 20480
	s_add_u32 s21, s19, 184320
	buffer_load_dwordx4 v1, s[8:11], s21 offen lds
	s_add_u32 m0, s40, 24576
	s_add_u32 s21, s19, 221184
	buffer_load_dwordx4 v1, s[8:11], s21 offen lds
	v_mfma_f32_32x32x16_bf16 a[160:175], v[72:75], v[56:59], a[160:175]
	s_add_u32 m0, s40, 28672
	s_add_u32 s21, s19, 258048
	buffer_load_dwordx4 v1, s[8:11], s21 offen lds
	v_mfma_f32_32x32x16_bf16 a[176:191], v[76:79], v[56:59], a[176:191]
	s_add_u32 m0, s40, 32768
	s_mov_b32 s22, s20
	buffer_load_dwordx4 v2, s[12:15], s22 offen lds
	s_add_u32 m0, s40, 36864
	s_add_u32 s22, s22, s24
	buffer_load_dwordx4 v2, s[12:15], s22 offen lds
	v_mfma_f32_32x32x16_bf16 a[192:207], v[64:67], v[60:63], a[192:207]
	s_add_u32 m0, s40, 40960
	s_add_u32 s22, s22, s24
	buffer_load_dwordx4 v2, s[12:15], s22 offen lds
	s_add_u32 m0, s40, 45056
	s_add_u32 s22, s22, s24
	buffer_load_dwordx4 v2, s[12:15], s22 offen lds
	v_mfma_f32_32x32x16_bf16 a[208:223], v[68:71], v[60:63], a[208:223]
	s_add_u32 m0, s40, 49152
	s_add_u32 s22, s22, s24
	buffer_load_dwordx4 v2, s[12:15], s22 offen lds
	s_add_u32 m0, s40, 53248
	s_add_u32 s22, s22, s24
	buffer_load_dwordx4 v2, s[12:15], s22 offen lds
	v_mfma_f32_32x32x16_bf16 a[224:239], v[72:75], v[60:63], a[224:239]
	s_add_u32 m0, s40, 57344
	s_add_u32 s22, s22, s24
	buffer_load_dwordx4 v2, s[12:15], s22 offen lds
	s_add_u32 m0, s40, 61440
	s_add_u32 s22, s22, s24
	buffer_load_dwordx4 v2, s[12:15], s22 offen lds
	v_mfma_f32_32x32x16_bf16 a[240:255], v[76:79], v[60:63], a[240:255]
	s_add_u32 s19, s19, 128
	s_add_u32 s20, s20, s42
	s_waitcnt lgkmcnt(9)
	v_mfma_f32_32x32x16_bf16 a[0:15], v[32:35], v[16:19], a[0:15]
	ds_read_b64_tr_b16 v[48:49], v9 offset:8192
	s_waitcnt lgkmcnt(7)
	v_mfma_f32_32x32x16_bf16 a[16:31], v[36:39], v[16:19], a[16:31]
	ds_read_b64_tr_b16 v[50:51], v9 offset:10240
	s_waitcnt lgkmcnt(7)
	v_mfma_f32_32x32x16_bf16 a[32:47], v[40:43], v[16:19], a[32:47]
	ds_read_b128 v[64:67], v6 offset:0
	s_waitcnt lgkmcnt(7)
	v_mfma_f32_32x32x16_bf16 a[48:63], v[44:47], v[16:19], a[48:63]
	v_mfma_f32_32x32x16_bf16 a[64:79], v[32:35], v[20:23], a[64:79]
	ds_read_b64_tr_b16 v[52:53], v10 offset:8192
	v_mfma_f32_32x32x16_bf16 a[80:95], v[36:39], v[20:23], a[80:95]
	ds_read_b64_tr_b16 v[54:55], v10 offset:10240
	v_mfma_f32_32x32x16_bf16 a[96:111], v[40:43], v[20:23], a[96:111]
	ds_read_b128 v[68:71], v6 offset:4096
	v_mfma_f32_32x32x16_bf16 a[112:127], v[44:47], v[20:23], a[112:127]
	s_waitcnt lgkmcnt(8)
	v_mfma_f32_32x32x16_bf16 a[128:143], v[32:35], v[24:27], a[128:143]
	ds_read_b128 v[72:75], v6 offset:8192
	v_mfma_f32_32x32x16_bf16 a[144:159], v[36:39], v[24:27], a[144:159]
	ds_read_b128 v[76:79], v6 offset:12288
	v_mfma_f32_32x32x16_bf16 a[160:175], v[40:43], v[24:27], a[160:175]
	ds_read_b64_tr_b16 v[56:57], v11 offset:8192
	v_mfma_f32_32x32x16_bf16 a[176:191], v[44:47], v[24:27], a[176:191]
	s_waitcnt lgkmcnt(9)
	v_mfma_f32_32x32x16_bf16 a[192:207], v[32:35], v[28:31], a[192:207]
	ds_read_b64_tr_b16 v[58:59], v11 offset:10240
	v_mfma_f32_32x32x16_bf16 a[208:223], v[36:39], v[28:31], a[208:223]
	ds_read_b64_tr_b16 v[60:61], v12 offset:8192
	v_mfma_f32_32x32x16_bf16 a[224:239], v[40:43], v[28:31], a[224:239]
	ds_read_b64_tr_b16 v[62:63], v12 offset:10240
	v_mfma_f32_32x32x16_bf16 a[240:255], v[44:47], v[28:31], a[240:255]
	s_waitcnt lgkmcnt(9)
	v_mfma_f32_32x32x16_bf16 a[0:15], v[64:67], v[48:51], a[0:15]
	ds_read_b64_tr_b16 v[16:17], v9 offset:16384
	s_waitcnt lgkmcnt(7)
	v_mfma_f32_32x32x16_bf16 a[16:31], v[68:71], v[48:51], a[16:31]
	ds_read_b64_tr_b16 v[18:19], v9 offset:18432
	s_waitcnt lgkmcnt(7)
	v_mfma_f32_32x32x16_bf16 a[32:47], v[72:75], v[48:51], a[32:47]
	ds_read_b128 v[32:35], v7 offset:0
	s_waitcnt lgkmcnt(7)
	v_mfma_f32_32x32x16_bf16 a[48:63], v[76:79], v[48:51], a[48:63]
	v_mfma_f32_32x32x16_bf16 a[64:79], v[64:67], v[52:55], a[64:79]
	ds_read_b64_tr_b16 v[20:21], v10 offset:16384
	v_mfma_f32_32x32x16_bf16 a[80:95], v[68:71], v[52:55], a[80:95]
	ds_read_b64_tr_b16 v[22:23], v10 offset:18432
	v_mfma_f32_32x32x16_bf16 a[96:111], v[72:75], v[52:55], a[96:111]
	ds_read_b128 v[36:39], v7 offset:4096
	v_mfma_f32_32x32x16_bf16 a[112:127], v[76:79], v[52:55], a[112:127]
	s_waitcnt lgkmcnt(8)
	v_mfma_f32_32x32x16_bf16 a[128:143], v[64:67], v[56:59], a[128:143]
	ds_read_b128 v[40:43], v7 offset:8192
	v_mfma_f32_32x32x16_bf16 a[144:159], v[68:71], v[56:59], a[144:159]
	ds_read_b128 v[44:47], v7 offset:12288
	v_mfma_f32_32x32x16_bf16 a[160:175], v[72:75], v[56:59], a[160:175]
	ds_read_b64_tr_b16 v[24:25], v11 offset:16384
	v_mfma_f32_32x32x16_bf16 a[176:191], v[76:79], v[56:59], a[176:191]
	s_waitcnt lgkmcnt(9)
	v_mfma_f32_32x32x16_bf16 a[192:207], v[64:67], v[60:63], a[192:207]
	ds_read_b64_tr_b16 v[26:27], v11 offset:18432
	v_mfma_f32_32x32x16_bf16 a[208:223], v[68:71], v[60:63], a[208:223]
	ds_read_b64_tr_b16 v[28:29], v12 offset:16384
	v_mfma_f32_32x32x16_bf16 a[224:239], v[72:75], v[60:63], a[224:239]
	ds_read_b64_tr_b16 v[30:31], v12 offset:18432
	v_mfma_f32_32x32x16_bf16 a[240:255], v[76:79], v[60:63], a[240:255]
	s_waitcnt lgkmcnt(9)
	v_mfma_f32_32x32x16_bf16 a[0:15], v[32:35], v[16:19], a[0:15]
	ds_read_b64_tr_b16 v[48:49], v9 offset:24576
	s_waitcnt lgkmcnt(7)
	v_mfma_f32_32x32x16_bf16 a[16:31], v[36:39], v[16:19], a[16:31]
	ds_read_b64_tr_b16 v[50:51], v9 offset:26624
	s_waitcnt lgkmcnt(7)
	v_mfma_f32_32x32x16_bf16 a[32:47], v[40:43], v[16:19], a[32:47]
	ds_read_b128 v[64:67], v8 offset:0
	s_waitcnt lgkmcnt(7)
	v_mfma_f32_32x32x16_bf16 a[48:63], v[44:47], v[16:19], a[48:63]
	v_mfma_f32_32x32x16_bf16 a[64:79], v[32:35], v[20:23], a[64:79]
	ds_read_b64_tr_b16 v[52:53], v10 offset:24576
	v_mfma_f32_32x32x16_bf16 a[80:95], v[36:39], v[20:23], a[80:95]
	ds_read_b64_tr_b16 v[54:55], v10 offset:26624
	v_mfma_f32_32x32x16_bf16 a[96:111], v[40:43], v[20:23], a[96:111]
	ds_read_b128 v[68:71], v8 offset:4096
	v_mfma_f32_32x32x16_bf16 a[112:127], v[44:47], v[20:23], a[112:127]
	s_waitcnt lgkmcnt(8)
	v_mfma_f32_32x32x16_bf16 a[128:143], v[32:35], v[24:27], a[128:143]
	ds_read_b128 v[72:75], v8 offset:8192
	v_mfma_f32_32x32x16_bf16 a[144:159], v[36:39], v[24:27], a[144:159]
	ds_read_b128 v[76:79], v8 offset:12288
	v_mfma_f32_32x32x16_bf16 a[160:175], v[40:43], v[24:27], a[160:175]
	ds_read_b64_tr_b16 v[56:57], v11 offset:24576
	v_mfma_f32_32x32x16_bf16 a[176:191], v[44:47], v[24:27], a[176:191]
	s_waitcnt lgkmcnt(9)
	v_mfma_f32_32x32x16_bf16 a[192:207], v[32:35], v[28:31], a[192:207]
	ds_read_b64_tr_b16 v[58:59], v11 offset:26624
	v_mfma_f32_32x32x16_bf16 a[208:223], v[36:39], v[28:31], a[208:223]
	ds_read_b64_tr_b16 v[60:61], v12 offset:24576
	v_mfma_f32_32x32x16_bf16 a[224:239], v[40:43], v[28:31], a[224:239]
	ds_read_b64_tr_b16 v[62:63], v12 offset:26624
	v_mfma_f32_32x32x16_bf16 a[240:255], v[44:47], v[28:31], a[240:255]
	s_waitcnt vmcnt(0) lgkmcnt(0)
	s_barrier
	v_add_u32 v5, 0xffff0000, v5
	v_add_u32 v6, 0xffff0000, v6
	v_add_u32 v7, 0xffff0000, v7
	v_add_u32 v8, 0xffff0000, v8
	v_add_u32 v9, 0xffff0000, v9
	v_add_u32 v10, 0xffff0000, v10
	v_add_u32 v11, 0xffff0000, v11
	v_add_u32 v12, 0xffff0000, v12
	v_mfma_f32_32x32x16_bf16 a[0:15], v[64:67], v[48:51], a[0:15]
	ds_read_b64_tr_b16 v[16:17], v9 offset:0
	ds_read_b64_tr_b16 v[18:19], v9 offset:2048
	v_mfma_f32_32x32x16_bf16 a[16:31], v[68:71], v[48:51], a[16:31]
	ds_read_b128 v[32:35], v5 offset:0
	s_add_u32 m0, s40, 65536
	s_add_u32 s21, s19, 0
	buffer_load_dwordx4 v1, s[8:11], s21 offen lds
	v_mfma_f32_32x32x16_bf16 a[32:47], v[72:75], v[48:51], a[32:47]
	s_add_u32 m0, s40, 69632
	s_add_u32 s21, s19, 36864
	buffer_load_dwordx4 v1, s[8:11], s21 offen lds
	s_add_u32 m0, s40, 73728
	s_add_u32 s21, s19, 73728
	buffer_load_dwordx4 v1, s[8:11], s21 offen lds
	v_mfma_f32_32x32x16_bf16 a[48:63], v[76:79], v[48:51], a[48:63]
	s_add_u32 m0, s40, 77824
	s_add_u32 s21, s19, 110592
	buffer_load_dwordx4 v1, s[8:11], s21 offen lds
	ds_read_b64_tr_b16 v[20:21], v10 offset:0
	v_mfma_f32_32x32x16_bf16 a[64:79], v[64:67], v[52:55], a[64:79]
	ds_read_b64_tr_b16 v[22:23], v10 offset:2048
	ds_read_b128 v[36:39], v5 offset:4096
	v_mfma_f32_32x32x16_bf16 a[80:95], v[68:71], v[52:55], a[80:95]
	ds_read_b128 v[40:43], v5 offset:8192
	v_mfma_f32_32x32x16_bf16 a[96:111], v[72:75], v[52:55], a[96:111]
	ds_read_b128 v[44:47], v5 offset:12288
	ds_read_b64_tr_b16 v[24:25], v11 offset:0
	v_mfma_f32_32x32x16_bf16 a[112:127], v[76:79], v[52:55], a[112:127]
	ds_read_b64_tr_b16 v[26:27], v11 offset:2048
	ds_read_b64_tr_b16 v[28:29], v12 offset:0
	v_mfma_f32_32x32x16_bf16 a[128:143], v[64:67], v[56:59], a[128:143]
	ds_read_b64_tr_b16 v[30:31], v12 offset:2048
	s_add_u32 m0, s40, 81920
	s_add_u32 s21, s19, 147456
	buffer_load_dwordx4 v1, s[8:11], s21 offen lds
	v_mfma_f32_32x32x16_bf16 a[144:159], v[68:71], v[56:59], a[144:159]
	s_add_u32 m0, s40, 86016
	s_add_u32 s21, s19, 184320
	buffer_load_dwordx4 v1, s[8:11], s21 offen lds
	s_add_u32 m0, s40, 90112
	s_add_u32 s21, s19, 221184
	buffer_load_dwordx4 v1, s[8:11], s21 offen lds
	v_mfma_f32_32x32x16_bf16 a[160:175], v[72:75], v[56:59], a[160:175]
	s_add_u32 m0, s40, 94208
	s_add_u32 s21, s19, 258048
	buffer_load_dwordx4 v1, s[8:11], s21 offen lds
	v_mfma_f32_32x32x16_bf16 a[176:191], v[76:79], v[56:59], a[176:191]
	s_add_u32 m0, s40, 98304
	s_mov_b32 s22, s20
	buffer_load_dwordx4 v2, s[12:15], s22 offen lds
	s_add_u32 m0, s40, 102400
	s_add_u32 s22, s22, s24
	buffer_load_dwordx4 v2, s[12:15], s22 offen lds
	v_mfma_f32_32x32x16_bf16 a[192:207], v[64:67], v[60:63], a[192:207]
	s_add_u32 m0, s40, 106496
	s_add_u32 s22, s22, s24
	buffer_load_dwordx4 v2, s[12:15], s22 offen lds
	s_add_u32 m0, s40, 110592
	s_add_u32 s22, s22, s24
	buffer_load_dwordx4 v2, s[12:15], s22 offen lds
	v_mfma_f32_32x32x16_bf16 a[208:223], v[68:71], v[60:63], a[208:223]
	s_add_u32 m0, s40, 114688
	s_add_u32 s22, s22, s24
	buffer_load_dwordx4 v2, s[12:15], s22 offen lds
	s_add_u32 m0, s40, 118784
	s_add_u32 s22, s22, s24
	buffer_load_dwordx4 v2, s[12:15], s22 offen lds
	v_mfma_f32_32x32x16_bf16 a[224:239], v[72:75], v[60:63], a[224:239]
	s_add_u32 m0, s40, 122880
	s_add_u32 s22, s22, s24
	buffer_load_dwordx4 v2, s[12:15], s22 offen lds
	s_add_u32 m0, s40, 126976
	s_add_u32 s22, s22, s24
	buffer_load_dwordx4 v2, s[12:15], s22 offen lds
	v_mfma_f32_32x32x16_bf16 a[240:255], v[76:79], v[60:63], a[240:255]
	s_add_u32 s19, s19, 128
	s_add_u32 s20, s20, s42
	s_waitcnt lgkmcnt(9)
	v_mfma_f32_32x32x16_bf16 a[0:15], v[32:35], v[16:19], a[0:15]
	ds_read_b64_tr_b16 v[48:49], v9 offset:8192
	s_waitcnt lgkmcnt(7)
	v_mfma_f32_32x32x16_bf16 a[16:31], v[36:39], v[16:19], a[16:31]
	ds_read_b64_tr_b16 v[50:51], v9 offset:10240
	s_waitcnt lgkmcnt(7)
	v_mfma_f32_32x32x16_bf16 a[32:47], v[40:43], v[16:19], a[32:47]
	ds_read_b128 v[64:67], v6 offset:0
	s_waitcnt lgkmcnt(7)
	v_mfma_f32_32x32x16_bf16 a[48:63], v[44:47], v[16:19], a[48:63]
	v_mfma_f32_32x32x16_bf16 a[64:79], v[32:35], v[20:23], a[64:79]
	ds_read_b64_tr_b16 v[52:53], v10 offset:8192
	v_mfma_f32_32x32x16_bf16 a[80:95], v[36:39], v[20:23], a[80:95]
	ds_read_b64_tr_b16 v[54:55], v10 offset:10240
	v_mfma_f32_32x32x16_bf16 a[96:111], v[40:43], v[20:23], a[96:111]
	ds_read_b128 v[68:71], v6 offset:4096
	v_mfma_f32_32x32x16_bf16 a[112:127], v[44:47], v[20:23], a[112:127]
	s_waitcnt lgkmcnt(8)
	v_mfma_f32_32x32x16_bf16 a[128:143], v[32:35], v[24:27], a[128:143]
	ds_read_b128 v[72:75], v6 offset:8192
	v_mfma_f32_32x32x16_bf16 a[144:159], v[36:39], v[24:27], a[144:159]
	ds_read_b128 v[76:79], v6 offset:12288
	v_mfma_f32_32x32x16_bf16 a[160:175], v[40:43], v[24:27], a[160:175]
	ds_read_b64_tr_b16 v[56:57], v11 offset:8192
	v_mfma_f32_32x32x16_bf16 a[176:191], v[44:47], v[24:27], a[176:191]
	s_waitcnt lgkmcnt(9)
	v_mfma_f32_32x32x16_bf16 a[192:207], v[32:35], v[28:31], a[192:207]
	ds_read_b64_tr_b16 v[58:59], v11 offset:10240
	v_mfma_f32_32x32x16_bf16 a[208:223], v[36:39], v[28:31], a[208:223]
	ds_read_b64_tr_b16 v[60:61], v12 offset:8192
	v_mfma_f32_32x32x16_bf16 a[224:239], v[40:43], v[28:31], a[224:239]
	ds_read_b64_tr_b16 v[62:63], v12 offset:10240
	v_mfma_f32_32x32x16_bf16 a[240:255], v[44:47], v[28:31], a[240:255]
	s_waitcnt lgkmcnt(9)
	v_mfma_f32_32x32x16_bf16 a[0:15], v[64:67], v[48:51], a[0:15]
	ds_read_b64_tr_b16 v[16:17], v9 offset:16384
	s_waitcnt lgkmcnt(7)
	v_mfma_f32_32x32x16_bf16 a[16:31], v[68:71], v[48:51], a[16:31]
	ds_read_b64_tr_b16 v[18:19], v9 offset:18432
	s_waitcnt lgkmcnt(7)
	v_mfma_f32_32x32x16_bf16 a[32:47], v[72:75], v[48:51], a[32:47]
	ds_read_b128 v[32:35], v7 offset:0
	s_waitcnt lgkmcnt(7)
	v_mfma_f32_32x32x16_bf16 a[48:63], v[76:79], v[48:51], a[48:63]
	v_mfma_f32_32x32x16_bf16 a[64:79], v[64:67], v[52:55], a[64:79]
	ds_read_b64_tr_b16 v[20:21], v10 offset:16384
	v_mfma_f32_32x32x16_bf16 a[80:95], v[68:71], v[52:55], a[80:95]
	ds_read_b64_tr_b16 v[22:23], v10 offset:18432
	v_mfma_f32_32x32x16_bf16 a[96:111], v[72:75], v[52:55], a[96:111]
	ds_read_b128 v[36:39], v7 offset:4096
	v_mfma_f32_32x32x16_bf16 a[112:127], v[76:79], v[52:55], a[112:127]
	s_waitcnt lgkmcnt(8)
	v_mfma_f32_32x32x16_bf16 a[128:143], v[64:67], v[56:59], a[128:143]
	ds_read_b128 v[40:43], v7 offset:8192
	v_mfma_f32_32x32x16_bf16 a[144:159], v[68:71], v[56:59], a[144:159]
	ds_read_b128 v[44:47], v7 offset:12288
	v_mfma_f32_32x32x16_bf16 a[160:175], v[72:75], v[56:59], a[160:175]
	ds_read_b64_tr_b16 v[24:25], v11 offset:16384
	v_mfma_f32_32x32x16_bf16 a[176:191], v[76:79], v[56:59], a[176:191]
	s_waitcnt lgkmcnt(9)
	v_mfma_f32_32x32x16_bf16 a[192:207], v[64:67], v[60:63], a[192:207]
	ds_read_b64_tr_b16 v[26:27], v11 offset:18432
	v_mfma_f32_32x32x16_bf16 a[208:223], v[68:71], v[60:63], a[208:223]
	ds_read_b64_tr_b16 v[28:29], v12 offset:16384
	v_mfma_f32_32x32x16_bf16 a[224:239], v[72:75], v[60:63], a[224:239]
	ds_read_b64_tr_b16 v[30:31], v12 offset:18432
	v_mfma_f32_32x32x16_bf16 a[240:255], v[76:79], v[60:63], a[240:255]
	s_waitcnt lgkmcnt(9)
	v_mfma_f32_32x32x16_bf16 a[0:15], v[32:35], v[16:19], a[0:15]
	ds_read_b64_tr_b16 v[48:49], v9 offset:24576
	s_waitcnt lgkmcnt(7)
	v_mfma_f32_32x32x16_bf16 a[16:31], v[36:39], v[16:19], a[16:31]
	ds_read_b64_tr_b16 v[50:51], v9 offset:26624
	s_waitcnt lgkmcnt(7)
	v_mfma_f32_32x32x16_bf16 a[32:47], v[40:43], v[16:19], a[32:47]
	ds_read_b128 v[64:67], v8 offset:0
	s_waitcnt lgkmcnt(7)
	v_mfma_f32_32x32x16_bf16 a[48:63], v[44:47], v[16:19], a[48:63]
	v_mfma_f32_32x32x16_bf16 a[64:79], v[32:35], v[20:23], a[64:79]
	ds_read_b64_tr_b16 v[52:53], v10 offset:24576
	v_mfma_f32_32x32x16_bf16 a[80:95], v[36:39], v[20:23], a[80:95]
	ds_read_b64_tr_b16 v[54:55], v10 offset:26624
	v_mfma_f32_32x32x16_bf16 a[96:111], v[40:43], v[20:23], a[96:111]
	ds_read_b128 v[68:71], v8 offset:4096
	v_mfma_f32_32x32x16_bf16 a[112:127], v[44:47], v[20:23], a[112:127]
	s_waitcnt lgkmcnt(8)
	v_mfma_f32_32x32x16_bf16 a[128:143], v[32:35], v[24:27], a[128:143]
	ds_read_b128 v[72:75], v8 offset:8192
	v_mfma_f32_32x32x16_bf16 a[144:159], v[36:39], v[24:27], a[144:159]
	ds_read_b128 v[76:79], v8 offset:12288
	v_mfma_f32_32x32x16_bf16 a[160:175], v[40:43], v[24:27], a[160:175]
	ds_read_b64_tr_b16 v[56:57], v11 offset:24576
	v_mfma_f32_32x32x16_bf16 a[176:191], v[44:47], v[24:27], a[176:191]
	s_waitcnt lgkmcnt(9)
	v_mfma_f32_32x32x16_bf16 a[192:207], v[32:35], v[28:31], a[192:207]
	ds_read_b64_tr_b16 v[58:59], v11 offset:26624
	v_mfma_f32_32x32x16_bf16 a[208:223], v[36:39], v[28:31], a[208:223]
	ds_read_b64_tr_b16 v[60:61], v12 offset:24576
	v_mfma_f32_32x32x16_bf16 a[224:239], v[40:43], v[28:31], a[224:239]
	ds_read_b64_tr_b16 v[62:63], v12 offset:26624
	v_mfma_f32_32x32x16_bf16 a[240:255], v[44:47], v[28:31], a[240:255]
	s_waitcnt vmcnt(0) lgkmcnt(0)
	s_barrier
	v_add_u32 v5, 0x10000, v5
	v_add_u32 v6, 0x10000, v6
	v_add_u32 v7, 0x10000, v7
	v_add_u32 v8, 0x10000, v8
	v_add_u32 v9, 0x10000, v9
	v_add_u32 v10, 0x10000, v10
	v_add_u32 v11, 0x10000, v11
	v_add_u32 v12, 0x10000, v12
	v_mfma_f32_32x32x16_bf16 a[0:15], v[64:67], v[48:51], a[0:15]
	ds_read_b64_tr_b16 v[16:17], v9 offset:0
	ds_read_b64_tr_b16 v[18:19], v9 offset:2048
	v_mfma_f32_32x32x16_bf16 a[16:31], v[68:71], v[48:51], a[16:31]
	ds_read_b128 v[32:35], v5 offset:0
	s_add_u32 m0, s40, 0
	s_add_u32 s21, s19, 0
	buffer_load_dwordx4 v1, s[8:11], s21 offen lds
	v_mfma_f32_32x32x16_bf16 a[32:47], v[72:75], v[48:51], a[32:47]
	s_add_u32 m0, s40, 4096
	s_add_u32 s21, s19, 36864
	buffer_load_dwordx4 v1, s[8:11], s21 offen lds
	s_add_u32 m0, s40, 8192
	s_add_u32 s21, s19, 73728
	buffer_load_dwordx4 v1, s[8:11], s21 offen lds
	v_mfma_f32_32x32x16_bf16 a[48:63], v[76:79], v[48:51], a[48:63]
	s_add_u32 m0, s40, 12288
	s_add_u32 s21, s19, 110592
	buffer_load_dwordx4 v1, s[8:11], s21 offen lds
	ds_read_b64_tr_b16 v[20:21], v10 offset:0
	v_mfma_f32_32x32x16_bf16 a[64:79], v[64:67], v[52:55], a[64:79]
	ds_read_b64_tr_b16 v[22:23], v10 offset:2048
	ds_read_b128 v[36:39], v5 offset:4096
	v_mfma_f32_32x32x16_bf16 a[80:95], v[68:71], v[52:55], a[80:95]
	ds_read_b128 v[40:43], v5 offset:8192
	v_mfma_f32_32x32x16_bf16 a[96:111], v[72:75], v[52:55], a[96:111]
	ds_read_b128 v[44:47], v5 offset:12288
	ds_read_b64_tr_b16 v[24:25], v11 offset:0
	v_mfma_f32_32x32x16_bf16 a[112:127], v[76:79], v[52:55], a[112:127]
	ds_read_b64_tr_b16 v[26:27], v11 offset:2048
	ds_read_b64_tr_b16 v[28:29], v12 offset:0
	v_mfma_f32_32x32x16_bf16 a[128:143], v[64:67], v[56:59], a[128:143]
	ds_read_b64_tr_b16 v[30:31], v12 offset:2048
	s_add_u32 m0, s40, 16384
	s_add_u32 s21, s19, 147456
	buffer_load_dwordx4 v1, s[8:11], s21 offen lds
	v_mfma_f32_32x32x16_bf16 a[144:159], v[68:71], v[56:59], a[144:159]
	s_add_u32 m0, s40, 20480
	s_add_u32 s21, s19, 184320
	buffer_load_dwordx4 v1, s[8:11], s21 offen lds
	s_add_u32 m0, s40, 24576
	s_add_u32 s21, s19, 221184
	buffer_load_dwordx4 v1, s[8:11], s21 offen lds
	v_mfma_f32_32x32x16_bf16 a[160:175], v[72:75], v[56:59], a[160:175]
	s_add_u32 m0, s40, 28672
	s_add_u32 s21, s19, 258048
	buffer_load_dwordx4 v1, s[8:11], s21 offen lds
	v_mfma_f32_32x32x16_bf16 a[176:191], v[76:79], v[56:59], a[176:191]
	s_add_u32 m0, s40, 32768
	s_mov_b32 s22, s20
	buffer_load_dwordx4 v2, s[12:15], s22 offen lds
	s_add_u32 m0, s40, 36864
	s_add_u32 s22, s22, s24
	buffer_load_dwordx4 v2, s[12:15], s22 offen lds
	v_mfma_f32_32x32x16_bf16 a[192:207], v[64:67], v[60:63], a[192:207]
	s_add_u32 m0, s40, 40960
	s_add_u32 s22, s22, s24
	buffer_load_dwordx4 v2, s[12:15], s22 offen lds
	s_add_u32 m0, s40, 45056
	s_add_u32 s22, s22, s24
	buffer_load_dwordx4 v2, s[12:15], s22 offen lds
	v_mfma_f32_32x32x16_bf16 a[208:223], v[68:71], v[60:63], a[208:223]
	s_add_u32 m0, s40, 49152
	s_add_u32 s22, s22, s24
	buffer_load_dwordx4 v2, s[12:15], s22 offen lds
	s_add_u32 m0, s40, 53248
	s_add_u32 s22, s22, s24
	buffer_load_dwordx4 v2, s[12:15], s22 offen lds
	v_mfma_f32_32x32x16_bf16 a[224:239], v[72:75], v[60:63], a[224:239]
	s_add_u32 m0, s40, 57344
	s_add_u32 s22, s22, s24
	buffer_load_dwordx4 v2, s[12:15], s22 offen lds
	s_add_u32 m0, s40, 61440
	s_add_u32 s22, s22, s24
	buffer_load_dwordx4 v2, s[12:15], s22 offen lds
	v_mfma_f32_32x32x16_bf16 a[240:255], v[76:79], v[60:63], a[240:255]
	s_add_u32 s19, s19, 128
	s_add_u32 s20, s20, s42
	s_waitcnt lgkmcnt(9)
	v_mfma_f32_32x32x16_bf16 a[0:15], v[32:35], v[16:19], a[0:15]
	ds_read_b64_tr_b16 v[48:49], v9 offset:8192
	s_waitcnt lgkmcnt(7)
	v_mfma_f32_32x32x16_bf16 a[16:31], v[36:39], v[16:19], a[16:31]
	ds_read_b64_tr_b16 v[50:51], v9 offset:10240
	s_waitcnt lgkmcnt(7)
	v_mfma_f32_32x32x16_bf16 a[32:47], v[40:43], v[16:19], a[32:47]
	ds_read_b128 v[64:67], v6 offset:0
	s_waitcnt lgkmcnt(7)
	v_mfma_f32_32x32x16_bf16 a[48:63], v[44:47], v[16:19], a[48:63]
	v_mfma_f32_32x32x16_bf16 a[64:79], v[32:35], v[20:23], a[64:79]
	ds_read_b64_tr_b16 v[52:53], v10 offset:8192
	v_mfma_f32_32x32x16_bf16 a[80:95], v[36:39], v[20:23], a[80:95]
	ds_read_b64_tr_b16 v[54:55], v10 offset:10240
	v_mfma_f32_32x32x16_bf16 a[96:111], v[40:43], v[20:23], a[96:111]
	ds_read_b128 v[68:71], v6 offset:4096
	v_mfma_f32_32x32x16_bf16 a[112:127], v[44:47], v[20:23], a[112:127]
	s_waitcnt lgkmcnt(8)
	v_mfma_f32_32x32x16_bf16 a[128:143], v[32:35], v[24:27], a[128:143]
	ds_read_b128 v[72:75], v6 offset:8192
	v_mfma_f32_32x32x16_bf16 a[144:159], v[36:39], v[24:27], a[144:159]
	ds_read_b128 v[76:79], v6 offset:12288
	v_mfma_f32_32x32x16_bf16 a[160:175], v[40:43], v[24:27], a[160:175]
	ds_read_b64_tr_b16 v[56:57], v11 offset:8192
	v_mfma_f32_32x32x16_bf16 a[176:191], v[44:47], v[24:27], a[176:191]
	s_waitcnt lgkmcnt(9)
	v_mfma_f32_32x32x16_bf16 a[192:207], v[32:35], v[28:31], a[192:207]
	ds_read_b64_tr_b16 v[58:59], v11 offset:10240
	v_mfma_f32_32x32x16_bf16 a[208:223], v[36:39], v[28:31], a[208:223]
	ds_read_b64_tr_b16 v[60:61], v12 offset:8192
	v_mfma_f32_32x32x16_bf16 a[224:239], v[40:43], v[28:31], a[224:239]
	ds_read_b64_tr_b16 v[62:63], v12 offset:10240
	v_mfma_f32_32x32x16_bf16 a[240:255], v[44:47], v[28:31], a[240:255]
	s_waitcnt lgkmcnt(9)
	v_mfma_f32_32x32x16_bf16 a[0:15], v[64:67], v[48:51], a[0:15]
	ds_read_b64_tr_b16 v[16:17], v9 offset:16384
	s_waitcnt lgkmcnt(7)
	v_mfma_f32_32x32x16_bf16 a[16:31], v[68:71], v[48:51], a[16:31]
	ds_read_b64_tr_b16 v[18:19], v9 offset:18432
	s_waitcnt lgkmcnt(7)
	v_mfma_f32_32x32x16_bf16 a[32:47], v[72:75], v[48:51], a[32:47]
	ds_read_b128 v[32:35], v7 offset:0
	s_waitcnt lgkmcnt(7)
	v_mfma_f32_32x32x16_bf16 a[48:63], v[76:79], v[48:51], a[48:63]
	v_mfma_f32_32x32x16_bf16 a[64:79], v[64:67], v[52:55], a[64:79]
	ds_read_b64_tr_b16 v[20:21], v10 offset:16384
	v_mfma_f32_32x32x16_bf16 a[80:95], v[68:71], v[52:55], a[80:95]
	ds_read_b64_tr_b16 v[22:23], v10 offset:18432
	v_mfma_f32_32x32x16_bf16 a[96:111], v[72:75], v[52:55], a[96:111]
	ds_read_b128 v[36:39], v7 offset:4096
	v_mfma_f32_32x32x16_bf16 a[112:127], v[76:79], v[52:55], a[112:127]
	s_waitcnt lgkmcnt(8)
	v_mfma_f32_32x32x16_bf16 a[128:143], v[64:67], v[56:59], a[128:143]
	ds_read_b128 v[40:43], v7 offset:8192
	v_mfma_f32_32x32x16_bf16 a[144:159], v[68:71], v[56:59], a[144:159]
	ds_read_b128 v[44:47], v7 offset:12288
	v_mfma_f32_32x32x16_bf16 a[160:175], v[72:75], v[56:59], a[160:175]
	ds_read_b64_tr_b16 v[24:25], v11 offset:16384
	v_mfma_f32_32x32x16_bf16 a[176:191], v[76:79], v[56:59], a[176:191]
	s_waitcnt lgkmcnt(9)
	v_mfma_f32_32x32x16_bf16 a[192:207], v[64:67], v[60:63], a[192:207]
	ds_read_b64_tr_b16 v[26:27], v11 offset:18432
	v_mfma_f32_32x32x16_bf16 a[208:223], v[68:71], v[60:63], a[208:223]
	ds_read_b64_tr_b16 v[28:29], v12 offset:16384
	v_mfma_f32_32x32x16_bf16 a[224:239], v[72:75], v[60:63], a[224:239]
	ds_read_b64_tr_b16 v[30:31], v12 offset:18432
	v_mfma_f32_32x32x16_bf16 a[240:255], v[76:79], v[60:63], a[240:255]
	s_waitcnt lgkmcnt(9)
	v_mfma_f32_32x32x16_bf16 a[0:15], v[32:35], v[16:19], a[0:15]
	ds_read_b64_tr_b16 v[48:49], v9 offset:24576
	s_waitcnt lgkmcnt(7)
	v_mfma_f32_32x32x16_bf16 a[16:31], v[36:39], v[16:19], a[16:31]
	ds_read_b64_tr_b16 v[50:51], v9 offset:26624
	s_waitcnt lgkmcnt(7)
	v_mfma_f32_32x32x16_bf16 a[32:47], v[40:43], v[16:19], a[32:47]
	ds_read_b128 v[64:67], v8 offset:0
	s_waitcnt lgkmcnt(7)
	v_mfma_f32_32x32x16_bf16 a[48:63], v[44:47], v[16:19], a[48:63]
	v_mfma_f32_32x32x16_bf16 a[64:79], v[32:35], v[20:23], a[64:79]
	ds_read_b64_tr_b16 v[52:53], v10 offset:24576
	v_mfma_f32_32x32x16_bf16 a[80:95], v[36:39], v[20:23], a[80:95]
	ds_read_b64_tr_b16 v[54:55], v10 offset:26624
	v_mfma_f32_32x32x16_bf16 a[96:111], v[40:43], v[20:23], a[96:111]
	ds_read_b128 v[68:71], v8 offset:4096
	v_mfma_f32_32x32x16_bf16 a[112:127], v[44:47], v[20:23], a[112:127]
	s_waitcnt lgkmcnt(8)
	v_mfma_f32_32x32x16_bf16 a[128:143], v[32:35], v[24:27], a[128:143]
	ds_read_b128 v[72:75], v8 offset:8192
	v_mfma_f32_32x32x16_bf16 a[144:159], v[36:39], v[24:27], a[144:159]
	ds_read_b128 v[76:79], v8 offset:12288
	v_mfma_f32_32x32x16_bf16 a[160:175], v[40:43], v[24:27], a[160:175]
	ds_read_b64_tr_b16 v[56:57], v11 offset:24576
	v_mfma_f32_32x32x16_bf16 a[176:191], v[44:47], v[24:27], a[176:191]
	s_waitcnt lgkmcnt(9)
	v_mfma_f32_32x32x16_bf16 a[192:207], v[32:35], v[28:31], a[192:207]
	ds_read_b64_tr_b16 v[58:59], v11 offset:26624
	v_mfma_f32_32x32x16_bf16 a[208:223], v[36:39], v[28:31], a[208:223]
	ds_read_b64_tr_b16 v[60:61], v12 offset:24576
	v_mfma_f32_32x32x16_bf16 a[224:239], v[40:43], v[28:31], a[224:239]
	ds_read_b64_tr_b16 v[62:63], v12 offset:26624
	v_mfma_f32_32x32x16_bf16 a[240:255], v[44:47], v[28:31], a[240:255]
	s_waitcnt vmcnt(0) lgkmcnt(0)
	s_barrier
	v_add_u32 v5, 0xffff0000, v5
	v_add_u32 v6, 0xffff0000, v6
	v_add_u32 v7, 0xffff0000, v7
	v_add_u32 v8, 0xffff0000, v8
	v_add_u32 v9, 0xffff0000, v9
	v_add_u32 v10, 0xffff0000, v10
	v_add_u32 v11, 0xffff0000, v11
	v_add_u32 v12, 0xffff0000, v12
	v_mfma_f32_32x32x16_bf16 a[0:15], v[64:67], v[48:51], a[0:15]
	ds_read_b64_tr_b16 v[16:17], v9 offset:0
	v_mfma_f32_32x32x16_bf16 a[16:31], v[68:71], v[48:51], a[16:31]
	ds_read_b64_tr_b16 v[18:19], v9 offset:2048
	v_mfma_f32_32x32x16_bf16 a[32:47], v[72:75], v[48:51], a[32:47]
	ds_read_b128 v[32:35], v5 offset:0
	v_mfma_f32_32x32x16_bf16 a[48:63], v[76:79], v[48:51], a[48:63]
	v_mfma_f32_32x32x16_bf16 a[64:79], v[64:67], v[52:55], a[64:79]
	ds_read_b64_tr_b16 v[20:21], v10 offset:0
	v_mfma_f32_32x32x16_bf16 a[80:95], v[68:71], v[52:55], a[80:95]
	ds_read_b64_tr_b16 v[22:23], v10 offset:2048
	v_mfma_f32_32x32x16_bf16 a[96:111], v[72:75], v[52:55], a[96:111]
	ds_read_b128 v[36:39], v5 offset:4096
	v_mfma_f32_32x32x16_bf16 a[112:127], v[76:79], v[52:55], a[112:127]
	v_mfma_f32_32x32x16_bf16 a[128:143], v[64:67], v[56:59], a[128:143]
	ds_read_b128 v[40:43], v5 offset:8192
	v_mfma_f32_32x32x16_bf16 a[144:159], v[68:71], v[56:59], a[144:159]
	ds_read_b128 v[44:47], v5 offset:12288
	v_mfma_f32_32x32x16_bf16 a[160:175], v[72:75], v[56:59], a[160:175]
	ds_read_b64_tr_b16 v[24:25], v11 offset:0
	v_mfma_f32_32x32x16_bf16 a[176:191], v[76:79], v[56:59], a[176:191]
	v_mfma_f32_32x32x16_bf16 a[192:207], v[64:67], v[60:63], a[192:207]
	ds_read_b64_tr_b16 v[26:27], v11 offset:2048
	v_mfma_f32_32x32x16_bf16 a[208:223], v[68:71], v[60:63], a[208:223]
	ds_read_b64_tr_b16 v[28:29], v12 offset:0
	v_mfma_f32_32x32x16_bf16 a[224:239], v[72:75], v[60:63], a[224:239]
	ds_read_b64_tr_b16 v[30:31], v12 offset:2048
	v_mfma_f32_32x32x16_bf16 a[240:255], v[76:79], v[60:63], a[240:255]
	s_waitcnt lgkmcnt(9)
	v_mfma_f32_32x32x16_bf16 a[0:15], v[32:35], v[16:19], a[0:15]
	ds_read_b64_tr_b16 v[48:49], v9 offset:8192
	s_waitcnt lgkmcnt(7)
	v_mfma_f32_32x32x16_bf16 a[16:31], v[36:39], v[16:19], a[16:31]
	ds_read_b64_tr_b16 v[50:51], v9 offset:10240
	s_waitcnt lgkmcnt(7)
	v_mfma_f32_32x32x16_bf16 a[32:47], v[40:43], v[16:19], a[32:47]
	ds_read_b128 v[64:67], v6 offset:0
	s_waitcnt lgkmcnt(7)
	v_mfma_f32_32x32x16_bf16 a[48:63], v[44:47], v[16:19], a[48:63]
	v_mfma_f32_32x32x16_bf16 a[64:79], v[32:35], v[20:23], a[64:79]
	ds_read_b64_tr_b16 v[52:53], v10 offset:8192
	v_mfma_f32_32x32x16_bf16 a[80:95], v[36:39], v[20:23], a[80:95]
	ds_read_b64_tr_b16 v[54:55], v10 offset:10240
	v_mfma_f32_32x32x16_bf16 a[96:111], v[40:43], v[20:23], a[96:111]
	ds_read_b128 v[68:71], v6 offset:4096
	v_mfma_f32_32x32x16_bf16 a[112:127], v[44:47], v[20:23], a[112:127]
	s_waitcnt lgkmcnt(8)
	v_mfma_f32_32x32x16_bf16 a[128:143], v[32:35], v[24:27], a[128:143]
	ds_read_b128 v[72:75], v6 offset:8192
	v_mfma_f32_32x32x16_bf16 a[144:159], v[36:39], v[24:27], a[144:159]
	ds_read_b128 v[76:79], v6 offset:12288
	v_mfma_f32_32x32x16_bf16 a[160:175], v[40:43], v[24:27], a[160:175]
	ds_read_b64_tr_b16 v[56:57], v11 offset:8192
	v_mfma_f32_32x32x16_bf16 a[176:191], v[44:47], v[24:27], a[176:191]
	s_waitcnt lgkmcnt(9)
	v_mfma_f32_32x32x16_bf16 a[192:207], v[32:35], v[28:31], a[192:207]
	ds_read_b64_tr_b16 v[58:59], v11 offset:10240
	v_mfma_f32_32x32x16_bf16 a[208:223], v[36:39], v[28:31], a[208:223]
	ds_read_b64_tr_b16 v[60:61], v12 offset:8192
	v_mfma_f32_32x32x16_bf16 a[224:239], v[40:43], v[28:31], a[224:239]
	ds_read_b64_tr_b16 v[62:63], v12 offset:10240
	v_mfma_f32_32x32x16_bf16 a[240:255], v[44:47], v[28:31], a[240:255]
	s_waitcnt lgkmcnt(9)
	v_mfma_f32_32x32x16_bf16 a[0:15], v[64:67], v[48:51], a[0:15]
	ds_read_b64_tr_b16 v[16:17], v9 offset:16384
	s_waitcnt lgkmcnt(7)
	v_mfma_f32_32x32x16_bf16 a[16:31], v[68:71], v[48:51], a[16:31]
	ds_read_b64_tr_b16 v[18:19], v9 offset:18432
	s_waitcnt lgkmcnt(7)
	v_mfma_f32_32x32x16_bf16 a[32:47], v[72:75], v[48:51], a[32:47]
	ds_read_b128 v[32:35], v7 offset:0
	s_waitcnt lgkmcnt(7)
	v_mfma_f32_32x32x16_bf16 a[48:63], v[76:79], v[48:51], a[48:63]
	v_mfma_f32_32x32x16_bf16 a[64:79], v[64:67], v[52:55], a[64:79]
	ds_read_b64_tr_b16 v[20:21], v10 offset:16384
	v_mfma_f32_32x32x16_bf16 a[80:95], v[68:71], v[52:55], a[80:95]
	ds_read_b64_tr_b16 v[22:23], v10 offset:18432
	v_mfma_f32_32x32x16_bf16 a[96:111], v[72:75], v[52:55], a[96:111]
	ds_read_b128 v[36:39], v7 offset:4096
	v_mfma_f32_32x32x16_bf16 a[112:127], v[76:79], v[52:55], a[112:127]
	s_waitcnt lgkmcnt(8)
	v_mfma_f32_32x32x16_bf16 a[128:143], v[64:67], v[56:59], a[128:143]
	ds_read_b128 v[40:43], v7 offset:8192
	v_mfma_f32_32x32x16_bf16 a[144:159], v[68:71], v[56:59], a[144:159]
	ds_read_b128 v[44:47], v7 offset:12288
	v_mfma_f32_32x32x16_bf16 a[160:175], v[72:75], v[56:59], a[160:175]
	ds_read_b64_tr_b16 v[24:25], v11 offset:16384
	v_mfma_f32_32x32x16_bf16 a[176:191], v[76:79], v[56:59], a[176:191]
	s_waitcnt lgkmcnt(9)
	v_mfma_f32_32x32x16_bf16 a[192:207], v[64:67], v[60:63], a[192:207]
	ds_read_b64_tr_b16 v[26:27], v11 offset:18432
	v_mfma_f32_32x32x16_bf16 a[208:223], v[68:71], v[60:63], a[208:223]
	ds_read_b64_tr_b16 v[28:29], v12 offset:16384
	v_mfma_f32_32x32x16_bf16 a[224:239], v[72:75], v[60:63], a[224:239]
	ds_read_b64_tr_b16 v[30:31], v12 offset:18432
	v_mfma_f32_32x32x16_bf16 a[240:255], v[76:79], v[60:63], a[240:255]
	s_waitcnt lgkmcnt(9)
	v_mfma_f32_32x32x16_bf16 a[0:15], v[32:35], v[16:19], a[0:15]
	ds_read_b64_tr_b16 v[48:49], v9 offset:24576
	s_waitcnt lgkmcnt(7)
	v_mfma_f32_32x32x16_bf16 a[16:31], v[36:39], v[16:19], a[16:31]
	ds_read_b64_tr_b16 v[50:51], v9 offset:26624
	s_waitcnt lgkmcnt(7)
	v_mfma_f32_32x32x16_bf16 a[32:47], v[40:43], v[16:19], a[32:47]
	ds_read_b128 v[64:67], v8 offset:0
	s_waitcnt lgkmcnt(7)
	v_mfma_f32_32x32x16_bf16 a[48:63], v[44:47], v[16:19], a[48:63]
	v_mfma_f32_32x32x16_bf16 a[64:79], v[32:35], v[20:23], a[64:79]
	ds_read_b64_tr_b16 v[52:53], v10 offset:24576
	v_mfma_f32_32x32x16_bf16 a[80:95], v[36:39], v[20:23], a[80:95]
	ds_read_b64_tr_b16 v[54:55], v10 offset:26624
	v_mfma_f32_32x32x16_bf16 a[96:111], v[40:43], v[20:23], a[96:111]
	ds_read_b128 v[68:71], v8 offset:4096
	v_mfma_f32_32x32x16_bf16 a[112:127], v[44:47], v[20:23], a[112:127]
	s_waitcnt lgkmcnt(8)
	v_mfma_f32_32x32x16_bf16 a[128:143], v[32:35], v[24:27], a[128:143]
	ds_read_b128 v[72:75], v8 offset:8192
	v_mfma_f32_32x32x16_bf16 a[144:159], v[36:39], v[24:27], a[144:159]
	ds_read_b128 v[76:79], v8 offset:12288
	v_mfma_f32_32x32x16_bf16 a[160:175], v[40:43], v[24:27], a[160:175]
	ds_read_b64_tr_b16 v[56:57], v11 offset:24576
	v_mfma_f32_32x32x16_bf16 a[176:191], v[44:47], v[24:27], a[176:191]
	s_waitcnt lgkmcnt(9)
	v_mfma_f32_32x32x16_bf16 a[192:207], v[32:35], v[28:31], a[192:207]
	ds_read_b64_tr_b16 v[58:59], v11 offset:26624
	v_mfma_f32_32x32x16_bf16 a[208:223], v[36:39], v[28:31], a[208:223]
	ds_read_b64_tr_b16 v[60:61], v12 offset:24576
	v_mfma_f32_32x32x16_bf16 a[224:239], v[40:43], v[28:31], a[224:239]
	ds_read_b64_tr_b16 v[62:63], v12 offset:26624
	v_mfma_f32_32x32x16_bf16 a[240:255], v[44:47], v[28:31], a[240:255]
	s_waitcnt lgkmcnt(9)
	v_mfma_f32_32x32x16_bf16 a[0:15], v[64:67], v[48:51], a[0:15]
	s_waitcnt lgkmcnt(6)
	v_mfma_f32_32x32x16_bf16 a[16:31], v[68:71], v[48:51], a[16:31]
	s_waitcnt lgkmcnt(5)
	v_mfma_f32_32x32x16_bf16 a[32:47], v[72:75], v[48:51], a[32:47]
	s_waitcnt lgkmcnt(4)
	v_mfma_f32_32x32x16_bf16 a[48:63], v[76:79], v[48:51], a[48:63]
	v_mfma_f32_32x32x16_bf16 a[64:79], v[64:67], v[52:55], a[64:79]
	v_mfma_f32_32x32x16_bf16 a[80:95], v[68:71], v[52:55], a[80:95]
	v_mfma_f32_32x32x16_bf16 a[96:111], v[72:75], v[52:55], a[96:111]
	v_mfma_f32_32x32x16_bf16 a[112:127], v[76:79], v[52:55], a[112:127]
	s_waitcnt lgkmcnt(2)
	v_mfma_f32_32x32x16_bf16 a[128:143], v[64:67], v[56:59], a[128:143]
	v_mfma_f32_32x32x16_bf16 a[144:159], v[68:71], v[56:59], a[144:159]
	v_mfma_f32_32x32x16_bf16 a[160:175], v[72:75], v[56:59], a[160:175]
	v_mfma_f32_32x32x16_bf16 a[176:191], v[76:79], v[56:59], a[176:191]
	s_waitcnt lgkmcnt(0)
	v_mfma_f32_32x32x16_bf16 a[192:207], v[64:67], v[60:63], a[192:207]
	v_mfma_f32_32x32x16_bf16 a[208:223], v[68:71], v[60:63], a[208:223]
	v_mfma_f32_32x32x16_bf16 a[224:239], v[72:75], v[60:63], a[224:239]
	v_mfma_f32_32x32x16_bf16 a[240:255], v[76:79], v[60:63], a[240:255]
	s_barrier
	s_mov_b32 s26, 64
	s_lshl_b32 s25, s27, 6
	s_lshl_b32 s21, s28, 13
	s_add_u32 s25, s25, s21
	s_add_u32 s25, s25, 37748736
	s_and_b32 s21, s4, 1
	s_lshr_b32 s22, s4, 1
	s_mul_i32 s21, s21, 128
	s_mul_i32 s22, s22, 1048576
	v_and_b32 v13, 15, v0
	v_add_u32 v13, s21, v13
	v_mul_lo_u32 v13, v13, s26
	v_bfe_u32 v14, v0, 4, 1
	v_lshl_add_u32 v13, v14, 5, v13
	v_lshrrev_b32 v14, 5, v0
	v_lshl_add_u32 v13, v14, 4, v13
	v_add_u32 v15, s22, v13
	s_lshl_b32 s22, s26, 4
	v_add_u32 v157, s22, v15
	s_lshl_b32 s22, s26, 5
	v_accvgpr_read_b32 v80, a0
	v_accvgpr_read_b32 v81, a1
	v_accvgpr_read_b32 v82, a2
	v_accvgpr_read_b32 v83, a3
	v_accvgpr_read_b32 v84, a4
	v_accvgpr_read_b32 v85, a5
	v_accvgpr_read_b32 v86, a6
	v_accvgpr_read_b32 v87, a7
	v_accvgpr_read_b32 v88, a8
	v_accvgpr_read_b32 v89, a9
	v_accvgpr_read_b32 v90, a10
	v_accvgpr_read_b32 v91, a11
	v_accvgpr_read_b32 v92, a12
	v_accvgpr_read_b32 v93, a13
	v_accvgpr_read_b32 v94, a14
	v_accvgpr_read_b32 v95, a15
	v_cvt_pk_bf16_f32 v80, v80, v81
	v_cvt_pk_bf16_f32 v81, v82, v83
	v_cvt_pk_bf16_f32 v82, v84, v85
	v_cvt_pk_bf16_f32 v83, v86, v87
	s_nop 0
	v_permlane32_swap_b32 v80, v82
	v_permlane32_swap_b32 v81, v83
	v_cvt_pk_bf16_f32 v88, v88, v89
	v_cvt_pk_bf16_f32 v89, v90, v91
	v_cvt_pk_bf16_f32 v90, v92, v93
	v_cvt_pk_bf16_f32 v91, v94, v95
	s_nop 0
	v_permlane32_swap_b32 v88, v90
	v_permlane32_swap_b32 v89, v91
	s_nop 0
	v_permlane16_swap_b32 v80, v88
	v_permlane16_swap_b32 v81, v89
	v_permlane16_swap_b32 v82, v90
	v_permlane16_swap_b32 v83, v91
	s_mov_b32 s23, s25
	buffer_store_dwordx4 v[80:83], v15, s[8:11], s23 offen offset:0 sc1
	buffer_store_dwordx4 v[88:91], v157, s[8:11], s23 offen offset:0 sc1
	v_accvgpr_read_b32 v100, a16
	v_accvgpr_read_b32 v101, a17
	v_accvgpr_read_b32 v102, a18
	v_accvgpr_read_b32 v103, a19
	v_accvgpr_read_b32 v104, a20
	v_accvgpr_read_b32 v105, a21
	v_accvgpr_read_b32 v106, a22
	v_accvgpr_read_b32 v107, a23
	v_accvgpr_read_b32 v108, a24
	v_accvgpr_read_b32 v109, a25
	v_accvgpr_read_b32 v110, a26
	v_accvgpr_read_b32 v111, a27
	v_accvgpr_read_b32 v112, a28
	v_accvgpr_read_b32 v113, a29
	v_accvgpr_read_b32 v114, a30
	v_accvgpr_read_b32 v115, a31
	v_cvt_pk_bf16_f32 v100, v100, v101
	v_cvt_pk_bf16_f32 v101, v102, v103
	v_cvt_pk_bf16_f32 v102, v104, v105
	v_cvt_pk_bf16_f32 v103, v106, v107
	s_nop 0
	v_permlane32_swap_b32 v100, v102
	v_permlane32_swap_b32 v101, v103
	v_cvt_pk_bf16_f32 v108, v108, v109
	v_cvt_pk_bf16_f32 v109, v110, v111
	v_cvt_pk_bf16_f32 v110, v112, v113
	v_cvt_pk_bf16_f32 v111, v114, v115
	s_nop 0
	v_permlane32_swap_b32 v108, v110
	v_permlane32_swap_b32 v109, v111
	s_nop 0
	v_permlane16_swap_b32 v100, v108
	v_permlane16_swap_b32 v101, v109
	v_permlane16_swap_b32 v102, v110
	v_permlane16_swap_b32 v103, v111
	s_mov_b32 s23, s25
	s_add_u32 s23, s23, 262144
	buffer_store_dwordx4 v[100:103], v15, s[8:11], s23 offen offset:0 sc1
	buffer_store_dwordx4 v[108:111], v157, s[8:11], s23 offen offset:0 sc1
	v_accvgpr_read_b32 v80, a32
	v_accvgpr_read_b32 v81, a33
	v_accvgpr_read_b32 v82, a34
	v_accvgpr_read_b32 v83, a35
	v_accvgpr_read_b32 v84, a36
	v_accvgpr_read_b32 v85, a37
	v_accvgpr_read_b32 v86, a38
	v_accvgpr_read_b32 v87, a39
	v_accvgpr_read_b32 v88, a40
	v_accvgpr_read_b32 v89, a41
	v_accvgpr_read_b32 v90, a42
	v_accvgpr_read_b32 v91, a43
	v_accvgpr_read_b32 v92, a44
	v_accvgpr_read_b32 v93, a45
	v_accvgpr_read_b32 v94, a46
	v_accvgpr_read_b32 v95, a47
	v_cvt_pk_bf16_f32 v80, v80, v81
	v_cvt_pk_bf16_f32 v81, v82, v83
	v_cvt_pk_bf16_f32 v82, v84, v85
	v_cvt_pk_bf16_f32 v83, v86, v87
	s_nop 0
	v_permlane32_swap_b32 v80, v82
	v_permlane32_swap_b32 v81, v83
	v_cvt_pk_bf16_f32 v88, v88, v89
	v_cvt_pk_bf16_f32 v89, v90, v91
	v_cvt_pk_bf16_f32 v90, v92, v93
	v_cvt_pk_bf16_f32 v91, v94, v95
	s_nop 0
	v_permlane32_swap_b32 v88, v90
	v_permlane32_swap_b32 v89, v91
	s_nop 0
	v_permlane16_swap_b32 v80, v88
	v_permlane16_swap_b32 v81, v89
	v_permlane16_swap_b32 v82, v90
	v_permlane16_swap_b32 v83, v91
	s_mov_b32 s23, s25
	s_add_u32 s23, s23, 524288
	buffer_store_dwordx4 v[80:83], v15, s[8:11], s23 offen offset:0 sc1
	buffer_store_dwordx4 v[88:91], v157, s[8:11], s23 offen offset:0 sc1
	v_accvgpr_read_b32 v100, a48
	v_accvgpr_read_b32 v101, a49
	v_accvgpr_read_b32 v102, a50
	v_accvgpr_read_b32 v103, a51
	v_accvgpr_read_b32 v104, a52
	v_accvgpr_read_b32 v105, a53
	v_accvgpr_read_b32 v106, a54
	v_accvgpr_read_b32 v107, a55
	v_accvgpr_read_b32 v108, a56
	v_accvgpr_read_b32 v109, a57
	v_accvgpr_read_b32 v110, a58
	v_accvgpr_read_b32 v111, a59
	v_accvgpr_read_b32 v112, a60
	v_accvgpr_read_b32 v113, a61
	v_accvgpr_read_b32 v114, a62
	v_accvgpr_read_b32 v115, a63
	v_cvt_pk_bf16_f32 v100, v100, v101
	v_cvt_pk_bf16_f32 v101, v102, v103
	v_cvt_pk_bf16_f32 v102, v104, v105
	v_cvt_pk_bf16_f32 v103, v106, v107
	s_nop 0
	v_permlane32_swap_b32 v100, v102
	v_permlane32_swap_b32 v101, v103
	v_cvt_pk_bf16_f32 v108, v108, v109
	v_cvt_pk_bf16_f32 v109, v110, v111
	v_cvt_pk_bf16_f32 v110, v112, v113
	v_cvt_pk_bf16_f32 v111, v114, v115
	s_nop 0
	v_permlane32_swap_b32 v108, v110
	v_permlane32_swap_b32 v109, v111
	s_nop 0
	v_permlane16_swap_b32 v100, v108
	v_permlane16_swap_b32 v101, v109
	v_permlane16_swap_b32 v102, v110
	v_permlane16_swap_b32 v103, v111
	s_mov_b32 s23, s25
	s_add_u32 s23, s23, 786432
	buffer_store_dwordx4 v[100:103], v15, s[8:11], s23 offen offset:0 sc1
	buffer_store_dwordx4 v[108:111], v157, s[8:11], s23 offen offset:0 sc1
	v_accvgpr_read_b32 v80, a64
	v_accvgpr_read_b32 v81, a65
	v_accvgpr_read_b32 v82, a66
	v_accvgpr_read_b32 v83, a67
	v_accvgpr_read_b32 v84, a68
	v_accvgpr_read_b32 v85, a69
	v_accvgpr_read_b32 v86, a70
	v_accvgpr_read_b32 v87, a71
	v_accvgpr_read_b32 v88, a72
	v_accvgpr_read_b32 v89, a73
	v_accvgpr_read_b32 v90, a74
	v_accvgpr_read_b32 v91, a75
	v_accvgpr_read_b32 v92, a76
	v_accvgpr_read_b32 v93, a77
	v_accvgpr_read_b32 v94, a78
	v_accvgpr_read_b32 v95, a79
	v_cvt_pk_bf16_f32 v80, v80, v81
	v_cvt_pk_bf16_f32 v81, v82, v83
	v_cvt_pk_bf16_f32 v82, v84, v85
	v_cvt_pk_bf16_f32 v83, v86, v87
	s_nop 0
	v_permlane32_swap_b32 v80, v82
	v_permlane32_swap_b32 v81, v83
	v_cvt_pk_bf16_f32 v88, v88, v89
	v_cvt_pk_bf16_f32 v89, v90, v91
	v_cvt_pk_bf16_f32 v90, v92, v93
	v_cvt_pk_bf16_f32 v91, v94, v95
	s_nop 0
	v_permlane32_swap_b32 v88, v90
	v_permlane32_swap_b32 v89, v91
	s_nop 0
	v_permlane16_swap_b32 v80, v88
	v_permlane16_swap_b32 v81, v89
	v_permlane16_swap_b32 v82, v90
	v_permlane16_swap_b32 v83, v91
	s_mul_i32 s23, s22, 1
	s_add_u32 s23, s23, s25
	buffer_store_dwordx4 v[80:83], v15, s[8:11], s23 offen offset:0 sc1
	buffer_store_dwordx4 v[88:91], v157, s[8:11], s23 offen offset:0 sc1
	v_accvgpr_read_b32 v100, a80
	v_accvgpr_read_b32 v101, a81
	v_accvgpr_read_b32 v102, a82
	v_accvgpr_read_b32 v103, a83
	v_accvgpr_read_b32 v104, a84
	v_accvgpr_read_b32 v105, a85
	v_accvgpr_read_b32 v106, a86
	v_accvgpr_read_b32 v107, a87
	v_accvgpr_read_b32 v108, a88
	v_accvgpr_read_b32 v109, a89
	v_accvgpr_read_b32 v110, a90
	v_accvgpr_read_b32 v111, a91
	v_accvgpr_read_b32 v112, a92
	v_accvgpr_read_b32 v113, a93
	v_accvgpr_read_b32 v114, a94
	v_accvgpr_read_b32 v115, a95
	v_cvt_pk_bf16_f32 v100, v100, v101
	v_cvt_pk_bf16_f32 v101, v102, v103
	v_cvt_pk_bf16_f32 v102, v104, v105
	v_cvt_pk_bf16_f32 v103, v106, v107
	s_nop 0
	v_permlane32_swap_b32 v100, v102
	v_permlane32_swap_b32 v101, v103
	v_cvt_pk_bf16_f32 v108, v108, v109
	v_cvt_pk_bf16_f32 v109, v110, v111
	v_cvt_pk_bf16_f32 v110, v112, v113
	v_cvt_pk_bf16_f32 v111, v114, v115
	s_nop 0
	v_permlane32_swap_b32 v108, v110
	v_permlane32_swap_b32 v109, v111
	s_nop 0
	v_permlane16_swap_b32 v100, v108
	v_permlane16_swap_b32 v101, v109
	v_permlane16_swap_b32 v102, v110
	v_permlane16_swap_b32 v103, v111
	s_mul_i32 s23, s22, 1
	s_add_u32 s23, s23, s25
	s_add_u32 s23, s23, 262144
	buffer_store_dwordx4 v[100:103], v15, s[8:11], s23 offen offset:0 sc1
	buffer_store_dwordx4 v[108:111], v157, s[8:11], s23 offen offset:0 sc1
	v_accvgpr_read_b32 v80, a96
	v_accvgpr_read_b32 v81, a97
	v_accvgpr_read_b32 v82, a98
	v_accvgpr_read_b32 v83, a99
	v_accvgpr_read_b32 v84, a100
	v_accvgpr_read_b32 v85, a101
	v_accvgpr_read_b32 v86, a102
	v_accvgpr_read_b32 v87, a103
	v_accvgpr_read_b32 v88, a104
	v_accvgpr_read_b32 v89, a105
	v_accvgpr_read_b32 v90, a106
	v_accvgpr_read_b32 v91, a107
	v_accvgpr_read_b32 v92, a108
	v_accvgpr_read_b32 v93, a109
	v_accvgpr_read_b32 v94, a110
	v_accvgpr_read_b32 v95, a111
	v_cvt_pk_bf16_f32 v80, v80, v81
	v_cvt_pk_bf16_f32 v81, v82, v83
	v_cvt_pk_bf16_f32 v82, v84, v85
	v_cvt_pk_bf16_f32 v83, v86, v87
	s_nop 0
	v_permlane32_swap_b32 v80, v82
	v_permlane32_swap_b32 v81, v83
	v_cvt_pk_bf16_f32 v88, v88, v89
	v_cvt_pk_bf16_f32 v89, v90, v91
	v_cvt_pk_bf16_f32 v90, v92, v93
	v_cvt_pk_bf16_f32 v91, v94, v95
	s_nop 0
	v_permlane32_swap_b32 v88, v90
	v_permlane32_swap_b32 v89, v91
	s_nop 0
	v_permlane16_swap_b32 v80, v88
	v_permlane16_swap_b32 v81, v89
	v_permlane16_swap_b32 v82, v90
	v_permlane16_swap_b32 v83, v91
	s_mul_i32 s23, s22, 1
	s_add_u32 s23, s23, s25
	s_add_u32 s23, s23, 524288
	buffer_store_dwordx4 v[80:83], v15, s[8:11], s23 offen offset:0 sc1
	buffer_store_dwordx4 v[88:91], v157, s[8:11], s23 offen offset:0 sc1
	v_accvgpr_read_b32 v100, a112
	v_accvgpr_read_b32 v101, a113
	v_accvgpr_read_b32 v102, a114
	v_accvgpr_read_b32 v103, a115
	v_accvgpr_read_b32 v104, a116
	v_accvgpr_read_b32 v105, a117
	v_accvgpr_read_b32 v106, a118
	v_accvgpr_read_b32 v107, a119
	v_accvgpr_read_b32 v108, a120
	v_accvgpr_read_b32 v109, a121
	v_accvgpr_read_b32 v110, a122
	v_accvgpr_read_b32 v111, a123
	v_accvgpr_read_b32 v112, a124
	v_accvgpr_read_b32 v113, a125
	v_accvgpr_read_b32 v114, a126
	v_accvgpr_read_b32 v115, a127
	v_cvt_pk_bf16_f32 v100, v100, v101
	v_cvt_pk_bf16_f32 v101, v102, v103
	v_cvt_pk_bf16_f32 v102, v104, v105
	v_cvt_pk_bf16_f32 v103, v106, v107
	s_nop 0
	v_permlane32_swap_b32 v100, v102
	v_permlane32_swap_b32 v101, v103
	v_cvt_pk_bf16_f32 v108, v108, v109
	v_cvt_pk_bf16_f32 v109, v110, v111
	v_cvt_pk_bf16_f32 v110, v112, v113
	v_cvt_pk_bf16_f32 v111, v114, v115
	s_nop 0
	v_permlane32_swap_b32 v108, v110
	v_permlane32_swap_b32 v109, v111
	s_nop 0
	v_permlane16_swap_b32 v100, v108
	v_permlane16_swap_b32 v101, v109
	v_permlane16_swap_b32 v102, v110
	v_permlane16_swap_b32 v103, v111
	s_mul_i32 s23, s22, 1
	s_add_u32 s23, s23, s25
	s_add_u32 s23, s23, 786432
	buffer_store_dwordx4 v[100:103], v15, s[8:11], s23 offen offset:0 sc1
	buffer_store_dwordx4 v[108:111], v157, s[8:11], s23 offen offset:0 sc1
	v_accvgpr_read_b32 v80, a128
	v_accvgpr_read_b32 v81, a129
	v_accvgpr_read_b32 v82, a130
	v_accvgpr_read_b32 v83, a131
	v_accvgpr_read_b32 v84, a132
	v_accvgpr_read_b32 v85, a133
	v_accvgpr_read_b32 v86, a134
	v_accvgpr_read_b32 v87, a135
	v_accvgpr_read_b32 v88, a136
	v_accvgpr_read_b32 v89, a137
	v_accvgpr_read_b32 v90, a138
	v_accvgpr_read_b32 v91, a139
	v_accvgpr_read_b32 v92, a140
	v_accvgpr_read_b32 v93, a141
	v_accvgpr_read_b32 v94, a142
	v_accvgpr_read_b32 v95, a143
	v_cvt_pk_bf16_f32 v80, v80, v81
	v_cvt_pk_bf16_f32 v81, v82, v83
	v_cvt_pk_bf16_f32 v82, v84, v85
	v_cvt_pk_bf16_f32 v83, v86, v87
	s_nop 0
	v_permlane32_swap_b32 v80, v82
	v_permlane32_swap_b32 v81, v83
	v_cvt_pk_bf16_f32 v88, v88, v89
	v_cvt_pk_bf16_f32 v89, v90, v91
	v_cvt_pk_bf16_f32 v90, v92, v93
	v_cvt_pk_bf16_f32 v91, v94, v95
	s_nop 0
	v_permlane32_swap_b32 v88, v90
	v_permlane32_swap_b32 v89, v91
	s_nop 0
	v_permlane16_swap_b32 v80, v88
	v_permlane16_swap_b32 v81, v89
	v_permlane16_swap_b32 v82, v90
	v_permlane16_swap_b32 v83, v91
	s_mul_i32 s23, s22, 2
	s_add_u32 s23, s23, s25
	buffer_store_dwordx4 v[80:83], v15, s[8:11], s23 offen offset:0 sc1
	buffer_store_dwordx4 v[88:91], v157, s[8:11], s23 offen offset:0 sc1
	v_accvgpr_read_b32 v100, a144
	v_accvgpr_read_b32 v101, a145
	v_accvgpr_read_b32 v102, a146
	v_accvgpr_read_b32 v103, a147
	v_accvgpr_read_b32 v104, a148
	v_accvgpr_read_b32 v105, a149
	v_accvgpr_read_b32 v106, a150
	v_accvgpr_read_b32 v107, a151
	v_accvgpr_read_b32 v108, a152
	v_accvgpr_read_b32 v109, a153
	v_accvgpr_read_b32 v110, a154
	v_accvgpr_read_b32 v111, a155
	v_accvgpr_read_b32 v112, a156
	v_accvgpr_read_b32 v113, a157
	v_accvgpr_read_b32 v114, a158
	v_accvgpr_read_b32 v115, a159
	v_cvt_pk_bf16_f32 v100, v100, v101
	v_cvt_pk_bf16_f32 v101, v102, v103
	v_cvt_pk_bf16_f32 v102, v104, v105
	v_cvt_pk_bf16_f32 v103, v106, v107
	s_nop 0
	v_permlane32_swap_b32 v100, v102
	v_permlane32_swap_b32 v101, v103
	v_cvt_pk_bf16_f32 v108, v108, v109
	v_cvt_pk_bf16_f32 v109, v110, v111
	v_cvt_pk_bf16_f32 v110, v112, v113
	v_cvt_pk_bf16_f32 v111, v114, v115
	s_nop 0
	v_permlane32_swap_b32 v108, v110
	v_permlane32_swap_b32 v109, v111
	s_nop 0
	v_permlane16_swap_b32 v100, v108
	v_permlane16_swap_b32 v101, v109
	v_permlane16_swap_b32 v102, v110
	v_permlane16_swap_b32 v103, v111
	s_mul_i32 s23, s22, 2
	s_add_u32 s23, s23, s25
	s_add_u32 s23, s23, 262144
	buffer_store_dwordx4 v[100:103], v15, s[8:11], s23 offen offset:0 sc1
	buffer_store_dwordx4 v[108:111], v157, s[8:11], s23 offen offset:0 sc1
	v_accvgpr_read_b32 v80, a160
	v_accvgpr_read_b32 v81, a161
	v_accvgpr_read_b32 v82, a162
	v_accvgpr_read_b32 v83, a163
	v_accvgpr_read_b32 v84, a164
	v_accvgpr_read_b32 v85, a165
	v_accvgpr_read_b32 v86, a166
	v_accvgpr_read_b32 v87, a167
	v_accvgpr_read_b32 v88, a168
	v_accvgpr_read_b32 v89, a169
	v_accvgpr_read_b32 v90, a170
	v_accvgpr_read_b32 v91, a171
	v_accvgpr_read_b32 v92, a172
	v_accvgpr_read_b32 v93, a173
	v_accvgpr_read_b32 v94, a174
	v_accvgpr_read_b32 v95, a175
	v_cvt_pk_bf16_f32 v80, v80, v81
	v_cvt_pk_bf16_f32 v81, v82, v83
	v_cvt_pk_bf16_f32 v82, v84, v85
	v_cvt_pk_bf16_f32 v83, v86, v87
	s_nop 0
	v_permlane32_swap_b32 v80, v82
	v_permlane32_swap_b32 v81, v83
	v_cvt_pk_bf16_f32 v88, v88, v89
	v_cvt_pk_bf16_f32 v89, v90, v91
	v_cvt_pk_bf16_f32 v90, v92, v93
	v_cvt_pk_bf16_f32 v91, v94, v95
	s_nop 0
	v_permlane32_swap_b32 v88, v90
	v_permlane32_swap_b32 v89, v91
	s_nop 0
	v_permlane16_swap_b32 v80, v88
	v_permlane16_swap_b32 v81, v89
	v_permlane16_swap_b32 v82, v90
	v_permlane16_swap_b32 v83, v91
	s_mul_i32 s23, s22, 2
	s_add_u32 s23, s23, s25
	s_add_u32 s23, s23, 524288
	buffer_store_dwordx4 v[80:83], v15, s[8:11], s23 offen offset:0 sc1
	buffer_store_dwordx4 v[88:91], v157, s[8:11], s23 offen offset:0 sc1
	v_accvgpr_read_b32 v100, a176
	v_accvgpr_read_b32 v101, a177
	v_accvgpr_read_b32 v102, a178
	v_accvgpr_read_b32 v103, a179
	v_accvgpr_read_b32 v104, a180
	v_accvgpr_read_b32 v105, a181
	v_accvgpr_read_b32 v106, a182
	v_accvgpr_read_b32 v107, a183
	v_accvgpr_read_b32 v108, a184
	v_accvgpr_read_b32 v109, a185
	v_accvgpr_read_b32 v110, a186
	v_accvgpr_read_b32 v111, a187
	v_accvgpr_read_b32 v112, a188
	v_accvgpr_read_b32 v113, a189
	v_accvgpr_read_b32 v114, a190
	v_accvgpr_read_b32 v115, a191
	v_cvt_pk_bf16_f32 v100, v100, v101
	v_cvt_pk_bf16_f32 v101, v102, v103
	v_cvt_pk_bf16_f32 v102, v104, v105
	v_cvt_pk_bf16_f32 v103, v106, v107
	s_nop 0
	v_permlane32_swap_b32 v100, v102
	v_permlane32_swap_b32 v101, v103
	v_cvt_pk_bf16_f32 v108, v108, v109
	v_cvt_pk_bf16_f32 v109, v110, v111
	v_cvt_pk_bf16_f32 v110, v112, v113
	v_cvt_pk_bf16_f32 v111, v114, v115
	s_nop 0
	v_permlane32_swap_b32 v108, v110
	v_permlane32_swap_b32 v109, v111
	s_nop 0
	v_permlane16_swap_b32 v100, v108
	v_permlane16_swap_b32 v101, v109
	v_permlane16_swap_b32 v102, v110
	v_permlane16_swap_b32 v103, v111
	s_mul_i32 s23, s22, 2
	s_add_u32 s23, s23, s25
	s_add_u32 s23, s23, 786432
	buffer_store_dwordx4 v[100:103], v15, s[8:11], s23 offen offset:0 sc1
	buffer_store_dwordx4 v[108:111], v157, s[8:11], s23 offen offset:0 sc1
	v_accvgpr_read_b32 v80, a192
	v_accvgpr_read_b32 v81, a193
	v_accvgpr_read_b32 v82, a194
	v_accvgpr_read_b32 v83, a195
	v_accvgpr_read_b32 v84, a196
	v_accvgpr_read_b32 v85, a197
	v_accvgpr_read_b32 v86, a198
	v_accvgpr_read_b32 v87, a199
	v_accvgpr_read_b32 v88, a200
	v_accvgpr_read_b32 v89, a201
	v_accvgpr_read_b32 v90, a202
	v_accvgpr_read_b32 v91, a203
	v_accvgpr_read_b32 v92, a204
	v_accvgpr_read_b32 v93, a205
	v_accvgpr_read_b32 v94, a206
	v_accvgpr_read_b32 v95, a207
	v_cvt_pk_bf16_f32 v80, v80, v81
	v_cvt_pk_bf16_f32 v81, v82, v83
	v_cvt_pk_bf16_f32 v82, v84, v85
	v_cvt_pk_bf16_f32 v83, v86, v87
	s_nop 0
	v_permlane32_swap_b32 v80, v82
	v_permlane32_swap_b32 v81, v83
	v_cvt_pk_bf16_f32 v88, v88, v89
	v_cvt_pk_bf16_f32 v89, v90, v91
	v_cvt_pk_bf16_f32 v90, v92, v93
	v_cvt_pk_bf16_f32 v91, v94, v95
	s_nop 0
	v_permlane32_swap_b32 v88, v90
	v_permlane32_swap_b32 v89, v91
	s_nop 0
	v_permlane16_swap_b32 v80, v88
	v_permlane16_swap_b32 v81, v89
	v_permlane16_swap_b32 v82, v90
	v_permlane16_swap_b32 v83, v91
	s_mul_i32 s23, s22, 3
	s_add_u32 s23, s23, s25
	buffer_store_dwordx4 v[80:83], v15, s[8:11], s23 offen offset:0 sc1
	buffer_store_dwordx4 v[88:91], v157, s[8:11], s23 offen offset:0 sc1
	v_accvgpr_read_b32 v100, a208
	v_accvgpr_read_b32 v101, a209
	v_accvgpr_read_b32 v102, a210
	v_accvgpr_read_b32 v103, a211
	v_accvgpr_read_b32 v104, a212
	v_accvgpr_read_b32 v105, a213
	v_accvgpr_read_b32 v106, a214
	v_accvgpr_read_b32 v107, a215
	v_accvgpr_read_b32 v108, a216
	v_accvgpr_read_b32 v109, a217
	v_accvgpr_read_b32 v110, a218
	v_accvgpr_read_b32 v111, a219
	v_accvgpr_read_b32 v112, a220
	v_accvgpr_read_b32 v113, a221
	v_accvgpr_read_b32 v114, a222
	v_accvgpr_read_b32 v115, a223
	v_cvt_pk_bf16_f32 v100, v100, v101
	v_cvt_pk_bf16_f32 v101, v102, v103
	v_cvt_pk_bf16_f32 v102, v104, v105
	v_cvt_pk_bf16_f32 v103, v106, v107
	s_nop 0
	v_permlane32_swap_b32 v100, v102
	v_permlane32_swap_b32 v101, v103
	v_cvt_pk_bf16_f32 v108, v108, v109
	v_cvt_pk_bf16_f32 v109, v110, v111
	v_cvt_pk_bf16_f32 v110, v112, v113
	v_cvt_pk_bf16_f32 v111, v114, v115
	s_nop 0
	v_permlane32_swap_b32 v108, v110
	v_permlane32_swap_b32 v109, v111
	s_nop 0
	v_permlane16_swap_b32 v100, v108
	v_permlane16_swap_b32 v101, v109
	v_permlane16_swap_b32 v102, v110
	v_permlane16_swap_b32 v103, v111
	s_mul_i32 s23, s22, 3
	s_add_u32 s23, s23, s25
	s_add_u32 s23, s23, 262144
	buffer_store_dwordx4 v[100:103], v15, s[8:11], s23 offen offset:0 sc1
	buffer_store_dwordx4 v[108:111], v157, s[8:11], s23 offen offset:0 sc1
	v_accvgpr_read_b32 v80, a224
	v_accvgpr_read_b32 v81, a225
	v_accvgpr_read_b32 v82, a226
	v_accvgpr_read_b32 v83, a227
	v_accvgpr_read_b32 v84, a228
	v_accvgpr_read_b32 v85, a229
	v_accvgpr_read_b32 v86, a230
	v_accvgpr_read_b32 v87, a231
	v_accvgpr_read_b32 v88, a232
	v_accvgpr_read_b32 v89, a233
	v_accvgpr_read_b32 v90, a234
	v_accvgpr_read_b32 v91, a235
	v_accvgpr_read_b32 v92, a236
	v_accvgpr_read_b32 v93, a237
	v_accvgpr_read_b32 v94, a238
	v_accvgpr_read_b32 v95, a239
	v_cvt_pk_bf16_f32 v80, v80, v81
	v_cvt_pk_bf16_f32 v81, v82, v83
	v_cvt_pk_bf16_f32 v82, v84, v85
	v_cvt_pk_bf16_f32 v83, v86, v87
	s_nop 0
	v_permlane32_swap_b32 v80, v82
	v_permlane32_swap_b32 v81, v83
	v_cvt_pk_bf16_f32 v88, v88, v89
	v_cvt_pk_bf16_f32 v89, v90, v91
	v_cvt_pk_bf16_f32 v90, v92, v93
	v_cvt_pk_bf16_f32 v91, v94, v95
	s_nop 0
	v_permlane32_swap_b32 v88, v90
	v_permlane32_swap_b32 v89, v91
	s_nop 0
	v_permlane16_swap_b32 v80, v88
	v_permlane16_swap_b32 v81, v89
	v_permlane16_swap_b32 v82, v90
	v_permlane16_swap_b32 v83, v91
	s_mul_i32 s23, s22, 3
	s_add_u32 s23, s23, s25
	s_add_u32 s23, s23, 524288
	buffer_store_dwordx4 v[80:83], v15, s[8:11], s23 offen offset:0 sc1
	buffer_store_dwordx4 v[88:91], v157, s[8:11], s23 offen offset:0 sc1
	v_accvgpr_read_b32 v100, a240
	v_accvgpr_read_b32 v101, a241
	v_accvgpr_read_b32 v102, a242
	v_accvgpr_read_b32 v103, a243
	v_accvgpr_read_b32 v104, a244
	v_accvgpr_read_b32 v105, a245
	v_accvgpr_read_b32 v106, a246
	v_accvgpr_read_b32 v107, a247
	v_accvgpr_read_b32 v108, a248
	v_accvgpr_read_b32 v109, a249
	v_accvgpr_read_b32 v110, a250
	v_accvgpr_read_b32 v111, a251
	v_accvgpr_read_b32 v112, a252
	v_accvgpr_read_b32 v113, a253
	v_accvgpr_read_b32 v114, a254
	v_accvgpr_read_b32 v115, a255
	v_cvt_pk_bf16_f32 v100, v100, v101
	v_cvt_pk_bf16_f32 v101, v102, v103
	v_cvt_pk_bf16_f32 v102, v104, v105
	v_cvt_pk_bf16_f32 v103, v106, v107
	s_nop 0
	v_permlane32_swap_b32 v100, v102
	v_permlane32_swap_b32 v101, v103
	v_cvt_pk_bf16_f32 v108, v108, v109
	v_cvt_pk_bf16_f32 v109, v110, v111
	v_cvt_pk_bf16_f32 v110, v112, v113
	v_cvt_pk_bf16_f32 v111, v114, v115
	s_nop 0
	v_permlane32_swap_b32 v108, v110
	v_permlane32_swap_b32 v109, v111
	s_nop 0
	v_permlane16_swap_b32 v100, v108
	v_permlane16_swap_b32 v101, v109
	v_permlane16_swap_b32 v102, v110
	v_permlane16_swap_b32 v103, v111
	s_mul_i32 s23, s22, 3
	s_add_u32 s23, s23, s25
	s_add_u32 s23, s23, 786432
	buffer_store_dwordx4 v[100:103], v15, s[8:11], s23 offen offset:0 sc1
	buffer_store_dwordx4 v[108:111], v157, s[8:11], s23 offen offset:0 sc1
main_kernel_g1_done:
	s_waitcnt vmcnt(0)
	s_barrier
	s_cmp_lg_u32 s4, 0
	s_cbranch_scc1 main_kernel_sig1
	s_mov_b64 exec, 1
	v_mov_b32 v13, s100
	v_mov_b32 v14, s93
	buffer_atomic_add v13, v14, s[96:99], 0 offen sc1
	s_mov_b64 exec, -1
main_kernel_sig1:
main_kernel_r0skip:
	s_add_u32 s90, s90, 1
	s_cmp_eq_u32 s90, 1
	s_cbranch_scc0 main_kernel_lnall
	v_lshlrev_b32 v14, 2, v0
	v_add_u32 v14, 112, v14
main_kernel_lnall_poll:
	s_mov_b64 exec, 0xff
	buffer_load_dword v13, v14, s[96:99], 0 offen sc1
	s_waitcnt vmcnt(0)
	v_cmp_gt_u32 vcc, 32, v13
	s_mov_b64 exec, -1
	s_cbranch_vccz main_kernel_lnall
	s_sub_u32 s94, s94, 1
	s_cbranch_scc1 main_kernel_lnall
	s_sleep 8
	s_branch main_kernel_lnall_poll
main_kernel_lnall:
	s_cmp_eq_u32 s90, 1
	s_cbranch_scc0 main_kernel_r2
	s_lshl_b32 s95, s88, 5
	s_add_u32 s95, s95, s89
	s_and_b32 s92, s95, 7
	s_lshr_b32 s91, s95, 3
	s_add_u32 s91, s91, 48
	s_cmp_lt_u32 s95, 144
	s_cbranch_scc1 main_kernel_task
	s_sub_u32 s91, s91, 66
	s_branch main_kernel_task
main_kernel_r2:
	s_cmp_eq_u32 s90, 2
	s_cbranch_scc0 main_kernel_g1done
	s_cmp_ge_u32 s88, 4
	s_cbranch_scc1 main_kernel_g1done
	s_cmp_lt_u32 s89, 20
	s_cbranch_scc1 main_kernel_g1done
	s_mul_i32 s95, s88, 12
	s_add_u32 s95, s95, s89
	s_sub_u32 s95, s95, 20
	s_and_b32 s92, s95, 7
	s_lshr_b32 s91, s95, 3
	s_add_u32 s91, s91, 10
	s_branch main_kernel_task
main_kernel_g1done:
	s_mul_i32 s95, s88, 18
	s_add_u32 s95, s95, s89
	s_cmp_lt_u32 s88, 4
	s_cbranch_scc0 main_kernel_k3hi
	s_cmp_lt_u32 s89, 18
	s_cbranch_scc1 main_kernel_k3go
	s_branch main_kernel_phaseb
main_kernel_k3hi:
	s_mul_i32 s95, s88, 24
	s_add_u32 s95, s95, s89
	s_sub_u32 s95, s95, 24
	s_cmp_lt_u32 s89, 18
	s_cbranch_scc1 main_kernel_k3go
	s_sub_u32 s95, s95, 8
	s_cmp_lt_u32 s89, 26
	s_cbranch_scc1 main_kernel_phaseb
main_kernel_k3go:
	s_mul_i32 s101, s95, 1366
	s_lshr_b32 s101, s101, 16
	s_mul_i32 s91, s101, 48
	s_sub_u32 s95, s95, s91
	s_mul_i32 s92, s95, 21846
	s_lshr_b32 s92, s92, 16
	s_mul_i32 s91, s92, 3
	s_sub_u32 s91, s95, s91
	s_lshr_b32 s93, s92, 1
	s_lshl_b32 s93, s93, 2
	s_add_u32 s93, s93, 48
	s_cmp_lg_u32 s4, 0
	s_cbranch_scc1 main_kernel_acq2_go
	v_mov_b32 v14, s93
main_kernel_acq2_poll:
	buffer_load_dword v13, v14, s[96:99], 0 offen sc1
	s_waitcnt vmcnt(0)
	v_readfirstlane_b32 s95, v13
	s_sub_u32 s94, s94, 1
	s_cbranch_scc1 main_kernel_acq2_got
	s_cmp_ge_u32 s95, 18
	s_cbranch_scc1 main_kernel_acq2_got
	s_sleep 16
	s_branch main_kernel_acq2_poll
main_kernel_acq2_got:
	buffer_inv sc1
	s_waitcnt vmcnt(0)
main_kernel_acq2_go:
	s_barrier
	s_load_dwordx2 s[12:13], s[0:1], 80
	s_load_dwordx2 s[32:33], s[0:1], 88
	s_load_dwordx2 s[36:37], s[0:1], 0
	s_cmp_eq_u32 s101, 0
	s_cselect_b32 s34, 1152, 0
	s_cselect_b32 s38, 2359296, 0
	s_mov_b32 s14, 5308416
	s_mov_b32 s18, 1152
	s_mul_i32 s27, s91, 192
	s_lshl_b32 s17, s27, 1
	s_mul_i32 s21, s101, 1769472
	s_add_u32 s17, s17, s21
	s_mul_i32 s28, s92, 128
	s_mul_i32 s16, s28, 9216
	s_mul_i32 s21, s101, 3072
	s_add_u32 s16, s16, s21
	s_add_u32 s16, s16, 54525952
	s_mul_i32 s43, s101, 5242880
	s_add_u32 s43, s43, 117440512
	s_waitcnt lgkmcnt(0)
	v_lshrrev_b32 v13, 4, v0
	s_and_b32 s21, s4, 1
	s_lshl_b32 s21, s21, 2
	v_add_u32 v13, s21, v13
	v_and_b32 v14, 7, v0
	v_xor_b32 v13, v13, v14
	v_lshlrev_b32 v13, 4, v13
	v_lshrrev_b32 v14, 3, v0
	s_lshl_b32 s21, s4, 3
	v_add_u32 v14, s21, v14
	s_mov_b32 s21, 9216
	v_mul_lo_u32 v14, v14, s21
	v_add_u32 v1, v13, v14
	v_add_u32 v13, 0, v0
	v_mul_u32_u24 v14, 2731, v13
	v_lshrrev_b32 v14, 16, v14
	v_mul_u32_u24 v15, 24, v14
	v_sub_u32 v13, v13, v15
	v_and_b32 v15, 2, v14
	v_lshlrev_b32 v15, 1, v15
	v_xor_b32 v13, v13, v15
	v_lshlrev_b32 v13, 4, v13
	s_lshl_b32 s21, s4, 4
	v_add_u32 v14, s21, v14
	v_mul_lo_u32 v14, v14, s18
	v_add_u32 v2, v13, v14
	v_add_u32 v13, 64, v0
	v_mul_u32_u24 v14, 2731, v13
	v_lshrrev_b32 v14, 16, v14
	v_mul_u32_u24 v15, 24, v14
	v_sub_u32 v13, v13, v15
	v_and_b32 v15, 2, v14
	v_lshlrev_b32 v15, 1, v15
	v_xor_b32 v13, v13, v15
	v_lshlrev_b32 v13, 4, v13
	s_lshl_b32 s21, s4, 4
	v_add_u32 v14, s21, v14
	v_mul_lo_u32 v14, v14, s18
	v_add_u32 v3, v13, v14
	v_add_u32 v13, 128, v0
	v_mul_u32_u24 v14, 2731, v13
	v_lshrrev_b32 v14, 16, v14
	v_mul_u32_u24 v15, 24, v14
	v_sub_u32 v13, v13, v15
	v_and_b32 v15, 2, v14
	v_lshlrev_b32 v15, 1, v15
	v_xor_b32 v13, v13, v15
	v_lshlrev_b32 v13, 4, v13
	s_lshl_b32 s21, s4, 4
	v_add_u32 v14, s21, v14
	v_mul_lo_u32 v14, v14, s18
	v_add_u32 v4, v13, v14
	s_lshl_b32 s24, s18, 3
	v_and_b32 v13, 31, v0
	v_bfe_u32 v14, v0, 1, 3
	v_lshrrev_b32 v15, 5, v0
	v_xor_b32 v14, v14, v15
	v_lshlrev_b32 v14, 4, v14
	s_lshr_b32 s21, s4, 1
	s_mul_i32 s21, s21, 64
	v_add_u32 v13, s21, v13
	v_lshl_add_u32 v5, v13, 7, v14
	v_xor_b32 v6, 32, v5
	v_xor_b32 v7, 64, v5
	v_xor_b32 v8, 96, v5
	v_bfe_u32 v15, v0, 2, 2
	v_lshrrev_b32 v13, 5, v0
	v_lshl_add_u32 v13, v13, 3, v15
	v_mul_u32_u24 v13, 384, v13
	v_and_b32 v14, 1, v0
	v_lshl_add_u32 v13, v14, 3, v13
	v_add_u32 v13, 16384, v13
	v_and_b32 v15, 2, v15
	v_lshlrev_b32 v15, 1, v15
	v_bfe_u32 v14, v0, 4, 1
	v_lshlrev_b32 v14, 1, v14
	v_bfe_u32 v9, v0, 1, 1
	v_add_u32 v14, v14, v9
	s_and_b32 s21, s4, 1
	s_mul_i32 s21, s21, 12
	s_add_u32 s21, s21, 0
	v_add_u32 v14, s21, v14
	v_xor_b32 v14, v14, v15
	v_lshl_add_u32 v9, v14, 4, v13
	v_bfe_u32 v14, v0, 4, 1
	v_lshlrev_b32 v14, 1, v14
	v_bfe_u32 v10, v0, 1, 1
	v_add_u32 v14, v14, v10
	s_and_b32 s21, s4, 1
	s_mul_i32 s21, s21, 12
	s_add_u32 s21, s21, 4
	v_add_u32 v14, s21, v14
	v_xor_b32 v14, v14, v15
	v_lshl_add_u32 v10, v14, 4, v13
	v_bfe_u32 v14, v0, 4, 1
	v_lshlrev_b32 v14, 1, v14
	v_bfe_u32 v11, v0, 1, 1
	v_add_u32 v14, v14, v11
	s_and_b32 s21, s4, 1
	s_mul_i32 s21, s21, 12
	s_add_u32 s21, s21, 8
	v_add_u32 v14, s21, v14
	v_xor_b32 v14, v14, v15
	v_lshl_add_u32 v11, v14, 4, v13
	s_lshl_b32 s40, s4, 10
	s_mul_i32 s41, s4, 6144
	s_lshl_b32 s42, s18, 6
	s_mov_b32 s19, s16
	s_mov_b32 s20, s17
	s_add_u32 m0, s40, 0
	s_add_u32 s21, s19, 0
	buffer_load_dwordx4 v1, s[8:11], s21 offen lds
	s_add_u32 m0, s40, 4096
	s_add_u32 s21, s19, 294912
	buffer_load_dwordx4 v1, s[8:11], s21 offen lds
	s_add_u32 m0, s40, 8192
	s_add_u32 s21, s19, 589824
	buffer_load_dwordx4 v1, s[8:11], s21 offen lds
	s_add_u32 m0, s40, 12288
	s_add_u32 s21, s19, 884736
	buffer_load_dwordx4 v1, s[8:11], s21 offen lds
	s_add_u32 m0, s41, 16384
	s_mov_b32 s22, s20
	buffer_load_dwordx4 v2, s[12:15], s22 offen lds
	s_add_u32 m0, s41, 17408
	s_nop 0
	buffer_load_dwordx4 v3, s[12:15], s22 offen lds
	s_add_u32 m0, s41, 18432
	s_nop 0
	buffer_load_dwordx4 v4, s[12:15], s22 offen lds
	s_add_u32 m0, s41, 19456
	s_add_u32 s22, s22, s24
	buffer_load_dwordx4 v2, s[12:15], s22 offen lds
	s_add_u32 m0, s41, 20480
	s_nop 0
	buffer_load_dwordx4 v3, s[12:15], s22 offen lds
	s_add_u32 m0, s41, 21504
	s_nop 0
	buffer_load_dwordx4 v4, s[12:15], s22 offen lds
	s_add_u32 s19, s19, 128
	s_add_u32 s20, s20, s42
	s_add_u32 m0, s40, 40960
	s_add_u32 s21, s19, 0
	buffer_load_dwordx4 v1, s[8:11], s21 offen lds
	s_add_u32 m0, s40, 45056
	s_add_u32 s21, s19, 294912
	buffer_load_dwordx4 v1, s[8:11], s21 offen lds
	s_add_u32 m0, s40, 49152
	s_add_u32 s21, s19, 589824
	buffer_load_dwordx4 v1, s[8:11], s21 offen lds
	s_add_u32 m0, s40, 53248
	s_add_u32 s21, s19, 884736
	buffer_load_dwordx4 v1, s[8:11], s21 offen lds
	s_add_u32 m0, s41, 57344
	s_mov_b32 s22, s20
	buffer_load_dwordx4 v2, s[12:15], s22 offen lds
	s_add_u32 m0, s41, 58368
	s_nop 0
	buffer_load_dwordx4 v3, s[12:15], s22 offen lds
	s_add_u32 m0, s41, 59392
	s_nop 0
	buffer_load_dwordx4 v4, s[12:15], s22 offen lds
	s_add_u32 m0, s41, 60416
	s_add_u32 s22, s22, s24
	buffer_load_dwordx4 v2, s[12:15], s22 offen lds
	s_add_u32 m0, s41, 61440
	s_nop 0
	buffer_load_dwordx4 v3, s[12:15], s22 offen lds
	s_add_u32 m0, s41, 62464
	s_nop 0
	buffer_load_dwordx4 v4, s[12:15], s22 offen lds
	s_add_u32 s19, s19, 128
	s_add_u32 s20, s20, s42
	s_add_u32 m0, s40, 81920
	s_add_u32 s21, s19, 0
	buffer_load_dwordx4 v1, s[8:11], s21 offen lds
	s_add_u32 m0, s40, 86016
	s_add_u32 s21, s19, 294912
	buffer_load_dwordx4 v1, s[8:11], s21 offen lds
	s_add_u32 m0, s40, 90112
	s_add_u32 s21, s19, 589824
	buffer_load_dwordx4 v1, s[8:11], s21 offen lds
	s_add_u32 m0, s40, 94208
	s_add_u32 s21, s19, 884736
	buffer_load_dwordx4 v1, s[8:11], s21 offen lds
	s_add_u32 m0, s41, 98304
	s_mov_b32 s22, s20
	buffer_load_dwordx4 v2, s[12:15], s22 offen lds
	s_add_u32 m0, s41, 99328
	s_nop 0
	buffer_load_dwordx4 v3, s[12:15], s22 offen lds
	s_add_u32 m0, s41, 100352
	s_nop 0
	buffer_load_dwordx4 v4, s[12:15], s22 offen lds
	s_add_u32 m0, s41, 101376
	s_add_u32 s22, s22, s24
	buffer_load_dwordx4 v2, s[12:15], s22 offen lds
	s_add_u32 m0, s41, 102400
	s_nop 0
	buffer_load_dwordx4 v3, s[12:15], s22 offen lds
	s_add_u32 m0, s41, 103424
	s_nop 0
	buffer_load_dwordx4 v4, s[12:15], s22 offen lds
	s_add_u32 s19, s19, 128
	s_add_u32 s20, s20, s42
	s_add_u32 m0, s40, 122880
	s_add_u32 s21, s19, 0
	buffer_load_dwordx4 v1, s[8:11], s21 offen lds
	s_add_u32 m0, s40, 126976
	s_add_u32 s21, s19, 294912
	buffer_load_dwordx4 v1, s[8:11], s21 offen lds
	s_add_u32 m0, s40, 131072
	s_add_u32 s21, s19, 589824
	buffer_load_dwordx4 v1, s[8:11], s21 offen lds
	s_add_u32 m0, s40, 135168
	s_add_u32 s21, s19, 884736
	buffer_load_dwordx4 v1, s[8:11], s21 offen lds
	s_add_u32 m0, s41, 139264
	s_mov_b32 s22, s20
	buffer_load_dwordx4 v2, s[12:15], s22 offen lds
	s_add_u32 m0, s41, 140288
	s_nop 0
	buffer_load_dwordx4 v3, s[12:15], s22 offen lds
	s_add_u32 m0, s41, 141312
	s_nop 0
	buffer_load_dwordx4 v4, s[12:15], s22 offen lds
	s_add_u32 m0, s41, 142336
	s_add_u32 s22, s22, s24
	buffer_load_dwordx4 v2, s[12:15], s22 offen lds
	s_add_u32 m0, s41, 143360
	s_nop 0
	buffer_load_dwordx4 v3, s[12:15], s22 offen lds
	s_add_u32 m0, s41, 144384
	s_nop 0
	buffer_load_dwordx4 v4, s[12:15], s22 offen lds
	s_add_u32 s19, s19, 128
	s_add_u32 s20, s20, s42
	s_waitcnt vmcnt(30)
	s_barrier
	ds_read_b64_tr_b16 v[16:17], v9 offset:0
	ds_read_b64_tr_b16 v[18:19], v9 offset:1536
	ds_read_b128 v[28:31], v5 offset:0
	ds_read_b64_tr_b16 v[20:21], v10 offset:0
	ds_read_b64_tr_b16 v[22:23], v10 offset:1536
	ds_read_b128 v[32:35], v5 offset:4096
	ds_read_b64_tr_b16 v[24:25], v11 offset:0
	ds_read_b64_tr_b16 v[26:27], v11 offset:1536
	v_accvgpr_write_b32 a0, 0
	v_accvgpr_write_b32 a1, 0
	v_accvgpr_write_b32 a2, 0
	v_accvgpr_write_b32 a3, 0
	v_accvgpr_write_b32 a4, 0
	v_accvgpr_write_b32 a5, 0
	v_accvgpr_write_b32 a6, 0
	v_accvgpr_write_b32 a7, 0
	v_accvgpr_write_b32 a8, 0
	v_accvgpr_write_b32 a9, 0
	v_accvgpr_write_b32 a10, 0
	v_accvgpr_write_b32 a11, 0
	v_accvgpr_write_b32 a12, 0
	v_accvgpr_write_b32 a13, 0
	v_accvgpr_write_b32 a14, 0
	v_accvgpr_write_b32 a15, 0
	v_accvgpr_write_b32 a16, 0
	v_accvgpr_write_b32 a17, 0
	v_accvgpr_write_b32 a18, 0
	v_accvgpr_write_b32 a19, 0
	v_accvgpr_write_b32 a20, 0
	v_accvgpr_write_b32 a21, 0
	v_accvgpr_write_b32 a22, 0
	v_accvgpr_write_b32 a23, 0
	v_accvgpr_write_b32 a24, 0
	v_accvgpr_write_b32 a25, 0
	v_accvgpr_write_b32 a26, 0
	v_accvgpr_write_b32 a27, 0
	v_accvgpr_write_b32 a28, 0
	v_accvgpr_write_b32 a29, 0
	v_accvgpr_write_b32 a30, 0
	v_accvgpr_write_b32 a31, 0
	v_accvgpr_write_b32 a32, 0
	v_accvgpr_write_b32 a33, 0
	v_accvgpr_write_b32 a34, 0
	v_accvgpr_write_b32 a35, 0
	v_accvgpr_write_b32 a36, 0
	v_accvgpr_write_b32 a37, 0
	v_accvgpr_write_b32 a38, 0
	v_accvgpr_write_b32 a39, 0
	v_accvgpr_write_b32 a40, 0
	v_accvgpr_write_b32 a41, 0
	v_accvgpr_write_b32 a42, 0
	v_accvgpr_write_b32 a43, 0
	v_accvgpr_write_b32 a44, 0
	v_accvgpr_write_b32 a45, 0
	v_accvgpr_write_b32 a46, 0
	v_accvgpr_write_b32 a47, 0
	v_accvgpr_write_b32 a48, 0
	v_accvgpr_write_b32 a49, 0
	v_accvgpr_write_b32 a50, 0
	v_accvgpr_write_b32 a51, 0
	v_accvgpr_write_b32 a52, 0
	v_accvgpr_write_b32 a53, 0
	v_accvgpr_write_b32 a54, 0
	v_accvgpr_write_b32 a55, 0
	v_accvgpr_write_b32 a56, 0
	v_accvgpr_write_b32 a57, 0
	v_accvgpr_write_b32 a58, 0
	v_accvgpr_write_b32 a59, 0
	v_accvgpr_write_b32 a60, 0
	v_accvgpr_write_b32 a61, 0
	v_accvgpr_write_b32 a62, 0
	v_accvgpr_write_b32 a63, 0
	v_accvgpr_write_b32 a64, 0
	v_accvgpr_write_b32 a65, 0
	v_accvgpr_write_b32 a66, 0
	v_accvgpr_write_b32 a67, 0
	v_accvgpr_write_b32 a68, 0
	v_accvgpr_write_b32 a69, 0
	v_accvgpr_write_b32 a70, 0
	v_accvgpr_write_b32 a71, 0
	v_accvgpr_write_b32 a72, 0
	v_accvgpr_write_b32 a73, 0
	v_accvgpr_write_b32 a74, 0
	v_accvgpr_write_b32 a75, 0
	v_accvgpr_write_b32 a76, 0
	v_accvgpr_write_b32 a77, 0
	v_accvgpr_write_b32 a78, 0
	v_accvgpr_write_b32 a79, 0
	v_accvgpr_write_b32 a80, 0
	v_accvgpr_write_b32 a81, 0
	v_accvgpr_write_b32 a82, 0
	v_accvgpr_write_b32 a83, 0
	v_accvgpr_write_b32 a84, 0
	v_accvgpr_write_b32 a85, 0
	v_accvgpr_write_b32 a86, 0
	v_accvgpr_write_b32 a87, 0
	v_accvgpr_write_b32 a88, 0
	v_accvgpr_write_b32 a89, 0
	v_accvgpr_write_b32 a90, 0
	v_accvgpr_write_b32 a91, 0
	v_accvgpr_write_b32 a92, 0
	v_accvgpr_write_b32 a93, 0
	v_accvgpr_write_b32 a94, 0
	v_accvgpr_write_b32 a95, 0
	s_mov_b32 s23, 5
main_kernel_f2_m_loop:
	s_waitcnt lgkmcnt(5)
	v_mfma_f32_32x32x16_bf16 a[0:15], v[16:19], v[28:31], a[0:15]
	ds_read_b64_tr_b16 v[36:37], v9 offset:6144
	ds_read_b64_tr_b16 v[38:39], v9 offset:7680
	s_waitcnt lgkmcnt(4)
	v_mfma_f32_32x32x16_bf16 a[16:31], v[16:19], v[32:35], a[16:31]
	ds_read_b128 v[48:51], v6 offset:0
	v_mfma_f32_32x32x16_bf16 a[32:47], v[20:23], v[28:31], a[32:47]
	ds_read_b64_tr_b16 v[40:41], v10 offset:6144
	v_mfma_f32_32x32x16_bf16 a[48:63], v[20:23], v[32:35], a[48:63]
	ds_read_b64_tr_b16 v[42:43], v10 offset:7680
	ds_read_b128 v[52:55], v6 offset:4096
	s_waitcnt lgkmcnt(6)
	v_mfma_f32_32x32x16_bf16 a[64:79], v[24:27], v[28:31], a[64:79]
	ds_read_b64_tr_b16 v[44:45], v11 offset:6144
	v_mfma_f32_32x32x16_bf16 a[80:95], v[24:27], v[32:35], a[80:95]
	ds_read_b64_tr_b16 v[46:47], v11 offset:7680
	s_waitcnt lgkmcnt(5)
	v_mfma_f32_32x32x16_bf16 a[0:15], v[36:39], v[48:51], a[0:15]
	ds_read_b64_tr_b16 v[16:17], v9 offset:12288
	ds_read_b64_tr_b16 v[18:19], v9 offset:13824
	s_waitcnt lgkmcnt(4)
	v_mfma_f32_32x32x16_bf16 a[16:31], v[36:39], v[52:55], a[16:31]
	ds_read_b128 v[28:31], v7 offset:0
	v_mfma_f32_32x32x16_bf16 a[32:47], v[40:43], v[48:51], a[32:47]
	ds_read_b64_tr_b16 v[20:21], v10 offset:12288
	v_mfma_f32_32x32x16_bf16 a[48:63], v[40:43], v[52:55], a[48:63]
	ds_read_b64_tr_b16 v[22:23], v10 offset:13824
	ds_read_b128 v[32:35], v7 offset:4096
	s_waitcnt lgkmcnt(6)
	v_mfma_f32_32x32x16_bf16 a[64:79], v[44:47], v[48:51], a[64:79]
	ds_read_b64_tr_b16 v[24:25], v11 offset:12288
	v_mfma_f32_32x32x16_bf16 a[80:95], v[44:47], v[52:55], a[80:95]
	ds_read_b64_tr_b16 v[26:27], v11 offset:13824
	s_waitcnt lgkmcnt(5)
	v_mfma_f32_32x32x16_bf16 a[0:15], v[16:19], v[28:31], a[0:15]
	ds_read_b64_tr_b16 v[36:37], v9 offset:18432
	ds_read_b64_tr_b16 v[38:39], v9 offset:19968
	s_waitcnt lgkmcnt(4)
	v_mfma_f32_32x32x16_bf16 a[16:31], v[16:19], v[32:35], a[16:31]
	ds_read_b128 v[48:51], v8 offset:0
	v_mfma_f32_32x32x16_bf16 a[32:47], v[20:23], v[28:31], a[32:47]
	ds_read_b64_tr_b16 v[40:41], v10 offset:18432
	v_mfma_f32_32x32x16_bf16 a[48:63], v[20:23], v[32:35], a[48:63]
	ds_read_b64_tr_b16 v[42:43], v10 offset:19968
	ds_read_b128 v[52:55], v8 offset:4096
	s_waitcnt lgkmcnt(6)
	v_mfma_f32_32x32x16_bf16 a[64:79], v[24:27], v[28:31], a[64:79]
	ds_read_b64_tr_b16 v[44:45], v11 offset:18432
	v_mfma_f32_32x32x16_bf16 a[80:95], v[24:27], v[32:35], a[80:95]
	ds_read_b64_tr_b16 v[46:47], v11 offset:19968
	s_waitcnt vmcnt(20) lgkmcnt(0)
	s_barrier
	v_add_u32 v5, 0xa000, v5
	v_add_u32 v6, 0xa000, v6
	v_add_u32 v7, 0xa000, v7
	v_add_u32 v8, 0xa000, v8
	v_add_u32 v9, 0xa000, v9
	v_add_u32 v10, 0xa000, v10
	v_add_u32 v11, 0xa000, v11
	v_mfma_f32_32x32x16_bf16 a[0:15], v[36:39], v[48:51], a[0:15]
	ds_read_b64_tr_b16 v[16:17], v9 offset:0
	ds_read_b64_tr_b16 v[18:19], v9 offset:1536
	ds_read_b128 v[28:31], v5 offset:0
	s_add_u32 m0, s40, 0
	s_add_u32 s21, s19, 0
	buffer_load_dwordx4 v1, s[8:11], s21 offen lds
	v_mfma_f32_32x32x16_bf16 a[16:31], v[36:39], v[52:55], a[16:31]
	s_add_u32 m0, s40, 4096
	s_add_u32 s21, s19, 294912
	buffer_load_dwordx4 v1, s[8:11], s21 offen lds
	s_add_u32 m0, s40, 8192
	s_add_u32 s21, s19, 589824
	buffer_load_dwordx4 v1, s[8:11], s21 offen lds
	s_add_u32 m0, s40, 12288
	s_add_u32 s21, s19, 884736
	buffer_load_dwordx4 v1, s[8:11], s21 offen lds
	v_mfma_f32_32x32x16_bf16 a[32:47], v[40:43], v[48:51], a[32:47]
	ds_read_b64_tr_b16 v[20:21], v10 offset:0
	ds_read_b64_tr_b16 v[22:23], v10 offset:1536
	ds_read_b128 v[32:35], v5 offset:4096
	v_mfma_f32_32x32x16_bf16 a[48:63], v[40:43], v[52:55], a[48:63]
	ds_read_b64_tr_b16 v[24:25], v11 offset:0
	ds_read_b64_tr_b16 v[26:27], v11 offset:1536
	s_add_u32 m0, s41, 16384
	s_mov_b32 s22, s20
	buffer_load_dwordx4 v2, s[12:15], s22 offen lds
	v_mfma_f32_32x32x16_bf16 a[64:79], v[44:47], v[48:51], a[64:79]
	s_add_u32 m0, s41, 17408
	s_nop 0
	buffer_load_dwordx4 v3, s[12:15], s22 offen lds
	s_add_u32 m0, s41, 18432
	s_nop 0
	buffer_load_dwordx4 v4, s[12:15], s22 offen lds
	s_add_u32 m0, s41, 19456
	s_add_u32 s22, s22, s24
	buffer_load_dwordx4 v2, s[12:15], s22 offen lds
	v_mfma_f32_32x32x16_bf16 a[80:95], v[44:47], v[52:55], a[80:95]
	s_add_u32 m0, s41, 20480
	s_nop 0
	buffer_load_dwordx4 v3, s[12:15], s22 offen lds
	s_add_u32 m0, s41, 21504
	s_nop 0
	buffer_load_dwordx4 v4, s[12:15], s22 offen lds
	s_add_u32 s19, s19, 128
	s_add_u32 s20, s20, s42
	s_waitcnt lgkmcnt(5)
	v_mfma_f32_32x32x16_bf16 a[0:15], v[16:19], v[28:31], a[0:15]
	ds_read_b64_tr_b16 v[36:37], v9 offset:6144
	ds_read_b64_tr_b16 v[38:39], v9 offset:7680
	s_waitcnt lgkmcnt(4)
	v_mfma_f32_32x32x16_bf16 a[16:31], v[16:19], v[32:35], a[16:31]
	ds_read_b128 v[48:51], v6 offset:0
	v_mfma_f32_32x32x16_bf16 a[32:47], v[20:23], v[28:31], a[32:47]
	ds_read_b64_tr_b16 v[40:41], v10 offset:6144
	v_mfma_f32_32x32x16_bf16 a[48:63], v[20:23], v[32:35], a[48:63]
	ds_read_b64_tr_b16 v[42:43], v10 offset:7680
	ds_read_b128 v[52:55], v6 offset:4096
	s_waitcnt lgkmcnt(6)
	v_mfma_f32_32x32x16_bf16 a[64:79], v[24:27], v[28:31], a[64:79]
	ds_read_b64_tr_b16 v[44:45], v11 offset:6144
	v_mfma_f32_32x32x16_bf16 a[80:95], v[24:27], v[32:35], a[80:95]
	ds_read_b64_tr_b16 v[46:47], v11 offset:7680
	s_waitcnt lgkmcnt(5)
	v_mfma_f32_32x32x16_bf16 a[0:15], v[36:39], v[48:51], a[0:15]
	ds_read_b64_tr_b16 v[16:17], v9 offset:12288
	ds_read_b64_tr_b16 v[18:19], v9 offset:13824
	s_waitcnt lgkmcnt(4)
	v_mfma_f32_32x32x16_bf16 a[16:31], v[36:39], v[52:55], a[16:31]
	ds_read_b128 v[28:31], v7 offset:0
	v_mfma_f32_32x32x16_bf16 a[32:47], v[40:43], v[48:51], a[32:47]
	ds_read_b64_tr_b16 v[20:21], v10 offset:12288
	v_mfma_f32_32x32x16_bf16 a[48:63], v[40:43], v[52:55], a[48:63]
	ds_read_b64_tr_b16 v[22:23], v10 offset:13824
	ds_read_b128 v[32:35], v7 offset:4096
	s_waitcnt lgkmcnt(6)
	v_mfma_f32_32x32x16_bf16 a[64:79], v[44:47], v[48:51], a[64:79]
	ds_read_b64_tr_b16 v[24:25], v11 offset:12288
	v_mfma_f32_32x32x16_bf16 a[80:95], v[44:47], v[52:55], a[80:95]
	ds_read_b64_tr_b16 v[26:27], v11 offset:13824
	s_waitcnt lgkmcnt(5)
	v_mfma_f32_32x32x16_bf16 a[0:15], v[16:19], v[28:31], a[0:15]
	ds_read_b64_tr_b16 v[36:37], v9 offset:18432
	ds_read_b64_tr_b16 v[38:39], v9 offset:19968
	s_waitcnt lgkmcnt(4)
	v_mfma_f32_32x32x16_bf16 a[16:31], v[16:19], v[32:35], a[16:31]
	ds_read_b128 v[48:51], v8 offset:0
	v_mfma_f32_32x32x16_bf16 a[32:47], v[20:23], v[28:31], a[32:47]
	ds_read_b64_tr_b16 v[40:41], v10 offset:18432
	v_mfma_f32_32x32x16_bf16 a[48:63], v[20:23], v[32:35], a[48:63]
	ds_read_b64_tr_b16 v[42:43], v10 offset:19968
	ds_read_b128 v[52:55], v8 offset:4096
	s_waitcnt lgkmcnt(6)
	v_mfma_f32_32x32x16_bf16 a[64:79], v[24:27], v[28:31], a[64:79]
	ds_read_b64_tr_b16 v[44:45], v11 offset:18432
	v_mfma_f32_32x32x16_bf16 a[80:95], v[24:27], v[32:35], a[80:95]
	ds_read_b64_tr_b16 v[46:47], v11 offset:19968
	s_waitcnt vmcnt(20) lgkmcnt(0)
	s_barrier
	v_add_u32 v5, 0xa000, v5
	v_add_u32 v6, 0xa000, v6
	v_add_u32 v7, 0xa000, v7
	v_add_u32 v8, 0xa000, v8
	v_add_u32 v9, 0xa000, v9
	v_add_u32 v10, 0xa000, v10
	v_add_u32 v11, 0xa000, v11
	v_mfma_f32_32x32x16_bf16 a[0:15], v[36:39], v[48:51], a[0:15]
	ds_read_b64_tr_b16 v[16:17], v9 offset:0
	ds_read_b64_tr_b16 v[18:19], v9 offset:1536
	ds_read_b128 v[28:31], v5 offset:0
	s_add_u32 m0, s40, 40960
	s_add_u32 s21, s19, 0
	buffer_load_dwordx4 v1, s[8:11], s21 offen lds
	v_mfma_f32_32x32x16_bf16 a[16:31], v[36:39], v[52:55], a[16:31]
	s_add_u32 m0, s40, 45056
	s_add_u32 s21, s19, 294912
	buffer_load_dwordx4 v1, s[8:11], s21 offen lds
	s_add_u32 m0, s40, 49152
	s_add_u32 s21, s19, 589824
	buffer_load_dwordx4 v1, s[8:11], s21 offen lds
	s_add_u32 m0, s40, 53248
	s_add_u32 s21, s19, 884736
	buffer_load_dwordx4 v1, s[8:11], s21 offen lds
	v_mfma_f32_32x32x16_bf16 a[32:47], v[40:43], v[48:51], a[32:47]
	ds_read_b64_tr_b16 v[20:21], v10 offset:0
	ds_read_b64_tr_b16 v[22:23], v10 offset:1536
	ds_read_b128 v[32:35], v5 offset:4096
	v_mfma_f32_32x32x16_bf16 a[48:63], v[40:43], v[52:55], a[48:63]
	ds_read_b64_tr_b16 v[24:25], v11 offset:0
	ds_read_b64_tr_b16 v[26:27], v11 offset:1536
	s_add_u32 m0, s41, 57344
	s_mov_b32 s22, s20
	buffer_load_dwordx4 v2, s[12:15], s22 offen lds
	v_mfma_f32_32x32x16_bf16 a[64:79], v[44:47], v[48:51], a[64:79]
	s_add_u32 m0, s41, 58368
	s_nop 0
	buffer_load_dwordx4 v3, s[12:15], s22 offen lds
	s_add_u32 m0, s41, 59392
	s_nop 0
	buffer_load_dwordx4 v4, s[12:15], s22 offen lds
	s_add_u32 m0, s41, 60416
	s_add_u32 s22, s22, s24
	buffer_load_dwordx4 v2, s[12:15], s22 offen lds
	v_mfma_f32_32x32x16_bf16 a[80:95], v[44:47], v[52:55], a[80:95]
	s_add_u32 m0, s41, 61440
	s_nop 0
	buffer_load_dwordx4 v3, s[12:15], s22 offen lds
	s_add_u32 m0, s41, 62464
	s_nop 0
	buffer_load_dwordx4 v4, s[12:15], s22 offen lds
	s_add_u32 s19, s19, 128
	s_add_u32 s20, s20, s42
	s_waitcnt lgkmcnt(5)
	v_mfma_f32_32x32x16_bf16 a[0:15], v[16:19], v[28:31], a[0:15]
	ds_read_b64_tr_b16 v[36:37], v9 offset:6144
	ds_read_b64_tr_b16 v[38:39], v9 offset:7680
	s_waitcnt lgkmcnt(4)
	v_mfma_f32_32x32x16_bf16 a[16:31], v[16:19], v[32:35], a[16:31]
	ds_read_b128 v[48:51], v6 offset:0
	v_mfma_f32_32x32x16_bf16 a[32:47], v[20:23], v[28:31], a[32:47]
	ds_read_b64_tr_b16 v[40:41], v10 offset:6144
	v_mfma_f32_32x32x16_bf16 a[48:63], v[20:23], v[32:35], a[48:63]
	ds_read_b64_tr_b16 v[42:43], v10 offset:7680
	ds_read_b128 v[52:55], v6 offset:4096
	s_waitcnt lgkmcnt(6)
	v_mfma_f32_32x32x16_bf16 a[64:79], v[24:27], v[28:31], a[64:79]
	ds_read_b64_tr_b16 v[44:45], v11 offset:6144
	v_mfma_f32_32x32x16_bf16 a[80:95], v[24:27], v[32:35], a[80:95]
	ds_read_b64_tr_b16 v[46:47], v11 offset:7680
	s_waitcnt lgkmcnt(5)
	v_mfma_f32_32x32x16_bf16 a[0:15], v[36:39], v[48:51], a[0:15]
	ds_read_b64_tr_b16 v[16:17], v9 offset:12288
	ds_read_b64_tr_b16 v[18:19], v9 offset:13824
	s_waitcnt lgkmcnt(4)
	v_mfma_f32_32x32x16_bf16 a[16:31], v[36:39], v[52:55], a[16:31]
	ds_read_b128 v[28:31], v7 offset:0
	v_mfma_f32_32x32x16_bf16 a[32:47], v[40:43], v[48:51], a[32:47]
	ds_read_b64_tr_b16 v[20:21], v10 offset:12288
	v_mfma_f32_32x32x16_bf16 a[48:63], v[40:43], v[52:55], a[48:63]
	ds_read_b64_tr_b16 v[22:23], v10 offset:13824
	ds_read_b128 v[32:35], v7 offset:4096
	s_waitcnt lgkmcnt(6)
	v_mfma_f32_32x32x16_bf16 a[64:79], v[44:47], v[48:51], a[64:79]
	ds_read_b64_tr_b16 v[24:25], v11 offset:12288
	v_mfma_f32_32x32x16_bf16 a[80:95], v[44:47], v[52:55], a[80:95]
	ds_read_b64_tr_b16 v[26:27], v11 offset:13824
	s_waitcnt lgkmcnt(5)
	v_mfma_f32_32x32x16_bf16 a[0:15], v[16:19], v[28:31], a[0:15]
	ds_read_b64_tr_b16 v[36:37], v9 offset:18432
	ds_read_b64_tr_b16 v[38:39], v9 offset:19968
	s_waitcnt lgkmcnt(4)
	v_mfma_f32_32x32x16_bf16 a[16:31], v[16:19], v[32:35], a[16:31]
	ds_read_b128 v[48:51], v8 offset:0
	v_mfma_f32_32x32x16_bf16 a[32:47], v[20:23], v[28:31], a[32:47]
	ds_read_b64_tr_b16 v[40:41], v10 offset:18432
	v_mfma_f32_32x32x16_bf16 a[48:63], v[20:23], v[32:35], a[48:63]
	ds_read_b64_tr_b16 v[42:43], v10 offset:19968
	ds_read_b128 v[52:55], v8 offset:4096
	s_waitcnt lgkmcnt(6)
	v_mfma_f32_32x32x16_bf16 a[64:79], v[24:27], v[28:31], a[64:79]
	ds_read_b64_tr_b16 v[44:45], v11 offset:18432
	v_mfma_f32_32x32x16_bf16 a[80:95], v[24:27], v[32:35], a[80:95]
	ds_read_b64_tr_b16 v[46:47], v11 offset:19968
	s_waitcnt vmcnt(20) lgkmcnt(0)
	s_barrier
	v_add_u32 v5, 0xa000, v5
	v_add_u32 v6, 0xa000, v6
	v_add_u32 v7, 0xa000, v7
	v_add_u32 v8, 0xa000, v8
	v_add_u32 v9, 0xa000, v9
	v_add_u32 v10, 0xa000, v10
	v_add_u32 v11, 0xa000, v11
	v_mfma_f32_32x32x16_bf16 a[0:15], v[36:39], v[48:51], a[0:15]
	ds_read_b64_tr_b16 v[16:17], v9 offset:0
	ds_read_b64_tr_b16 v[18:19], v9 offset:1536
	ds_read_b128 v[28:31], v5 offset:0
	s_add_u32 m0, s40, 81920
	s_add_u32 s21, s19, 0
	buffer_load_dwordx4 v1, s[8:11], s21 offen lds
	v_mfma_f32_32x32x16_bf16 a[16:31], v[36:39], v[52:55], a[16:31]
	s_add_u32 m0, s40, 86016
	s_add_u32 s21, s19, 294912
	buffer_load_dwordx4 v1, s[8:11], s21 offen lds
	s_add_u32 m0, s40, 90112
	s_add_u32 s21, s19, 589824
	buffer_load_dwordx4 v1, s[8:11], s21 offen lds
	s_add_u32 m0, s40, 94208
	s_add_u32 s21, s19, 884736
	buffer_load_dwordx4 v1, s[8:11], s21 offen lds
	v_mfma_f32_32x32x16_bf16 a[32:47], v[40:43], v[48:51], a[32:47]
	ds_read_b64_tr_b16 v[20:21], v10 offset:0
	ds_read_b64_tr_b16 v[22:23], v10 offset:1536
	ds_read_b128 v[32:35], v5 offset:4096
	v_mfma_f32_32x32x16_bf16 a[48:63], v[40:43], v[52:55], a[48:63]
	ds_read_b64_tr_b16 v[24:25], v11 offset:0
	ds_read_b64_tr_b16 v[26:27], v11 offset:1536
	s_add_u32 m0, s41, 98304
	s_mov_b32 s22, s20
	buffer_load_dwordx4 v2, s[12:15], s22 offen lds
	v_mfma_f32_32x32x16_bf16 a[64:79], v[44:47], v[48:51], a[64:79]
	s_add_u32 m0, s41, 99328
	s_nop 0
	buffer_load_dwordx4 v3, s[12:15], s22 offen lds
	s_add_u32 m0, s41, 100352
	s_nop 0
	buffer_load_dwordx4 v4, s[12:15], s22 offen lds
	s_add_u32 m0, s41, 101376
	s_add_u32 s22, s22, s24
	buffer_load_dwordx4 v2, s[12:15], s22 offen lds
	v_mfma_f32_32x32x16_bf16 a[80:95], v[44:47], v[52:55], a[80:95]
	s_add_u32 m0, s41, 102400
	s_nop 0
	buffer_load_dwordx4 v3, s[12:15], s22 offen lds
	s_add_u32 m0, s41, 103424
	s_nop 0
	buffer_load_dwordx4 v4, s[12:15], s22 offen lds
	s_add_u32 s19, s19, 128
	s_add_u32 s20, s20, s42
	s_waitcnt lgkmcnt(5)
	v_mfma_f32_32x32x16_bf16 a[0:15], v[16:19], v[28:31], a[0:15]
	ds_read_b64_tr_b16 v[36:37], v9 offset:6144
	ds_read_b64_tr_b16 v[38:39], v9 offset:7680
	s_waitcnt lgkmcnt(4)
	v_mfma_f32_32x32x16_bf16 a[16:31], v[16:19], v[32:35], a[16:31]
	ds_read_b128 v[48:51], v6 offset:0
	v_mfma_f32_32x32x16_bf16 a[32:47], v[20:23], v[28:31], a[32:47]
	ds_read_b64_tr_b16 v[40:41], v10 offset:6144
	v_mfma_f32_32x32x16_bf16 a[48:63], v[20:23], v[32:35], a[48:63]
	ds_read_b64_tr_b16 v[42:43], v10 offset:7680
	ds_read_b128 v[52:55], v6 offset:4096
	s_waitcnt lgkmcnt(6)
	v_mfma_f32_32x32x16_bf16 a[64:79], v[24:27], v[28:31], a[64:79]
	ds_read_b64_tr_b16 v[44:45], v11 offset:6144
	v_mfma_f32_32x32x16_bf16 a[80:95], v[24:27], v[32:35], a[80:95]
	ds_read_b64_tr_b16 v[46:47], v11 offset:7680
	s_waitcnt lgkmcnt(5)
	v_mfma_f32_32x32x16_bf16 a[0:15], v[36:39], v[48:51], a[0:15]
	ds_read_b64_tr_b16 v[16:17], v9 offset:12288
	ds_read_b64_tr_b16 v[18:19], v9 offset:13824
	s_waitcnt lgkmcnt(4)
	v_mfma_f32_32x32x16_bf16 a[16:31], v[36:39], v[52:55], a[16:31]
	ds_read_b128 v[28:31], v7 offset:0
	v_mfma_f32_32x32x16_bf16 a[32:47], v[40:43], v[48:51], a[32:47]
	ds_read_b64_tr_b16 v[20:21], v10 offset:12288
	v_mfma_f32_32x32x16_bf16 a[48:63], v[40:43], v[52:55], a[48:63]
	ds_read_b64_tr_b16 v[22:23], v10 offset:13824
	ds_read_b128 v[32:35], v7 offset:4096
	s_waitcnt lgkmcnt(6)
	v_mfma_f32_32x32x16_bf16 a[64:79], v[44:47], v[48:51], a[64:79]
	ds_read_b64_tr_b16 v[24:25], v11 offset:12288
	v_mfma_f32_32x32x16_bf16 a[80:95], v[44:47], v[52:55], a[80:95]
	ds_read_b64_tr_b16 v[26:27], v11 offset:13824
	s_waitcnt lgkmcnt(5)
	v_mfma_f32_32x32x16_bf16 a[0:15], v[16:19], v[28:31], a[0:15]
	ds_read_b64_tr_b16 v[36:37], v9 offset:18432
	ds_read_b64_tr_b16 v[38:39], v9 offset:19968
	s_waitcnt lgkmcnt(4)
	v_mfma_f32_32x32x16_bf16 a[16:31], v[16:19], v[32:35], a[16:31]
	ds_read_b128 v[48:51], v8 offset:0
	v_mfma_f32_32x32x16_bf16 a[32:47], v[20:23], v[28:31], a[32:47]
	ds_read_b64_tr_b16 v[40:41], v10 offset:18432
	v_mfma_f32_32x32x16_bf16 a[48:63], v[20:23], v[32:35], a[48:63]
	ds_read_b64_tr_b16 v[42:43], v10 offset:19968
	ds_read_b128 v[52:55], v8 offset:4096
	s_waitcnt lgkmcnt(6)
	v_mfma_f32_32x32x16_bf16 a[64:79], v[24:27], v[28:31], a[64:79]
	ds_read_b64_tr_b16 v[44:45], v11 offset:18432
	v_mfma_f32_32x32x16_bf16 a[80:95], v[24:27], v[32:35], a[80:95]
	ds_read_b64_tr_b16 v[46:47], v11 offset:19968
	s_waitcnt vmcnt(20) lgkmcnt(0)
	s_barrier
	v_add_u32 v5, 0xfffe2000, v5
	v_add_u32 v6, 0xfffe2000, v6
	v_add_u32 v7, 0xfffe2000, v7
	v_add_u32 v8, 0xfffe2000, v8
	v_add_u32 v9, 0xfffe2000, v9
	v_add_u32 v10, 0xfffe2000, v10
	v_add_u32 v11, 0xfffe2000, v11
	v_mfma_f32_32x32x16_bf16 a[0:15], v[36:39], v[48:51], a[0:15]
	ds_read_b64_tr_b16 v[16:17], v9 offset:0
	ds_read_b64_tr_b16 v[18:19], v9 offset:1536
	ds_read_b128 v[28:31], v5 offset:0
	s_add_u32 m0, s40, 122880
	s_add_u32 s21, s19, 0
	buffer_load_dwordx4 v1, s[8:11], s21 offen lds
	v_mfma_f32_32x32x16_bf16 a[16:31], v[36:39], v[52:55], a[16:31]
	s_add_u32 m0, s40, 126976
	s_add_u32 s21, s19, 294912
	buffer_load_dwordx4 v1, s[8:11], s21 offen lds
	s_add_u32 m0, s40, 131072
	s_add_u32 s21, s19, 589824
	buffer_load_dwordx4 v1, s[8:11], s21 offen lds
	s_add_u32 m0, s40, 135168
	s_add_u32 s21, s19, 884736
	buffer_load_dwordx4 v1, s[8:11], s21 offen lds
	v_mfma_f32_32x32x16_bf16 a[32:47], v[40:43], v[48:51], a[32:47]
	ds_read_b64_tr_b16 v[20:21], v10 offset:0
	ds_read_b64_tr_b16 v[22:23], v10 offset:1536
	ds_read_b128 v[32:35], v5 offset:4096
	v_mfma_f32_32x32x16_bf16 a[48:63], v[40:43], v[52:55], a[48:63]
	ds_read_b64_tr_b16 v[24:25], v11 offset:0
	ds_read_b64_tr_b16 v[26:27], v11 offset:1536
	s_add_u32 m0, s41, 139264
	s_mov_b32 s22, s20
	buffer_load_dwordx4 v2, s[12:15], s22 offen lds
	v_mfma_f32_32x32x16_bf16 a[64:79], v[44:47], v[48:51], a[64:79]
	s_add_u32 m0, s41, 140288
	s_nop 0
	buffer_load_dwordx4 v3, s[12:15], s22 offen lds
	s_add_u32 m0, s41, 141312
	s_nop 0
	buffer_load_dwordx4 v4, s[12:15], s22 offen lds
	s_add_u32 m0, s41, 142336
	s_add_u32 s22, s22, s24
	buffer_load_dwordx4 v2, s[12:15], s22 offen lds
	v_mfma_f32_32x32x16_bf16 a[80:95], v[44:47], v[52:55], a[80:95]
	s_add_u32 m0, s41, 143360
	s_nop 0
	buffer_load_dwordx4 v3, s[12:15], s22 offen lds
	s_add_u32 m0, s41, 144384
	s_nop 0
	buffer_load_dwordx4 v4, s[12:15], s22 offen lds
	s_add_u32 s19, s19, 128
	s_add_u32 s20, s20, s42
	s_sub_u32 s23, s23, 1
	s_cmp_lg_u32 s23, 0
	s_cbranch_scc1 main_kernel_f2_m_loop
	s_waitcnt lgkmcnt(5)
	v_mfma_f32_32x32x16_bf16 a[0:15], v[16:19], v[28:31], a[0:15]
	ds_read_b64_tr_b16 v[36:37], v9 offset:6144
	ds_read_b64_tr_b16 v[38:39], v9 offset:7680
	s_waitcnt lgkmcnt(4)
	v_mfma_f32_32x32x16_bf16 a[16:31], v[16:19], v[32:35], a[16:31]
	ds_read_b128 v[48:51], v6 offset:0
	v_mfma_f32_32x32x16_bf16 a[32:47], v[20:23], v[28:31], a[32:47]
	ds_read_b64_tr_b16 v[40:41], v10 offset:6144
	v_mfma_f32_32x32x16_bf16 a[48:63], v[20:23], v[32:35], a[48:63]
	ds_read_b64_tr_b16 v[42:43], v10 offset:7680
	ds_read_b128 v[52:55], v6 offset:4096
	s_waitcnt lgkmcnt(6)
	v_mfma_f32_32x32x16_bf16 a[64:79], v[24:27], v[28:31], a[64:79]
	ds_read_b64_tr_b16 v[44:45], v11 offset:6144
	v_mfma_f32_32x32x16_bf16 a[80:95], v[24:27], v[32:35], a[80:95]
	ds_read_b64_tr_b16 v[46:47], v11 offset:7680
	s_waitcnt lgkmcnt(5)
	v_mfma_f32_32x32x16_bf16 a[0:15], v[36:39], v[48:51], a[0:15]
	ds_read_b64_tr_b16 v[16:17], v9 offset:12288
	ds_read_b64_tr_b16 v[18:19], v9 offset:13824
	s_waitcnt lgkmcnt(4)
	v_mfma_f32_32x32x16_bf16 a[16:31], v[36:39], v[52:55], a[16:31]
	ds_read_b128 v[28:31], v7 offset:0
	v_mfma_f32_32x32x16_bf16 a[32:47], v[40:43], v[48:51], a[32:47]
	ds_read_b64_tr_b16 v[20:21], v10 offset:12288
	v_mfma_f32_32x32x16_bf16 a[48:63], v[40:43], v[52:55], a[48:63]
	ds_read_b64_tr_b16 v[22:23], v10 offset:13824
	ds_read_b128 v[32:35], v7 offset:4096
	s_waitcnt lgkmcnt(6)
	v_mfma_f32_32x32x16_bf16 a[64:79], v[44:47], v[48:51], a[64:79]
	ds_read_b64_tr_b16 v[24:25], v11 offset:12288
	v_mfma_f32_32x32x16_bf16 a[80:95], v[44:47], v[52:55], a[80:95]
	ds_read_b64_tr_b16 v[26:27], v11 offset:13824
	s_waitcnt lgkmcnt(5)
	v_mfma_f32_32x32x16_bf16 a[0:15], v[16:19], v[28:31], a[0:15]
	ds_read_b64_tr_b16 v[36:37], v9 offset:18432
	ds_read_b64_tr_b16 v[38:39], v9 offset:19968
	s_waitcnt lgkmcnt(4)
	v_mfma_f32_32x32x16_bf16 a[16:31], v[16:19], v[32:35], a[16:31]
	ds_read_b128 v[48:51], v8 offset:0
	v_mfma_f32_32x32x16_bf16 a[32:47], v[20:23], v[28:31], a[32:47]
	ds_read_b64_tr_b16 v[40:41], v10 offset:18432
	v_mfma_f32_32x32x16_bf16 a[48:63], v[20:23], v[32:35], a[48:63]
	ds_read_b64_tr_b16 v[42:43], v10 offset:19968
	ds_read_b128 v[52:55], v8 offset:4096
	s_waitcnt lgkmcnt(6)
	v_mfma_f32_32x32x16_bf16 a[64:79], v[24:27], v[28:31], a[64:79]
	ds_read_b64_tr_b16 v[44:45], v11 offset:18432
	v_mfma_f32_32x32x16_bf16 a[80:95], v[24:27], v[32:35], a[80:95]
	ds_read_b64_tr_b16 v[46:47], v11 offset:19968
	s_waitcnt vmcnt(20) lgkmcnt(0)
	s_barrier
	v_add_u32 v5, 0xa000, v5
	v_add_u32 v6, 0xa000, v6
	v_add_u32 v7, 0xa000, v7
	v_add_u32 v8, 0xa000, v8
	v_add_u32 v9, 0xa000, v9
	v_add_u32 v10, 0xa000, v10
	v_add_u32 v11, 0xa000, v11
	v_mfma_f32_32x32x16_bf16 a[0:15], v[36:39], v[48:51], a[0:15]
	ds_read_b64_tr_b16 v[16:17], v9 offset:0
	ds_read_b64_tr_b16 v[18:19], v9 offset:1536
	v_mfma_f32_32x32x16_bf16 a[16:31], v[36:39], v[52:55], a[16:31]
	ds_read_b128 v[28:31], v5 offset:0
	v_mfma_f32_32x32x16_bf16 a[32:47], v[40:43], v[48:51], a[32:47]
	ds_read_b64_tr_b16 v[20:21], v10 offset:0
	v_mfma_f32_32x32x16_bf16 a[48:63], v[40:43], v[52:55], a[48:63]
	ds_read_b64_tr_b16 v[22:23], v10 offset:1536
	ds_read_b128 v[32:35], v5 offset:4096
	v_mfma_f32_32x32x16_bf16 a[64:79], v[44:47], v[48:51], a[64:79]
	ds_read_b64_tr_b16 v[24:25], v11 offset:0
	v_mfma_f32_32x32x16_bf16 a[80:95], v[44:47], v[52:55], a[80:95]
	ds_read_b64_tr_b16 v[26:27], v11 offset:1536
	s_waitcnt lgkmcnt(5)
	v_mfma_f32_32x32x16_bf16 a[0:15], v[16:19], v[28:31], a[0:15]
	ds_read_b64_tr_b16 v[36:37], v9 offset:6144
	ds_read_b64_tr_b16 v[38:39], v9 offset:7680
	s_waitcnt lgkmcnt(4)
	v_mfma_f32_32x32x16_bf16 a[16:31], v[16:19], v[32:35], a[16:31]
	ds_read_b128 v[48:51], v6 offset:0
	v_mfma_f32_32x32x16_bf16 a[32:47], v[20:23], v[28:31], a[32:47]
	ds_read_b64_tr_b16 v[40:41], v10 offset:6144
	v_mfma_f32_32x32x16_bf16 a[48:63], v[20:23], v[32:35], a[48:63]
	ds_read_b64_tr_b16 v[42:43], v10 offset:7680
	ds_read_b128 v[52:55], v6 offset:4096
	s_waitcnt lgkmcnt(6)
	v_mfma_f32_32x32x16_bf16 a[64:79], v[24:27], v[28:31], a[64:79]
	ds_read_b64_tr_b16 v[44:45], v11 offset:6144
	v_mfma_f32_32x32x16_bf16 a[80:95], v[24:27], v[32:35], a[80:95]
	ds_read_b64_tr_b16 v[46:47], v11 offset:7680
	s_waitcnt lgkmcnt(5)
	v_mfma_f32_32x32x16_bf16 a[0:15], v[36:39], v[48:51], a[0:15]
	ds_read_b64_tr_b16 v[16:17], v9 offset:12288
	ds_read_b64_tr_b16 v[18:19], v9 offset:13824
	s_waitcnt lgkmcnt(4)
	v_mfma_f32_32x32x16_bf16 a[16:31], v[36:39], v[52:55], a[16:31]
	ds_read_b128 v[28:31], v7 offset:0
	v_mfma_f32_32x32x16_bf16 a[32:47], v[40:43], v[48:51], a[32:47]
	ds_read_b64_tr_b16 v[20:21], v10 offset:12288
	v_mfma_f32_32x32x16_bf16 a[48:63], v[40:43], v[52:55], a[48:63]
	ds_read_b64_tr_b16 v[22:23], v10 offset:13824
	ds_read_b128 v[32:35], v7 offset:4096
	s_waitcnt lgkmcnt(6)
	v_mfma_f32_32x32x16_bf16 a[64:79], v[44:47], v[48:51], a[64:79]
	ds_read_b64_tr_b16 v[24:25], v11 offset:12288
	v_mfma_f32_32x32x16_bf16 a[80:95], v[44:47], v[52:55], a[80:95]
	ds_read_b64_tr_b16 v[26:27], v11 offset:13824
	s_waitcnt lgkmcnt(5)
	v_mfma_f32_32x32x16_bf16 a[0:15], v[16:19], v[28:31], a[0:15]
	ds_read_b64_tr_b16 v[36:37], v9 offset:18432
	ds_read_b64_tr_b16 v[38:39], v9 offset:19968
	s_waitcnt lgkmcnt(4)
	v_mfma_f32_32x32x16_bf16 a[16:31], v[16:19], v[32:35], a[16:31]
	ds_read_b128 v[48:51], v8 offset:0
	v_mfma_f32_32x32x16_bf16 a[32:47], v[20:23], v[28:31], a[32:47]
	ds_read_b64_tr_b16 v[40:41], v10 offset:18432
	v_mfma_f32_32x32x16_bf16 a[48:63], v[20:23], v[32:35], a[48:63]
	ds_read_b64_tr_b16 v[42:43], v10 offset:19968
	ds_read_b128 v[52:55], v8 offset:4096
	s_waitcnt lgkmcnt(6)
	v_mfma_f32_32x32x16_bf16 a[64:79], v[24:27], v[28:31], a[64:79]
	ds_read_b64_tr_b16 v[44:45], v11 offset:18432
	v_mfma_f32_32x32x16_bf16 a[80:95], v[24:27], v[32:35], a[80:95]
	ds_read_b64_tr_b16 v[46:47], v11 offset:19968
	s_waitcnt vmcnt(10) lgkmcnt(0)
	s_barrier
	v_add_u32 v5, 0xa000, v5
	v_add_u32 v6, 0xa000, v6
	v_add_u32 v7, 0xa000, v7
	v_add_u32 v8, 0xa000, v8
	v_add_u32 v9, 0xa000, v9
	v_add_u32 v10, 0xa000, v10
	v_add_u32 v11, 0xa000, v11
	v_mfma_f32_32x32x16_bf16 a[0:15], v[36:39], v[48:51], a[0:15]
	ds_read_b64_tr_b16 v[16:17], v9 offset:0
	ds_read_b64_tr_b16 v[18:19], v9 offset:1536
	v_mfma_f32_32x32x16_bf16 a[16:31], v[36:39], v[52:55], a[16:31]
	ds_read_b128 v[28:31], v5 offset:0
	v_mfma_f32_32x32x16_bf16 a[32:47], v[40:43], v[48:51], a[32:47]
	ds_read_b64_tr_b16 v[20:21], v10 offset:0
	v_mfma_f32_32x32x16_bf16 a[48:63], v[40:43], v[52:55], a[48:63]
	ds_read_b64_tr_b16 v[22:23], v10 offset:1536
	ds_read_b128 v[32:35], v5 offset:4096
	v_mfma_f32_32x32x16_bf16 a[64:79], v[44:47], v[48:51], a[64:79]
	ds_read_b64_tr_b16 v[24:25], v11 offset:0
	v_mfma_f32_32x32x16_bf16 a[80:95], v[44:47], v[52:55], a[80:95]
	ds_read_b64_tr_b16 v[26:27], v11 offset:1536
	s_waitcnt lgkmcnt(5)
	v_mfma_f32_32x32x16_bf16 a[0:15], v[16:19], v[28:31], a[0:15]
	ds_read_b64_tr_b16 v[36:37], v9 offset:6144
	ds_read_b64_tr_b16 v[38:39], v9 offset:7680
	s_waitcnt lgkmcnt(4)
	v_mfma_f32_32x32x16_bf16 a[16:31], v[16:19], v[32:35], a[16:31]
	ds_read_b128 v[48:51], v6 offset:0
	v_mfma_f32_32x32x16_bf16 a[32:47], v[20:23], v[28:31], a[32:47]
	ds_read_b64_tr_b16 v[40:41], v10 offset:6144
	v_mfma_f32_32x32x16_bf16 a[48:63], v[20:23], v[32:35], a[48:63]
	ds_read_b64_tr_b16 v[42:43], v10 offset:7680
	ds_read_b128 v[52:55], v6 offset:4096
	s_waitcnt lgkmcnt(6)
	v_mfma_f32_32x32x16_bf16 a[64:79], v[24:27], v[28:31], a[64:79]
	ds_read_b64_tr_b16 v[44:45], v11 offset:6144
	v_mfma_f32_32x32x16_bf16 a[80:95], v[24:27], v[32:35], a[80:95]
	ds_read_b64_tr_b16 v[46:47], v11 offset:7680
	s_waitcnt lgkmcnt(5)
	v_mfma_f32_32x32x16_bf16 a[0:15], v[36:39], v[48:51], a[0:15]
	ds_read_b64_tr_b16 v[16:17], v9 offset:12288
	ds_read_b64_tr_b16 v[18:19], v9 offset:13824
	s_waitcnt lgkmcnt(4)
	v_mfma_f32_32x32x16_bf16 a[16:31], v[36:39], v[52:55], a[16:31]
	ds_read_b128 v[28:31], v7 offset:0
	v_mfma_f32_32x32x16_bf16 a[32:47], v[40:43], v[48:51], a[32:47]
	ds_read_b64_tr_b16 v[20:21], v10 offset:12288
	v_mfma_f32_32x32x16_bf16 a[48:63], v[40:43], v[52:55], a[48:63]
	ds_read_b64_tr_b16 v[22:23], v10 offset:13824
	ds_read_b128 v[32:35], v7 offset:4096
	s_waitcnt lgkmcnt(6)
	v_mfma_f32_32x32x16_bf16 a[64:79], v[44:47], v[48:51], a[64:79]
	ds_read_b64_tr_b16 v[24:25], v11 offset:12288
	v_mfma_f32_32x32x16_bf16 a[80:95], v[44:47], v[52:55], a[80:95]
	ds_read_b64_tr_b16 v[26:27], v11 offset:13824
	s_waitcnt lgkmcnt(5)
	v_mfma_f32_32x32x16_bf16 a[0:15], v[16:19], v[28:31], a[0:15]
	ds_read_b64_tr_b16 v[36:37], v9 offset:18432
	ds_read_b64_tr_b16 v[38:39], v9 offset:19968
	s_waitcnt lgkmcnt(4)
	v_mfma_f32_32x32x16_bf16 a[16:31], v[16:19], v[32:35], a[16:31]
	ds_read_b128 v[48:51], v8 offset:0
	v_mfma_f32_32x32x16_bf16 a[32:47], v[20:23], v[28:31], a[32:47]
	ds_read_b64_tr_b16 v[40:41], v10 offset:18432
	v_mfma_f32_32x32x16_bf16 a[48:63], v[20:23], v[32:35], a[48:63]
	ds_read_b64_tr_b16 v[42:43], v10 offset:19968
	ds_read_b128 v[52:55], v8 offset:4096
	s_waitcnt lgkmcnt(6)
	v_mfma_f32_32x32x16_bf16 a[64:79], v[24:27], v[28:31], a[64:79]
	ds_read_b64_tr_b16 v[44:45], v11 offset:18432
	v_mfma_f32_32x32x16_bf16 a[80:95], v[24:27], v[32:35], a[80:95]
	ds_read_b64_tr_b16 v[46:47], v11 offset:19968
	s_waitcnt vmcnt(0) lgkmcnt(0)
	s_barrier
	v_add_u32 v5, 0xa000, v5
	v_add_u32 v6, 0xa000, v6
	v_add_u32 v7, 0xa000, v7
	v_add_u32 v8, 0xa000, v8
	v_add_u32 v9, 0xa000, v9
	v_add_u32 v10, 0xa000, v10
	v_add_u32 v11, 0xa000, v11
	v_mfma_f32_32x32x16_bf16 a[0:15], v[36:39], v[48:51], a[0:15]
	ds_read_b64_tr_b16 v[16:17], v9 offset:0
	ds_read_b64_tr_b16 v[18:19], v9 offset:1536
	v_mfma_f32_32x32x16_bf16 a[16:31], v[36:39], v[52:55], a[16:31]
	ds_read_b128 v[28:31], v5 offset:0
	v_mfma_f32_32x32x16_bf16 a[32:47], v[40:43], v[48:51], a[32:47]
	ds_read_b64_tr_b16 v[20:21], v10 offset:0
	v_mfma_f32_32x32x16_bf16 a[48:63], v[40:43], v[52:55], a[48:63]
	ds_read_b64_tr_b16 v[22:23], v10 offset:1536
	ds_read_b128 v[32:35], v5 offset:4096
	v_mfma_f32_32x32x16_bf16 a[64:79], v[44:47], v[48:51], a[64:79]
	ds_read_b64_tr_b16 v[24:25], v11 offset:0
	v_mfma_f32_32x32x16_bf16 a[80:95], v[44:47], v[52:55], a[80:95]
	ds_read_b64_tr_b16 v[26:27], v11 offset:1536
	s_waitcnt lgkmcnt(5)
	v_mfma_f32_32x32x16_bf16 a[0:15], v[16:19], v[28:31], a[0:15]
	ds_read_b64_tr_b16 v[36:37], v9 offset:6144
	ds_read_b64_tr_b16 v[38:39], v9 offset:7680
	s_waitcnt lgkmcnt(4)
	v_mfma_f32_32x32x16_bf16 a[16:31], v[16:19], v[32:35], a[16:31]
	ds_read_b128 v[48:51], v6 offset:0
	v_mfma_f32_32x32x16_bf16 a[32:47], v[20:23], v[28:31], a[32:47]
	ds_read_b64_tr_b16 v[40:41], v10 offset:6144
	v_mfma_f32_32x32x16_bf16 a[48:63], v[20:23], v[32:35], a[48:63]
	ds_read_b64_tr_b16 v[42:43], v10 offset:7680
	ds_read_b128 v[52:55], v6 offset:4096
	s_waitcnt lgkmcnt(6)
	v_mfma_f32_32x32x16_bf16 a[64:79], v[24:27], v[28:31], a[64:79]
	ds_read_b64_tr_b16 v[44:45], v11 offset:6144
	v_mfma_f32_32x32x16_bf16 a[80:95], v[24:27], v[32:35], a[80:95]
	ds_read_b64_tr_b16 v[46:47], v11 offset:7680
	s_waitcnt lgkmcnt(5)
	v_mfma_f32_32x32x16_bf16 a[0:15], v[36:39], v[48:51], a[0:15]
	ds_read_b64_tr_b16 v[16:17], v9 offset:12288
	ds_read_b64_tr_b16 v[18:19], v9 offset:13824
	s_waitcnt lgkmcnt(4)
	v_mfma_f32_32x32x16_bf16 a[16:31], v[36:39], v[52:55], a[16:31]
	ds_read_b128 v[28:31], v7 offset:0
	v_mfma_f32_32x32x16_bf16 a[32:47], v[40:43], v[48:51], a[32:47]
	ds_read_b64_tr_b16 v[20:21], v10 offset:12288
	v_mfma_f32_32x32x16_bf16 a[48:63], v[40:43], v[52:55], a[48:63]
	ds_read_b64_tr_b16 v[22:23], v10 offset:13824
	ds_read_b128 v[32:35], v7 offset:4096
	s_waitcnt lgkmcnt(6)
	v_mfma_f32_32x32x16_bf16 a[64:79], v[44:47], v[48:51], a[64:79]
	ds_read_b64_tr_b16 v[24:25], v11 offset:12288
	v_mfma_f32_32x32x16_bf16 a[80:95], v[44:47], v[52:55], a[80:95]
	ds_read_b64_tr_b16 v[26:27], v11 offset:13824
	s_waitcnt lgkmcnt(5)
	v_mfma_f32_32x32x16_bf16 a[0:15], v[16:19], v[28:31], a[0:15]
	ds_read_b64_tr_b16 v[36:37], v9 offset:18432
	ds_read_b64_tr_b16 v[38:39], v9 offset:19968
	s_waitcnt lgkmcnt(4)
	v_mfma_f32_32x32x16_bf16 a[16:31], v[16:19], v[32:35], a[16:31]
	ds_read_b128 v[48:51], v8 offset:0
	v_mfma_f32_32x32x16_bf16 a[32:47], v[20:23], v[28:31], a[32:47]
	ds_read_b64_tr_b16 v[40:41], v10 offset:18432
	v_mfma_f32_32x32x16_bf16 a[48:63], v[20:23], v[32:35], a[48:63]
	ds_read_b64_tr_b16 v[42:43], v10 offset:19968
	ds_read_b128 v[52:55], v8 offset:4096
	s_waitcnt lgkmcnt(6)
	v_mfma_f32_32x32x16_bf16 a[64:79], v[24:27], v[28:31], a[64:79]
	ds_read_b64_tr_b16 v[44:45], v11 offset:18432
	v_mfma_f32_32x32x16_bf16 a[80:95], v[24:27], v[32:35], a[80:95]
	ds_read_b64_tr_b16 v[46:47], v11 offset:19968
	s_waitcnt lgkmcnt(5)
	v_mfma_f32_32x32x16_bf16 a[0:15], v[36:39], v[48:51], a[0:15]
	s_waitcnt lgkmcnt(2)
	v_mfma_f32_32x32x16_bf16 a[16:31], v[36:39], v[52:55], a[16:31]
	v_mfma_f32_32x32x16_bf16 a[32:47], v[40:43], v[48:51], a[32:47]
	v_mfma_f32_32x32x16_bf16 a[48:63], v[40:43], v[52:55], a[48:63]
	s_waitcnt lgkmcnt(0)
	v_mfma_f32_32x32x16_bf16 a[64:79], v[44:47], v[48:51], a[64:79]
	v_mfma_f32_32x32x16_bf16 a[80:95], v[44:47], v[52:55], a[80:95]
	v_add_u32 v5, 0xfffe2000, v5
	v_add_u32 v6, 0xfffe2000, v6
	v_add_u32 v7, 0xfffe2000, v7
	v_add_u32 v8, 0xfffe2000, v8
	v_add_u32 v9, 0xfffe2000, v9
	v_add_u32 v10, 0xfffe2000, v10
	v_add_u32 v11, 0xfffe2000, v11
	s_barrier
	s_lshr_b32 s21, s4, 1
	s_and_b32 s22, s4, 1
	s_mul_i32 s21, s21, 64
	s_add_u32 s21, s21, s28
	s_mul_i32 s22, s22, 96
	s_add_u32 s22, s22, s27
	v_and_b32 v13, 31, v0
	v_add_u32 v13, s21, v13
	v_lshrrev_b32 v14, 5, v0
	v_lshlrev_b32 v14, 2, v14
	v_add_u32 v14, s22, v14
	v_mul_u32_u24 v15, 2304, v13
	v_lshl_add_u32 v15, v14, 2, v15
	v_mul_u32_u24 v140, 1152, v13
	v_lshl_add_u32 v140, v14, 1, v140
	v_lshlrev_b32 v14, 1, v14
	s_lshr_b32 s21, s4, 1
	s_and_b32 s22, s4, 1
	s_mul_i32 s21, s21, 64
	s_add_u32 s21, s21, s28
	s_mul_i32 s22, s22, 96
	s_add_u32 s22, s22, s27
	s_lshl_b32 s22, s22, 2
	v_and_b32 v13, 7, v0
	v_add_u32 v13, s21, v13
	v_mul_u32_u24 v138, 2304, v13
	v_add_u32 v138, s22, v138
	v_bfe_u32 v13, v0, 4, 1
	v_lshl_add_u32 v138, v13, 6, v138
	v_bfe_u32 v13, v0, 3, 1
	v_lshl_add_u32 v138, v13, 5, v138
	v_lshrrev_b32 v13, 5, v0
	v_lshl_add_u32 v138, v13, 4, v138
	buffer_load_dwordx2 v[120:121], v14, s[32:35], 0 offen offset:0
	buffer_load_dwordx2 v[122:123], v14, s[32:35], 0 offen offset:16
	buffer_load_dwordx2 v[124:125], v14, s[32:35], 0 offen offset:32
	buffer_load_dwordx2 v[126:127], v14, s[32:35], 0 offen offset:48
	s_mov_b32 s23, 0
	buffer_load_dwordx2 v[128:129], v140, s[36:39], s23 offen offset:0
	buffer_load_dwordx2 v[130:131], v140, s[36:39], s23 offen offset:16
	buffer_load_dwordx2 v[132:133], v140, s[36:39], s23 offen offset:32
	buffer_load_dwordx2 v[134:135], v140, s[36:39], s23 offen offset:48
	v_accvgpr_read_b32 v80, a0
	v_accvgpr_read_b32 v81, a1
	v_accvgpr_read_b32 v82, a2
	v_accvgpr_read_b32 v83, a3
	v_accvgpr_read_b32 v84, a4
	v_accvgpr_read_b32 v85, a5
	v_accvgpr_read_b32 v86, a6
	v_accvgpr_read_b32 v87, a7
	v_accvgpr_read_b32 v88, a8
	v_accvgpr_read_b32 v89, a9
	v_accvgpr_read_b32 v90, a10
	v_accvgpr_read_b32 v91, a11
	v_accvgpr_read_b32 v92, a12
	v_accvgpr_read_b32 v93, a13
	v_accvgpr_read_b32 v94, a14
	v_accvgpr_read_b32 v95, a15
	s_waitcnt vmcnt(7)
	v_lshlrev_b32 v136, 16, v120
	v_add_f32 v80, v80, v136
	s_waitcnt vmcnt(3)
	v_lshlrev_b32 v136, 16, v128
	v_add_f32 v80, v80, v136
	v_and_b32 v136, 0xffff0000, v120
	v_add_f32 v81, v81, v136
	v_and_b32 v136, 0xffff0000, v128
	v_add_f32 v81, v81, v136
	v_lshlrev_b32 v136, 16, v121
	v_add_f32 v82, v82, v136
	v_lshlrev_b32 v136, 16, v129
	v_add_f32 v82, v82, v136
	v_and_b32 v136, 0xffff0000, v121
	v_add_f32 v83, v83, v136
	v_and_b32 v136, 0xffff0000, v129
	v_add_f32 v83, v83, v136
	v_lshlrev_b32 v136, 16, v122
	v_add_f32 v84, v84, v136
	s_waitcnt vmcnt(2)
	v_lshlrev_b32 v136, 16, v130
	v_add_f32 v84, v84, v136
	v_and_b32 v136, 0xffff0000, v122
	v_add_f32 v85, v85, v136
	v_and_b32 v136, 0xffff0000, v130
	v_add_f32 v85, v85, v136
	v_lshlrev_b32 v136, 16, v123
	v_add_f32 v86, v86, v136
	v_lshlrev_b32 v136, 16, v131
	v_add_f32 v86, v86, v136
	v_and_b32 v136, 0xffff0000, v123
	v_add_f32 v87, v87, v136
	v_and_b32 v136, 0xffff0000, v131
	v_add_f32 v87, v87, v136
	v_lshlrev_b32 v136, 16, v124
	v_add_f32 v88, v88, v136
	s_waitcnt vmcnt(1)
	v_lshlrev_b32 v136, 16, v132
	v_add_f32 v88, v88, v136
	v_and_b32 v136, 0xffff0000, v124
	v_add_f32 v89, v89, v136
	v_and_b32 v136, 0xffff0000, v132
	v_add_f32 v89, v89, v136
	v_lshlrev_b32 v136, 16, v125
	v_add_f32 v90, v90, v136
	v_lshlrev_b32 v136, 16, v133
	v_add_f32 v90, v90, v136
	v_and_b32 v136, 0xffff0000, v125
	v_add_f32 v91, v91, v136
	v_and_b32 v136, 0xffff0000, v133
	v_add_f32 v91, v91, v136
	v_lshlrev_b32 v136, 16, v126
	v_add_f32 v92, v92, v136
	s_waitcnt vmcnt(0)
	v_lshlrev_b32 v136, 16, v134
	v_add_f32 v92, v92, v136
	v_and_b32 v136, 0xffff0000, v126
	v_add_f32 v93, v93, v136
	v_and_b32 v136, 0xffff0000, v134
	v_add_f32 v93, v93, v136
	v_lshlrev_b32 v136, 16, v127
	v_add_f32 v94, v94, v136
	v_lshlrev_b32 v136, 16, v135
	v_add_f32 v94, v94, v136
	v_and_b32 v136, 0xffff0000, v127
	v_add_f32 v95, v95, v136
	v_and_b32 v136, 0xffff0000, v135
	v_add_f32 v95, v95, v136
	s_add_u32 s23, s43, 0
	v_permlane16_swap_b32 v80, v88
	v_permlane16_swap_b32 v81, v89
	v_permlane16_swap_b32 v82, v90
	v_permlane16_swap_b32 v83, v91
	v_permlane16_swap_b32 v84, v92
	v_permlane16_swap_b32 v85, v93
	v_permlane16_swap_b32 v86, v94
	v_permlane16_swap_b32 v87, v95
	v_mov_b32 v128, v80
	v_mov_b32 v129, v81
	v_mov_b32 v130, v82
	v_mov_b32 v131, v83
	v_mov_b32_dpp v80, v84 row_ror:8 row_mask:0xf bank_mask:0xc
	v_mov_b32_dpp v81, v85 row_ror:8 row_mask:0xf bank_mask:0xc
	v_mov_b32_dpp v82, v86 row_ror:8 row_mask:0xf bank_mask:0xc
	v_mov_b32_dpp v83, v87 row_ror:8 row_mask:0xf bank_mask:0xc
	v_mov_b32_dpp v84, v128 row_ror:8 row_mask:0xf bank_mask:0x3
	v_mov_b32_dpp v85, v129 row_ror:8 row_mask:0xf bank_mask:0x3
	v_mov_b32_dpp v86, v130 row_ror:8 row_mask:0xf bank_mask:0x3
	v_mov_b32_dpp v87, v131 row_ror:8 row_mask:0xf bank_mask:0x3
	v_mov_b32 v128, v88
	v_mov_b32 v129, v89
	v_mov_b32 v130, v90
	v_mov_b32 v131, v91
	v_mov_b32_dpp v88, v92 row_ror:8 row_mask:0xf bank_mask:0xc
	v_mov_b32_dpp v89, v93 row_ror:8 row_mask:0xf bank_mask:0xc
	v_mov_b32_dpp v90, v94 row_ror:8 row_mask:0xf bank_mask:0xc
	v_mov_b32_dpp v91, v95 row_ror:8 row_mask:0xf bank_mask:0xc
	v_mov_b32_dpp v92, v128 row_ror:8 row_mask:0xf bank_mask:0x3
	v_mov_b32_dpp v93, v129 row_ror:8 row_mask:0xf bank_mask:0x3
	v_mov_b32_dpp v94, v130 row_ror:8 row_mask:0xf bank_mask:0x3
	v_mov_b32_dpp v95, v131 row_ror:8 row_mask:0xf bank_mask:0x3
	buffer_store_dwordx4 v[80:83], v138, s[8:11], s23 offen offset:0 sc1
	s_add_u32 s23, s23, 18432
	buffer_store_dwordx4 v[84:87], v138, s[8:11], s23 offen offset:0 sc1
	s_add_u32 s23, s23, 18432
	buffer_store_dwordx4 v[88:91], v138, s[8:11], s23 offen offset:0 sc1
	s_add_u32 s23, s23, 18432
	buffer_store_dwordx4 v[92:95], v138, s[8:11], s23 offen offset:0 sc1
	s_mov_b32 s23, 36864
	buffer_load_dwordx2 v[128:129], v140, s[36:39], s23 offen offset:0
	buffer_load_dwordx2 v[130:131], v140, s[36:39], s23 offen offset:16
	buffer_load_dwordx2 v[132:133], v140, s[36:39], s23 offen offset:32
	buffer_load_dwordx2 v[134:135], v140, s[36:39], s23 offen offset:48
	v_accvgpr_read_b32 v100, a16
	v_accvgpr_read_b32 v101, a17
	v_accvgpr_read_b32 v102, a18
	v_accvgpr_read_b32 v103, a19
	v_accvgpr_read_b32 v104, a20
	v_accvgpr_read_b32 v105, a21
	v_accvgpr_read_b32 v106, a22
	v_accvgpr_read_b32 v107, a23
	v_accvgpr_read_b32 v108, a24
	v_accvgpr_read_b32 v109, a25
	v_accvgpr_read_b32 v110, a26
	v_accvgpr_read_b32 v111, a27
	v_accvgpr_read_b32 v112, a28
	v_accvgpr_read_b32 v113, a29
	v_accvgpr_read_b32 v114, a30
	v_accvgpr_read_b32 v115, a31
	v_lshlrev_b32 v136, 16, v120
	v_add_f32 v100, v100, v136
	s_waitcnt vmcnt(3)
	v_lshlrev_b32 v136, 16, v128
	v_add_f32 v100, v100, v136
	v_and_b32 v136, 0xffff0000, v120
	v_add_f32 v101, v101, v136
	v_and_b32 v136, 0xffff0000, v128
	v_add_f32 v101, v101, v136
	v_lshlrev_b32 v136, 16, v121
	v_add_f32 v102, v102, v136
	v_lshlrev_b32 v136, 16, v129
	v_add_f32 v102, v102, v136
	v_and_b32 v136, 0xffff0000, v121
	v_add_f32 v103, v103, v136
	v_and_b32 v136, 0xffff0000, v129
	v_add_f32 v103, v103, v136
	v_lshlrev_b32 v136, 16, v122
	v_add_f32 v104, v104, v136
	s_waitcnt vmcnt(2)
	v_lshlrev_b32 v136, 16, v130
	v_add_f32 v104, v104, v136
	v_and_b32 v136, 0xffff0000, v122
	v_add_f32 v105, v105, v136
	v_and_b32 v136, 0xffff0000, v130
	v_add_f32 v105, v105, v136
	v_lshlrev_b32 v136, 16, v123
	v_add_f32 v106, v106, v136
	v_lshlrev_b32 v136, 16, v131
	v_add_f32 v106, v106, v136
	v_and_b32 v136, 0xffff0000, v123
	v_add_f32 v107, v107, v136
	v_and_b32 v136, 0xffff0000, v131
	v_add_f32 v107, v107, v136
	v_lshlrev_b32 v136, 16, v124
	v_add_f32 v108, v108, v136
	s_waitcnt vmcnt(1)
	v_lshlrev_b32 v136, 16, v132
	v_add_f32 v108, v108, v136
	v_and_b32 v136, 0xffff0000, v124
	v_add_f32 v109, v109, v136
	v_and_b32 v136, 0xffff0000, v132
	v_add_f32 v109, v109, v136
	v_lshlrev_b32 v136, 16, v125
	v_add_f32 v110, v110, v136
	v_lshlrev_b32 v136, 16, v133
	v_add_f32 v110, v110, v136
	v_and_b32 v136, 0xffff0000, v125
	v_add_f32 v111, v111, v136
	v_and_b32 v136, 0xffff0000, v133
	v_add_f32 v111, v111, v136
	v_lshlrev_b32 v136, 16, v126
	v_add_f32 v112, v112, v136
	s_waitcnt vmcnt(0)
	v_lshlrev_b32 v136, 16, v134
	v_add_f32 v112, v112, v136
	v_and_b32 v136, 0xffff0000, v126
	v_add_f32 v113, v113, v136
	v_and_b32 v136, 0xffff0000, v134
	v_add_f32 v113, v113, v136
	v_lshlrev_b32 v136, 16, v127
	v_add_f32 v114, v114, v136
	v_lshlrev_b32 v136, 16, v135
	v_add_f32 v114, v114, v136
	v_and_b32 v136, 0xffff0000, v127
	v_add_f32 v115, v115, v136
	v_and_b32 v136, 0xffff0000, v135
	v_add_f32 v115, v115, v136
	s_add_u32 s23, s43, 73728
	v_permlane16_swap_b32 v100, v108
	v_permlane16_swap_b32 v101, v109
	v_permlane16_swap_b32 v102, v110
	v_permlane16_swap_b32 v103, v111
	v_permlane16_swap_b32 v104, v112
	v_permlane16_swap_b32 v105, v113
	v_permlane16_swap_b32 v106, v114
	v_permlane16_swap_b32 v107, v115
	v_mov_b32 v128, v100
	v_mov_b32 v129, v101
	v_mov_b32 v130, v102
	v_mov_b32 v131, v103
	v_mov_b32_dpp v100, v104 row_ror:8 row_mask:0xf bank_mask:0xc
	v_mov_b32_dpp v101, v105 row_ror:8 row_mask:0xf bank_mask:0xc
	v_mov_b32_dpp v102, v106 row_ror:8 row_mask:0xf bank_mask:0xc
	v_mov_b32_dpp v103, v107 row_ror:8 row_mask:0xf bank_mask:0xc
	v_mov_b32_dpp v104, v128 row_ror:8 row_mask:0xf bank_mask:0x3
	v_mov_b32_dpp v105, v129 row_ror:8 row_mask:0xf bank_mask:0x3
	v_mov_b32_dpp v106, v130 row_ror:8 row_mask:0xf bank_mask:0x3
	v_mov_b32_dpp v107, v131 row_ror:8 row_mask:0xf bank_mask:0x3
	v_mov_b32 v128, v108
	v_mov_b32 v129, v109
	v_mov_b32 v130, v110
	v_mov_b32 v131, v111
	v_mov_b32_dpp v108, v112 row_ror:8 row_mask:0xf bank_mask:0xc
	v_mov_b32_dpp v109, v113 row_ror:8 row_mask:0xf bank_mask:0xc
	v_mov_b32_dpp v110, v114 row_ror:8 row_mask:0xf bank_mask:0xc
	v_mov_b32_dpp v111, v115 row_ror:8 row_mask:0xf bank_mask:0xc
	v_mov_b32_dpp v112, v128 row_ror:8 row_mask:0xf bank_mask:0x3
	v_mov_b32_dpp v113, v129 row_ror:8 row_mask:0xf bank_mask:0x3
	v_mov_b32_dpp v114, v130 row_ror:8 row_mask:0xf bank_mask:0x3
	v_mov_b32_dpp v115, v131 row_ror:8 row_mask:0xf bank_mask:0x3
	buffer_store_dwordx4 v[100:103], v138, s[8:11], s23 offen offset:0 sc1
	s_add_u32 s23, s23, 18432
	buffer_store_dwordx4 v[104:107], v138, s[8:11], s23 offen offset:0 sc1
	s_add_u32 s23, s23, 18432
	buffer_store_dwordx4 v[108:111], v138, s[8:11], s23 offen offset:0 sc1
	s_add_u32 s23, s23, 18432
	buffer_store_dwordx4 v[112:115], v138, s[8:11], s23 offen offset:0 sc1
	buffer_load_dwordx2 v[120:121], v14, s[32:35], 0 offen offset:64
	buffer_load_dwordx2 v[122:123], v14, s[32:35], 0 offen offset:80
	buffer_load_dwordx2 v[124:125], v14, s[32:35], 0 offen offset:96
	buffer_load_dwordx2 v[126:127], v14, s[32:35], 0 offen offset:112
	s_mov_b32 s23, 0
	buffer_load_dwordx2 v[128:129], v140, s[36:39], s23 offen offset:64
	buffer_load_dwordx2 v[130:131], v140, s[36:39], s23 offen offset:80
	buffer_load_dwordx2 v[132:133], v140, s[36:39], s23 offen offset:96
	buffer_load_dwordx2 v[134:135], v140, s[36:39], s23 offen offset:112
	v_accvgpr_read_b32 v80, a32
	v_accvgpr_read_b32 v81, a33
	v_accvgpr_read_b32 v82, a34
	v_accvgpr_read_b32 v83, a35
	v_accvgpr_read_b32 v84, a36
	v_accvgpr_read_b32 v85, a37
	v_accvgpr_read_b32 v86, a38
	v_accvgpr_read_b32 v87, a39
	v_accvgpr_read_b32 v88, a40
	v_accvgpr_read_b32 v89, a41
	v_accvgpr_read_b32 v90, a42
	v_accvgpr_read_b32 v91, a43
	v_accvgpr_read_b32 v92, a44
	v_accvgpr_read_b32 v93, a45
	v_accvgpr_read_b32 v94, a46
	v_accvgpr_read_b32 v95, a47
	s_waitcnt vmcnt(7)
	v_lshlrev_b32 v136, 16, v120
	v_add_f32 v80, v80, v136
	s_waitcnt vmcnt(3)
	v_lshlrev_b32 v136, 16, v128
	v_add_f32 v80, v80, v136
	v_and_b32 v136, 0xffff0000, v120
	v_add_f32 v81, v81, v136
	v_and_b32 v136, 0xffff0000, v128
	v_add_f32 v81, v81, v136
	v_lshlrev_b32 v136, 16, v121
	v_add_f32 v82, v82, v136
	v_lshlrev_b32 v136, 16, v129
	v_add_f32 v82, v82, v136
	v_and_b32 v136, 0xffff0000, v121
	v_add_f32 v83, v83, v136
	v_and_b32 v136, 0xffff0000, v129
	v_add_f32 v83, v83, v136
	v_lshlrev_b32 v136, 16, v122
	v_add_f32 v84, v84, v136
	s_waitcnt vmcnt(2)
	v_lshlrev_b32 v136, 16, v130
	v_add_f32 v84, v84, v136
	v_and_b32 v136, 0xffff0000, v122
	v_add_f32 v85, v85, v136
	v_and_b32 v136, 0xffff0000, v130
	v_add_f32 v85, v85, v136
	v_lshlrev_b32 v136, 16, v123
	v_add_f32 v86, v86, v136
	v_lshlrev_b32 v136, 16, v131
	v_add_f32 v86, v86, v136
	v_and_b32 v136, 0xffff0000, v123
	v_add_f32 v87, v87, v136
	v_and_b32 v136, 0xffff0000, v131
	v_add_f32 v87, v87, v136
	v_lshlrev_b32 v136, 16, v124
	v_add_f32 v88, v88, v136
	s_waitcnt vmcnt(1)
	v_lshlrev_b32 v136, 16, v132
	v_add_f32 v88, v88, v136
	v_and_b32 v136, 0xffff0000, v124
	v_add_f32 v89, v89, v136
	v_and_b32 v136, 0xffff0000, v132
	v_add_f32 v89, v89, v136
	v_lshlrev_b32 v136, 16, v125
	v_add_f32 v90, v90, v136
	v_lshlrev_b32 v136, 16, v133
	v_add_f32 v90, v90, v136
	v_and_b32 v136, 0xffff0000, v125
	v_add_f32 v91, v91, v136
	v_and_b32 v136, 0xffff0000, v133
	v_add_f32 v91, v91, v136
	v_lshlrev_b32 v136, 16, v126
	v_add_f32 v92, v92, v136
	s_waitcnt vmcnt(0)
	v_lshlrev_b32 v136, 16, v134
	v_add_f32 v92, v92, v136
	v_and_b32 v136, 0xffff0000, v126
	v_add_f32 v93, v93, v136
	v_and_b32 v136, 0xffff0000, v134
	v_add_f32 v93, v93, v136
	v_lshlrev_b32 v136, 16, v127
	v_add_f32 v94, v94, v136
	v_lshlrev_b32 v136, 16, v135
	v_add_f32 v94, v94, v136
	v_and_b32 v136, 0xffff0000, v127
	v_add_f32 v95, v95, v136
	v_and_b32 v136, 0xffff0000, v135
	v_add_f32 v95, v95, v136
	s_add_u32 s23, s43, 0
	v_permlane16_swap_b32 v80, v88
	v_permlane16_swap_b32 v81, v89
	v_permlane16_swap_b32 v82, v90
	v_permlane16_swap_b32 v83, v91
	v_permlane16_swap_b32 v84, v92
	v_permlane16_swap_b32 v85, v93
	v_permlane16_swap_b32 v86, v94
	v_permlane16_swap_b32 v87, v95
	v_mov_b32 v128, v80
	v_mov_b32 v129, v81
	v_mov_b32 v130, v82
	v_mov_b32 v131, v83
	v_mov_b32_dpp v80, v84 row_ror:8 row_mask:0xf bank_mask:0xc
	v_mov_b32_dpp v81, v85 row_ror:8 row_mask:0xf bank_mask:0xc
	v_mov_b32_dpp v82, v86 row_ror:8 row_mask:0xf bank_mask:0xc
	v_mov_b32_dpp v83, v87 row_ror:8 row_mask:0xf bank_mask:0xc
	v_mov_b32_dpp v84, v128 row_ror:8 row_mask:0xf bank_mask:0x3
	v_mov_b32_dpp v85, v129 row_ror:8 row_mask:0xf bank_mask:0x3
	v_mov_b32_dpp v86, v130 row_ror:8 row_mask:0xf bank_mask:0x3
	v_mov_b32_dpp v87, v131 row_ror:8 row_mask:0xf bank_mask:0x3
	v_mov_b32 v128, v88
	v_mov_b32 v129, v89
	v_mov_b32 v130, v90
	v_mov_b32 v131, v91
	v_mov_b32_dpp v88, v92 row_ror:8 row_mask:0xf bank_mask:0xc
	v_mov_b32_dpp v89, v93 row_ror:8 row_mask:0xf bank_mask:0xc
	v_mov_b32_dpp v90, v94 row_ror:8 row_mask:0xf bank_mask:0xc
	v_mov_b32_dpp v91, v95 row_ror:8 row_mask:0xf bank_mask:0xc
	v_mov_b32_dpp v92, v128 row_ror:8 row_mask:0xf bank_mask:0x3
	v_mov_b32_dpp v93, v129 row_ror:8 row_mask:0xf bank_mask:0x3
	v_mov_b32_dpp v94, v130 row_ror:8 row_mask:0xf bank_mask:0x3
	v_mov_b32_dpp v95, v131 row_ror:8 row_mask:0xf bank_mask:0x3
	buffer_store_dwordx4 v[80:83], v138, s[8:11], s23 offen offset:128 sc1
	s_add_u32 s23, s23, 18432
	buffer_store_dwordx4 v[84:87], v138, s[8:11], s23 offen offset:128 sc1
	s_add_u32 s23, s23, 18432
	buffer_store_dwordx4 v[88:91], v138, s[8:11], s23 offen offset:128 sc1
	s_add_u32 s23, s23, 18432
	buffer_store_dwordx4 v[92:95], v138, s[8:11], s23 offen offset:128 sc1
	s_mov_b32 s23, 36864
	buffer_load_dwordx2 v[128:129], v140, s[36:39], s23 offen offset:64
	buffer_load_dwordx2 v[130:131], v140, s[36:39], s23 offen offset:80
	buffer_load_dwordx2 v[132:133], v140, s[36:39], s23 offen offset:96
	buffer_load_dwordx2 v[134:135], v140, s[36:39], s23 offen offset:112
	v_accvgpr_read_b32 v100, a48
	v_accvgpr_read_b32 v101, a49
	v_accvgpr_read_b32 v102, a50
	v_accvgpr_read_b32 v103, a51
	v_accvgpr_read_b32 v104, a52
	v_accvgpr_read_b32 v105, a53
	v_accvgpr_read_b32 v106, a54
	v_accvgpr_read_b32 v107, a55
	v_accvgpr_read_b32 v108, a56
	v_accvgpr_read_b32 v109, a57
	v_accvgpr_read_b32 v110, a58
	v_accvgpr_read_b32 v111, a59
	v_accvgpr_read_b32 v112, a60
	v_accvgpr_read_b32 v113, a61
	v_accvgpr_read_b32 v114, a62
	v_accvgpr_read_b32 v115, a63
	v_lshlrev_b32 v136, 16, v120
	v_add_f32 v100, v100, v136
	s_waitcnt vmcnt(3)
	v_lshlrev_b32 v136, 16, v128
	v_add_f32 v100, v100, v136
	v_and_b32 v136, 0xffff0000, v120
	v_add_f32 v101, v101, v136
	v_and_b32 v136, 0xffff0000, v128
	v_add_f32 v101, v101, v136
	v_lshlrev_b32 v136, 16, v121
	v_add_f32 v102, v102, v136
	v_lshlrev_b32 v136, 16, v129
	v_add_f32 v102, v102, v136
	v_and_b32 v136, 0xffff0000, v121
	v_add_f32 v103, v103, v136
	v_and_b32 v136, 0xffff0000, v129
	v_add_f32 v103, v103, v136
	v_lshlrev_b32 v136, 16, v122
	v_add_f32 v104, v104, v136
	s_waitcnt vmcnt(2)
	v_lshlrev_b32 v136, 16, v130
	v_add_f32 v104, v104, v136
	v_and_b32 v136, 0xffff0000, v122
	v_add_f32 v105, v105, v136
	v_and_b32 v136, 0xffff0000, v130
	v_add_f32 v105, v105, v136
	v_lshlrev_b32 v136, 16, v123
	v_add_f32 v106, v106, v136
	v_lshlrev_b32 v136, 16, v131
	v_add_f32 v106, v106, v136
	v_and_b32 v136, 0xffff0000, v123
	v_add_f32 v107, v107, v136
	v_and_b32 v136, 0xffff0000, v131
	v_add_f32 v107, v107, v136
	v_lshlrev_b32 v136, 16, v124
	v_add_f32 v108, v108, v136
	s_waitcnt vmcnt(1)
	v_lshlrev_b32 v136, 16, v132
	v_add_f32 v108, v108, v136
	v_and_b32 v136, 0xffff0000, v124
	v_add_f32 v109, v109, v136
	v_and_b32 v136, 0xffff0000, v132
	v_add_f32 v109, v109, v136
	v_lshlrev_b32 v136, 16, v125
	v_add_f32 v110, v110, v136
	v_lshlrev_b32 v136, 16, v133
	v_add_f32 v110, v110, v136
	v_and_b32 v136, 0xffff0000, v125
	v_add_f32 v111, v111, v136
	v_and_b32 v136, 0xffff0000, v133
	v_add_f32 v111, v111, v136
	v_lshlrev_b32 v136, 16, v126
	v_add_f32 v112, v112, v136
	s_waitcnt vmcnt(0)
	v_lshlrev_b32 v136, 16, v134
	v_add_f32 v112, v112, v136
	v_and_b32 v136, 0xffff0000, v126
	v_add_f32 v113, v113, v136
	v_and_b32 v136, 0xffff0000, v134
	v_add_f32 v113, v113, v136
	v_lshlrev_b32 v136, 16, v127
	v_add_f32 v114, v114, v136
	v_lshlrev_b32 v136, 16, v135
	v_add_f32 v114, v114, v136
	v_and_b32 v136, 0xffff0000, v127
	v_add_f32 v115, v115, v136
	v_and_b32 v136, 0xffff0000, v135
	v_add_f32 v115, v115, v136
	s_add_u32 s23, s43, 73728
	v_permlane16_swap_b32 v100, v108
	v_permlane16_swap_b32 v101, v109
	v_permlane16_swap_b32 v102, v110
	v_permlane16_swap_b32 v103, v111
	v_permlane16_swap_b32 v104, v112
	v_permlane16_swap_b32 v105, v113
	v_permlane16_swap_b32 v106, v114
	v_permlane16_swap_b32 v107, v115
	v_mov_b32 v128, v100
	v_mov_b32 v129, v101
	v_mov_b32 v130, v102
	v_mov_b32 v131, v103
	v_mov_b32_dpp v100, v104 row_ror:8 row_mask:0xf bank_mask:0xc
	v_mov_b32_dpp v101, v105 row_ror:8 row_mask:0xf bank_mask:0xc
	v_mov_b32_dpp v102, v106 row_ror:8 row_mask:0xf bank_mask:0xc
	v_mov_b32_dpp v103, v107 row_ror:8 row_mask:0xf bank_mask:0xc
	v_mov_b32_dpp v104, v128 row_ror:8 row_mask:0xf bank_mask:0x3
	v_mov_b32_dpp v105, v129 row_ror:8 row_mask:0xf bank_mask:0x3
	v_mov_b32_dpp v106, v130 row_ror:8 row_mask:0xf bank_mask:0x3
	v_mov_b32_dpp v107, v131 row_ror:8 row_mask:0xf bank_mask:0x3
	v_mov_b32 v128, v108
	v_mov_b32 v129, v109
	v_mov_b32 v130, v110
	v_mov_b32 v131, v111
	v_mov_b32_dpp v108, v112 row_ror:8 row_mask:0xf bank_mask:0xc
	v_mov_b32_dpp v109, v113 row_ror:8 row_mask:0xf bank_mask:0xc
	v_mov_b32_dpp v110, v114 row_ror:8 row_mask:0xf bank_mask:0xc
	v_mov_b32_dpp v111, v115 row_ror:8 row_mask:0xf bank_mask:0xc
	v_mov_b32_dpp v112, v128 row_ror:8 row_mask:0xf bank_mask:0x3
	v_mov_b32_dpp v113, v129 row_ror:8 row_mask:0xf bank_mask:0x3
	v_mov_b32_dpp v114, v130 row_ror:8 row_mask:0xf bank_mask:0x3
	v_mov_b32_dpp v115, v131 row_ror:8 row_mask:0xf bank_mask:0x3
	buffer_store_dwordx4 v[100:103], v138, s[8:11], s23 offen offset:128 sc1
	s_add_u32 s23, s23, 18432
	buffer_store_dwordx4 v[104:107], v138, s[8:11], s23 offen offset:128 sc1
	s_add_u32 s23, s23, 18432
	buffer_store_dwordx4 v[108:111], v138, s[8:11], s23 offen offset:128 sc1
	s_add_u32 s23, s23, 18432
	buffer_store_dwordx4 v[112:115], v138, s[8:11], s23 offen offset:128 sc1
	buffer_load_dwordx2 v[120:121], v14, s[32:35], 0 offen offset:128
	buffer_load_dwordx2 v[122:123], v14, s[32:35], 0 offen offset:144
	buffer_load_dwordx2 v[124:125], v14, s[32:35], 0 offen offset:160
	buffer_load_dwordx2 v[126:127], v14, s[32:35], 0 offen offset:176
	s_mov_b32 s23, 0
	buffer_load_dwordx2 v[128:129], v140, s[36:39], s23 offen offset:128
	buffer_load_dwordx2 v[130:131], v140, s[36:39], s23 offen offset:144
	buffer_load_dwordx2 v[132:133], v140, s[36:39], s23 offen offset:160
	buffer_load_dwordx2 v[134:135], v140, s[36:39], s23 offen offset:176
	v_accvgpr_read_b32 v80, a64
	v_accvgpr_read_b32 v81, a65
	v_accvgpr_read_b32 v82, a66
	v_accvgpr_read_b32 v83, a67
	v_accvgpr_read_b32 v84, a68
	v_accvgpr_read_b32 v85, a69
	v_accvgpr_read_b32 v86, a70
	v_accvgpr_read_b32 v87, a71
	v_accvgpr_read_b32 v88, a72
	v_accvgpr_read_b32 v89, a73
	v_accvgpr_read_b32 v90, a74
	v_accvgpr_read_b32 v91, a75
	v_accvgpr_read_b32 v92, a76
	v_accvgpr_read_b32 v93, a77
	v_accvgpr_read_b32 v94, a78
	v_accvgpr_read_b32 v95, a79
	s_waitcnt vmcnt(7)
	v_lshlrev_b32 v136, 16, v120
	v_add_f32 v80, v80, v136
	s_waitcnt vmcnt(3)
	v_lshlrev_b32 v136, 16, v128
	v_add_f32 v80, v80, v136
	v_and_b32 v136, 0xffff0000, v120
	v_add_f32 v81, v81, v136
	v_and_b32 v136, 0xffff0000, v128
	v_add_f32 v81, v81, v136
	v_lshlrev_b32 v136, 16, v121
	v_add_f32 v82, v82, v136
	v_lshlrev_b32 v136, 16, v129
	v_add_f32 v82, v82, v136
	v_and_b32 v136, 0xffff0000, v121
	v_add_f32 v83, v83, v136
	v_and_b32 v136, 0xffff0000, v129
	v_add_f32 v83, v83, v136
	v_lshlrev_b32 v136, 16, v122
	v_add_f32 v84, v84, v136
	s_waitcnt vmcnt(2)
	v_lshlrev_b32 v136, 16, v130
	v_add_f32 v84, v84, v136
	v_and_b32 v136, 0xffff0000, v122
	v_add_f32 v85, v85, v136
	v_and_b32 v136, 0xffff0000, v130
	v_add_f32 v85, v85, v136
	v_lshlrev_b32 v136, 16, v123
	v_add_f32 v86, v86, v136
	v_lshlrev_b32 v136, 16, v131
	v_add_f32 v86, v86, v136
	v_and_b32 v136, 0xffff0000, v123
	v_add_f32 v87, v87, v136
	v_and_b32 v136, 0xffff0000, v131
	v_add_f32 v87, v87, v136
	v_lshlrev_b32 v136, 16, v124
	v_add_f32 v88, v88, v136
	s_waitcnt vmcnt(1)
	v_lshlrev_b32 v136, 16, v132
	v_add_f32 v88, v88, v136
	v_and_b32 v136, 0xffff0000, v124
	v_add_f32 v89, v89, v136
	v_and_b32 v136, 0xffff0000, v132
	v_add_f32 v89, v89, v136
	v_lshlrev_b32 v136, 16, v125
	v_add_f32 v90, v90, v136
	v_lshlrev_b32 v136, 16, v133
	v_add_f32 v90, v90, v136
	v_and_b32 v136, 0xffff0000, v125
	v_add_f32 v91, v91, v136
	v_and_b32 v136, 0xffff0000, v133
	v_add_f32 v91, v91, v136
	v_lshlrev_b32 v136, 16, v126
	v_add_f32 v92, v92, v136
	s_waitcnt vmcnt(0)
	v_lshlrev_b32 v136, 16, v134
	v_add_f32 v92, v92, v136
	v_and_b32 v136, 0xffff0000, v126
	v_add_f32 v93, v93, v136
	v_and_b32 v136, 0xffff0000, v134
	v_add_f32 v93, v93, v136
	v_lshlrev_b32 v136, 16, v127
	v_add_f32 v94, v94, v136
	v_lshlrev_b32 v136, 16, v135
	v_add_f32 v94, v94, v136
	v_and_b32 v136, 0xffff0000, v127
	v_add_f32 v95, v95, v136
	v_and_b32 v136, 0xffff0000, v135
	v_add_f32 v95, v95, v136
	s_add_u32 s23, s43, 0
	v_permlane16_swap_b32 v80, v88
	v_permlane16_swap_b32 v81, v89
	v_permlane16_swap_b32 v82, v90
	v_permlane16_swap_b32 v83, v91
	v_permlane16_swap_b32 v84, v92
	v_permlane16_swap_b32 v85, v93
	v_permlane16_swap_b32 v86, v94
	v_permlane16_swap_b32 v87, v95
	v_mov_b32 v128, v80
	v_mov_b32 v129, v81
	v_mov_b32 v130, v82
	v_mov_b32 v131, v83
	v_mov_b32_dpp v80, v84 row_ror:8 row_mask:0xf bank_mask:0xc
	v_mov_b32_dpp v81, v85 row_ror:8 row_mask:0xf bank_mask:0xc
	v_mov_b32_dpp v82, v86 row_ror:8 row_mask:0xf bank_mask:0xc
	v_mov_b32_dpp v83, v87 row_ror:8 row_mask:0xf bank_mask:0xc
	v_mov_b32_dpp v84, v128 row_ror:8 row_mask:0xf bank_mask:0x3
	v_mov_b32_dpp v85, v129 row_ror:8 row_mask:0xf bank_mask:0x3
	v_mov_b32_dpp v86, v130 row_ror:8 row_mask:0xf bank_mask:0x3
	v_mov_b32_dpp v87, v131 row_ror:8 row_mask:0xf bank_mask:0x3
	v_mov_b32 v128, v88
	v_mov_b32 v129, v89
	v_mov_b32 v130, v90
	v_mov_b32 v131, v91
	v_mov_b32_dpp v88, v92 row_ror:8 row_mask:0xf bank_mask:0xc
	v_mov_b32_dpp v89, v93 row_ror:8 row_mask:0xf bank_mask:0xc
	v_mov_b32_dpp v90, v94 row_ror:8 row_mask:0xf bank_mask:0xc
	v_mov_b32_dpp v91, v95 row_ror:8 row_mask:0xf bank_mask:0xc
	v_mov_b32_dpp v92, v128 row_ror:8 row_mask:0xf bank_mask:0x3
	v_mov_b32_dpp v93, v129 row_ror:8 row_mask:0xf bank_mask:0x3
	v_mov_b32_dpp v94, v130 row_ror:8 row_mask:0xf bank_mask:0x3
	v_mov_b32_dpp v95, v131 row_ror:8 row_mask:0xf bank_mask:0x3
	buffer_store_dwordx4 v[80:83], v138, s[8:11], s23 offen offset:256 sc1
	s_add_u32 s23, s23, 18432
	buffer_store_dwordx4 v[84:87], v138, s[8:11], s23 offen offset:256 sc1
	s_add_u32 s23, s23, 18432
	buffer_store_dwordx4 v[88:91], v138, s[8:11], s23 offen offset:256 sc1
	s_add_u32 s23, s23, 18432
	buffer_store_dwordx4 v[92:95], v138, s[8:11], s23 offen offset:256 sc1
	s_mov_b32 s23, 36864
	buffer_load_dwordx2 v[128:129], v140, s[36:39], s23 offen offset:128
	buffer_load_dwordx2 v[130:131], v140, s[36:39], s23 offen offset:144
	buffer_load_dwordx2 v[132:133], v140, s[36:39], s23 offen offset:160
	buffer_load_dwordx2 v[134:135], v140, s[36:39], s23 offen offset:176
	v_accvgpr_read_b32 v100, a80
	v_accvgpr_read_b32 v101, a81
	v_accvgpr_read_b32 v102, a82
	v_accvgpr_read_b32 v103, a83
	v_accvgpr_read_b32 v104, a84
	v_accvgpr_read_b32 v105, a85
	v_accvgpr_read_b32 v106, a86
	v_accvgpr_read_b32 v107, a87
	v_accvgpr_read_b32 v108, a88
	v_accvgpr_read_b32 v109, a89
	v_accvgpr_read_b32 v110, a90
	v_accvgpr_read_b32 v111, a91
	v_accvgpr_read_b32 v112, a92
	v_accvgpr_read_b32 v113, a93
	v_accvgpr_read_b32 v114, a94
	v_accvgpr_read_b32 v115, a95
	v_lshlrev_b32 v136, 16, v120
	v_add_f32 v100, v100, v136
	s_waitcnt vmcnt(3)
	v_lshlrev_b32 v136, 16, v128
	v_add_f32 v100, v100, v136
	v_and_b32 v136, 0xffff0000, v120
	v_add_f32 v101, v101, v136
	v_and_b32 v136, 0xffff0000, v128
	v_add_f32 v101, v101, v136
	v_lshlrev_b32 v136, 16, v121
	v_add_f32 v102, v102, v136
	v_lshlrev_b32 v136, 16, v129
	v_add_f32 v102, v102, v136
	v_and_b32 v136, 0xffff0000, v121
	v_add_f32 v103, v103, v136
	v_and_b32 v136, 0xffff0000, v129
	v_add_f32 v103, v103, v136
	v_lshlrev_b32 v136, 16, v122
	v_add_f32 v104, v104, v136
	s_waitcnt vmcnt(2)
	v_lshlrev_b32 v136, 16, v130
	v_add_f32 v104, v104, v136
	v_and_b32 v136, 0xffff0000, v122
	v_add_f32 v105, v105, v136
	v_and_b32 v136, 0xffff0000, v130
	v_add_f32 v105, v105, v136
	v_lshlrev_b32 v136, 16, v123
	v_add_f32 v106, v106, v136
	v_lshlrev_b32 v136, 16, v131
	v_add_f32 v106, v106, v136
	v_and_b32 v136, 0xffff0000, v123
	v_add_f32 v107, v107, v136
	v_and_b32 v136, 0xffff0000, v131
	v_add_f32 v107, v107, v136
	v_lshlrev_b32 v136, 16, v124
	v_add_f32 v108, v108, v136
	s_waitcnt vmcnt(1)
	v_lshlrev_b32 v136, 16, v132
	v_add_f32 v108, v108, v136
	v_and_b32 v136, 0xffff0000, v124
	v_add_f32 v109, v109, v136
	v_and_b32 v136, 0xffff0000, v132
	v_add_f32 v109, v109, v136
	v_lshlrev_b32 v136, 16, v125
	v_add_f32 v110, v110, v136
	v_lshlrev_b32 v136, 16, v133
	v_add_f32 v110, v110, v136
	v_and_b32 v136, 0xffff0000, v125
	v_add_f32 v111, v111, v136
	v_and_b32 v136, 0xffff0000, v133
	v_add_f32 v111, v111, v136
	v_lshlrev_b32 v136, 16, v126
	v_add_f32 v112, v112, v136
	s_waitcnt vmcnt(0)
	v_lshlrev_b32 v136, 16, v134
	v_add_f32 v112, v112, v136
	v_and_b32 v136, 0xffff0000, v126
	v_add_f32 v113, v113, v136
	v_and_b32 v136, 0xffff0000, v134
	v_add_f32 v113, v113, v136
	v_lshlrev_b32 v136, 16, v127
	v_add_f32 v114, v114, v136
	v_lshlrev_b32 v136, 16, v135
	v_add_f32 v114, v114, v136
	v_and_b32 v136, 0xffff0000, v127
	v_add_f32 v115, v115, v136
	v_and_b32 v136, 0xffff0000, v135
	v_add_f32 v115, v115, v136
	s_add_u32 s23, s43, 73728
	v_permlane16_swap_b32 v100, v108
	v_permlane16_swap_b32 v101, v109
	v_permlane16_swap_b32 v102, v110
	v_permlane16_swap_b32 v103, v111
	v_permlane16_swap_b32 v104, v112
	v_permlane16_swap_b32 v105, v113
	v_permlane16_swap_b32 v106, v114
	v_permlane16_swap_b32 v107, v115
	v_mov_b32 v128, v100
	v_mov_b32 v129, v101
	v_mov_b32 v130, v102
	v_mov_b32 v131, v103
	v_mov_b32_dpp v100, v104 row_ror:8 row_mask:0xf bank_mask:0xc
	v_mov_b32_dpp v101, v105 row_ror:8 row_mask:0xf bank_mask:0xc
	v_mov_b32_dpp v102, v106 row_ror:8 row_mask:0xf bank_mask:0xc
	v_mov_b32_dpp v103, v107 row_ror:8 row_mask:0xf bank_mask:0xc
	v_mov_b32_dpp v104, v128 row_ror:8 row_mask:0xf bank_mask:0x3
	v_mov_b32_dpp v105, v129 row_ror:8 row_mask:0xf bank_mask:0x3
	v_mov_b32_dpp v106, v130 row_ror:8 row_mask:0xf bank_mask:0x3
	v_mov_b32_dpp v107, v131 row_ror:8 row_mask:0xf bank_mask:0x3
	v_mov_b32 v128, v108
	v_mov_b32 v129, v109
	v_mov_b32 v130, v110
	v_mov_b32 v131, v111
	v_mov_b32_dpp v108, v112 row_ror:8 row_mask:0xf bank_mask:0xc
	v_mov_b32_dpp v109, v113 row_ror:8 row_mask:0xf bank_mask:0xc
	v_mov_b32_dpp v110, v114 row_ror:8 row_mask:0xf bank_mask:0xc
	v_mov_b32_dpp v111, v115 row_ror:8 row_mask:0xf bank_mask:0xc
	v_mov_b32_dpp v112, v128 row_ror:8 row_mask:0xf bank_mask:0x3
	v_mov_b32_dpp v113, v129 row_ror:8 row_mask:0xf bank_mask:0x3
	v_mov_b32_dpp v114, v130 row_ror:8 row_mask:0xf bank_mask:0x3
	v_mov_b32_dpp v115, v131 row_ror:8 row_mask:0xf bank_mask:0x3
	buffer_store_dwordx4 v[100:103], v138, s[8:11], s23 offen offset:256 sc1
	s_add_u32 s23, s23, 18432
	buffer_store_dwordx4 v[104:107], v138, s[8:11], s23 offen offset:256 sc1
	s_add_u32 s23, s23, 18432
	buffer_store_dwordx4 v[108:111], v138, s[8:11], s23 offen offset:256 sc1
	s_add_u32 s23, s23, 18432
	buffer_store_dwordx4 v[112:115], v138, s[8:11], s23 offen offset:256 sc1
	s_add_u32 s93, s93, 32
	s_mov_b32 s100, 0x10000
	s_waitcnt vmcnt(0)
	s_barrier
	s_cmp_lg_u32 s4, 0
	s_cbranch_scc1 main_kernel_sig2
	s_mov_b64 exec, 1
	v_mov_b32 v13, s100
	v_mov_b32 v14, s93
	buffer_atomic_add v13, v14, s[96:99], 0 offen sc1
	s_mov_b64 exec, -1
main_kernel_sig2:
main_kernel_phaseb:
	s_cmp_ge_u32 s89, 26
	s_cbranch_scc1 main_kernel_wexit
	s_cmp_ge_u32 s89, 18
	s_cbranch_scc1 main_kernel_attn
	s_load_dwordx2 s[12:13], s[0:1], 40
	s_load_dwordx2 s[44:45], s[0:1], 96
	s_mov_b32 s14, 4718592
	s_mov_b32 s15, 0x20000
	s_mov_b32 s46, 2359296
	s_mov_b32 s47, 0x20000
	s_lshl_b32 s16, s89, 6
	v_lshrrev_b32 v8, 2, v0
	v_mul_u32_u24 v8, 1152, v8
	v_and_b32 v9, 3, v0
	v_lshl_add_u32 v6, v9, 4, v8
	v_lshrrev_b32 v8, 4, v0
	v_bfe_u32 v10, v0, 2, 2
	v_lshl_add_u32 v8, v8, 3, v10
	v_lshlrev_b32 v8, 6, v8
	v_lshl_add_u32 v8, v9, 3, v8
	s_lshl_b32 s21, s4, 15
	v_add_u32 v7, s21, v8
	v_lshrrev_b32 v8, 4, v0
	v_and_b32 v9, 15, v0
	v_lshlrev_b32 v10, 4, v9
	v_lshl_add_u32 v1, v8, 9, v10
	s_and_b32 s21, s4, 1
	s_lshl_b32 s21, s21, 4
	v_lshlrev_b32 v8, 2, v8
	v_add_u32 v8, s21, v8
	v_mul_u32_u24 v10, 2304, v9
	v_lshl_add_u32 v2, v8, 2, v10
	v_mul_u32_u24 v10, 1152, v9
	v_lshl_add_u32 v3, v8, 1, v10
	v_lshlrev_b32 v8, 4, v0
	s_lshl_b32 s21, s4, 11
	v_add_u32 v4, s21, v8
	s_and_b32 s21, s4, 1
	s_lshl_b32 s21, s21, 10
	v_add_u32 v5, s21, v8
	s_waitcnt lgkmcnt(0)
	s_lshl_b32 s21, s4, 10
	s_add_u32 s21, s21, 0
	s_mul_i32 s21, s21, 1152
	s_add_u32 s21, s21, s16
	s_lshl_b32 s22, s4, 15
	s_mov_b32 m0, s22
	s_nop 0
	buffer_load_dwordx4 v6, s[12:15], s21 offen lds
	s_add_u32 s21, s21, 18432
	s_add_u32 s22, s22, 1024
	s_mov_b32 m0, s22
	s_nop 0
	buffer_load_dwordx4 v6, s[12:15], s21 offen lds
	s_add_u32 s21, s21, 18432
	s_add_u32 s22, s22, 1024
	s_mov_b32 m0, s22
	s_nop 0
	buffer_load_dwordx4 v6, s[12:15], s21 offen lds
	s_add_u32 s21, s21, 18432
	s_add_u32 s22, s22, 1024
	s_mov_b32 m0, s22
	s_nop 0
	buffer_load_dwordx4 v6, s[12:15], s21 offen lds
	s_add_u32 s21, s21, 18432
	s_add_u32 s22, s22, 1024
	s_mov_b32 m0, s22
	s_nop 0
	buffer_load_dwordx4 v6, s[12:15], s21 offen lds
	s_add_u32 s21, s21, 18432
	s_add_u32 s22, s22, 1024
	s_mov_b32 m0, s22
	s_nop 0
	buffer_load_dwordx4 v6, s[12:15], s21 offen lds
	s_add_u32 s21, s21, 18432
	s_add_u32 s22, s22, 1024
	s_mov_b32 m0, s22
	s_nop 0
	buffer_load_dwordx4 v6, s[12:15], s21 offen lds
	s_add_u32 s21, s21, 18432
	s_add_u32 s22, s22, 1024
	s_mov_b32 m0, s22
	s_nop 0
	buffer_load_dwordx4 v6, s[12:15], s21 offen lds
	s_add_u32 s21, s21, 18432
	s_add_u32 s22, s22, 1024
	s_mov_b32 m0, s22
	s_nop 0
	buffer_load_dwordx4 v6, s[12:15], s21 offen lds
	s_add_u32 s21, s21, 18432
	s_add_u32 s22, s22, 1024
	s_mov_b32 m0, s22
	s_nop 0
	buffer_load_dwordx4 v6, s[12:15], s21 offen lds
	s_add_u32 s21, s21, 18432
	s_add_u32 s22, s22, 1024
	s_mov_b32 m0, s22
	s_nop 0
	buffer_load_dwordx4 v6, s[12:15], s21 offen lds
	s_add_u32 s21, s21, 18432
	s_add_u32 s22, s22, 1024
	s_mov_b32 m0, s22
	s_nop 0
	buffer_load_dwordx4 v6, s[12:15], s21 offen lds
	s_add_u32 s21, s21, 18432
	s_add_u32 s22, s22, 1024
	s_mov_b32 m0, s22
	s_nop 0
	buffer_load_dwordx4 v6, s[12:15], s21 offen lds
	s_add_u32 s21, s21, 18432
	s_add_u32 s22, s22, 1024
	s_mov_b32 m0, s22
	s_nop 0
	buffer_load_dwordx4 v6, s[12:15], s21 offen lds
	s_add_u32 s21, s21, 18432
	s_add_u32 s22, s22, 1024
	s_mov_b32 m0, s22
	s_nop 0
	buffer_load_dwordx4 v6, s[12:15], s21 offen lds
	s_add_u32 s21, s21, 18432
	s_add_u32 s22, s22, 1024
	s_mov_b32 m0, s22
	s_nop 0
	buffer_load_dwordx4 v6, s[12:15], s21 offen lds
	s_add_u32 s21, s21, 18432
	s_add_u32 s22, s22, 1024
	s_mov_b32 m0, s22
	s_nop 0
	buffer_load_dwordx4 v6, s[12:15], s21 offen lds
	s_add_u32 s21, s21, 18432
	s_add_u32 s22, s22, 1024
	s_mov_b32 m0, s22
	s_nop 0
	buffer_load_dwordx4 v6, s[12:15], s21 offen lds
	s_add_u32 s21, s21, 18432
	s_add_u32 s22, s22, 1024
	s_mov_b32 m0, s22
	s_nop 0
	buffer_load_dwordx4 v6, s[12:15], s21 offen lds
	s_add_u32 s21, s21, 18432
	s_add_u32 s22, s22, 1024
	s_mov_b32 m0, s22
	s_nop 0
	buffer_load_dwordx4 v6, s[12:15], s21 offen lds
	s_add_u32 s21, s21, 18432
	s_add_u32 s22, s22, 1024
	s_mov_b32 m0, s22
	s_nop 0
	buffer_load_dwordx4 v6, s[12:15], s21 offen lds
	s_add_u32 s21, s21, 18432
	s_add_u32 s22, s22, 1024
	s_mov_b32 m0, s22
	s_nop 0
	buffer_load_dwordx4 v6, s[12:15], s21 offen lds
	s_add_u32 s21, s21, 18432
	s_add_u32 s22, s22, 1024
	s_mov_b32 m0, s22
	s_nop 0
	buffer_load_dwordx4 v6, s[12:15], s21 offen lds
	s_add_u32 s21, s21, 18432
	s_add_u32 s22, s22, 1024
	s_mov_b32 m0, s22
	s_nop 0
	buffer_load_dwordx4 v6, s[12:15], s21 offen lds
	s_add_u32 s21, s21, 18432
	s_add_u32 s22, s22, 1024
	s_mov_b32 m0, s22
	s_nop 0
	buffer_load_dwordx4 v6, s[12:15], s21 offen lds
	s_add_u32 s21, s21, 18432
	s_add_u32 s22, s22, 1024
	s_mov_b32 m0, s22
	s_nop 0
	buffer_load_dwordx4 v6, s[12:15], s21 offen lds
	s_add_u32 s21, s21, 18432
	s_add_u32 s22, s22, 1024
	s_mov_b32 m0, s22
	s_nop 0
	buffer_load_dwordx4 v6, s[12:15], s21 offen lds
	s_add_u32 s21, s21, 18432
	s_add_u32 s22, s22, 1024
	s_mov_b32 m0, s22
	s_nop 0
	buffer_load_dwordx4 v6, s[12:15], s21 offen lds
	s_add_u32 s21, s21, 18432
	s_add_u32 s22, s22, 1024
	s_mov_b32 m0, s22
	s_nop 0
	buffer_load_dwordx4 v6, s[12:15], s21 offen lds
	s_add_u32 s21, s21, 18432
	s_add_u32 s22, s22, 1024
	s_mov_b32 m0, s22
	s_nop 0
	buffer_load_dwordx4 v6, s[12:15], s21 offen lds
	s_add_u32 s21, s21, 18432
	s_add_u32 s22, s22, 1024
	s_mov_b32 m0, s22
	s_nop 0
	buffer_load_dwordx4 v6, s[12:15], s21 offen lds
	s_add_u32 s21, s21, 18432
	s_add_u32 s22, s22, 1024
	s_mov_b32 m0, s22
	s_nop 0
	buffer_load_dwordx4 v6, s[12:15], s21 offen lds
	s_waitcnt vmcnt(0)
	ds_read_b64_tr_b16 a[0:1], v7 offset:0
	ds_read_b64_tr_b16 a[2:3], v7 offset:256
	ds_read_b64_tr_b16 a[4:5], v7 offset:32
	ds_read_b64_tr_b16 a[6:7], v7 offset:288
	ds_read_b64_tr_b16 a[8:9], v7 offset:2048
	ds_read_b64_tr_b16 a[10:11], v7 offset:2304
	ds_read_b64_tr_b16 a[12:13], v7 offset:2080
	ds_read_b64_tr_b16 a[14:15], v7 offset:2336
	ds_read_b64_tr_b16 a[16:17], v7 offset:4096
	ds_read_b64_tr_b16 a[18:19], v7 offset:4352
	ds_read_b64_tr_b16 a[20:21], v7 offset:4128
	ds_read_b64_tr_b16 a[22:23], v7 offset:4384
	ds_read_b64_tr_b16 a[24:25], v7 offset:6144
	ds_read_b64_tr_b16 a[26:27], v7 offset:6400
	ds_read_b64_tr_b16 a[28:29], v7 offset:6176
	ds_read_b64_tr_b16 a[30:31], v7 offset:6432
	ds_read_b64_tr_b16 a[32:33], v7 offset:8192
	ds_read_b64_tr_b16 a[34:35], v7 offset:8448
	ds_read_b64_tr_b16 a[36:37], v7 offset:8224
	ds_read_b64_tr_b16 a[38:39], v7 offset:8480
	ds_read_b64_tr_b16 a[40:41], v7 offset:10240
	ds_read_b64_tr_b16 a[42:43], v7 offset:10496
	ds_read_b64_tr_b16 a[44:45], v7 offset:10272
	ds_read_b64_tr_b16 a[46:47], v7 offset:10528
	ds_read_b64_tr_b16 a[48:49], v7 offset:12288
	ds_read_b64_tr_b16 a[50:51], v7 offset:12544
	ds_read_b64_tr_b16 a[52:53], v7 offset:12320
	ds_read_b64_tr_b16 a[54:55], v7 offset:12576
	ds_read_b64_tr_b16 a[56:57], v7 offset:14336
	ds_read_b64_tr_b16 a[58:59], v7 offset:14592
	ds_read_b64_tr_b16 a[60:61], v7 offset:14368
	ds_read_b64_tr_b16 a[62:63], v7 offset:14624
	ds_read_b64_tr_b16 a[64:65], v7 offset:16384
	ds_read_b64_tr_b16 a[66:67], v7 offset:16640
	ds_read_b64_tr_b16 a[68:69], v7 offset:16416
	ds_read_b64_tr_b16 a[70:71], v7 offset:16672
	ds_read_b64_tr_b16 a[72:73], v7 offset:18432
	ds_read_b64_tr_b16 a[74:75], v7 offset:18688
	ds_read_b64_tr_b16 a[76:77], v7 offset:18464
	ds_read_b64_tr_b16 a[78:79], v7 offset:18720
	ds_read_b64_tr_b16 a[80:81], v7 offset:20480
	ds_read_b64_tr_b16 a[82:83], v7 offset:20736
	ds_read_b64_tr_b16 a[84:85], v7 offset:20512
	ds_read_b64_tr_b16 a[86:87], v7 offset:20768
	ds_read_b64_tr_b16 a[88:89], v7 offset:22528
	ds_read_b64_tr_b16 a[90:91], v7 offset:22784
	ds_read_b64_tr_b16 a[92:93], v7 offset:22560
	ds_read_b64_tr_b16 a[94:95], v7 offset:22816
	ds_read_b64_tr_b16 a[96:97], v7 offset:24576
	ds_read_b64_tr_b16 a[98:99], v7 offset:24832
	ds_read_b64_tr_b16 a[100:101], v7 offset:24608
	ds_read_b64_tr_b16 a[102:103], v7 offset:24864
	ds_read_b64_tr_b16 a[104:105], v7 offset:26624
	ds_read_b64_tr_b16 a[106:107], v7 offset:26880
	ds_read_b64_tr_b16 a[108:109], v7 offset:26656
	ds_read_b64_tr_b16 a[110:111], v7 offset:26912
	ds_read_b64_tr_b16 a[112:113], v7 offset:28672
	ds_read_b64_tr_b16 a[114:115], v7 offset:28928
	ds_read_b64_tr_b16 a[116:117], v7 offset:28704
	ds_read_b64_tr_b16 a[118:119], v7 offset:28960
	ds_read_b64_tr_b16 a[120:121], v7 offset:30720
	ds_read_b64_tr_b16 a[122:123], v7 offset:30976
	ds_read_b64_tr_b16 a[124:125], v7 offset:30752
	ds_read_b64_tr_b16 a[126:127], v7 offset:31008
	s_waitcnt lgkmcnt(0)
	s_lshl_b32 s21, s4, 10
	s_add_u32 s21, s21, 512
	s_mul_i32 s21, s21, 1152
	s_add_u32 s21, s21, s16
	s_lshl_b32 s22, s4, 15
	s_mov_b32 m0, s22
	s_nop 0
	buffer_load_dwordx4 v6, s[12:15], s21 offen lds
	s_add_u32 s21, s21, 18432
	s_add_u32 s22, s22, 1024
	s_mov_b32 m0, s22
	s_nop 0
	buffer_load_dwordx4 v6, s[12:15], s21 offen lds
	s_add_u32 s21, s21, 18432
	s_add_u32 s22, s22, 1024
	s_mov_b32 m0, s22
	s_nop 0
	buffer_load_dwordx4 v6, s[12:15], s21 offen lds
	s_add_u32 s21, s21, 18432
	s_add_u32 s22, s22, 1024
	s_mov_b32 m0, s22
	s_nop 0
	buffer_load_dwordx4 v6, s[12:15], s21 offen lds
	s_add_u32 s21, s21, 18432
	s_add_u32 s22, s22, 1024
	s_mov_b32 m0, s22
	s_nop 0
	buffer_load_dwordx4 v6, s[12:15], s21 offen lds
	s_add_u32 s21, s21, 18432
	s_add_u32 s22, s22, 1024
	s_mov_b32 m0, s22
	s_nop 0
	buffer_load_dwordx4 v6, s[12:15], s21 offen lds
	s_add_u32 s21, s21, 18432
	s_add_u32 s22, s22, 1024
	s_mov_b32 m0, s22
	s_nop 0
	buffer_load_dwordx4 v6, s[12:15], s21 offen lds
	s_add_u32 s21, s21, 18432
	s_add_u32 s22, s22, 1024
	s_mov_b32 m0, s22
	s_nop 0
	buffer_load_dwordx4 v6, s[12:15], s21 offen lds
	s_add_u32 s21, s21, 18432
	s_add_u32 s22, s22, 1024
	s_mov_b32 m0, s22
	s_nop 0
	buffer_load_dwordx4 v6, s[12:15], s21 offen lds
	s_add_u32 s21, s21, 18432
	s_add_u32 s22, s22, 1024
	s_mov_b32 m0, s22
	s_nop 0
	buffer_load_dwordx4 v6, s[12:15], s21 offen lds
	s_add_u32 s21, s21, 18432
	s_add_u32 s22, s22, 1024
	s_mov_b32 m0, s22
	s_nop 0
	buffer_load_dwordx4 v6, s[12:15], s21 offen lds
	s_add_u32 s21, s21, 18432
	s_add_u32 s22, s22, 1024
	s_mov_b32 m0, s22
	s_nop 0
	buffer_load_dwordx4 v6, s[12:15], s21 offen lds
	s_add_u32 s21, s21, 18432
	s_add_u32 s22, s22, 1024
	s_mov_b32 m0, s22
	s_nop 0
	buffer_load_dwordx4 v6, s[12:15], s21 offen lds
	s_add_u32 s21, s21, 18432
	s_add_u32 s22, s22, 1024
	s_mov_b32 m0, s22
	s_nop 0
	buffer_load_dwordx4 v6, s[12:15], s21 offen lds
	s_add_u32 s21, s21, 18432
	s_add_u32 s22, s22, 1024
	s_mov_b32 m0, s22
	s_nop 0
	buffer_load_dwordx4 v6, s[12:15], s21 offen lds
	s_add_u32 s21, s21, 18432
	s_add_u32 s22, s22, 1024
	s_mov_b32 m0, s22
	s_nop 0
	buffer_load_dwordx4 v6, s[12:15], s21 offen lds
	s_add_u32 s21, s21, 18432
	s_add_u32 s22, s22, 1024
	s_mov_b32 m0, s22
	s_nop 0
	buffer_load_dwordx4 v6, s[12:15], s21 offen lds
	s_add_u32 s21, s21, 18432
	s_add_u32 s22, s22, 1024
	s_mov_b32 m0, s22
	s_nop 0
	buffer_load_dwordx4 v6, s[12:15], s21 offen lds
	s_add_u32 s21, s21, 18432
	s_add_u32 s22, s22, 1024
	s_mov_b32 m0, s22
	s_nop 0
	buffer_load_dwordx4 v6, s[12:15], s21 offen lds
	s_add_u32 s21, s21, 18432
	s_add_u32 s22, s22, 1024
	s_mov_b32 m0, s22
	s_nop 0
	buffer_load_dwordx4 v6, s[12:15], s21 offen lds
	s_add_u32 s21, s21, 18432
	s_add_u32 s22, s22, 1024
	s_mov_b32 m0, s22
	s_nop 0
	buffer_load_dwordx4 v6, s[12:15], s21 offen lds
	s_add_u32 s21, s21, 18432
	s_add_u32 s22, s22, 1024
	s_mov_b32 m0, s22
	s_nop 0
	buffer_load_dwordx4 v6, s[12:15], s21 offen lds
	s_add_u32 s21, s21, 18432
	s_add_u32 s22, s22, 1024
	s_mov_b32 m0, s22
	s_nop 0
	buffer_load_dwordx4 v6, s[12:15], s21 offen lds
	s_add_u32 s21, s21, 18432
	s_add_u32 s22, s22, 1024
	s_mov_b32 m0, s22
	s_nop 0
	buffer_load_dwordx4 v6, s[12:15], s21 offen lds
	s_add_u32 s21, s21, 18432
	s_add_u32 s22, s22, 1024
	s_mov_b32 m0, s22
	s_nop 0
	buffer_load_dwordx4 v6, s[12:15], s21 offen lds
	s_add_u32 s21, s21, 18432
	s_add_u32 s22, s22, 1024
	s_mov_b32 m0, s22
	s_nop 0
	buffer_load_dwordx4 v6, s[12:15], s21 offen lds
	s_add_u32 s21, s21, 18432
	s_add_u32 s22, s22, 1024
	s_mov_b32 m0, s22
	s_nop 0
	buffer_load_dwordx4 v6, s[12:15], s21 offen lds
	s_add_u32 s21, s21, 18432
	s_add_u32 s22, s22, 1024
	s_mov_b32 m0, s22
	s_nop 0
	buffer_load_dwordx4 v6, s[12:15], s21 offen lds
	s_add_u32 s21, s21, 18432
	s_add_u32 s22, s22, 1024
	s_mov_b32 m0, s22
	s_nop 0
	buffer_load_dwordx4 v6, s[12:15], s21 offen lds
	s_add_u32 s21, s21, 18432
	s_add_u32 s22, s22, 1024
	s_mov_b32 m0, s22
	s_nop 0
	buffer_load_dwordx4 v6, s[12:15], s21 offen lds
	s_add_u32 s21, s21, 18432
	s_add_u32 s22, s22, 1024
	s_mov_b32 m0, s22
	s_nop 0
	buffer_load_dwordx4 v6, s[12:15], s21 offen lds
	s_add_u32 s21, s21, 18432
	s_add_u32 s22, s22, 1024
	s_mov_b32 m0, s22
	s_nop 0
	buffer_load_dwordx4 v6, s[12:15], s21 offen lds
	s_waitcnt vmcnt(0)
	ds_read_b64_tr_b16 a[128:129], v7 offset:0
	ds_read_b64_tr_b16 a[130:131], v7 offset:256
	ds_read_b64_tr_b16 a[132:133], v7 offset:32
	ds_read_b64_tr_b16 a[134:135], v7 offset:288
	ds_read_b64_tr_b16 a[136:137], v7 offset:2048
	ds_read_b64_tr_b16 a[138:139], v7 offset:2304
	ds_read_b64_tr_b16 a[140:141], v7 offset:2080
	ds_read_b64_tr_b16 a[142:143], v7 offset:2336
	ds_read_b64_tr_b16 a[144:145], v7 offset:4096
	ds_read_b64_tr_b16 a[146:147], v7 offset:4352
	ds_read_b64_tr_b16 a[148:149], v7 offset:4128
	ds_read_b64_tr_b16 a[150:151], v7 offset:4384
	ds_read_b64_tr_b16 a[152:153], v7 offset:6144
	ds_read_b64_tr_b16 a[154:155], v7 offset:6400
	ds_read_b64_tr_b16 a[156:157], v7 offset:6176
	ds_read_b64_tr_b16 a[158:159], v7 offset:6432
	ds_read_b64_tr_b16 a[160:161], v7 offset:8192
	ds_read_b64_tr_b16 a[162:163], v7 offset:8448
	ds_read_b64_tr_b16 a[164:165], v7 offset:8224
	ds_read_b64_tr_b16 a[166:167], v7 offset:8480
	ds_read_b64_tr_b16 a[168:169], v7 offset:10240
	ds_read_b64_tr_b16 a[170:171], v7 offset:10496
	ds_read_b64_tr_b16 a[172:173], v7 offset:10272
	ds_read_b64_tr_b16 a[174:175], v7 offset:10528
	ds_read_b64_tr_b16 a[176:177], v7 offset:12288
	ds_read_b64_tr_b16 a[178:179], v7 offset:12544
	ds_read_b64_tr_b16 a[180:181], v7 offset:12320
	ds_read_b64_tr_b16 a[182:183], v7 offset:12576
	ds_read_b64_tr_b16 a[184:185], v7 offset:14336
	ds_read_b64_tr_b16 a[186:187], v7 offset:14592
	ds_read_b64_tr_b16 a[188:189], v7 offset:14368
	ds_read_b64_tr_b16 a[190:191], v7 offset:14624
	ds_read_b64_tr_b16 a[192:193], v7 offset:16384
	ds_read_b64_tr_b16 a[194:195], v7 offset:16640
	ds_read_b64_tr_b16 a[196:197], v7 offset:16416
	ds_read_b64_tr_b16 a[198:199], v7 offset:16672
	ds_read_b64_tr_b16 a[200:201], v7 offset:18432
	ds_read_b64_tr_b16 a[202:203], v7 offset:18688
	ds_read_b64_tr_b16 a[204:205], v7 offset:18464
	ds_read_b64_tr_b16 a[206:207], v7 offset:18720
	ds_read_b64_tr_b16 a[208:209], v7 offset:20480
	ds_read_b64_tr_b16 a[210:211], v7 offset:20736
	ds_read_b64_tr_b16 a[212:213], v7 offset:20512
	ds_read_b64_tr_b16 a[214:215], v7 offset:20768
	ds_read_b64_tr_b16 a[216:217], v7 offset:22528
	ds_read_b64_tr_b16 a[218:219], v7 offset:22784
	ds_read_b64_tr_b16 a[220:221], v7 offset:22560
	ds_read_b64_tr_b16 a[222:223], v7 offset:22816
	ds_read_b64_tr_b16 a[224:225], v7 offset:24576
	ds_read_b64_tr_b16 a[226:227], v7 offset:24832
	ds_read_b64_tr_b16 a[228:229], v7 offset:24608
	ds_read_b64_tr_b16 a[230:231], v7 offset:24864
	ds_read_b64_tr_b16 a[232:233], v7 offset:26624
	ds_read_b64_tr_b16 a[234:235], v7 offset:26880
	ds_read_b64_tr_b16 a[236:237], v7 offset:26656
	ds_read_b64_tr_b16 a[238:239], v7 offset:26912
	ds_read_b64_tr_b16 a[240:241], v7 offset:28672
	ds_read_b64_tr_b16 a[242:243], v7 offset:28928
	ds_read_b64_tr_b16 a[244:245], v7 offset:28704
	ds_read_b64_tr_b16 a[246:247], v7 offset:28960
	ds_read_b64_tr_b16 a[248:249], v7 offset:30720
	ds_read_b64_tr_b16 a[250:251], v7 offset:30976
	ds_read_b64_tr_b16 a[252:253], v7 offset:30752
	ds_read_b64_tr_b16 a[254:255], v7 offset:31008
	s_waitcnt lgkmcnt(0)
	s_barrier
	s_mov_b32 s17, s88
	s_mov_b32 s19, -1
	s_mov_b32 s23, 0
	s_mov_b32 s29, 0
	s_mov_b32 s28, 0
	s_cmp_lg_u32 s4, 0
	s_cbranch_scc1 main_kernel_op_arm_go
	v_mov_b32 v14, 4
main_kernel_op_arm_poll:
	buffer_load_dword v13, v14, s[96:99], 0 offen sc1
	s_waitcnt vmcnt(0)
	v_readfirstlane_b32 s95, v13
	s_sub_u32 s94, s94, 1
	s_cbranch_scc1 main_kernel_op_arm_go
	s_cmp_ge_u32 s95, 32
	s_cbranch_scc1 main_kernel_op_arm_go
	s_sleep 32
	s_branch main_kernel_op_arm_poll
main_kernel_op_arm_go:
	s_barrier
main_kernel_op_task:
	s_lshr_b32 s18, s17, 1
	s_lshr_b32 s21, s18, 3
	s_cmp_eq_u32 s21, s19
	s_cbranch_scc1 main_kernel_op_rbok
	s_mov_b32 s19, s21
	s_lshl_b32 s25, s21, 2
	s_add_u32 s25, s25, 80
	s_cmp_lg_u32 s4, 0
	s_cbranch_scc1 main_kernel_op_aqb_go
	v_mov_b32 v14, s25
main_kernel_op_aqb_poll:
	buffer_load_dword v13, v14, s[96:99], 0 offen sc1
	s_waitcnt vmcnt(0)
	v_readfirstlane_b32 s95, v13
	s_nop 0
	s_lshr_b32 s95, s95, 16
	s_sub_u32 s94, s94, 1
	s_cbranch_scc1 main_kernel_op_aqb_got
	s_cmp_ge_u32 s95, 18
	s_cbranch_scc1 main_kernel_op_aqb_got
	s_sleep 32
	s_branch main_kernel_op_aqb_poll
main_kernel_op_aqb_got:
main_kernel_op_aqb_go:
	s_barrier
main_kernel_op_rbok:
	s_lshl_b32 s21, s17, 4
	s_mul_i32 s26, s21, 2304
	s_lshl_b32 s22, s16, 1
	s_add_u32 s26, s26, s22
	s_add_u32 s26, s26, 117440512
	s_mul_i32 s27, s21, 1152
	s_add_u32 s27, s27, s16
	s_and_b32 s25, s18, 0xfc
	s_add_u32 s25, s25, 176
	s_and_b32 s24, s18, 3
	s_lshl_b32 s24, s24, 3
	s_lshl_b32 s20, s18, 18
	s_lshl_b32 s21, s4, 16
	s_add_u32 s20, s20, s21
	s_and_b32 s21, s17, 1
	s_lshl_b32 s21, s21, 8
	s_add_u32 s20, s20, s21
	s_add_u32 s20, s20, 73400320
	s_lshl_b32 s25, s18, 7
	s_add_u32 s25, s25, 111153152
	s_cmp_ge_u32 s28, 32
	s_cbranch_scc1 main_kernel_op_attskip
	s_cmp_lg_u32 s4, 0
	s_cbranch_scc1 main_kernel_op_att_go
	v_mov_b32 v14, 0
main_kernel_op_att_poll:
	buffer_load_dword v13, v14, s[8:11], s25 offen sc1
	s_waitcnt vmcnt(0)
	v_readfirstlane_b32 s95, v13
	s_sub_u32 s94, s94, 1
	s_cbranch_scc1 main_kernel_op_att_go
	s_cmp_ge_u32 s95, 32
	s_cbranch_scc1 main_kernel_op_att_go
	s_sleep 2
	s_branch main_kernel_op_att_poll
main_kernel_op_att_go:
	s_barrier
main_kernel_op_attskip:
	buffer_load_dwordx4 v[64:67], v1, s[8:11], s20 offen offset:0 sc1
	buffer_load_dwordx4 v[68:71], v1, s[8:11], s20 offen offset:2048 sc1
	s_add_u32 s20, s20, 4096
	buffer_load_dwordx4 v[72:75], v1, s[8:11], s20 offen offset:0 sc1
	buffer_load_dwordx4 v[76:79], v1, s[8:11], s20 offen offset:2048 sc1
	s_add_u32 s20, s20, 4096
	buffer_load_dwordx4 v[80:83], v1, s[8:11], s20 offen offset:0 sc1
	buffer_load_dwordx4 v[84:87], v1, s[8:11], s20 offen offset:2048 sc1
	s_add_u32 s20, s20, 4096
	buffer_load_dwordx4 v[88:91], v1, s[8:11], s20 offen offset:0 sc1
	buffer_load_dwordx4 v[92:95], v1, s[8:11], s20 offen offset:2048 sc1
	s_add_u32 s20, s20, 4096
	buffer_load_dwordx4 v[96:99], v1, s[8:11], s20 offen offset:0 sc1
	buffer_load_dwordx4 v[100:103], v1, s[8:11], s20 offen offset:2048 sc1
	s_add_u32 s20, s20, 4096
	buffer_load_dwordx4 v[104:107], v1, s[8:11], s20 offen offset:0 sc1
	buffer_load_dwordx4 v[108:111], v1, s[8:11], s20 offen offset:2048 sc1
	s_add_u32 s20, s20, 4096
	buffer_load_dwordx4 v[112:115], v1, s[8:11], s20 offen offset:0 sc1
	buffer_load_dwordx4 v[116:119], v1, s[8:11], s20 offen offset:2048 sc1
	s_add_u32 s20, s20, 4096
	buffer_load_dwordx4 v[120:123], v1, s[8:11], s20 offen offset:0 sc1
	buffer_load_dwordx4 v[124:127], v1, s[8:11], s20 offen offset:2048 sc1
	s_add_u32 s20, s20, 4096
	buffer_load_dwordx4 v[128:131], v1, s[8:11], s20 offen offset:0 sc1
	buffer_load_dwordx4 v[132:135], v1, s[8:11], s20 offen offset:2048 sc1
	s_add_u32 s20, s20, 4096
	buffer_load_dwordx4 v[136:139], v1, s[8:11], s20 offen offset:0 sc1
	buffer_load_dwordx4 v[140:143], v1, s[8:11], s20 offen offset:2048 sc1
	s_add_u32 s20, s20, 4096
	buffer_load_dwordx4 v[144:147], v1, s[8:11], s20 offen offset:0 sc1
	buffer_load_dwordx4 v[148:151], v1, s[8:11], s20 offen offset:2048 sc1
	s_add_u32 s20, s20, 4096
	buffer_load_dwordx4 v[152:155], v1, s[8:11], s20 offen offset:0 sc1
	buffer_load_dwordx4 v[156:159], v1, s[8:11], s20 offen offset:2048 sc1
	s_add_u32 s20, s20, 4096
	buffer_load_dwordx4 v[160:163], v1, s[8:11], s20 offen offset:0 sc1
	buffer_load_dwordx4 v[164:167], v1, s[8:11], s20 offen offset:2048 sc1
	s_add_u32 s20, s20, 4096
	buffer_load_dwordx4 v[168:171], v1, s[8:11], s20 offen offset:0 sc1
	buffer_load_dwordx4 v[172:175], v1, s[8:11], s20 offen offset:2048 sc1
	s_add_u32 s20, s20, 4096
	buffer_load_dwordx4 v[176:179], v1, s[8:11], s20 offen offset:0 sc1
	buffer_load_dwordx4 v[180:183], v1, s[8:11], s20 offen offset:2048 sc1
	s_add_u32 s20, s20, 4096
	buffer_load_dwordx4 v[184:187], v1, s[8:11], s20 offen offset:0 sc1
	buffer_load_dwordx4 v[188:191], v1, s[8:11], s20 offen offset:2048 sc1
	buffer_load_dwordx4 v[32:35], v2, s[8:11], s26 offen sc1
	s_add_u32 s26, s26, 5242880
	buffer_load_dwordx4 v[52:55], v2, s[8:11], s26 offen sc1
	s_add_u32 s26, s26, 5242880
	buffer_load_dwordx4 v[56:59], v2, s[8:11], s26 offen sc1
	s_add_u32 s25, s17, 7
	s_min_u32 s25, s25, 127
	s_lshr_b32 s25, s25, 1
	s_lshl_b32 s25, s25, 7
	s_add_u32 s25, s25, 111153152
	v_mov_b32 v14, 0
	buffer_load_dword v13, v14, s[8:11], s25 offen sc1
	s_waitcnt vmcnt(35)
	v_mfma_f32_16x16x32_bf16 v[16:19], a[0:3], v[64:67], 0
	v_mfma_f32_16x16x32_bf16 v[20:23], a[4:7], v[64:67], 0
	s_waitcnt vmcnt(34)
	v_mfma_f32_16x16x32_bf16 v[24:27], a[8:11], v[68:71], 0
	v_mfma_f32_16x16x32_bf16 v[28:31], a[12:15], v[68:71], 0
	s_waitcnt vmcnt(33)
	v_mfma_f32_16x16x32_bf16 v[16:19], a[16:19], v[72:75], v[16:19]
	v_mfma_f32_16x16x32_bf16 v[20:23], a[20:23], v[72:75], v[20:23]
	s_waitcnt vmcnt(32)
	v_mfma_f32_16x16x32_bf16 v[24:27], a[24:27], v[76:79], v[24:27]
	v_mfma_f32_16x16x32_bf16 v[28:31], a[28:31], v[76:79], v[28:31]
	s_waitcnt vmcnt(31)
	v_mfma_f32_16x16x32_bf16 v[16:19], a[32:35], v[80:83], v[16:19]
	v_mfma_f32_16x16x32_bf16 v[20:23], a[36:39], v[80:83], v[20:23]
	s_waitcnt vmcnt(30)
	v_mfma_f32_16x16x32_bf16 v[24:27], a[40:43], v[84:87], v[24:27]
	v_mfma_f32_16x16x32_bf16 v[28:31], a[44:47], v[84:87], v[28:31]
	s_waitcnt vmcnt(29)
	v_mfma_f32_16x16x32_bf16 v[16:19], a[48:51], v[88:91], v[16:19]
	v_mfma_f32_16x16x32_bf16 v[20:23], a[52:55], v[88:91], v[20:23]
	s_waitcnt vmcnt(28)
	v_mfma_f32_16x16x32_bf16 v[24:27], a[56:59], v[92:95], v[24:27]
	v_mfma_f32_16x16x32_bf16 v[28:31], a[60:63], v[92:95], v[28:31]
	s_waitcnt vmcnt(27)
	v_mfma_f32_16x16x32_bf16 v[16:19], a[64:67], v[96:99], v[16:19]
	v_mfma_f32_16x16x32_bf16 v[20:23], a[68:71], v[96:99], v[20:23]
	s_waitcnt vmcnt(26)
	v_mfma_f32_16x16x32_bf16 v[24:27], a[72:75], v[100:103], v[24:27]
	v_mfma_f32_16x16x32_bf16 v[28:31], a[76:79], v[100:103], v[28:31]
	s_waitcnt vmcnt(25)
	v_mfma_f32_16x16x32_bf16 v[16:19], a[80:83], v[104:107], v[16:19]
	v_mfma_f32_16x16x32_bf16 v[20:23], a[84:87], v[104:107], v[20:23]
	s_waitcnt vmcnt(24)
	v_mfma_f32_16x16x32_bf16 v[24:27], a[88:91], v[108:111], v[24:27]
	v_mfma_f32_16x16x32_bf16 v[28:31], a[92:95], v[108:111], v[28:31]
	s_waitcnt vmcnt(23)
	v_mfma_f32_16x16x32_bf16 v[16:19], a[96:99], v[112:115], v[16:19]
	v_mfma_f32_16x16x32_bf16 v[20:23], a[100:103], v[112:115], v[20:23]
	s_waitcnt vmcnt(22)
	v_mfma_f32_16x16x32_bf16 v[24:27], a[104:107], v[116:119], v[24:27]
	v_mfma_f32_16x16x32_bf16 v[28:31], a[108:111], v[116:119], v[28:31]
	s_waitcnt vmcnt(21)
	v_mfma_f32_16x16x32_bf16 v[16:19], a[112:115], v[120:123], v[16:19]
	v_mfma_f32_16x16x32_bf16 v[20:23], a[116:119], v[120:123], v[20:23]
	s_waitcnt vmcnt(20)
	v_mfma_f32_16x16x32_bf16 v[24:27], a[120:123], v[124:127], v[24:27]
	v_mfma_f32_16x16x32_bf16 v[28:31], a[124:127], v[124:127], v[28:31]
	s_waitcnt vmcnt(19)
	v_mfma_f32_16x16x32_bf16 v[16:19], a[128:131], v[128:131], v[16:19]
	v_mfma_f32_16x16x32_bf16 v[20:23], a[132:135], v[128:131], v[20:23]
	s_waitcnt vmcnt(18)
	v_mfma_f32_16x16x32_bf16 v[24:27], a[136:139], v[132:135], v[24:27]
	v_mfma_f32_16x16x32_bf16 v[28:31], a[140:143], v[132:135], v[28:31]
	s_waitcnt vmcnt(17)
	v_mfma_f32_16x16x32_bf16 v[16:19], a[144:147], v[136:139], v[16:19]
	v_mfma_f32_16x16x32_bf16 v[20:23], a[148:151], v[136:139], v[20:23]
	s_waitcnt vmcnt(16)
	v_mfma_f32_16x16x32_bf16 v[24:27], a[152:155], v[140:143], v[24:27]
	v_mfma_f32_16x16x32_bf16 v[28:31], a[156:159], v[140:143], v[28:31]
	s_waitcnt vmcnt(15)
	v_mfma_f32_16x16x32_bf16 v[16:19], a[160:163], v[144:147], v[16:19]
	v_mfma_f32_16x16x32_bf16 v[20:23], a[164:167], v[144:147], v[20:23]
	s_waitcnt vmcnt(14)
	v_mfma_f32_16x16x32_bf16 v[24:27], a[168:171], v[148:151], v[24:27]
	v_mfma_f32_16x16x32_bf16 v[28:31], a[172:175], v[148:151], v[28:31]
	s_waitcnt vmcnt(13)
	v_mfma_f32_16x16x32_bf16 v[16:19], a[176:179], v[152:155], v[16:19]
	v_mfma_f32_16x16x32_bf16 v[20:23], a[180:183], v[152:155], v[20:23]
	s_waitcnt vmcnt(12)
	v_mfma_f32_16x16x32_bf16 v[24:27], a[184:187], v[156:159], v[24:27]
	v_mfma_f32_16x16x32_bf16 v[28:31], a[188:191], v[156:159], v[28:31]
	s_waitcnt vmcnt(11)
	v_mfma_f32_16x16x32_bf16 v[16:19], a[192:195], v[160:163], v[16:19]
	v_mfma_f32_16x16x32_bf16 v[20:23], a[196:199], v[160:163], v[20:23]
	s_waitcnt vmcnt(10)
	v_mfma_f32_16x16x32_bf16 v[24:27], a[200:203], v[164:167], v[24:27]
	v_mfma_f32_16x16x32_bf16 v[28:31], a[204:207], v[164:167], v[28:31]
	s_waitcnt vmcnt(9)
	v_mfma_f32_16x16x32_bf16 v[16:19], a[208:211], v[168:171], v[16:19]
	v_mfma_f32_16x16x32_bf16 v[20:23], a[212:215], v[168:171], v[20:23]
	s_waitcnt vmcnt(8)
	v_mfma_f32_16x16x32_bf16 v[24:27], a[216:219], v[172:175], v[24:27]
	v_mfma_f32_16x16x32_bf16 v[28:31], a[220:223], v[172:175], v[28:31]
	s_waitcnt vmcnt(7)
	v_mfma_f32_16x16x32_bf16 v[16:19], a[224:227], v[176:179], v[16:19]
	v_mfma_f32_16x16x32_bf16 v[20:23], a[228:231], v[176:179], v[20:23]
	s_waitcnt vmcnt(6)
	v_mfma_f32_16x16x32_bf16 v[24:27], a[232:235], v[180:183], v[24:27]
	v_mfma_f32_16x16x32_bf16 v[28:31], a[236:239], v[180:183], v[28:31]
	s_waitcnt vmcnt(5)
	v_mfma_f32_16x16x32_bf16 v[16:19], a[240:243], v[184:187], v[16:19]
	v_mfma_f32_16x16x32_bf16 v[20:23], a[244:247], v[184:187], v[20:23]
	s_waitcnt vmcnt(4)
	v_mfma_f32_16x16x32_bf16 v[24:27], a[248:251], v[188:191], v[24:27]
	v_mfma_f32_16x16x32_bf16 v[28:31], a[252:255], v[188:191], v[28:31]
	s_nop 6
	v_add_f32 v16, v16, v24
	v_add_f32 v17, v17, v25
	v_add_f32 v18, v18, v26
	v_add_f32 v19, v19, v27
	v_add_f32 v20, v20, v28
	v_add_f32 v21, v21, v29
	v_add_f32 v22, v22, v30
	v_add_f32 v23, v23, v31
	v_add_u32 v8, s23, v4
	ds_write_b128 v8, v[16:19]
	ds_write_b128 v8, v[20:23] offset:1024
	v_add_u32 v9, s23, v5
	v_mov_b32 v15, s23
	s_cmp_lg_u32 s4, 0
	s_cbranch_scc1 main_kernel_op_nf
	s_waitcnt vmcnt(0)
	ds_write_b32 v15, v13 offset:32768
main_kernel_op_nf:
	s_xor_b32 s23, s23, 8192
	s_waitcnt lgkmcnt(0)
	s_barrier
	s_waitcnt vmcnt(0)
	ds_read_b32 v13, v15 offset:32768
	s_waitcnt lgkmcnt(0)
	v_readfirstlane_b32 s28, v13
	s_cmp_ge_u32 s4, 2
	s_cbranch_scc1 main_kernel_op_next
	ds_read_b128 v[36:39], v9 offset:0
	ds_read_b128 v[40:43], v9 offset:2048
	ds_read_b128 v[44:47], v9 offset:4096
	ds_read_b128 v[48:51], v9 offset:6144
	s_waitcnt lgkmcnt(2)
	v_add_f32 v36, v36, v40
	s_waitcnt lgkmcnt(0)
	v_add_f32 v44, v44, v48
	v_add_f32 v37, v37, v41
	v_add_f32 v45, v45, v49
	v_add_f32 v38, v38, v42
	v_add_f32 v46, v46, v50
	v_add_f32 v39, v39, v43
	v_add_f32 v47, v47, v51
	v_add_f32 v36, v36, v44
	v_add_f32 v37, v37, v45
	v_add_f32 v38, v38, v46
	v_add_f32 v39, v39, v47
	v_add_f32 v52, v52, v56
	v_add_f32 v53, v53, v57
	v_add_f32 v54, v54, v58
	v_add_f32 v55, v55, v59
	v_add_f32 v32, v32, v52
	v_add_f32 v33, v33, v53
	v_add_f32 v34, v34, v54
	v_add_f32 v35, v35, v55
	v_add_f32 v36, v36, v32
	v_add_f32 v37, v37, v33
	v_add_f32 v38, v38, v34
	v_add_f32 v39, v39, v35
	v_cvt_pk_bf16_f32 v36, v36, v37
	v_cvt_pk_bf16_f32 v37, v38, v39
	buffer_store_dwordx2 v[36:37], v3, s[44:47], s27 offen
main_kernel_op_next:
	s_add_u32 s29, s29, 1
	s_add_u32 s17, s17, 7
	s_cmp_lt_u32 s17, 128
	s_cbranch_scc1 main_kernel_op_task
	s_branch main_kernel_wexit
main_kernel_attn:
	s_sub_u32 s25, s89, 18
	s_lshl_b32 s25, s25, 2
	s_add_u32 s25, s25, s4
	s_mov_b32 s24, s88
	s_mov_b32 s26, -1
	v_and_b32 v11, 31, v0
	v_lshrrev_b32 v12, 5, v0
	v_lshlrev_b32 v13, 4, v12
	v_lshl_add_u32 v1, v11, 13, v13
	v_lshl_add_u32 v3, v11, 6, v13
	v_lshl_add_u32 v4, v11, 5, v13
	v_and_b32 v2, 7, v11
	v_lshl_add_u32 v2, v2, 8, v13
	v_lshlrev_b32 v10, 4, v0
	v_lshlrev_b32 v12, 2, v12
	v_sub_u32 v13, v11, v12
	v_cmp_le_i32 s[56:57], 0, v13
	v_cmp_le_i32 s[58:59], 1, v13
	v_cmp_le_i32 s[60:61], 2, v13
	v_cmp_le_i32 s[62:63], 3, v13
	v_cmp_le_i32 s[64:65], 8, v13
	v_cmp_le_i32 s[66:67], 9, v13
	v_cmp_le_i32 s[68:69], 10, v13
	v_cmp_le_i32 s[70:71], 11, v13
	v_cmp_le_i32 s[72:73], 16, v13
	v_cmp_le_i32 s[74:75], 17, v13
	v_cmp_le_i32 s[76:77], 18, v13
	v_cmp_le_i32 s[78:79], 19, v13
	v_cmp_le_i32 s[80:81], 24, v13
	v_cmp_le_i32 s[82:83], 25, v13
	v_cmp_le_i32 s[84:85], 26, v13
	v_cmp_le_i32 s[86:87], 27, v13
	s_mov_b32 s21, 0x3e0293ee
	s_mov_b32 s29, 0
	v_mov_b32 v14, 4
main_kernel_at_arm_poll:
	buffer_load_dword v13, v14, s[96:99], 0 offen sc1
	s_waitcnt vmcnt(0)
	v_readfirstlane_b32 s95, v13
	s_sub_u32 s94, s94, 1
	s_cbranch_scc1 main_kernel_at_arm_go
	s_cmp_ge_u32 s95, 32
	s_cbranch_scc1 main_kernel_at_arm_go
	s_sleep 32
	s_branch main_kernel_at_arm_poll
main_kernel_at_arm_go:
main_kernel_at_task:
	s_lshr_b32 s27, s24, 3
	s_cmp_eq_u32 s27, s26
	s_cbranch_scc1 main_kernel_at_rbok
	s_mov_b32 s26, s27
	s_lshl_b32 s27, s27, 2
	s_add_u32 s27, s27, 80
	v_mov_b32 v14, 0
main_kernel_at_aq_poll:
	buffer_load_dword v13, v14, s[96:99], s27 offen sc1
	s_waitcnt vmcnt(0)
	v_readfirstlane_b32 s95, v13
	s_nop 0
	s_and_b32 s95, s95, 0xffff
	s_sub_u32 s94, s94, 1
	s_cbranch_scc1 main_kernel_at_aq_go
	s_cmp_ge_u32 s95, 16
	s_cbranch_scc1 main_kernel_at_aq_go
	s_sleep 32
	s_branch main_kernel_at_aq_poll
main_kernel_at_aq_go:
	s_sub_u32 s27, s27, 64
	v_mov_b32 v14, 0
main_kernel_at_akv_poll:
	buffer_load_dword v13, v14, s[96:99], s27 offen sc1
	s_waitcnt vmcnt(0)
	v_readfirstlane_b32 s95, v13
	s_sub_u32 s94, s94, 1
	s_cbranch_scc1 main_kernel_at_akv_go
	s_cmp_ge_u32 s95, 128
	s_cbranch_scc1 main_kernel_at_akv_go
	s_sleep 32
	s_branch main_kernel_at_akv_poll
main_kernel_at_akv_go:
main_kernel_at_rbok:
	s_lshl_b32 s27, s25, 7
	s_add_u32 s27, s27, 111149056
	s_add_u32 s28, s24, 1
	s_cmp_ge_u32 s24, 62
	s_cselect_b32 s28, s24, s28
	s_lshl_b32 s16, s24, 18
	s_lshl_b32 s17, s25, 8
	s_add_u32 s16, s16, s17
	s_add_u32 s17, s16, 20971520
	s_add_u32 s16, s16, 4194304
	s_lshl_b32 s18, s25, 13
	s_lshl_b32 s19, s24, 18
	s_add_u32 s18, s18, s19
	s_add_u32 s20, s18, 73400320
	s_add_u32 s18, s18, 37748736
	buffer_load_dwordx4 v[48:51], v1, s[8:11], s17 offen offset:0 sc1
	buffer_load_dwordx4 v[16:19], v1, s[8:11], s16 offen offset:0 sc1
	buffer_load_dwordx4 v[52:55], v1, s[8:11], s17 offen offset:32 sc1
	buffer_load_dwordx4 v[20:23], v1, s[8:11], s16 offen offset:32 sc1
	buffer_load_dwordx4 v[56:59], v1, s[8:11], s17 offen offset:64 sc1
	buffer_load_dwordx4 v[24:27], v1, s[8:11], s16 offen offset:64 sc1
	buffer_load_dwordx4 v[60:63], v1, s[8:11], s17 offen offset:96 sc1
	buffer_load_dwordx4 v[28:31], v1, s[8:11], s16 offen offset:96 sc1
	buffer_load_dwordx4 v[64:67], v1, s[8:11], s17 offen offset:128 sc1
	buffer_load_dwordx4 v[32:35], v1, s[8:11], s16 offen offset:128 sc1
	buffer_load_dwordx4 v[68:71], v1, s[8:11], s17 offen offset:160 sc1
	buffer_load_dwordx4 v[36:39], v1, s[8:11], s16 offen offset:160 sc1
	buffer_load_dwordx4 v[72:75], v1, s[8:11], s17 offen offset:192 sc1
	buffer_load_dwordx4 v[40:43], v1, s[8:11], s16 offen offset:192 sc1
	buffer_load_dwordx4 v[76:79], v1, s[8:11], s17 offen offset:224 sc1
	buffer_load_dwordx4 v[44:47], v1, s[8:11], s16 offen offset:224 sc1
	buffer_load_dwordx4 v[112:115], v3, s[8:11], s18 offen offset:0 sc1
	buffer_load_dwordx4 v[116:119], v3, s[8:11], s18 offen offset:32 sc1
	s_add_u32 s18, s18, 2048
	buffer_load_dwordx4 v[120:123], v3, s[8:11], s18 offen offset:0 sc1
	buffer_load_dwordx4 v[124:127], v3, s[8:11], s18 offen offset:32 sc1
	s_add_u32 s18, s18, 2048
	buffer_load_dwordx4 v[128:131], v3, s[8:11], s18 offen offset:0 sc1
	buffer_load_dwordx4 v[132:135], v3, s[8:11], s18 offen offset:32 sc1
	s_add_u32 s18, s18, 2048
	buffer_load_dwordx4 v[136:139], v3, s[8:11], s18 offen offset:0 sc1
	buffer_load_dwordx4 v[140:143], v3, s[8:11], s18 offen offset:32 sc1
	s_waitcnt vmcnt(22)
	v_mfma_f32_32x32x16_bf16 v[160:175], v[48:51], v[16:19], 0
	s_waitcnt vmcnt(20)
	v_mfma_f32_32x32x16_bf16 v[160:175], v[52:55], v[20:23], v[160:175]
	s_waitcnt vmcnt(18)
	v_mfma_f32_32x32x16_bf16 v[160:175], v[56:59], v[24:27], v[160:175]
	s_waitcnt vmcnt(16)
	v_mfma_f32_32x32x16_bf16 v[160:175], v[60:63], v[28:31], v[160:175]
	s_waitcnt vmcnt(14)
	v_mfma_f32_32x32x16_bf16 v[160:175], v[64:67], v[32:35], v[160:175]
	s_waitcnt vmcnt(12)
	v_mfma_f32_32x32x16_bf16 v[160:175], v[68:71], v[36:39], v[160:175]
	s_waitcnt vmcnt(10)
	v_mfma_f32_32x32x16_bf16 v[160:175], v[72:75], v[40:43], v[160:175]
	s_waitcnt vmcnt(8)
	v_mfma_f32_32x32x16_bf16 v[160:175], v[76:79], v[44:47], v[160:175]
	v_mov_b32 v11, 0xd028965f
	s_nop 10
	v_cndmask_b32 v160, v11, v160, s[56:57]
	v_cndmask_b32 v161, v11, v161, s[58:59]
	v_cndmask_b32 v162, v11, v162, s[60:61]
	v_cndmask_b32 v163, v11, v163, s[62:63]
	v_cndmask_b32 v164, v11, v164, s[64:65]
	v_cndmask_b32 v165, v11, v165, s[66:67]
	v_cndmask_b32 v166, v11, v166, s[68:69]
	v_cndmask_b32 v167, v11, v167, s[70:71]
	v_cndmask_b32 v168, v11, v168, s[72:73]
	v_cndmask_b32 v169, v11, v169, s[74:75]
	v_cndmask_b32 v170, v11, v170, s[76:77]
	v_cndmask_b32 v171, v11, v171, s[78:79]
	v_cndmask_b32 v172, v11, v172, s[80:81]
	v_cndmask_b32 v173, v11, v173, s[82:83]
	v_cndmask_b32 v174, v11, v174, s[84:85]
	v_cndmask_b32 v175, v11, v175, s[86:87]
	v_max3_f32 v5, v160, v161, v162
	v_max3_f32 v5, v5, v163, v164
	v_max3_f32 v5, v5, v165, v166
	v_max3_f32 v5, v5, v167, v168
	v_max3_f32 v5, v5, v169, v170
	v_max3_f32 v5, v5, v171, v172
	v_max3_f32 v5, v5, v173, v174
	v_max_f32 v5, v5, v175
	s_waitcnt vmcnt(0)
	v_mov_b32 v14, 0
main_kernel_at_apr_poll:
	buffer_load_dword v13, v14, s[8:11], s27 offen sc1
	s_waitcnt vmcnt(0)
	v_readfirstlane_b32 s95, v13
	s_sub_u32 s94, s94, 1
	s_cbranch_scc1 main_kernel_at_apr_go
	s_cmp_ge_u32 s95, s28
	s_cbranch_scc1 main_kernel_at_apr_go
	s_sleep 8
	s_branch main_kernel_at_apr_poll
main_kernel_at_apr_go:
	s_lshl_b32 s16, s24, 16
	s_lshl_b32 s17, s25, 11
	s_add_u32 s16, s16, s17
	s_lshl_b32 s17, s16, 1
	s_add_u32 s16, s16, 90177536
	s_add_u32 s17, s17, 94371840
	s_mov_b32 s22, 0
main_kernel_at_ck_loop:
	buffer_load_dwordx4 v[80:83], v2, s[8:11], s16 offen offset:0 sc1
	buffer_load_dwordx4 v[84:87], v2, s[8:11], s16 offen offset:32 sc1
	buffer_load_dwordx4 v[88:91], v2, s[8:11], s16 offen offset:64 sc1
	buffer_load_dwordx4 v[92:95], v2, s[8:11], s16 offen offset:96 sc1
	buffer_load_dwordx4 v[96:99], v2, s[8:11], s16 offen offset:128 sc1
	buffer_load_dwordx4 v[100:103], v2, s[8:11], s16 offen offset:160 sc1
	buffer_load_dwordx4 v[104:107], v2, s[8:11], s16 offen offset:192 sc1
	buffer_load_dwordx4 v[108:111], v2, s[8:11], s16 offen offset:224 sc1
	buffer_load_dwordx4 v[144:147], v4, s[8:11], s17 offen offset:0 sc1
	buffer_load_dwordx4 v[148:151], v4, s[8:11], s17 offen offset:1024 sc1
	buffer_load_dwordx4 v[152:155], v4, s[8:11], s17 offen offset:2048 sc1
	buffer_load_dwordx4 v[156:159], v4, s[8:11], s17 offen offset:3072 sc1
	s_cmp_lt_u32 s24, 62
	s_cbranch_scc1 main_kernel_at_ck_ok
	v_mov_b32 v14, 0
	buffer_load_dword v13, v14, s[8:11], s27 offen sc1
	s_waitcnt vmcnt(12)
	v_max3_u32 v11, v80, v81, v82
	s_waitcnt vmcnt(11)
	v_max3_u32 v12, v83, v84, v85
	v_max3_u32 v11, v11, v86, v87
	s_waitcnt vmcnt(10)
	v_max3_u32 v12, v12, v88, v89
	v_max3_u32 v11, v11, v90, v91
	s_waitcnt vmcnt(9)
	v_max3_u32 v12, v12, v92, v93
	v_max3_u32 v11, v11, v94, v95
	s_waitcnt vmcnt(8)
	v_max3_u32 v12, v12, v96, v97
	v_max3_u32 v11, v11, v98, v99
	s_waitcnt vmcnt(7)
	v_max3_u32 v12, v12, v100, v101
	v_max3_u32 v11, v11, v102, v103
	s_waitcnt vmcnt(6)
	v_max3_u32 v12, v12, v104, v105
	v_max3_u32 v11, v11, v106, v107
	s_waitcnt vmcnt(5)
	v_max3_u32 v12, v12, v108, v109
	v_max3_u32 v11, v11, v110, v111
	s_waitcnt vmcnt(4)
	v_max3_u32 v12, v12, v144, v145
	v_max3_u32 v11, v11, v146, v147
	s_waitcnt vmcnt(3)
	v_max3_u32 v12, v12, v148, v149
	v_max3_u32 v11, v11, v150, v151
	s_waitcnt vmcnt(2)
	v_max3_u32 v12, v12, v152, v153
	v_max3_u32 v11, v11, v154, v155
	s_waitcnt vmcnt(1)
	v_max3_u32 v12, v12, v156, v157
	v_max3_u32 v11, v11, v158, v159
	v_max_u32 v11, v11, v12
	v_cmp_eq_u32 vcc, -1, v11
	s_nop 0
	s_cbranch_vccz main_kernel_at_ck_ok
	s_cmp_lg_u32 s22, 0
	s_cbranch_scc1 main_kernel_at_ck_ok
	s_waitcnt vmcnt(0)
	v_readfirstlane_b32 s95, v13
	s_nop 0
	s_cmp_gt_u32 s95, s24
	s_cselect_b32 s22, 1, 0
	s_sub_u32 s94, s94, 1
	s_cbranch_scc0 main_kernel_at_ck_loop
main_kernel_at_ck_ok:
	s_waitcnt vmcnt(11)
	v_mfma_f32_32x32x16_bf16 v[176:191], v[80:83], v[16:19], 0
	s_waitcnt vmcnt(10)
	v_mfma_f32_32x32x16_bf16 v[176:191], v[84:87], v[20:23], v[176:191]
	s_waitcnt vmcnt(9)
	v_mfma_f32_32x32x16_bf16 v[176:191], v[88:91], v[24:27], v[176:191]
	s_waitcnt vmcnt(8)
	v_mfma_f32_32x32x16_bf16 v[176:191], v[92:95], v[28:31], v[176:191]
	s_waitcnt vmcnt(7)
	v_mfma_f32_32x32x16_bf16 v[176:191], v[96:99], v[32:35], v[176:191]
	s_waitcnt vmcnt(6)
	v_mfma_f32_32x32x16_bf16 v[176:191], v[100:103], v[36:39], v[176:191]
	s_waitcnt vmcnt(5)
	v_mfma_f32_32x32x16_bf16 v[176:191], v[104:107], v[40:43], v[176:191]
	s_waitcnt vmcnt(4)
	v_mfma_f32_32x32x16_bf16 v[176:191], v[108:111], v[44:47], v[176:191]
	s_nop 11
	v_max3_f32 v5, v5, v176, v177
	v_max3_f32 v5, v5, v178, v179
	s_waitcnt vmcnt(0)
	v_mov_b32 v13, v5
	s_nop 1
	v_permlane32_swap_b32 v5, v13
	v_max_f32 v5, v5, v13
	v_mul_f32 v5, s21, v5
	v_fma_f32 v176, v176, s21, -v5
	v_fma_f32 v177, v177, s21, -v5
	v_fma_f32 v178, v178, s21, -v5
	v_fma_f32 v179, v179, s21, -v5
	v_fma_f32 v160, v160, s21, -v5
	v_fma_f32 v161, v161, s21, -v5
	v_fma_f32 v162, v162, s21, -v5
	v_fma_f32 v163, v163, s21, -v5
	v_fma_f32 v164, v164, s21, -v5
	v_fma_f32 v165, v165, s21, -v5
	v_fma_f32 v166, v166, s21, -v5
	v_fma_f32 v167, v167, s21, -v5
	v_fma_f32 v168, v168, s21, -v5
	v_fma_f32 v169, v169, s21, -v5
	v_fma_f32 v170, v170, s21, -v5
	v_fma_f32 v171, v171, s21, -v5
	v_fma_f32 v172, v172, s21, -v5
	v_fma_f32 v173, v173, s21, -v5
	v_fma_f32 v174, v174, s21, -v5
	v_fma_f32 v175, v175, s21, -v5
	v_exp_f32 v176, v176
	v_exp_f32 v177, v177
	v_exp_f32 v178, v178
	v_exp_f32 v179, v179
	v_exp_f32 v160, v160
	v_exp_f32 v161, v161
	v_exp_f32 v162, v162
	v_exp_f32 v163, v163
	v_exp_f32 v164, v164
	v_exp_f32 v165, v165
	v_exp_f32 v166, v166
	v_exp_f32 v167, v167
	v_exp_f32 v168, v168
	v_exp_f32 v169, v169
	v_exp_f32 v170, v170
	v_exp_f32 v171, v171
	v_exp_f32 v172, v172
	v_exp_f32 v173, v173
	v_exp_f32 v174, v174
	v_exp_f32 v175, v175
	v_add_f32 v12, v176, v177
	v_add_f32 v13, v178, v179
	v_add_f32 v12, v12, v160
	v_add_f32 v13, v13, v161
	v_add_f32 v12, v12, v162
	v_add_f32 v13, v13, v163
	v_add_f32 v12, v12, v164
	v_add_f32 v13, v13, v165
	v_add_f32 v12, v12, v166
	v_add_f32 v13, v13, v167
	v_add_f32 v12, v12, v168
	v_add_f32 v13, v13, v169
	v_add_f32 v12, v12, v170
	v_add_f32 v13, v13, v171
	v_add_f32 v12, v12, v172
	v_add_f32 v13, v13, v173
	v_add_f32 v12, v12, v174
	v_add_f32 v13, v13, v175
	v_add_f32 v12, v12, v13
	v_mov_b32 v13, v12
	s_nop 1
	v_permlane32_swap_b32 v12, v13
	v_add_f32 v12, v12, v13
	v_rcp_f32 v12, v12
	v_cvt_pk_bf16_f32 v48, v176, v177
	v_cvt_pk_bf16_f32 v49, v178, v179
	v_mov_b32 v50, v48
	v_mov_b32 v51, v49
	s_nop 0
	v_permlane32_swap_b32 v48, v50
	v_permlane32_swap_b32 v49, v51
	v_cvt_pk_bf16_f32 v52, v160, v161
	v_cvt_pk_bf16_f32 v53, v162, v163
	v_cvt_pk_bf16_f32 v54, v164, v165
	v_cvt_pk_bf16_f32 v55, v166, v167
	s_nop 0
	v_permlane32_swap_b32 v52, v54
	v_permlane32_swap_b32 v53, v55
	v_cvt_pk_bf16_f32 v56, v168, v169
	v_cvt_pk_bf16_f32 v57, v170, v171
	v_cvt_pk_bf16_f32 v58, v172, v173
	v_cvt_pk_bf16_f32 v59, v174, v175
	s_nop 0
	v_permlane32_swap_b32 v56, v58
	v_permlane32_swap_b32 v57, v59
	v_mfma_f32_32x32x16_bf16 v[192:207], v[112:115], v[52:55], 0
	s_nop 0
	v_mfma_f32_32x32x16_bf16 v[192:207], v[116:119], v[56:59], v[192:207]
	v_mfma_f32_32x32x16_bf16 v[192:207], v[144:147], v[48:51], v[192:207]
	v_mfma_f32_32x32x16_bf16 v[208:223], v[120:123], v[52:55], 0
	v_mfma_f32_32x32x16_bf16 v[208:223], v[124:127], v[56:59], v[208:223]
	v_mfma_f32_32x32x16_bf16 v[208:223], v[148:151], v[48:51], v[208:223]
	v_mfma_f32_32x32x16_bf16 v[224:239], v[128:131], v[52:55], 0
	v_mfma_f32_32x32x16_bf16 v[224:239], v[132:135], v[56:59], v[224:239]
	v_mfma_f32_32x32x16_bf16 v[224:239], v[152:155], v[48:51], v[224:239]
	v_mfma_f32_32x32x16_bf16 v[240:255], v[136:139], v[52:55], 0
	v_mfma_f32_32x32x16_bf16 v[240:255], v[140:143], v[56:59], v[240:255]
	v_mfma_f32_32x32x16_bf16 v[240:255], v[156:159], v[48:51], v[240:255]
	s_nop 2
	v_mul_f32 v192, v192, v12
	v_mul_f32 v193, v193, v12
	v_mul_f32 v194, v194, v12
	v_mul_f32 v195, v195, v12
	v_mul_f32 v196, v196, v12
	v_mul_f32 v197, v197, v12
	v_mul_f32 v198, v198, v12
	v_mul_f32 v199, v199, v12
	v_mul_f32 v200, v200, v12
	v_mul_f32 v201, v201, v12
	v_mul_f32 v202, v202, v12
	v_mul_f32 v203, v203, v12
	v_mul_f32 v204, v204, v12
	v_mul_f32 v205, v205, v12
	v_mul_f32 v206, v206, v12
	v_mul_f32 v207, v207, v12
	v_cvt_pk_bf16_f32 v192, v192, v193
	v_cvt_pk_bf16_f32 v193, v194, v195
	v_cvt_pk_bf16_f32 v194, v196, v197
	v_cvt_pk_bf16_f32 v195, v198, v199
	s_nop 0
	v_permlane32_swap_b32 v192, v194
	v_permlane32_swap_b32 v193, v195
	buffer_store_dwordx4 v[192:195], v10, s[8:11], s20 offen offset:0 sc1
	v_cvt_pk_bf16_f32 v200, v200, v201
	v_cvt_pk_bf16_f32 v201, v202, v203
	v_cvt_pk_bf16_f32 v202, v204, v205
	v_cvt_pk_bf16_f32 v203, v206, v207
	s_nop 0
	v_permlane32_swap_b32 v200, v202
	v_permlane32_swap_b32 v201, v203
	buffer_store_dwordx4 v[200:203], v10, s[8:11], s20 offen offset:1024 sc1
	v_mul_f32 v208, v208, v12
	v_mul_f32 v209, v209, v12
	v_mul_f32 v210, v210, v12
	v_mul_f32 v211, v211, v12
	v_mul_f32 v212, v212, v12
	v_mul_f32 v213, v213, v12
	v_mul_f32 v214, v214, v12
	v_mul_f32 v215, v215, v12
	v_mul_f32 v216, v216, v12
	v_mul_f32 v217, v217, v12
	v_mul_f32 v218, v218, v12
	v_mul_f32 v219, v219, v12
	v_mul_f32 v220, v220, v12
	v_mul_f32 v221, v221, v12
	v_mul_f32 v222, v222, v12
	v_mul_f32 v223, v223, v12
	v_cvt_pk_bf16_f32 v208, v208, v209
	v_cvt_pk_bf16_f32 v209, v210, v211
	v_cvt_pk_bf16_f32 v210, v212, v213
	v_cvt_pk_bf16_f32 v211, v214, v215
	s_nop 0
	v_permlane32_swap_b32 v208, v210
	v_permlane32_swap_b32 v209, v211
	buffer_store_dwordx4 v[208:211], v10, s[8:11], s20 offen offset:2048 sc1
	v_cvt_pk_bf16_f32 v216, v216, v217
	v_cvt_pk_bf16_f32 v217, v218, v219
	v_cvt_pk_bf16_f32 v218, v220, v221
	v_cvt_pk_bf16_f32 v219, v222, v223
	s_nop 0
	v_permlane32_swap_b32 v216, v218
	v_permlane32_swap_b32 v217, v219
	buffer_store_dwordx4 v[216:219], v10, s[8:11], s20 offen offset:3072 sc1
	v_mul_f32 v224, v224, v12
	v_mul_f32 v225, v225, v12
	v_mul_f32 v226, v226, v12
	v_mul_f32 v227, v227, v12
	v_mul_f32 v228, v228, v12
	v_mul_f32 v229, v229, v12
	v_mul_f32 v230, v230, v12
	v_mul_f32 v231, v231, v12
	v_mul_f32 v232, v232, v12
	v_mul_f32 v233, v233, v12
	v_mul_f32 v234, v234, v12
	v_mul_f32 v235, v235, v12
	v_mul_f32 v236, v236, v12
	v_mul_f32 v237, v237, v12
	v_mul_f32 v238, v238, v12
	v_mul_f32 v239, v239, v12
	v_cvt_pk_bf16_f32 v224, v224, v225
	v_cvt_pk_bf16_f32 v225, v226, v227
	v_cvt_pk_bf16_f32 v226, v228, v229
	v_cvt_pk_bf16_f32 v227, v230, v231
	s_nop 0
	v_permlane32_swap_b32 v224, v226
	v_permlane32_swap_b32 v225, v227
	s_add_u32 s20, s20, 4096
	buffer_store_dwordx4 v[224:227], v10, s[8:11], s20 offen offset:0 sc1
	v_cvt_pk_bf16_f32 v232, v232, v233
	v_cvt_pk_bf16_f32 v233, v234, v235
	v_cvt_pk_bf16_f32 v234, v236, v237
	v_cvt_pk_bf16_f32 v235, v238, v239
	s_nop 0
	v_permlane32_swap_b32 v232, v234
	v_permlane32_swap_b32 v233, v235
	buffer_store_dwordx4 v[232:235], v10, s[8:11], s20 offen offset:1024 sc1
	v_mul_f32 v240, v240, v12
	v_mul_f32 v241, v241, v12
	v_mul_f32 v242, v242, v12
	v_mul_f32 v243, v243, v12
	v_mul_f32 v244, v244, v12
	v_mul_f32 v245, v245, v12
	v_mul_f32 v246, v246, v12
	v_mul_f32 v247, v247, v12
	v_mul_f32 v248, v248, v12
	v_mul_f32 v249, v249, v12
	v_mul_f32 v250, v250, v12
	v_mul_f32 v251, v251, v12
	v_mul_f32 v252, v252, v12
	v_mul_f32 v253, v253, v12
	v_mul_f32 v254, v254, v12
	v_mul_f32 v255, v255, v12
	v_cvt_pk_bf16_f32 v240, v240, v241
	v_cvt_pk_bf16_f32 v241, v242, v243
	v_cvt_pk_bf16_f32 v242, v244, v245
	v_cvt_pk_bf16_f32 v243, v246, v247
	s_nop 0
	v_permlane32_swap_b32 v240, v242
	v_permlane32_swap_b32 v241, v243
	buffer_store_dwordx4 v[240:243], v10, s[8:11], s20 offen offset:2048 sc1
	v_cvt_pk_bf16_f32 v248, v248, v249
	v_cvt_pk_bf16_f32 v249, v250, v251
	v_cvt_pk_bf16_f32 v250, v252, v253
	v_cvt_pk_bf16_f32 v251, v254, v255
	s_nop 0
	v_permlane32_swap_b32 v248, v250
	v_permlane32_swap_b32 v249, v251
	buffer_store_dwordx4 v[248:251], v10, s[8:11], s20 offen offset:3072 sc1
	s_lshl_b32 s27, s24, 7
	s_add_u32 s27, s27, 111153152
	v_mov_b32 v13, 1
	v_mov_b32 v14, 0
	s_waitcnt vmcnt(0)
	s_mov_b64 exec, 1
	buffer_atomic_add v13, v14, s[8:11], s27 offen sc1
	s_mov_b64 exec, -1
	s_add_u32 s29, s29, 1
	s_add_u32 s24, s24, 7
	s_cmp_lt_u32 s24, 64
	s_cbranch_scc1 main_kernel_at_task
main_kernel_wexit:
	s_endpgm
.section .rodata,"a"
.p2align 6
.amdhsa_kernel main_kernel
  .amdhsa_next_free_vgpr 512
  .amdhsa_next_free_sgpr 102
  .amdhsa_accum_offset 256
  .amdhsa_group_segment_fixed_size 0
  .amdhsa_kernarg_size 120
  .amdhsa_user_sgpr_count 2
  .amdhsa_user_sgpr_kernarg_segment_ptr 1
  .amdhsa_system_sgpr_workgroup_id_x 1
.end_amdhsa_kernel
```
